```python
import torch

def _softmax(x, axis=-1):
    return torch.softmax(x, dim=axis)

def _gelu(x):
    return torch.nn.functional.gelu(x, approximate='tanh')

def _silu(x):
    return torch.nn.functional.silu(x)

def _sigmoid(x):
    return torch.sigmoid(x)

def _layernorm(x, axis=-1, eps=1e-05):
    m = x.mean(dim=axis, keepdim=True)
    v = x.var(dim=axis, keepdim=True, unbiased=False)
    return (x - m) / torch.sqrt(v + eps)

def _scatter_add(tgt, idx, src, axis=0):
    return tgt.clone().index_add_(axis, idx, src)

def _segment_sum(src, seg, n):
    out = torch.zeros((n,) + src.shape[1:], dtype=src.dtype)
    return out.index_add_(0, seg, src)

def _pad(x, pw):
    flat = tuple((v for pair in reversed(pw) for v in pair))
    return torch.nn.functional.pad(x, flat)
kernel_name = 'adaLN_cond__gqa_block_cached__glu_gated_bilinear__prompt'

def setup_inputs():

    _w = lambda a: (lambda t: t.to(torch.bfloat16) if t.is_floating_point() else t)(torch.as_tensor(a))

    def _A_setup():
        B, Sq, D = (1, 2048, 448)
        Hq, Hkv, Sk, Dh = (16, 8, 2048, 256)
        assert Hq % Hkv == 0, (Hq, Hkv)
        return {'x': _w((lambda *s: torch.randn(*s, dtype=torch.bfloat16) * 0.05)(B, Sq, D)), 'k_cache': _w((lambda *s: torch.randn(*s, dtype=torch.bfloat16) * 0.8)(B, Hkv, Sk, Dh)), 'v_cache': _w((lambda *s: torch.randn(*s, dtype=torch.bfloat16) * 3.2)(B, Hkv, Sk, Dh)), 'wq': _w((lambda *s: torch.randn(*s, dtype=torch.bfloat16) * 0.8)(D, Hq * Dh) * D ** (-0.5)), 'wo': _w((lambda *s: torch.randn(*s, dtype=torch.bfloat16) * 3.2)(Hq * Dh, D) * (Hq * Dh) ** (-0.5))}
    _A_in = _A_setup()

    def _B_setup():
        B, S, D, F = (1, 2048, 448, 1792)
        return {'x': _w((lambda *s: torch.randn(*s, dtype=torch.bfloat16) * 0.05)(B, S, D)), 'w_gate': _w((lambda *s: torch.randn(*s, dtype=torch.bfloat16) * 3.2)(D, F) * D ** (-0.5)), 'w_up': _w((lambda *s: torch.randn(*s, dtype=torch.bfloat16) * 3.2)(D, F) * D ** (-0.5)), 'w_down': _w((lambda *s: torch.randn(*s, dtype=torch.bfloat16) * 3.2)(F, D) * F ** (-0.5))}
    _B_in = _B_setup()
    return {'A_x': _A_in['x'], 'A_k_cache': _A_in['k_cache'], 'A_v_cache': _A_in['v_cache'], 'A_wq': _A_in['wq'], 'A_wo': _A_in['wo'], 'B_x': _B_in['x'], 'B_w_gate': _B_in['w_gate'], 'B_w_up': _B_in['w_up'], 'B_w_down': _B_in['w_down'], 'c': _w((lambda *s: torch.randn(*s, dtype=torch.bfloat16) * 0.4)(1, 448) * 8.0), 'w_mod': _w((lambda *s: torch.randn(*s, dtype=torch.bfloat16) * 0.4)(448, 6 * 448) * 448 ** (-0.5) * 8.0)}

def reference(A_x, A_k_cache, A_v_cache, A_wq, A_wo, B_x, B_w_gate, B_w_up, B_w_down, c, w_mod):

    def _A_ref(x, k_cache, v_cache, wq, wo):
        B, Sq, D = x.shape
        Hq, Dh = (16, 256)
        Hkv = k_cache.shape[1]
        rep = Hq // Hkv
        q = (lambda x, *d: x.permute(*d))((x @ wq).reshape(B, Sq, Hq, Dh), 0, 2, 1, 3)
        k = (lambda x, n, axis: torch.repeat_interleave(x, n, dim=axis))(k_cache, rep, axis=1)
        v = (lambda x, n, axis: torch.repeat_interleave(x, n, dim=axis))(v_cache, rep, axis=1)
        scores = torch.einsum('bhqd,bhkd->bhqk', q, k) * Dh ** (-0.5)
        p = _softmax(scores, axis=-1)
        o = torch.einsum('bhqk,bhkd->bhqd', p, v)
        return (lambda x, *d: x.permute(*d))(o, 0, 2, 1, 3).reshape(B, Sq, Hq * Dh) @ wo

    def _B_ref(x, w_gate, w_up, w_down):
        g = torch.einsum('bsd,df->bsf', x, w_gate)
        u = torch.einsum('bsd,df->bsf', x, w_up)
        h = g * u
        return torch.einsum('bsf,fd->bsd', h, w_down)
    x = A_x
    mod = (_silu(c) @ w_mod).reshape(c.shape[0], 6, 1, -1)
    sa, ca, ga, sb, cb, gb = (mod[:, 0].clone(), mod[:, 1].clone(), mod[:, 2].clone(), mod[:, 3].clone(), mod[:, 4].clone(), mod[:, 5].clone())
    h = _layernorm(x, axis=-1) * (1 + ca) + sa
    x = x + ga * _A_ref(h, A_k_cache, A_v_cache, A_wq, A_wo)
    h = _layernorm(x, axis=-1) * (1 + cb) + sb
    x = x + gb * _B_ref(h, B_w_gate, B_w_up, B_w_down)
    return x
```

```asm
; @launch grid=(256,1,1) block=(256,1,1) lds=157376
.amdgcn_target "amdgcn-amd-amdhsa--gfx950"
.text
.globl adaLN_cond__gqa_block_cached__glu_gated_bilinear__prompt_kernel
.p2align 8
.type adaLN_cond__gqa_block_cached__glu_gated_bilinear__prompt_kernel,@function
adaLN_cond__gqa_block_cached__glu_gated_bilinear__prompt_kernel:
    s_cmp_ge_u32 s2, 256
    s_cbranch_scc1 L2_end
    s_load_dwordx2 s[28:29], s[0:1], 80
    s_load_dwordx2 s[64:65], s[0:1], 72
    s_load_dwordx2 s[76:77], s[0:1], 0
    s_load_dwordx2 s[20:21], s[0:1], 104
    s_getpc_b64 s[92:93]
L2_pc0:
    s_lshr_b32 s71, s2, 3
    s_mov_b32 s94, 0x10000
    s_mov_b32 s95, 0x20000
    s_lshl_b32 s43, s71, 15
    v_lshlrev_b32 v16, 7, v0
    v_lshrrev_b32 v20, 6, v0
    buffer_load_dword a248, v16, s[92:95], s43 offen
    s_load_dwordx4 s[24:27], s[0:1], 24
    s_load_dwordx4 s[60:63], s[0:1], 8
    s_load_dwordx4 s[32:35], s[0:1], 48
    s_load_dwordx2 s[68:69], s[0:1], 64
    s_load_dwordx2 s[96:97], s[0:1], 80
    v_lshrrev_b32 v183, 2, v0
    v_and_b32 v29, 3, v0
    v_mul_u32_u24 v184, 5376, v183
    v_lshl_add_u32 v184, v29, 4, v184
    v_lshlrev_b32 v183, 1, v183
    v_readfirstlane_b32 s48, v20
    s_and_b32 s73, s2, 1
    s_sub_u32 s45, s71, 2
    s_mul_i32 s46, s73, 14
    s_add_u32 s46, s46, s45
    s_bfe_u32 s47, s2, 0x20001
    s_mul_i32 s40, s47, 602112
    s_mul_i32 s42, s47, 224
    s_lshl_b32 s43, s46, 6
    s_add_u32 s40, s40, s43
    s_cmp_lt_u32 s45, 14
    s_cselect_b32 s40, s40, 2147483648
    s_add_u32 s49, s40, 344064
    s_cmp_eq_u32 s48, 3
    s_cselect_b32 s49, 2147483648, s49
    s_mov_b32 s22, 268435456
    s_mov_b32 s23, 0x20000
    s_mov_b32 s43, 4247552
    s_mov_b32 s30, 2408448
    s_mov_b32 s31, 0x20000
    s_mov_b32 s66, 896
    s_mov_b32 s67, 0x20000
    s_waitcnt lgkmcnt(0)
    buffer_load_dwordx4 v[192:195], v184, s[28:31], s40 offen
    buffer_load_dword v249, off, s[20:23], s43 sc1
    buffer_load_ushort v200, v183, s[64:67], s42 offen
    buffer_load_ushort v202, v183, s[64:67], s42 offen offset:128
    buffer_load_dwordx4 v[196:199], v184, s[28:31], s49 offen
    v_and_b32 v21, 63, v0
    v_lshlrev_b32 v8, 4, v21
    s_lshr_b32 s75, s71, 2
    s_lshl3_add_u32 s73, s73, s75
    s_lshl2_add_u32 s74, s73, s48
    s_mul_i32 s50, s74, 28672
    s_mul_i32 s41, s48, 4256
    v_lshrrev_b32 v250, 7, v8
    v_lshrrev_b32 v251, 4, v8
    v_mul_u32_u24 v250, 896, v250
    v_and_b32 v251, 0x30, v251
    v_xor_b32 v251, v251, v8
    v_and_b32 v251, 0x70, v251
    v_add_u32 v250, v250, v251
    s_mov_b32 s78, 1835008
    s_mov_b32 s79, 0x20000
    s_bfe_u32 s43, s2, 0x20003
    s_mul_i32 s36, s43, 7168
    s_add_u32 s36, s36, s50
    s_lshl_b32 s44, s43, 10
    s_lshr_b32 s43, s43, 1
    s_lshl_b32 s43, s43, 7
    s_add_u32 s44, s44, s43
    s_add_u32 s28, s44, s41
    s_add_u32 m0, s28, 34048
    s_mov_b32 s3, s76
    s_mov_b32 s52, s77
    buffer_load_dwordx4 v250, s[76:79], s36 offen offset:0 lds
    s_add_u32 m0, s28, 50944
    s_and_b32 s70, s2, 7
    s_and_b32 s44, s71, 3
    s_and_b32 s53, s71, 1
    buffer_load_dwordx4 v250, s[76:79], s36 offen offset:128 lds
    s_add_u32 m0, s28, 67840
    s_lshl2_add_u32 s72, s47, s44
    s_lshl_b32 s42, s72, 9
    buffer_load_dwordx4 v250, s[76:79], s36 offen offset:256 lds
    s_add_u32 m0, s28, 84736
    s_add_u32 s12, s24, s42
    s_addc_u32 s13, s25, 0
    s_sub_u32 s14, 3670016, s42
    s_mov_b32 s15, 0x20000
    buffer_load_dwordx4 v250, s[76:79], s36 offen offset:384 lds
    s_add_u32 m0, s28, 101632
    s_lshl2_add_u32 s57, s75, s48
    s_mul_i32 s42, s57, 65536
    buffer_load_dwordx4 v250, s[76:79], s36 offen offset:512 lds
    s_add_u32 m0, s28, 118528
    v_lshrrev_b32 v255, 2, v21
    v_lshlrev_b32 v255, 13, v255
    buffer_load_dwordx4 v250, s[76:79], s36 offen offset:640 lds
    s_add_u32 m0, s28, 135424
    v_lshl_add_u32 v255, v29, 7, v255
    v_lshlrev_b32 v183, 1, v0
    buffer_load_dwordx4 v250, s[76:79], s36 offen offset:768 lds
    s_bfm_b64 exec, 32, 0
    buffer_load_dword a242, v255, s[12:15], s42 offen
    s_mov_b64 exec, -1
    buffer_load_ushort v216, v183, s[64:67], 0 offen
    buffer_load_ushort v218, v183, s[64:67], 0 offen offset:512
    s_bfe_u32 s43, s2, 0x20003
    s_xor_b32 s43, s43, 1
    s_mul_i32 s37, s43, 7168
    s_add_u32 s37, s37, s50
    s_lshl_b32 s44, s43, 10
    s_lshr_b32 s43, s43, 1
    s_lshl_b32 s43, s43, 7
    s_add_u32 s44, s44, s43
    s_add_u32 s29, s44, s41
    s_bfe_u32 s43, s2, 0x20003
    s_xor_b32 s43, s43, 2
    s_mul_i32 s38, s43, 7168
    s_add_u32 s38, s38, s50
    s_lshl_b32 s44, s43, 10
    s_lshr_b32 s43, s43, 1
    s_lshl_b32 s43, s43, 7
    s_add_u32 s44, s44, s43
    s_add_u32 s30, s44, s41
    s_bfe_u32 s43, s2, 0x20003
    s_xor_b32 s43, s43, 3
    s_mul_i32 s39, s43, 7168
    s_add_u32 s39, s39, s50
    s_lshl_b32 s44, s43, 10
    s_lshr_b32 s43, s43, 1
    s_lshl_b32 s43, s43, 7
    s_add_u32 s44, s44, s43
    s_add_u32 s31, s44, s41
    v_lshlrev_b32 v9, 7, v21
    s_lshl_b32 s56, s48, 2
    s_add_u32 s56, s56, 153216
    s_mul_i32 s59, s47, 3584
    s_lshl_b32 s49, s46, 7
    s_add_u32 s59, s59, s49
    s_add_u32 s59, s59, 4251648
    s_or_b32 s40, s40, s48
    s_and_b32 s40, s40, 2147483651
    s_cselect_b32 s59, 2147483648, s59
    s_min_u32 s43, s71, 27
    s_mul_i32 s99, s70, 28
    s_add_u32 s99, s99, s43
    s_lshl_b32 s47, s99, 4
    s_add_u32 s47, s47, 1792
    s_add_u32 s96, s96, s47
    s_addc_u32 s97, s97, 0
    s_sub_u32 s55, 2408448, s47
    s_lshl2_add_u32 s99, s99, 4243456
    s_and_b32 s47, s2, 1
    s_mul_i32 s47, s47, 28
    s_add_u32 s47, s47, s43
    s_lshr_b32 s98, s47, 2
    s_lshl_b32 s98, s98, 7
    s_bfe_u32 s49, s47, 0x10001
    s_lshl4_add_u32 s98, s49, s98
    s_and_b32 s47, s47, 1
    s_lshl_b32 s47, s47, 6
    s_add_u32 s98, s98, s47
    s_lshr_b32 s49, s70, 1
    s_mul_i32 s47, s49, 1792
    s_add_u32 s98, s98, s47
    s_add_u32 s98, s98, 1839104
    s_cmp_eq_u32 s49, 2
    s_cselect_b32 s46, 1.0, 0
    s_sub_u32 s43, s71, s43
    s_or_b32 s43, s43, s48
    s_cselect_b32 s98, 2147483648, s98
    s_cselect_b32 s99, 2147483648, s99
    s_lshr_b32 s70, s72, 1
    s_lshl2_add_u32 s58, s71, s48
    s_lshl_b32 s58, s58, 13
    s_add_u32 s58, s58, 3670016
    s_and_b32 s49, s71, 3
    s_lshl_b32 s49, s49, 9
    s_sub_u32 s58, s58, s49
    s_mov_b32 s49, 0
    v_bfe_u32 v24, v0, 5, 1
    v_and_b32 v25, 31, v0
    v_lshlrev_b32 v27, 4, v25
    v_lshl_add_u32 v26, v24, 2, v20
    v_lshl_add_u32 v5, v26, 13, v27
    v_and_b32 v22, 15, v0
    v_bfe_u32 v23, v0, 4, 2
    s_mul_i32 s51, s72, 1835008
    s_add_u32 s51, s51, s50
    s_add_u32 s51, s51, 16777216
    s_mul_i32 s40, s48, 4160
    s_lshl_b32 s42, s48, 13
    s_lshl1_add_u32 s54, s75, s53
    s_and_b32 s43, s48, 1
    s_lshl1_add_u32 s54, s54, s43
    s_lshl_b32 s54, s54, 11
    s_cmp_lt_u32 s48, 2
    s_cselect_b32 s43, 16, 0x8080
    s_add_u32 s54, s54, s43
    s_mul_i32 s57, s57, 7168
    v_add_u32 v26, 0x70000000, v9
    v_cmp_gt_u32 vcc, 16, v21
    s_nop 1
    v_cndmask_b32 v9, v26, v9, vcc
    v_lshl_add_u32 v26, v24, 4, v20
    v_lshl_add_u32 v6, v26, 9, v27
    v_accvgpr_write_b32 a252, v6
    v_lshlrev_b32 v7, 6, v23
    v_add_u32 v7, 153280, v7
    v_mov_b32 v13, 0xff800000
    v_accvgpr_write_b32 a250, v13
    v_accvgpr_write_b32 a251, v13
    v_lshrrev_b32 v26, 2, v22
    v_bfe_u32 v14, v22, 1, 2
    v_xor_b32 v14, v14, v23
    v_lshlrev_b32 v14, 4, v14
    v_lshl_add_u32 v14, v22, 7, v14
    s_add_u32 s43, s41, 136192
    v_add_u32 v0, s43, v14
    v_mul_u32_u24 v1, 4256, v26
    v_and_b32 v27, 1, v23
    v_mul_u32_u24 v28, 2176, v27
    v_add_u32 v1, v1, v28
    v_lshrrev_b32 v28, 1, v23
    v_lshl_add_u32 v1, v28, 10, v1
    v_lshl_add_u32 v1, v29, 3, v1
    v_add_u32 v4, 68096, v1
    v_mul_u32_u24 v3, 4160, v29
    v_and_b32 v30, 1, v26
    v_mul_u32_u24 v30, 2064, v30
    v_add_u32 v3, v3, v30
    v_lshrrev_b32 v30, 3, v22
    v_lshl_add_u32 v3, v30, 10, v3
    v_lshl_add_u32 v3, v27, 5, v3
    v_lshl_add_u32 v3, v28, 4, v3
    v_accvgpr_write_b32 a247, v3
    v_lshl_add_u32 v30, v23, 2, v26
    v_lshlrev_b32 v15, 7, v30
    v_bfe_u32 v30, v30, 1, 2
    v_lshl_add_u32 v15, v30, 5, v15
    v_lshl_add_u32 v15, v29, 3, v15
    v_accvgpr_write_b32 a246, v15
    v_lshrrev_b32 v30, 3, v21
    v_and_b32 v26, 7, v21
    v_lshl_add_u32 v30, v20, 6, v30
    v_mul_u32_u24 v30, 896, v30
    v_lshlrev_b32 v31, 1, v23
    v_xor_b32 v31, v31, v26
    v_lshl_add_u32 v14, v31, 4, v30
    v_accvgpr_write_b32 a245, v14
    v_lshlrev_b32 v17, 2, v25
    v_lshlrev_b32 v18, 3, v29
    s_lshl_b32 s70, s70, 20
    s_mul_i32 s72, s72, 229376
    s_add_u32 s4, s60, s70
    s_addc_u32 s5, s61, 0
    s_sub_u32 s4, s4, 16
    s_subb_u32 s5, s5, 0
    s_mov_b32 s6, 0x100010
    s_mov_b32 s7, 0x20000
    s_add_u32 s8, s62, s70
    s_addc_u32 s9, s63, 0
    s_sub_u32 s8, s8, 0x8080
    s_subb_u32 s9, s9, 0
    s_mov_b32 s10, 0x108080
    s_mov_b32 s11, 0x20000
    s_add_u32 s16, s26, s72
    s_addc_u32 s17, s27, 0
    s_mov_b32 s18, 229376
    s_mov_b32 s19, 0x20000
    s_and_b32 s43, s2, 7
    s_lshr_b32 s44, s2, 3
    s_mul_i32 s45, s44, 9363
    s_lshr_b32 s45, s45, 16
    s_mul_i32 s53, s45, 7
    s_sub_u32 s53, s44, s53
    s_lshr_b32 s44, s43, 1
    s_lshl_b32 s44, s44, 2
    s_add_u32 s45, s45, s44
    s_and_b32 s44, s43, 1
    s_mul_i32 s44, s44, 7
    s_add_u32 s53, s53, s44
    s_lshl_b32 s53, s53, 8
    s_sub_u32 s53, 4096, s53
    s_sub_u32 s60, s32, s53
    s_subb_u32 s61, s33, 0
    s_add_u32 s62, s53, 1605632
    s_mov_b32 s63, 0x20000
    s_sub_u32 s64, s34, s53
    s_subb_u32 s65, s35, 0
    s_mov_b32 s66, s62
    s_lshl2_add_u32 s72, s71, s48
    s_mov_b32 s70, 1605632
    s_mov_b32 s71, 0x20000
    s_lshl_b32 s73, s72, 11
    s_add_u32 s73, s73, L2_tail-L2_pc0
    s_mul_i32 s72, s72, 14336
    s_lshr_b32 s47, s72, 1
    s_add_u32 s47, s47, s72
    s_and_b32 s75, s2, 1
    s_lshr_b32 s74, s2, 3
    s_lshl2_add_u32 s74, s75, s74
    s_lshl_b32 s74, s74, 4
    s_sub_u32 s47, s47, s74
    s_max_i32 s47, s47, 0
    s_mul_i32 s75, s75, 1792
    s_add_u32 s72, s72, s75
    s_mov_b32 s74, s98
    s_mov_b32 s75, s99
    s_mov_b32 s98, s55
    s_mov_b32 s99, 0x20000
    s_add_u32 s72, s72, s53
    s_sub_u32 s72, s72, 0
    s_sub_u32 s57, s57, 20480
    s_mov_b32 s94, L2_end-L2_pc0
    s_mov_b32 s24, 16
    s_mov_b32 s32, 128
    s_mov_b32 s25, 3088
    s_mov_b32 s33, 3200
    s_mov_b32 s26, 0
    s_mov_b32 s34, 0
    s_mov_b32 s27, 3072
    s_mov_b32 s35, 3072
    s_mov_b32 s45, 0xff
    s_waitcnt vmcnt(11)
    v_add_u32 v249, 0x9e3779b1, v249
    v_accvgpr_write_b32 a253, v249
    v_lshlrev_b32 v200, 16, v200
    v_lshlrev_b32 v202, 16, v202
    v_mul_f32 v201, 0xbfb8aa3b, v200
    v_mul_f32 v203, 0xbfb8aa3b, v202
    v_exp_f32 v201, v201
    v_exp_f32 v203, v203
    v_add_f32 v201, 1.0, v201
    v_add_f32 v203, 1.0, v203
    v_rcp_f32 v201, v201
    v_rcp_f32 v203, v203
    v_mul_f32 v200, v200, v201
    v_mul_f32 v202, v202, v203
    v_cvt_pk_bf16_f32 v201, 0, v200
    v_cvt_pk_bf16_f32 v203, 0, v202
    v_cvt_pk_bf16_f32 v200, v200, 0
    v_cvt_pk_bf16_f32 v202, v202, 0
    v_dot2_f32_bf16 v208, v192, v200, 0
    v_dot2_f32_bf16 v209, v192, v201, 0
    v_dot2_f32_bf16 v210, v193, v200, 0
    v_dot2_f32_bf16 v211, v193, v201, 0
    v_dot2_f32_bf16 v212, v194, v200, 0
    v_dot2_f32_bf16 v213, v194, v201, 0
    v_dot2_f32_bf16 v214, v195, v200, 0
    v_dot2_f32_bf16 v215, v195, v201, 0
    v_lshrrev_b32 v18, v18, v249
    s_waitcnt vmcnt(10)
    v_dot2_f32_bf16 v208, v196, v202, v208
    v_dot2_f32_bf16 v209, v196, v203, v209
    v_dot2_f32_bf16 v210, v197, v202, v210
    v_dot2_f32_bf16 v211, v197, v203, v211
    v_dot2_f32_bf16 v212, v198, v202, v212
    v_dot2_f32_bf16 v213, v198, v203, v213
    v_dot2_f32_bf16 v214, v199, v202, v214
    v_dot2_f32_bf16 v215, v199, v203, v215
    v_lshrrev_b32 v204, 3, v8
    v_and_b32 v204, 0x60, v204
    v_add_u32 v204, s56, v204
    v_and_b32 v205, 0x1f0, v8
    v_add_u32 v205, 156864, v205
    v_lshl_add_u32 v204, v29, 7, v204
    v_permlane32_swap_b32 v208, v212
    v_permlane32_swap_b32 v209, v213
    v_permlane32_swap_b32 v210, v214
    v_permlane32_swap_b32 v211, v215
    v_add_f32 v208, v208, v212
    v_add_f32 v209, v209, v213
    v_add_f32 v210, v210, v214
    v_add_f32 v211, v211, v215
    s_nop 0
    v_permlane16_swap_b32 v208, v210
    s_nop 0
    v_permlane16_swap_b32 v209, v211
    v_add_f32 v208, v208, v210
    v_add_f32 v209, v209, v211
    s_nop 0
    v_add_f32_dpp v208, v208, v208 row_ror:8 row_mask:0xf bank_mask:0xf
    s_nop 0
    v_add_f32_dpp v209, v209, v209 row_ror:8 row_mask:0xf bank_mask:0xf
    s_nop 0
    v_add_f32_dpp v208, v208, v208 row_ror:4 row_mask:0xf bank_mask:0xf
    s_nop 0
    v_add_f32_dpp v209, v209, v209 row_ror:4 row_mask:0xf bank_mask:0xf
    v_add_u32 v204, 3648, v204
    ds_write2_b32 v204, v208, v209 offset0:0 offset1:4
    s_waitcnt lgkmcnt(0)
    s_barrier
    ds_read_b128 v[212:215], v205
    s_waitcnt lgkmcnt(0)
    v_add_f32 v212, v212, v213
    v_add_f32 v214, v214, v215
    v_add_f32 v208, v212, v214
    v_add_u32 v208, 0x80, v208
    v_bfi_b32 v208, s45, v18, v208
    buffer_store_dword v208, v17, s[20:23], s59 offen sc1
L2_nog:
    s_add_u32 m0, s41, 0
    s_mov_b32 s43, 0
    buffer_load_dwordx4 v5, s[12:15], s43 offen offset:0 lds
    s_mov_b32 s44, 130048
    buffer_load_dwordx4 v5, s[12:15], s44 offen offset:1024 lds
    s_mov_b32 s45, 63360
    buffer_load_dwordx4 v5, s[12:15], s45 offen offset:2176 lds
    s_mov_b32 s43, 193408
    buffer_load_dwordx4 v5, s[12:15], s43 offen offset:3200 lds
    v_subrev_u32 v251, 102144, v0
    v_subrev_u32 v252, 34048, v0
    s_lshl_b32 s53, s48, 10
    v_add_u32 v253, s53, v8
    v_min_u32 v253, 3568, v253
    v_lshlrev_b32 v254, 1, v253
    v_add_u32 v248, 149696, v254
    v_add_u32 v254, 153296, v254
    v_cmp_gt_u32 vcc, 1792, v253
    s_mov_b32 s53, 0
    s_mov_b32 s59, 4251648
    v_cndmask_b32 v254, v248, v254, vcc
    v_cndmask_b32 v248, 1.0, 0, vcc
    s_mov_b32 s55, 4258816
    v_sub_u32 v249, 0, v249
    s_add_u32 m0, s41, 17024
    s_mov_b32 s44, 262144
    buffer_load_dwordx4 v5, s[12:15], s44 offen offset:0 lds
    s_mov_b32 s45, 392192
    buffer_load_dwordx4 v5, s[12:15], s45 offen offset:1024 lds
    s_mov_b32 s43, 325504
    buffer_load_dwordx4 v5, s[12:15], s43 offen offset:2176 lds
    s_mov_b32 s44, 455552
    buffer_load_dwordx4 v5, s[12:15], s44 offen offset:3200 lds
    v_mov_b32 v144, 0x3f803f80
    v_mov_b32 v145, 0x3f803f80
    v_mov_b32 v146, 0x3f803f80
    v_mov_b32 v147, 0x3f803f80
    s_add_u32 m0, s29, 34048
    s_nop 0
    buffer_load_dwordx4 v250, s[76:79], s37 offen offset:0 lds
    s_add_u32 m0, s30, 34048
    s_nop 0
    buffer_load_dwordx4 v250, s[76:79], s38 offen offset:0 lds
    s_add_u32 m0, s31, 34048
    s_nop 0
    buffer_load_dwordx4 v250, s[76:79], s39 offen offset:0 lds
    s_add_u32 m0, s29, 50944
    s_nop 0
    buffer_load_dwordx4 v250, s[76:79], s37 offen offset:128 lds
    s_add_u32 m0, s30, 50944
    s_nop 0
    buffer_load_dwordx4 v250, s[76:79], s38 offen offset:128 lds
    s_add_u32 m0, s31, 50944
    s_nop 0
    buffer_load_dwordx4 v250, s[76:79], s39 offen offset:128 lds
    s_add_u32 m0, s29, 67840
    s_nop 0
    buffer_load_dwordx4 v250, s[76:79], s37 offen offset:256 lds
    s_add_u32 m0, s30, 67840
    s_nop 0
    buffer_load_dwordx4 v250, s[76:79], s38 offen offset:256 lds
    s_add_u32 m0, s31, 67840
    s_nop 0
    buffer_load_dwordx4 v250, s[76:79], s39 offen offset:256 lds
    s_add_u32 m0, s29, 84736
    s_nop 0
    buffer_load_dwordx4 v250, s[76:79], s37 offen offset:384 lds
    s_add_u32 m0, s30, 84736
    s_nop 0
    buffer_load_dwordx4 v250, s[76:79], s38 offen offset:384 lds
    s_add_u32 m0, s31, 84736
    s_nop 0
    buffer_load_dwordx4 v250, s[76:79], s39 offen offset:384 lds
    s_waitcnt vmcnt(9)
    ds_read_b128 v[16:19], v251 offset:0
    ds_read_b128 v[24:27], v251 offset:64
    ds_read_b128 v[20:23], v251 offset:2176
    ds_read_b128 v[28:31], v251 offset:2240
    s_add_u32 m0, s29, 101632
    s_nop 0
    buffer_load_dwordx4 v250, s[76:79], s37 offen offset:512 lds
    buffer_load_dwordx4 v[232:235], v253, s[20:23], s59 offen offset:0 sc1
    buffer_load_dwordx4 v[236:239], v253, s[20:23], s59 offen offset:3584 sc1
    buffer_load_dwordx4 v[240:243], v253, s[20:23], s55 offen offset:0 sc1
    buffer_load_dwordx4 v[244:247], v253, s[20:23], s55 offen offset:3584 sc1
    s_waitcnt lgkmcnt(3)
    v_mfma_f32_16x16x32_bf16 v[152:155], v[16:19], v[16:19], 0
    v_mfma_f32_16x16x32_bf16 v[148:151], v[144:147], v[16:19], 0
    s_waitcnt lgkmcnt(1)
    v_lshlrev_b32 v216, 16, v216
    v_lshlrev_b32 v218, 16, v218
    v_mfma_f32_16x16x32_bf16 v[160:163], v[20:23], v[20:23], 0
    v_mfma_f32_16x16x32_bf16 v[156:159], v[144:147], v[20:23], 0
    s_add_u32 m0, s30, 101632
    s_nop 0
    buffer_load_dwordx4 v250, s[76:79], s38 offen offset:512 lds
    v_mul_f32 v217, 0xbfb8aa3b, v216
    v_mul_f32 v219, 0xbfb8aa3b, v218
    v_mfma_f32_16x16x32_bf16 v[152:155], v[24:27], v[24:27], v[152:155]
    v_mfma_f32_16x16x32_bf16 v[148:151], v[144:147], v[24:27], v[148:151]
    s_waitcnt lgkmcnt(0)
    v_exp_f32 v217, v217
    v_exp_f32 v219, v219
    v_mfma_f32_16x16x32_bf16 v[160:163], v[28:31], v[28:31], v[160:163]
    v_mfma_f32_16x16x32_bf16 v[156:159], v[144:147], v[28:31], v[156:159]
    v_add_f32 v217, 1.0, v217
    v_add_f32 v219, 1.0, v219
    s_add_u32 m0, s31, 101632
    s_nop 0
    buffer_load_dwordx4 v250, s[76:79], s39 offen offset:512 lds
    s_waitcnt vmcnt(13)
    ds_read_b128 v[32:35], v251 offset:17024
    ds_read_b128 v[40:43], v251 offset:17088
    ds_read_b128 v[36:39], v251 offset:19200
    ds_read_b128 v[44:47], v251 offset:19264
    s_add_u32 m0, s29, 118528
    s_nop 0
    buffer_load_dwordx4 v250, s[76:79], s37 offen offset:640 lds
    s_add_u32 m0, s30, 118528
    s_nop 0
    buffer_load_dwordx4 v250, s[76:79], s38 offen offset:640 lds
    s_waitcnt lgkmcnt(3)
    v_mfma_f32_16x16x32_bf16 v[152:155], v[32:35], v[32:35], v[152:155]
    v_mfma_f32_16x16x32_bf16 v[148:151], v[144:147], v[32:35], v[148:151]
    s_waitcnt lgkmcnt(1)
    v_lshlrev_b32 v168, 16, v16
    v_and_b32 v169, 0xffff0000, v16
    v_mfma_f32_16x16x32_bf16 v[160:163], v[36:39], v[36:39], v[160:163]
    v_mfma_f32_16x16x32_bf16 v[156:159], v[144:147], v[36:39], v[156:159]
    s_add_u32 m0, s31, 118528
    s_nop 0
    buffer_load_dwordx4 v250, s[76:79], s39 offen offset:640 lds
    v_lshlrev_b32 v170, 16, v17
    v_and_b32 v171, 0xffff0000, v17
    v_mfma_f32_16x16x32_bf16 v[152:155], v[40:43], v[40:43], v[152:155]
    v_mfma_f32_16x16x32_bf16 v[148:151], v[144:147], v[40:43], v[148:151]
    s_waitcnt lgkmcnt(0)
    v_lshlrev_b32 v172, 16, v18
    v_and_b32 v173, 0xffff0000, v18
    v_mfma_f32_16x16x32_bf16 v[160:163], v[44:47], v[44:47], v[160:163]
    v_mfma_f32_16x16x32_bf16 v[156:159], v[144:147], v[44:47], v[156:159]
    v_lshlrev_b32 v174, 16, v19
    v_and_b32 v175, 0xffff0000, v19
    s_waitcnt vmcnt(13)
    ds_read_b128 v[48:51], v251 offset:34048
    ds_read_b128 v[56:59], v251 offset:34112
    ds_read_b128 v[52:55], v251 offset:36224
    ds_read_b128 v[60:63], v251 offset:36288
    s_add_u32 m0, s29, 135424
    s_nop 0
    buffer_load_dwordx4 v250, s[76:79], s37 offen offset:768 lds
    s_add_u32 m0, s30, 135424
    s_nop 0
    buffer_load_dwordx4 v250, s[76:79], s38 offen offset:768 lds
    s_waitcnt lgkmcnt(3)
    v_mfma_f32_16x16x32_bf16 v[152:155], v[48:51], v[48:51], v[152:155]
    v_mfma_f32_16x16x32_bf16 v[148:151], v[144:147], v[48:51], v[148:151]
    s_waitcnt lgkmcnt(1)
    v_lshlrev_b32 v176, 16, v20
    v_and_b32 v177, 0xffff0000, v20
    v_mfma_f32_16x16x32_bf16 v[160:163], v[52:55], v[52:55], v[160:163]
    v_mfma_f32_16x16x32_bf16 v[156:159], v[144:147], v[52:55], v[156:159]
    s_add_u32 m0, s31, 135424
    s_nop 0
    buffer_load_dwordx4 v250, s[76:79], s39 offen offset:768 lds
    s_cmp_lt_u32 s48, 2
    s_cselect_b32 s76, s4, s8
    s_cselect_b32 s77, s5, s9
    s_cselect_b32 s78, s6, s10
    s_mov_b32 s28, 16400
    s_mov_b32 s36, 16512
    s_mov_b32 s29, 19472
    s_mov_b32 s37, 19584
    s_mov_b32 s30, 16384
    s_mov_b32 s38, 16384
    s_mov_b32 s31, 19456
    s_mov_b32 s39, 19456
    v_lshlrev_b32 v178, 16, v21
    v_and_b32 v179, 0xffff0000, v21
    v_mfma_f32_16x16x32_bf16 v[152:155], v[56:59], v[56:59], v[152:155]
    v_mfma_f32_16x16x32_bf16 v[148:151], v[144:147], v[56:59], v[148:151]
    s_waitcnt lgkmcnt(0)
    v_lshlrev_b32 v180, 16, v22
    v_and_b32 v181, 0xffff0000, v22
    v_mfma_f32_16x16x32_bf16 v[160:163], v[60:63], v[60:63], v[160:163]
    v_mfma_f32_16x16x32_bf16 v[156:159], v[144:147], v[60:63], v[156:159]
    v_lshlrev_b32 v182, 16, v23
    v_and_b32 v183, 0xffff0000, v23
    s_waitcnt vmcnt(13)
    ds_read_b128 v[64:67], v251 offset:51072
    ds_read_b128 v[72:75], v251 offset:51136
    ds_read_b128 v[68:71], v251 offset:53248
    ds_read_b128 v[76:79], v251 offset:53312
    s_add_u32 m0, s41, 34048
    s_mov_b32 s45, 524288
    buffer_load_dwordx4 v5, s[12:15], s45 offen offset:0 lds
    s_mov_b32 s43, 654336
    buffer_load_dwordx4 v5, s[12:15], s43 offen offset:1024 lds
    s_waitcnt lgkmcnt(3)
    v_mfma_f32_16x16x32_bf16 v[152:155], v[64:67], v[64:67], v[152:155]
    v_mfma_f32_16x16x32_bf16 v[148:151], v[144:147], v[64:67], v[148:151]
    s_waitcnt lgkmcnt(1)
    v_lshlrev_b32 v184, 16, v24
    v_and_b32 v185, 0xffff0000, v24
    v_mfma_f32_16x16x32_bf16 v[160:163], v[68:71], v[68:71], v[160:163]
    v_mfma_f32_16x16x32_bf16 v[156:159], v[144:147], v[68:71], v[156:159]
    s_mov_b32 s44, 587648
    buffer_load_dwordx4 v5, s[12:15], s44 offen offset:2176 lds
    v_lshlrev_b32 v186, 16, v25
    v_and_b32 v187, 0xffff0000, v25
    v_mfma_f32_16x16x32_bf16 v[152:155], v[72:75], v[72:75], v[152:155]
    v_mfma_f32_16x16x32_bf16 v[148:151], v[144:147], v[72:75], v[148:151]
    s_waitcnt lgkmcnt(0)
    v_lshlrev_b32 v188, 16, v26
    v_and_b32 v189, 0xffff0000, v26
    v_mfma_f32_16x16x32_bf16 v[160:163], v[76:79], v[76:79], v[160:163]
    v_mfma_f32_16x16x32_bf16 v[156:159], v[144:147], v[76:79], v[156:159]
    v_lshlrev_b32 v190, 16, v27
    v_and_b32 v191, 0xffff0000, v27
    s_waitcnt vmcnt(9)
    ds_read_b128 v[80:83], v252 offset:0
    ds_read_b128 v[88:91], v252 offset:64
    ds_read_b128 v[84:87], v252 offset:2176
    ds_read_b128 v[92:95], v252 offset:2240
    s_mov_b32 s45, 717696
    buffer_load_dwordx4 v5, s[12:15], s45 offen offset:3200 lds
    s_add_u32 m0, s41, 51072
    s_mov_b32 s43, 786432
    buffer_load_dwordx4 v5, s[12:15], s43 offen offset:0 lds
    s_waitcnt lgkmcnt(3)
    v_mfma_f32_16x16x32_bf16 v[152:155], v[80:83], v[80:83], v[152:155]
    v_mfma_f32_16x16x32_bf16 v[148:151], v[144:147], v[80:83], v[148:151]
    s_waitcnt lgkmcnt(1)
    v_lshlrev_b32 v192, 16, v28
    v_and_b32 v193, 0xffff0000, v28
    v_mfma_f32_16x16x32_bf16 v[160:163], v[84:87], v[84:87], v[160:163]
    v_mfma_f32_16x16x32_bf16 v[156:159], v[144:147], v[84:87], v[156:159]
    s_mov_b32 s44, 916480
    buffer_load_dwordx4 v5, s[12:15], s44 offen offset:1024 lds
    v_lshlrev_b32 v194, 16, v29
    v_and_b32 v195, 0xffff0000, v29
    v_mfma_f32_16x16x32_bf16 v[152:155], v[88:91], v[88:91], v[152:155]
    v_mfma_f32_16x16x32_bf16 v[148:151], v[144:147], v[88:91], v[148:151]
    s_waitcnt lgkmcnt(0)
    v_lshlrev_b32 v196, 16, v30
    v_and_b32 v197, 0xffff0000, v30
    v_mfma_f32_16x16x32_bf16 v[160:163], v[92:95], v[92:95], v[160:163]
    v_mfma_f32_16x16x32_bf16 v[156:159], v[144:147], v[92:95], v[156:159]
    v_lshlrev_b32 v198, 16, v31
    v_and_b32 v199, 0xffff0000, v31
    s_waitcnt vmcnt(9)
    ds_read_b128 v[96:99], v252 offset:17024
    ds_read_b128 v[104:107], v252 offset:17088
    ds_read_b128 v[100:103], v252 offset:19200
    ds_read_b128 v[108:111], v252 offset:19264
    s_mov_b32 s45, 849792
    buffer_load_dwordx4 v5, s[12:15], s45 offen offset:2176 lds
    s_mov_b32 s43, 979840
    buffer_load_dwordx4 v5, s[12:15], s43 offen offset:3200 lds
    s_waitcnt lgkmcnt(3)
    v_mfma_f32_16x16x32_bf16 v[152:155], v[96:99], v[96:99], v[152:155]
    v_mfma_f32_16x16x32_bf16 v[148:151], v[144:147], v[96:99], v[148:151]
    s_waitcnt lgkmcnt(1)
    v_rcp_f32 v217, v217
    v_rcp_f32 v219, v219
    v_mfma_f32_16x16x32_bf16 v[160:163], v[100:103], v[100:103], v[160:163]
    v_mfma_f32_16x16x32_bf16 v[156:159], v[144:147], v[100:103], v[156:159]
    s_lshr_b32 s45, s2, 5
    s_lshl2_add_u32 s45, s45, s48
    s_mul_i32 s45, s45, 49152
    s_add_u32 s45, s45, 2097152
    s_bfm_b64 exec, 24, 0
    buffer_load_dword a249, v255, s[12:15], s45 offen
    s_mov_b64 exec, -1
    v_mul_f32 v216, v216, v217
    v_mul_f32 v218, v218, v219
    v_mfma_f32_16x16x32_bf16 v[152:155], v[104:107], v[104:107], v[152:155]
    v_mfma_f32_16x16x32_bf16 v[148:151], v[144:147], v[104:107], v[148:151]
    s_waitcnt lgkmcnt(0)
    v_cvt_pk_bf16_f32 v217, 0, v216
    v_cvt_pk_bf16_f32 v219, 0, v218
    v_mfma_f32_16x16x32_bf16 v[160:163], v[108:111], v[108:111], v[160:163]
    v_mfma_f32_16x16x32_bf16 v[156:159], v[144:147], v[108:111], v[156:159]
    v_accvgpr_write_b32 a230, v217
    v_accvgpr_write_b32 a231, v219
    s_waitcnt vmcnt(9)
    ds_read_b128 v[128:131], v252 offset:34048
    ds_read_b128 v[136:139], v252 offset:34112
    ds_read_b128 v[132:135], v252 offset:36224
    ds_read_b128 v[140:143], v252 offset:36288
    s_waitcnt lgkmcnt(3)
    v_mfma_f32_16x16x32_bf16 v[152:155], v[128:131], v[128:131], v[152:155]
    v_mfma_f32_16x16x32_bf16 v[148:151], v[144:147], v[128:131], v[148:151]
    s_waitcnt lgkmcnt(1)
    v_mfma_f32_16x16x32_bf16 v[160:163], v[132:135], v[132:135], v[160:163]
    v_mfma_f32_16x16x32_bf16 v[156:159], v[144:147], v[132:135], v[156:159]
    v_mfma_f32_16x16x32_bf16 v[152:155], v[136:139], v[136:139], v[152:155]
    v_mfma_f32_16x16x32_bf16 v[148:151], v[144:147], v[136:139], v[148:151]
    s_waitcnt lgkmcnt(0)
    v_mfma_f32_16x16x32_bf16 v[160:163], v[140:143], v[140:143], v[160:163]
    v_mfma_f32_16x16x32_bf16 v[156:159], v[144:147], v[140:143], v[156:159]
    s_mov_b32 s43, 0x0c0c0400
    s_mov_b32 s44, 0x04000c0c
    s_movk_i32 s45, 0xff00
L2_pchk:
    v_perm_b32 v200, v233, v232, s43
    v_perm_b32 v201, v235, v234, s44
    v_perm_b32 v202, v237, v236, s43
    v_perm_b32 v203, v239, v238, s44
    v_perm_b32 v204, v241, v240, s43
    v_perm_b32 v205, v243, v242, s44
    v_perm_b32 v206, v245, v244, s43
    v_perm_b32 v207, v247, v246, s44
    v_add3_u32 v200, v200, v201, v249
    v_add3_u32 v202, v202, v203, v249
    v_add3_u32 v204, v204, v205, v249
    v_add3_u32 v206, v206, v207, v249
    v_or3_b32 v200, v200, v202, v204
    v_or_b32 v200, v200, v206
    v_cmp_ne_u32 vcc, 0, v200
    v_and_b32 v232, s45, v232
    v_and_b32 v233, s45, v233
    v_and_b32 v234, s45, v234
    v_and_b32 v235, s45, v235
    v_and_b32 v236, s45, v236
    v_and_b32 v237, s45, v237
    v_and_b32 v238, s45, v238
    v_and_b32 v239, s45, v239
    v_and_b32 v240, s45, v240
    v_and_b32 v241, s45, v241
    v_and_b32 v242, s45, v242
    v_and_b32 v243, s45, v243
    v_and_b32 v244, s45, v244
    v_and_b32 v245, s45, v245
    v_and_b32 v246, s45, v246
    v_and_b32 v247, s45, v247
    v_add_f32 v208, v232, v240
    v_add_f32 v209, v233, v241
    v_add_f32 v210, v234, v242
    v_add_f32 v211, v235, v243
    v_add_f32 v212, v236, v244
    v_add_f32 v213, v237, v245
    v_add_f32 v214, v238, v246
    v_add_f32 v215, v239, v247
    s_cmp_lg_u64 vcc, 0
    s_cbranch_scc1 L2_pw
L2_pgo:
    v_add_f32 v208, v208, v212
    v_add_f32 v209, v209, v213
    v_add_f32 v210, v210, v214
    v_add_f32 v211, v211, v215
    v_cvt_pk_bf16_f32 v208, 0, v208
    v_cvt_pk_bf16_f32 v209, 0, v209
    v_cvt_pk_bf16_f32 v210, 0, v210
    v_cvt_pk_bf16_f32 v211, 0, v211
    v_add_f32 v208, v208, v248
    v_add_f32 v209, v209, v248
    v_add_f32 v210, v210, v248
    v_add_f32 v211, v211, v248
    v_cvt_pk_bf16_f32 v208, 0, v208
    v_cvt_pk_bf16_f32 v209, 0, v209
    v_cvt_pk_bf16_f32 v210, 0, v210
    v_cvt_pk_bf16_f32 v211, 0, v211
    v_mul_f32 v208, 0x3db8aa3b, v208
    v_mul_f32 v209, 0x3db8aa3b, v209
    v_mul_f32 v210, 0x3db8aa3b, v210
    v_mul_f32 v211, 0x3db8aa3b, v211
    ds_write_b128 v254, v[208:211]
    s_mov_b32 vcc_lo, 0x00100001
    s_mov_b32 vcc_hi, 0x10000100
    v_cndmask_b32 v14, 0, v152, vcc
    v_cndmask_b32 v2, 0, v160, vcc
    s_lshl_b64 vcc, vcc, 1
    v_cndmask_b32 v14, v14, v153, vcc
    v_cndmask_b32 v2, v2, v161, vcc
    s_lshl_b64 vcc, vcc, 1
    v_cndmask_b32 v14, v14, v154, vcc
    v_cndmask_b32 v2, v2, v162, vcc
    s_lshl_b64 vcc, vcc, 1
    v_cndmask_b32 v14, v14, v155, vcc
    v_cndmask_b32 v2, v2, v163, vcc
    v_mov_b32 v149, v14
    v_mov_b32 v157, v2
    v_mul_f32 v148, 0x3b124925, v148
    v_mul_f32 v156, 0x3b124925, v156
    v_permlane32_swap_b32 v14, v149
    v_permlane32_swap_b32 v2, v157
    v_add_f32 v14, v14, v149
    v_add_f32 v2, v2, v157
    v_mov_b32 v149, v14
    v_mov_b32 v157, v2
    s_nop 0
    v_permlane16_swap_b32 v14, v149
    s_nop 0
    v_permlane16_swap_b32 v2, v157
    v_add_f32 v14, v14, v149
    v_add_f32 v2, v2, v157
    v_mul_f32 v14, 0x3b124925, v14
    v_mul_f32 v2, 0x3b124925, v2
    v_fma_f32 v14, -v148, v148, v14
    v_fma_f32 v2, -v156, v156, v2
    v_max_f32 v14, 0, v14
    v_max_f32 v2, 0, v2
    v_add_f32 v14, 0x3727c5ac, v14
    v_add_f32 v2, 0x3727c5ac, v2
    v_rsq_f32 v14, v14
    v_rsq_f32 v2, v2
    v_mul_f32 v15, -v148, v14
    v_mul_f32 v3, -v156, v2
    v_pk_fma_f32 v[168:169], v[168:169], v[14:15], v[14:15] op_sel:[0,0,1] op_sel_hi:[1,0,1]
    v_pk_fma_f32 v[170:171], v[170:171], v[14:15], v[14:15] op_sel:[0,0,1] op_sel_hi:[1,0,1]
    v_pk_fma_f32 v[172:173], v[172:173], v[14:15], v[14:15] op_sel:[0,0,1] op_sel_hi:[1,0,1]
    v_pk_fma_f32 v[174:175], v[174:175], v[14:15], v[14:15] op_sel:[0,0,1] op_sel_hi:[1,0,1]
    v_pk_fma_f32 v[176:177], v[176:177], v[2:3], v[2:3] op_sel:[0,0,1] op_sel_hi:[1,0,1]
    v_pk_fma_f32 v[178:179], v[178:179], v[2:3], v[2:3] op_sel:[0,0,1] op_sel_hi:[1,0,1]
    v_pk_fma_f32 v[180:181], v[180:181], v[2:3], v[2:3] op_sel:[0,0,1] op_sel_hi:[1,0,1]
    v_pk_fma_f32 v[182:183], v[182:183], v[2:3], v[2:3] op_sel:[0,0,1] op_sel_hi:[1,0,1]
    v_pk_fma_f32 v[184:185], v[184:185], v[14:15], v[14:15] op_sel:[0,0,1] op_sel_hi:[1,0,1]
    v_pk_fma_f32 v[186:187], v[186:187], v[14:15], v[14:15] op_sel:[0,0,1] op_sel_hi:[1,0,1]
    v_pk_fma_f32 v[188:189], v[188:189], v[14:15], v[14:15] op_sel:[0,0,1] op_sel_hi:[1,0,1]
    v_pk_fma_f32 v[190:191], v[190:191], v[14:15], v[14:15] op_sel:[0,0,1] op_sel_hi:[1,0,1]
    v_pk_fma_f32 v[192:193], v[192:193], v[2:3], v[2:3] op_sel:[0,0,1] op_sel_hi:[1,0,1]
    v_pk_fma_f32 v[194:195], v[194:195], v[2:3], v[2:3] op_sel:[0,0,1] op_sel_hi:[1,0,1]
    v_pk_fma_f32 v[196:197], v[196:197], v[2:3], v[2:3] op_sel:[0,0,1] op_sel_hi:[1,0,1]
    v_pk_fma_f32 v[198:199], v[198:199], v[2:3], v[2:3] op_sel:[0,0,1] op_sel_hi:[1,0,1]
    s_waitcnt vmcnt(9) lgkmcnt(0)
    s_barrier
    ds_read_b128 v[200:203], v7 offset:0
    ds_read_b128 v[204:207], v7 offset:16
    ds_read_b128 v[208:211], v7 offset:32
    ds_read_b128 v[212:215], v7 offset:48
    ds_read_b128 v[216:219], v7 offset:256
    ds_read_b128 v[220:223], v7 offset:272
    ds_read_b128 v[224:227], v7 offset:288
    ds_read_b128 v[228:231], v7 offset:304
    ds_read_b64_tr_b16 a[0:1], v1 offset:0
    ds_read_b64_tr_b16 a[2:3], v1 offset:512
    ds_read_b64_tr_b16 a[4:5], v1 offset:17024
    ds_read_b64_tr_b16 a[6:7], v1 offset:17536
    ds_read_b64_tr_b16 a[8:9], v1 offset:32
    ds_read_b64_tr_b16 a[10:11], v1 offset:544
    ds_read_b64_tr_b16 a[12:13], v1 offset:17056
    ds_read_b64_tr_b16 a[14:15], v1 offset:17568
    ds_read_b64_tr_b16 a[16:17], v1 offset:64
    ds_read_b64_tr_b16 a[18:19], v1 offset:576
    s_waitcnt lgkmcnt(15)
    v_pk_fma_f32 v[168:169], v[168:169], v[200:201], v[204:205]
    v_pk_fma_f32 v[170:171], v[170:171], v[202:203], v[206:207]
    s_waitcnt lgkmcnt(14)
    v_pk_fma_f32 v[172:173], v[172:173], v[208:209], v[212:213]
    v_pk_fma_f32 v[174:175], v[174:175], v[210:211], v[214:215]
    v_pk_fma_f32 v[176:177], v[176:177], v[200:201], v[204:205]
    v_pk_fma_f32 v[178:179], v[178:179], v[202:203], v[206:207]
    v_pk_fma_f32 v[180:181], v[180:181], v[208:209], v[212:213]
    v_pk_fma_f32 v[182:183], v[182:183], v[210:211], v[214:215]
    s_waitcnt lgkmcnt(12)
    v_pk_fma_f32 v[184:185], v[184:185], v[216:217], v[220:221]
    v_pk_fma_f32 v[186:187], v[186:187], v[218:219], v[222:223]
    s_waitcnt lgkmcnt(10)
    v_pk_fma_f32 v[188:189], v[188:189], v[224:225], v[228:229]
    v_pk_fma_f32 v[190:191], v[190:191], v[226:227], v[230:231]
    v_pk_fma_f32 v[192:193], v[192:193], v[216:217], v[220:221]
    v_pk_fma_f32 v[194:195], v[194:195], v[218:219], v[222:223]
    v_pk_fma_f32 v[196:197], v[196:197], v[224:225], v[228:229]
    v_pk_fma_f32 v[198:199], v[198:199], v[226:227], v[230:231]
    v_cvt_pk_bf16_f32 v16, v168, v169
    v_cvt_pk_bf16_f32 v17, v170, v171
    v_cvt_pk_bf16_f32 v18, v172, v173
    v_cvt_pk_bf16_f32 v19, v174, v175
    v_cvt_pk_bf16_f32 v20, v176, v177
    v_cvt_pk_bf16_f32 v21, v178, v179
    v_cvt_pk_bf16_f32 v22, v180, v181
    v_cvt_pk_bf16_f32 v23, v182, v183
    v_cvt_pk_bf16_f32 v24, v184, v185
    v_cvt_pk_bf16_f32 v25, v186, v187
    v_cvt_pk_bf16_f32 v26, v188, v189
    v_cvt_pk_bf16_f32 v27, v190, v191
    v_cvt_pk_bf16_f32 v28, v192, v193
    v_cvt_pk_bf16_f32 v29, v194, v195
    v_cvt_pk_bf16_f32 v30, v196, v197
    v_cvt_pk_bf16_f32 v31, v198, v199
    s_waitcnt lgkmcnt(8)
    v_mfma_f32_16x16x32_bf16 v[128:131], a[0:3], v[16:19], 0
    s_add_u32 m0, s41, 68096
    ds_read_b64_tr_b16 a[20:21], v1 offset:17088
    ds_read_b64_tr_b16 a[22:23], v1 offset:17600
    ds_read_b64_tr_b16 a[24:25], v1 offset:96
    s_waitcnt lgkmcnt(9)
    v_mfma_f32_16x16x32_bf16 v[128:131], a[4:7], v[24:27], v[128:131]
    s_mov_b32 s44, 1048576
    ds_read_b64_tr_b16 a[26:27], v1 offset:608
    ds_read_b64_tr_b16 a[28:29], v1 offset:17120
    ds_read_b64_tr_b16 a[30:31], v1 offset:17632
    v_mfma_f32_16x16x32_bf16 v[136:139], a[0:3], v[20:23], 0
    s_mov_b32 s45, 1178624
    ds_read_b64_tr_b16 a[32:33], v1 offset:128
    ds_read_b64_tr_b16 a[34:35], v1 offset:640
    ds_read_b64_tr_b16 a[36:37], v1 offset:17152
    v_mfma_f32_16x16x32_bf16 v[136:139], a[4:7], v[28:31], v[136:139]
    s_mov_b32 s43, 1111936
    ds_read_b64_tr_b16 a[38:39], v1 offset:17664
    ds_read_b64_tr_b16 a[40:41], v1 offset:160
    ds_read_b64_tr_b16 a[42:43], v1 offset:672
    s_waitcnt lgkmcnt(15)
    v_mfma_f32_16x16x32_bf16 v[132:135], a[8:11], v[16:19], 0
    s_waitcnt lgkmcnt(14)
    ds_read_b128 v[112:115], v7 offset:512
    ds_read_b64_tr_b16 a[44:45], v1 offset:17184
    ds_read_b64_tr_b16 a[46:47], v1 offset:17696
    v_mfma_f32_16x16x32_bf16 v[132:135], a[12:15], v[24:27], v[132:135]
    ds_read_b128 v[116:119], v7 offset:528
    ds_read_b64_tr_b16 a[48:49], v1 offset:192
    ds_read_b64_tr_b16 a[50:51], v1 offset:704
    v_mfma_f32_16x16x32_bf16 v[140:143], a[8:11], v[20:23], 0
    ds_read_b64_tr_b16 a[52:53], v1 offset:17216
    ds_read_b64_tr_b16 a[54:55], v1 offset:17728
    ds_read_b64_tr_b16 a[56:57], v1 offset:224
    v_mfma_f32_16x16x32_bf16 v[140:143], a[12:15], v[28:31], v[140:143]
    s_waitcnt lgkmcnt(15)
    ds_read_b64_tr_b16 a[58:59], v1 offset:736
    ds_read_b64_tr_b16 a[60:61], v1 offset:17248
    ds_read_b64_tr_b16 a[62:63], v1 offset:17760
    v_mfma_f32_16x16x32_bf16 v[144:147], a[16:19], v[16:19], 0
    ds_read_b64_tr_b16 a[64:65], v1 offset:256
    v_lshlrev_b32 v10, 16, v32
    v_and_b32 v11, 0xffff0000, v32
    v_mfma_f32_16x16x32_bf16 v[144:147], a[20:23], v[24:27], v[144:147]
    ds_read_b64_tr_b16 a[66:67], v1 offset:768
    v_fma_f32 v10, v10, v14, v15
    v_fma_f32 v11, v11, v14, v15
    v_mfma_f32_16x16x32_bf16 v[152:155], a[16:19], v[20:23], 0
    buffer_load_dwordx4 v5, s[12:15], s44 offen offset:0 lds
    ds_read_b64_tr_b16 a[68:69], v1 offset:17280
    v_mfma_f32_16x16x32_bf16 v[152:155], a[20:23], v[28:31], v[152:155]
    s_mov_b32 s44, 1241984
    ds_read_b128 v[120:123], v7 offset:544
    ds_read_b64_tr_b16 a[70:71], v1 offset:17792
    v_lshlrev_b32 v12, 16, v33
    v_mfma_f32_16x16x32_bf16 v[148:151], a[24:27], v[16:19], 0
    ds_read_b128 v[124:127], v7 offset:560
    v_and_b32 v13, 0xffff0000, v33
    v_fma_f32 v12, v12, v14, v15
    v_mfma_f32_16x16x32_bf16 v[148:151], a[28:31], v[24:27], v[148:151]
    ds_read_b64_tr_b16 a[72:73], v1 offset:288
    ds_read_b64_tr_b16 a[74:75], v1 offset:800
    v_fma_f32 v13, v13, v14, v15
    v_mfma_f32_16x16x32_bf16 v[156:159], a[24:27], v[20:23], 0
    s_waitcnt lgkmcnt(15)
    v_fma_f32 v10, v10, v112, v116
    v_fma_f32 v11, v11, v113, v117
    v_cvt_pk_bf16_f32 v32, v10, v11
    v_mfma_f32_16x16x32_bf16 v[156:159], a[28:31], v[28:31], v[156:159]
    buffer_load_dwordx4 v5, s[12:15], s45 offen offset:1024 lds
    v_fma_f32 v12, v12, v114, v118
    v_mfma_f32_16x16x32_bf16 v[160:163], a[32:35], v[16:19], 0
    s_mov_b32 s45, 1310720
    ds_read_b64_tr_b16 a[76:77], v1 offset:17312
    v_fma_f32 v13, v13, v115, v119
    v_cvt_pk_bf16_f32 v33, v12, v13
    v_mfma_f32_16x16x32_bf16 v[160:163], a[36:39], v[24:27], v[160:163]
    ds_read_b64_tr_b16 a[78:79], v1 offset:17824
    v_lshlrev_b32 v10, 16, v36
    v_and_b32 v11, 0xffff0000, v36
    v_mfma_f32_16x16x32_bf16 v[168:171], a[32:35], v[20:23], 0
    buffer_load_dwordx4 v5, s[12:15], s43 offen offset:2176 lds
    v_fma_f32 v10, v10, v2, v3
    v_mfma_f32_16x16x32_bf16 v[168:171], a[36:39], v[28:31], v[168:171]
    s_mov_b32 s43, 1440768
    ds_read_b64_tr_b16 a[80:81], v1 offset:320
    v_fma_f32 v11, v11, v2, v3
    v_fma_f32 v10, v10, v112, v116
    v_mfma_f32_16x16x32_bf16 v[164:167], a[40:43], v[16:19], 0
    s_waitcnt vmcnt(4)
    ds_read_b64_tr_b16 a[82:83], v1 offset:832
    ds_read_b64_tr_b16 a[84:85], v1 offset:17344
    v_fma_f32 v11, v11, v113, v117
    v_mfma_f32_16x16x32_bf16 v[164:167], a[44:47], v[24:27], v[164:167]
    s_barrier
    ds_read_b64_tr_b16 a[86:87], v1 offset:17856
    v_cvt_pk_bf16_f32 v36, v10, v11
    v_lshlrev_b32 v12, 16, v37
    v_mfma_f32_16x16x32_bf16 v[172:175], a[40:43], v[20:23], 0
    s_waitcnt lgkmcnt(8)
    buffer_load_dwordx4 v5, s[12:15], s44 offen offset:3200 lds
    v_and_b32 v13, 0xffff0000, v37
    v_mfma_f32_16x16x32_bf16 v[172:175], a[44:47], v[28:31], v[172:175]
    s_add_u32 m0, s41, 85120
    ds_read_b64_tr_b16 a[88:89], v1 offset:352
    v_fma_f32 v12, v12, v2, v3
    v_fma_f32 v13, v13, v2, v3
    v_mfma_f32_16x16x32_bf16 v[176:179], a[48:51], v[16:19], 0
    s_mov_b32 s44, 1374080
    ds_read_b64_tr_b16 a[90:91], v1 offset:864
    v_fma_f32 v12, v12, v114, v118
    v_fma_f32 v13, v13, v115, v119
    v_mfma_f32_16x16x32_bf16 v[176:179], a[52:55], v[24:27], v[176:179]
    buffer_load_dwordx4 v5, s[12:15], s45 offen offset:0 lds
    v_cvt_pk_bf16_f32 v37, v12, v13
    v_mfma_f32_16x16x32_bf16 v[184:187], a[48:51], v[20:23], 0
    s_mov_b32 s45, 1504128
    ds_read_b64_tr_b16 a[92:93], v1 offset:17376
    ds_read_b64_tr_b16 a[94:95], v1 offset:17888
    v_lshlrev_b32 v10, 16, v34
    v_mfma_f32_16x16x32_bf16 v[184:187], a[52:55], v[28:31], v[184:187]
    ds_read_b64_tr_b16 a[96:97], v1 offset:384
    v_and_b32 v11, 0xffff0000, v34
    v_fma_f32 v10, v10, v14, v15
    v_mfma_f32_16x16x32_bf16 v[180:183], a[56:59], v[16:19], 0
    ds_read_b64_tr_b16 a[98:99], v1 offset:896
    v_fma_f32 v11, v11, v14, v15
    v_fma_f32 v10, v10, v120, v124
    v_mfma_f32_16x16x32_bf16 v[180:183], a[60:63], v[24:27], v[180:183]
    buffer_load_dwordx4 v5, s[12:15], s43 offen offset:1024 lds
    v_fma_f32 v11, v11, v121, v125
    v_mfma_f32_16x16x32_bf16 v[188:191], a[56:59], v[20:23], 0
    s_mov_b32 s43, 1572864
    ds_read_b64_tr_b16 a[100:101], v1 offset:17408
    v_cvt_pk_bf16_f32 v34, v10, v11
    v_lshlrev_b32 v12, 16, v35
    v_mfma_f32_16x16x32_bf16 v[188:191], a[60:63], v[28:31], v[188:191]
    ds_read_b128 v[112:115], v7 offset:768
    ds_read_b64_tr_b16 a[102:103], v1 offset:17920
    v_and_b32 v13, 0xffff0000, v35
    v_mfma_f32_16x16x32_bf16 v[192:195], a[64:67], v[16:19], 0
    ds_read_b128 v[116:119], v7 offset:784
    ds_read_b64_tr_b16 a[104:105], v1 offset:416
    v_fma_f32 v12, v12, v14, v15
    v_mfma_f32_16x16x32_bf16 v[192:195], a[68:71], v[24:27], v[192:195]
    buffer_load_dwordx4 v5, s[12:15], s44 offen offset:2176 lds
    ds_read_b64_tr_b16 a[0:1], v1 offset:34048
    v_mfma_f32_16x16x32_bf16 v[200:203], a[64:67], v[20:23], 0
    s_mov_b32 s44, 1702912
    ds_read_b64_tr_b16 a[106:107], v1 offset:928
    v_fma_f32 v13, v13, v14, v15
    v_fma_f32 v12, v12, v122, v126
    v_mfma_f32_16x16x32_bf16 v[200:203], a[68:71], v[28:31], v[200:203]
    s_waitcnt lgkmcnt(11)
    ds_read_b64_tr_b16 a[2:3], v1 offset:34560
    v_fma_f32 v13, v13, v123, v127
    v_cvt_pk_bf16_f32 v35, v12, v13
    v_mfma_f32_16x16x32_bf16 v[196:199], a[72:75], v[16:19], 0
    ds_read_b64_tr_b16 a[108:109], v1 offset:17440
    ds_read_b64_tr_b16 a[4:5], v1 offset:51072
    v_lshlrev_b32 v10, 16, v38
    v_mfma_f32_16x16x32_bf16 v[196:199], a[76:79], v[24:27], v[196:199]
    buffer_load_dwordx4 v5, s[12:15], s45 offen offset:3200 lds
    v_and_b32 v11, 0xffff0000, v38
    v_mfma_f32_16x16x32_bf16 v[204:207], a[72:75], v[20:23], 0
    s_add_u32 m0, s41, 102144
    ds_read_b64_tr_b16 a[110:111], v1 offset:17952
    ds_read_b64_tr_b16 a[6:7], v1 offset:51584
    v_fma_f32 v10, v10, v2, v3
    v_mfma_f32_16x16x32_bf16 v[204:207], a[76:79], v[28:31], v[204:207]
    s_mov_b32 s45, 1636224
    ds_read_b64_tr_b16 a[112:113], v1 offset:448
    ds_read_b64_tr_b16 a[8:9], v1 offset:34080
    v_fma_f32 v11, v11, v2, v3
    v_mfma_f32_16x16x32_bf16 v[208:211], a[80:83], v[16:19], 0
    ds_read_b64_tr_b16 a[114:115], v1 offset:960
    ds_read_b64_tr_b16 a[10:11], v1 offset:34592
    v_fma_f32 v10, v10, v120, v124
    v_mfma_f32_16x16x32_bf16 v[208:211], a[84:87], v[24:27], v[208:211]
    ds_read_b64_tr_b16 a[116:117], v1 offset:17472
    v_fma_f32 v11, v11, v121, v125
    v_cvt_pk_bf16_f32 v38, v10, v11
    v_mfma_f32_16x16x32_bf16 v[216:219], a[80:83], v[20:23], 0
    buffer_load_dwordx4 v5, s[12:15], s43 offen offset:0 lds
    v_lshlrev_b32 v12, 16, v39
    v_mfma_f32_16x16x32_bf16 v[216:219], a[84:87], v[28:31], v[216:219]
    s_mov_b32 s43, 1766272
    ds_read_b64_tr_b16 a[118:119], v1 offset:17984
    ds_read_b64_tr_b16 a[12:13], v1 offset:51104
    v_and_b32 v13, 0xffff0000, v39
    v_mfma_f32_16x16x32_bf16 v[212:215], a[88:91], v[16:19], 0
    s_waitcnt lgkmcnt(12)
    ds_read_b64_tr_b16 a[120:121], v1 offset:480
    v_fma_f32 v12, v12, v2, v3
    v_fma_f32 v13, v13, v2, v3
    v_mfma_f32_16x16x32_bf16 v[212:215], a[92:95], v[24:27], v[212:215]
    ds_read_b64_tr_b16 a[14:15], v1 offset:51616
    v_fma_f32 v12, v12, v122, v126
    v_fma_f32 v13, v13, v123, v127
    v_mfma_f32_16x16x32_bf16 v[220:223], a[88:91], v[20:23], 0
    buffer_load_dwordx4 v5, s[12:15], s44 offen offset:1024 lds
    ds_read_b64_tr_b16 a[122:123], v1 offset:992
    v_mfma_f32_16x16x32_bf16 v[220:223], a[92:95], v[28:31], v[220:223]
    s_mov_b32 s44, 1835008
    ds_read_b64_tr_b16 a[16:17], v1 offset:34112
    ds_read_b64_tr_b16 a[124:125], v1 offset:17504
    v_cvt_pk_bf16_f32 v39, v12, v13
    v_mfma_f32_16x16x32_bf16 v[224:227], a[96:99], v[16:19], 0
    ds_read_b64_tr_b16 a[18:19], v1 offset:34624
    v_lshlrev_b32 v10, 16, v40
    v_and_b32 v11, 0xffff0000, v40
    v_mfma_f32_16x16x32_bf16 v[224:227], a[100:103], v[24:27], v[224:227]
    ds_read_b64_tr_b16 a[126:127], v1 offset:18016
    ds_read_b64_tr_b16 a[20:21], v1 offset:51136
    v_fma_f32 v10, v10, v14, v15
    v_mfma_f32_16x16x32_bf16 v[232:235], a[96:99], v[20:23], 0
    buffer_load_dwordx4 v5, s[12:15], s45 offen offset:2176 lds
    v_fma_f32 v11, v11, v14, v15
    v_mfma_f32_16x16x32_bf16 v[232:235], a[100:103], v[28:31], v[232:235]
    s_mov_b32 s45, 1965056
    ds_read_b64_tr_b16 a[22:23], v1 offset:51648
    v_fma_f32 v10, v10, v112, v116
    v_fma_f32 v11, v11, v113, v117
    v_mfma_f32_16x16x32_bf16 v[228:231], a[104:107], v[16:19], 0
    s_waitcnt lgkmcnt(11)
    ds_read_b128 v[120:123], v7 offset:800
    v_cvt_pk_bf16_f32 v40, v10, v11
    v_lshlrev_b32 v12, 16, v41
    v_mfma_f32_16x16x32_bf16 v[228:231], a[108:111], v[24:27], v[228:231]
    ds_read_b128 v[124:127], v7 offset:816
    ds_read_b64_tr_b16 a[24:25], v1 offset:34144
    v_and_b32 v13, 0xffff0000, v41
    v_mfma_f32_16x16x32_bf16 v[236:239], a[104:107], v[20:23], 0
    s_waitcnt lgkmcnt(11)
    buffer_load_dwordx4 v5, s[12:15], s43 offen offset:3200 lds
    v_fma_f32 v12, v12, v14, v15
    v_mfma_f32_16x16x32_bf16 v[236:239], a[108:111], v[28:31], v[236:239]
    s_add_u32 m0, s41, 119168
    ds_read_b64_tr_b16 a[26:27], v1 offset:34656
    ds_read_b64_tr_b16 a[28:29], v1 offset:51168
    v_fma_f32 v13, v13, v14, v15
    v_mfma_f32_16x16x32_bf16 v[240:243], a[112:115], v[16:19], 0
    s_mov_b32 s43, 1898368
    ds_read_b64_tr_b16 a[30:31], v1 offset:51680
    v_fma_f32 v12, v12, v114, v118
    v_fma_f32 v13, v13, v115, v119
    v_mfma_f32_16x16x32_bf16 v[240:243], a[116:119], v[24:27], v[240:243]
    v_cvt_pk_bf16_f32 v41, v12, v13
    v_lshlrev_b32 v10, 16, v44
    v_and_b32 v11, 0xffff0000, v44
    v_mfma_f32_16x16x32_bf16 v[248:251], a[112:115], v[20:23], 0
    s_waitcnt lgkmcnt(9)
    buffer_load_dwordx4 v5, s[12:15], s44 offen offset:0 lds
    v_fma_f32 v10, v10, v2, v3
    v_mfma_f32_16x16x32_bf16 v[248:251], a[116:119], v[28:31], v[248:251]
    s_mov_b32 s44, 2028416
    ds_read_b64_tr_b16 a[32:33], v1 offset:34176
    v_fma_f32 v11, v11, v2, v3
    v_fma_f32 v10, v10, v112, v116
    v_mfma_f32_16x16x32_bf16 v[244:247], a[120:123], v[16:19], 0
    s_waitcnt lgkmcnt(8)
    ds_read_b64_tr_b16 a[34:35], v1 offset:34688
    ds_read_b64_tr_b16 a[36:37], v1 offset:51200
    v_fma_f32 v11, v11, v113, v117
    v_mfma_f32_16x16x32_bf16 v[244:247], a[124:127], v[24:27], v[244:247]
    buffer_load_dwordx4 v5, s[12:15], s45 offen offset:1024 lds
    v_cvt_pk_bf16_f32 v44, v10, v11
    v_mfma_f32_16x16x32_bf16 v[252:255], a[120:123], v[20:23], 0
    ds_read_b64_tr_b16 a[38:39], v1 offset:51712
    v_lshlrev_b32 v12, 16, v45
    v_and_b32 v13, 0xffff0000, v45
    v_mfma_f32_16x16x32_bf16 v[252:255], a[124:127], v[28:31], v[252:255]
    s_waitcnt lgkmcnt(7)
    ds_read_b64_tr_b16 a[40:41], v1 offset:34208
    v_fma_f32 v12, v12, v2, v3
    v_fma_f32 v13, v13, v2, v3
    v_fma_f32 v12, v12, v114, v118
    v_fma_f32 v13, v13, v115, v119
    v_cvt_pk_bf16_f32 v45, v12, v13
    v_lshlrev_b32 v10, 16, v42
    v_and_b32 v11, 0xffff0000, v42
    v_fma_f32 v10, v10, v14, v15
    v_fma_f32 v11, v11, v14, v15
    v_fma_f32 v10, v10, v120, v124
    v_fma_f32 v11, v11, v121, v125
    v_cvt_pk_bf16_f32 v42, v10, v11
    v_lshlrev_b32 v12, 16, v43
    v_and_b32 v13, 0xffff0000, v43
    v_fma_f32 v12, v12, v14, v15
    v_fma_f32 v13, v13, v14, v15
    v_fma_f32 v12, v12, v122, v126
    v_fma_f32 v13, v13, v123, v127
    v_cvt_pk_bf16_f32 v43, v12, v13
    v_mfma_f32_16x16x32_bf16 v[128:131], a[0:3], v[32:35], v[128:131]
    buffer_load_dwordx4 v5, s[12:15], s43 offen offset:2176 lds
    ds_read_b64_tr_b16 a[42:43], v1 offset:34720
    v_mfma_f32_16x16x32_bf16 v[128:131], a[4:7], v[40:43], v[128:131]
    ds_read_b64_tr_b16 a[44:45], v1 offset:51232
    buffer_load_dwordx4 v5, s[12:15], s44 offen offset:3200 lds
    v_lshlrev_b32 v10, 16, v46
    v_and_b32 v11, 0xffff0000, v46
    v_fma_f32 v10, v10, v2, v3
    v_fma_f32 v11, v11, v2, v3
    v_fma_f32 v10, v10, v120, v124
    v_fma_f32 v11, v11, v121, v125
    v_cvt_pk_bf16_f32 v46, v10, v11
    v_lshlrev_b32 v12, 16, v47
    v_and_b32 v13, 0xffff0000, v47
    v_fma_f32 v12, v12, v2, v3
    v_fma_f32 v13, v13, v2, v3
    v_fma_f32 v12, v12, v122, v126
    v_fma_f32 v13, v13, v123, v127
    v_cvt_pk_bf16_f32 v47, v12, v13
    v_mfma_f32_16x16x32_bf16 v[136:139], a[0:3], v[36:39], v[136:139]
    ds_read_b64_tr_b16 a[46:47], v1 offset:51744
    ds_read_b64_tr_b16 a[48:49], v1 offset:34240
    ds_read_b64_tr_b16 a[50:51], v1 offset:34752
    v_mfma_f32_16x16x32_bf16 v[136:139], a[4:7], v[44:47], v[136:139]
    ds_read_b128 v[112:115], v7 offset:1024
    buffer_load_dword a240, v9, s[76:79], s54 offen
    v_mfma_f32_16x16x32_bf16 v[132:135], a[8:11], v[32:35], v[132:135]
    s_add_u32 s54, s54, 65536
    ds_read_b128 v[116:119], v7 offset:1040
    ds_read_b64_tr_b16 a[52:53], v1 offset:51264
    ds_read_b64_tr_b16 a[54:55], v1 offset:51776
    v_mfma_f32_16x16x32_bf16 v[132:135], a[12:15], v[40:43], v[132:135]
    ds_read_b64_tr_b16 a[56:57], v1 offset:34272
    ds_read_b64_tr_b16 a[58:59], v1 offset:34784
    ds_read_b64_tr_b16 a[60:61], v1 offset:51296
    v_mfma_f32_16x16x32_bf16 v[140:143], a[8:11], v[36:39], v[140:143]
    ds_read_b64_tr_b16 a[62:63], v1 offset:51808
    ds_read_b64_tr_b16 a[64:65], v1 offset:34304
    ds_read_b64_tr_b16 a[66:67], v1 offset:34816
    v_mfma_f32_16x16x32_bf16 v[140:143], a[12:15], v[44:47], v[140:143]
    ds_read_b64_tr_b16 a[68:69], v1 offset:51328
    ds_read_b64_tr_b16 a[70:71], v1 offset:51840
    v_lshlrev_b32 v10, 16, v48
    v_mfma_f32_16x16x32_bf16 v[144:147], a[16:19], v[32:35], v[144:147]
    ds_read_b64_tr_b16 a[72:73], v1 offset:34336
    v_and_b32 v11, 0xffff0000, v48
    v_fma_f32 v10, v10, v14, v15
    v_mfma_f32_16x16x32_bf16 v[144:147], a[20:23], v[40:43], v[144:147]
    ds_read_b64_tr_b16 a[74:75], v1 offset:34848
    v_fma_f32 v11, v11, v14, v15
    v_lshlrev_b32 v12, 16, v49
    v_mfma_f32_16x16x32_bf16 v[152:155], a[16:19], v[36:39], v[152:155]
    ds_read_b128 v[120:123], v7 offset:1056
    ds_read_b64_tr_b16 a[76:77], v1 offset:51360
    v_and_b32 v13, 0xffff0000, v49
    v_mfma_f32_16x16x32_bf16 v[152:155], a[20:23], v[44:47], v[152:155]
    s_waitcnt lgkmcnt(15)
    ds_read_b128 v[124:127], v7 offset:1072
    ds_read_b64_tr_b16 a[78:79], v1 offset:51872
    v_fma_f32 v12, v12, v14, v15
    v_mfma_f32_16x16x32_bf16 v[148:151], a[24:27], v[32:35], v[148:151]
    ds_read_b64_tr_b16 a[80:81], v1 offset:34368
    ds_read_b64_tr_b16 a[82:83], v1 offset:34880
    v_fma_f32 v13, v13, v14, v15
    v_mfma_f32_16x16x32_bf16 v[148:151], a[28:31], v[40:43], v[148:151]
    s_waitcnt lgkmcnt(15)
    v_fma_f32 v10, v10, v112, v116
    v_fma_f32 v11, v11, v113, v117
    v_cvt_pk_bf16_f32 v48, v10, v11
    v_mfma_f32_16x16x32_bf16 v[156:159], a[24:27], v[36:39], v[156:159]
    v_fma_f32 v12, v12, v114, v118
    v_fma_f32 v13, v13, v115, v119
    v_cvt_pk_bf16_f32 v49, v12, v13
    v_mfma_f32_16x16x32_bf16 v[156:159], a[28:31], v[44:47], v[156:159]
    ds_read_b64_tr_b16 a[84:85], v1 offset:51392
    v_lshlrev_b32 v10, 16, v52
    v_and_b32 v11, 0xffff0000, v52
    v_mfma_f32_16x16x32_bf16 v[160:163], a[32:35], v[32:35], v[160:163]
    v_fma_f32 v10, v10, v2, v3
    v_fma_f32 v11, v11, v2, v3
    v_fma_f32 v10, v10, v112, v116
    v_mfma_f32_16x16x32_bf16 v[160:163], a[36:39], v[40:43], v[160:163]
    ds_read_b64_tr_b16 a[86:87], v1 offset:51904
    ds_read_b64_tr_b16 a[88:89], v1 offset:34400
    v_fma_f32 v11, v11, v113, v117
    v_mfma_f32_16x16x32_bf16 v[168:171], a[32:35], v[36:39], v[168:171]
    ds_read_b64_tr_b16 a[90:91], v1 offset:34912
    v_cvt_pk_bf16_f32 v52, v10, v11
    v_lshlrev_b32 v12, 16, v53
    v_mfma_f32_16x16x32_bf16 v[168:171], a[36:39], v[44:47], v[168:171]
    ds_read_b64_tr_b16 a[92:93], v1 offset:51424
    v_and_b32 v13, 0xffff0000, v53
    v_fma_f32 v12, v12, v2, v3
    v_mfma_f32_16x16x32_bf16 v[164:167], a[40:43], v[32:35], v[164:167]
    ds_read_b64_tr_b16 a[94:95], v1 offset:51936
    v_fma_f32 v13, v13, v2, v3
    v_fma_f32 v12, v12, v114, v118
    v_mfma_f32_16x16x32_bf16 v[164:167], a[44:47], v[40:43], v[164:167]
    v_fma_f32 v13, v13, v115, v119
    v_cvt_pk_bf16_f32 v53, v12, v13
    v_lshlrev_b32 v10, 16, v50
    v_mfma_f32_16x16x32_bf16 v[172:175], a[40:43], v[36:39], v[172:175]
    ds_read_b64_tr_b16 a[96:97], v1 offset:34432
    v_and_b32 v11, 0xffff0000, v50
    v_fma_f32 v10, v10, v14, v15
    v_mfma_f32_16x16x32_bf16 v[172:175], a[44:47], v[44:47], v[172:175]
    s_waitcnt lgkmcnt(7)
    ds_read_b64_tr_b16 a[98:99], v1 offset:34944
    v_fma_f32 v11, v11, v14, v15
    v_fma_f32 v10, v10, v120, v124
    v_mfma_f32_16x16x32_bf16 v[176:179], a[48:51], v[32:35], v[176:179]
    ds_read_b64_tr_b16 a[100:101], v1 offset:51456
    v_fma_f32 v11, v11, v121, v125
    v_cvt_pk_bf16_f32 v50, v10, v11
    v_mfma_f32_16x16x32_bf16 v[176:179], a[52:55], v[40:43], v[176:179]
    ds_read_b64_tr_b16 a[102:103], v1 offset:51968
    v_lshlrev_b32 v12, 16, v51
    v_and_b32 v13, 0xffff0000, v51
    v_mfma_f32_16x16x32_bf16 v[184:187], a[48:51], v[36:39], v[184:187]
    ds_read_b128 v[112:115], v7 offset:1280
    ds_read_b64_tr_b16 a[104:105], v1 offset:34464
    v_fma_f32 v12, v12, v14, v15
    v_mfma_f32_16x16x32_bf16 v[184:187], a[52:55], v[44:47], v[184:187]
    ds_read_b128 v[116:119], v7 offset:1296
    ds_read_b64_tr_b16 a[106:107], v1 offset:34976
    v_fma_f32 v13, v13, v14, v15
    v_mfma_f32_16x16x32_bf16 v[180:183], a[56:59], v[32:35], v[180:183]
    v_fma_f32 v12, v12, v122, v126
    v_fma_f32 v13, v13, v123, v127
    v_cvt_pk_bf16_f32 v51, v12, v13
    v_mfma_f32_16x16x32_bf16 v[180:183], a[60:63], v[40:43], v[180:183]
    ds_read_b64_tr_b16 a[108:109], v1 offset:51488
    v_lshlrev_b32 v10, 16, v54
    v_and_b32 v11, 0xffff0000, v54
    v_mfma_f32_16x16x32_bf16 v[188:191], a[56:59], v[36:39], v[188:191]
    ds_read_b64_tr_b16 a[110:111], v1 offset:52000
    v_fma_f32 v10, v10, v2, v3
    v_fma_f32 v11, v11, v2, v3
    v_mfma_f32_16x16x32_bf16 v[188:191], a[60:63], v[44:47], v[188:191]
    ds_read_b64_tr_b16 a[112:113], v1 offset:34496
    ds_read_b64_tr_b16 a[114:115], v1 offset:35008
    v_fma_f32 v10, v10, v120, v124
    v_mfma_f32_16x16x32_bf16 v[192:195], a[64:67], v[32:35], v[192:195]
    ds_read_b64_tr_b16 a[116:117], v1 offset:51520
    v_fma_f32 v11, v11, v121, v125
    v_cvt_pk_bf16_f32 v54, v10, v11
    v_mfma_f32_16x16x32_bf16 v[192:195], a[68:71], v[40:43], v[192:195]
    ds_read_b64_tr_b16 a[118:119], v1 offset:52032
    ds_read_b64_tr_b16 a[120:121], v1 offset:34528
    ds_read_b64_tr_b16 a[122:123], v1 offset:35040
    ds_read_b64_tr_b16 a[124:125], v1 offset:51552
    ds_read_b64_tr_b16 a[126:127], v1 offset:52064
    v_lshlrev_b32 v12, 16, v55
    v_and_b32 v13, 0xffff0000, v55
    v_fma_f32 v12, v12, v2, v3
    v_mfma_f32_16x16x32_bf16 v[200:203], a[64:67], v[36:39], v[200:203]
    v_fma_f32 v13, v13, v2, v3
    v_fma_f32 v12, v12, v122, v126
    v_fma_f32 v13, v13, v123, v127
    v_mfma_f32_16x16x32_bf16 v[200:203], a[68:71], v[44:47], v[200:203]
    v_cvt_pk_bf16_f32 v55, v12, v13
    v_lshlrev_b32 v10, 16, v56
    v_and_b32 v11, 0xffff0000, v56
    v_mfma_f32_16x16x32_bf16 v[196:199], a[72:75], v[32:35], v[196:199]
    s_waitcnt lgkmcnt(11)
    v_fma_f32 v10, v10, v14, v15
    v_fma_f32 v11, v11, v14, v15
    v_fma_f32 v10, v10, v112, v116
    v_mfma_f32_16x16x32_bf16 v[196:199], a[76:79], v[40:43], v[196:199]
    v_fma_f32 v11, v11, v113, v117
    v_cvt_pk_bf16_f32 v56, v10, v11
    v_lshlrev_b32 v12, 16, v57
    v_mfma_f32_16x16x32_bf16 v[204:207], a[72:75], v[36:39], v[204:207]
    s_add_u32 m0, s41, 0
    ds_read_b128 v[120:123], v7 offset:1312
    v_and_b32 v13, 0xffff0000, v57
    v_fma_f32 v12, v12, v14, v15
    v_mfma_f32_16x16x32_bf16 v[204:207], a[76:79], v[44:47], v[204:207]
    s_mov_b32 s45, 2097152
    ds_read_b128 v[124:127], v7 offset:1328
    v_fma_f32 v13, v13, v14, v15
    v_fma_f32 v12, v12, v114, v118
    v_mfma_f32_16x16x32_bf16 v[208:211], a[80:83], v[32:35], v[208:211]
    s_waitcnt vmcnt(1) lgkmcnt(0)
    v_fma_f32 v13, v13, v115, v119
    v_cvt_pk_bf16_f32 v57, v12, v13
    v_lshlrev_b32 v10, 16, v60
    v_mfma_f32_16x16x32_bf16 v[208:211], a[84:87], v[40:43], v[208:211]
    s_barrier
    v_and_b32 v11, 0xffff0000, v60
    v_fma_f32 v10, v10, v2, v3
    v_fma_f32 v11, v11, v2, v3
    v_mfma_f32_16x16x32_bf16 v[216:219], a[80:83], v[36:39], v[216:219]
    s_mov_b32 s43, 2227200
    v_fma_f32 v10, v10, v112, v116
    v_fma_f32 v11, v11, v113, v117
    v_cvt_pk_bf16_f32 v60, v10, v11
    v_mfma_f32_16x16x32_bf16 v[216:219], a[84:87], v[44:47], v[216:219]
    s_mov_b32 s44, 2160512
    ds_read_b64_tr_b16 a[0:1], v4 offset:0
    ds_read_b64_tr_b16 a[2:3], v4 offset:512
    v_lshlrev_b32 v12, 16, v61
    v_mfma_f32_16x16x32_bf16 v[212:215], a[88:91], v[32:35], v[212:215]
    ds_read_b64_tr_b16 a[4:5], v4 offset:17024
    v_and_b32 v13, 0xffff0000, v61
    v_fma_f32 v12, v12, v2, v3
    v_mfma_f32_16x16x32_bf16 v[212:215], a[92:95], v[40:43], v[212:215]
    buffer_load_dwordx4 v5, s[12:15], s45 offen offset:0 lds
    v_fma_f32 v13, v13, v2, v3
    v_mfma_f32_16x16x32_bf16 v[220:223], a[88:91], v[36:39], v[220:223]
    s_mov_b32 s45, 2290560
    ds_read_b64_tr_b16 a[6:7], v4 offset:17536
    v_fma_f32 v12, v12, v114, v118
    v_fma_f32 v13, v13, v115, v119
    v_mfma_f32_16x16x32_bf16 v[220:223], a[92:95], v[44:47], v[220:223]
    ds_read_b64_tr_b16 a[8:9], v4 offset:32
    v_cvt_pk_bf16_f32 v61, v12, v13
    v_lshlrev_b32 v10, 16, v58
    v_mfma_f32_16x16x32_bf16 v[224:227], a[96:99], v[32:35], v[224:227]
    buffer_load_dwordx4 v5, s[12:15], s43 offen offset:1024 lds
    ds_read_b64_tr_b16 a[10:11], v4 offset:544
    v_mfma_f32_16x16x32_bf16 v[224:227], a[100:103], v[40:43], v[224:227]
    s_mov_b32 s43, 2359296
    ds_read_b64_tr_b16 a[12:13], v4 offset:17056
    v_and_b32 v11, 0xffff0000, v58
    v_fma_f32 v10, v10, v14, v15
    v_mfma_f32_16x16x32_bf16 v[232:235], a[96:99], v[36:39], v[232:235]
    ds_read_b64_tr_b16 a[14:15], v4 offset:17568
    v_fma_f32 v11, v11, v14, v15
    v_fma_f32 v10, v10, v120, v124
    v_mfma_f32_16x16x32_bf16 v[232:235], a[100:103], v[44:47], v[232:235]
    ds_read_b64_tr_b16 a[16:17], v4 offset:64
    v_fma_f32 v11, v11, v121, v125
    v_cvt_pk_bf16_f32 v58, v10, v11
    v_mfma_f32_16x16x32_bf16 v[228:231], a[104:107], v[32:35], v[228:231]
    buffer_load_dwordx4 v5, s[12:15], s44 offen offset:2176 lds
    v_lshlrev_b32 v12, 16, v59
    v_mfma_f32_16x16x32_bf16 v[228:231], a[108:111], v[40:43], v[228:231]
    s_mov_b32 s44, 2489344
    ds_read_b128 v[112:115], v7 offset:1536
    ds_read_b64_tr_b16 a[18:19], v4 offset:576
    v_and_b32 v13, 0xffff0000, v59
    v_mfma_f32_16x16x32_bf16 v[236:239], a[104:107], v[36:39], v[236:239]
    ds_read_b128 v[116:119], v7 offset:1552
    ds_read_b64_tr_b16 a[20:21], v4 offset:17088
    v_fma_f32 v12, v12, v14, v15
    v_mfma_f32_16x16x32_bf16 v[236:239], a[108:111], v[44:47], v[236:239]
    ds_read_b64_tr_b16 a[22:23], v4 offset:17600
    v_fma_f32 v13, v13, v14, v15
    v_fma_f32 v12, v12, v122, v126
    v_mfma_f32_16x16x32_bf16 v[240:243], a[112:115], v[32:35], v[240:243]
    buffer_load_dwordx4 v5, s[12:15], s45 offen offset:3200 lds
    v_fma_f32 v13, v13, v123, v127
    v_mfma_f32_16x16x32_bf16 v[240:243], a[116:119], v[40:43], v[240:243]
    s_add_u32 m0, s41, 17024
    ds_read_b64_tr_b16 a[24:25], v4 offset:96
    v_cvt_pk_bf16_f32 v59, v12, v13
    v_lshlrev_b32 v10, 16, v62
    v_mfma_f32_16x16x32_bf16 v[248:251], a[112:115], v[36:39], v[248:251]
    s_mov_b32 s45, 2422656
    ds_read_b64_tr_b16 a[26:27], v4 offset:608
    v_and_b32 v11, 0xffff0000, v62
    v_fma_f32 v10, v10, v2, v3
    v_mfma_f32_16x16x32_bf16 v[248:251], a[116:119], v[44:47], v[248:251]
    buffer_load_dwordx4 v5, s[12:15], s43 offen offset:0 lds
    v_fma_f32 v11, v11, v2, v3
    v_mfma_f32_16x16x32_bf16 v[244:247], a[120:123], v[32:35], v[244:247]
    s_mov_b32 s43, 2552704
    ds_read_b64_tr_b16 a[28:29], v4 offset:17120
    ds_read_b64_tr_b16 a[30:31], v4 offset:17632
    v_fma_f32 v10, v10, v120, v124
    v_mfma_f32_16x16x32_bf16 v[244:247], a[124:127], v[40:43], v[244:247]
    ds_read_b64_tr_b16 a[32:33], v4 offset:128
    v_fma_f32 v11, v11, v121, v125
    v_cvt_pk_bf16_f32 v62, v10, v11
    v_mfma_f32_16x16x32_bf16 v[252:255], a[120:123], v[36:39], v[252:255]
    ds_read_b64_tr_b16 a[34:35], v4 offset:640
    v_lshlrev_b32 v12, 16, v63
    v_and_b32 v13, 0xffff0000, v63
    v_mfma_f32_16x16x32_bf16 v[252:255], a[124:127], v[44:47], v[252:255]
    s_waitcnt lgkmcnt(9)
    buffer_load_dwordx4 v5, s[12:15], s44 offen offset:1024 lds
    ds_read_b64_tr_b16 a[36:37], v4 offset:17152
    v_mfma_f32_16x16x32_bf16 v[128:131], a[0:3], v[48:51], v[128:131]
    s_mov_b32 s44, 2621440
    ds_read_b64_tr_b16 a[38:39], v4 offset:17664
    v_fma_f32 v12, v12, v2, v3
    v_fma_f32 v13, v13, v2, v3
    v_mfma_f32_16x16x32_bf16 v[128:131], a[4:7], v[56:59], v[128:131]
    ds_read_b64_tr_b16 a[40:41], v4 offset:160
    v_fma_f32 v12, v12, v122, v126
    v_fma_f32 v13, v13, v123, v127
    v_cvt_pk_bf16_f32 v63, v12, v13
    v_mfma_f32_16x16x32_bf16 v[136:139], a[0:3], v[52:55], v[136:139]
    buffer_load_dwordx4 v5, s[12:15], s45 offen offset:2176 lds
    ds_read_b64_tr_b16 a[42:43], v4 offset:672
    v_mfma_f32_16x16x32_bf16 v[136:139], a[4:7], v[60:63], v[136:139]
    s_mov_b32 s45, 2751488
    ds_read_b64_tr_b16 a[44:45], v4 offset:17184
    v_lshlrev_b32 v10, 16, v64
    v_and_b32 v11, 0xffff0000, v64
    v_mfma_f32_16x16x32_bf16 v[132:135], a[8:11], v[48:51], v[132:135]
    ds_read_b64_tr_b16 a[46:47], v4 offset:17696
    v_fma_f32 v10, v10, v14, v15
    v_fma_f32 v11, v11, v14, v15
    v_mfma_f32_16x16x32_bf16 v[132:135], a[12:15], v[56:59], v[132:135]
    s_waitcnt lgkmcnt(10)
    ds_read_b64_tr_b16 a[48:49], v4 offset:192
    v_fma_f32 v10, v10, v112, v116
    v_fma_f32 v11, v11, v113, v117
    v_mfma_f32_16x16x32_bf16 v[140:143], a[8:11], v[52:55], v[140:143]
    buffer_load_dwordx4 v5, s[12:15], s43 offen offset:3200 lds
    v_cvt_pk_bf16_f32 v64, v10, v11
    v_mfma_f32_16x16x32_bf16 v[140:143], a[12:15], v[60:63], v[140:143]
    s_add_u32 m0, s41, 34048
    ds_read_b128 v[120:123], v7 offset:1568
    ds_read_b64_tr_b16 a[50:51], v4 offset:704
    v_lshlrev_b32 v12, 16, v65
    v_mfma_f32_16x16x32_bf16 v[144:147], a[16:19], v[48:51], v[144:147]
    s_mov_b32 s43, 2684800
    ds_read_b128 v[124:127], v7 offset:1584
    v_and_b32 v13, 0xffff0000, v65
    v_fma_f32 v12, v12, v14, v15
    v_mfma_f32_16x16x32_bf16 v[144:147], a[20:23], v[56:59], v[144:147]
    ds_read_b64_tr_b16 a[52:53], v4 offset:17216
    ds_read_b64_tr_b16 a[54:55], v4 offset:17728
    v_fma_f32 v13, v13, v14, v15
    v_mfma_f32_16x16x32_bf16 v[152:155], a[16:19], v[52:55], v[152:155]
    buffer_load_dwordx4 v5, s[12:15], s44 offen offset:0 lds
    v_fma_f32 v12, v12, v114, v118
    v_mfma_f32_16x16x32_bf16 v[152:155], a[20:23], v[60:63], v[152:155]
    s_mov_b32 s44, 2814848
    ds_read_b64_tr_b16 a[56:57], v4 offset:224
    v_fma_f32 v13, v13, v115, v119
    v_cvt_pk_bf16_f32 v65, v12, v13
    v_mfma_f32_16x16x32_bf16 v[148:151], a[24:27], v[48:51], v[148:151]
    s_waitcnt lgkmcnt(9)
    v_lshlrev_b32 v10, 16, v68
    v_lshrrev_b32 v16, 6, v8
    v_mul_u32_u24 v16, 4864, v16
    v_mfma_f32_16x16x32_bf16 v[148:151], a[28:31], v[56:59], v[148:151]
    ds_read_b64_tr_b16 a[58:59], v4 offset:736
    v_add_u32 v16, v16, v9
    v_and_b32 v11, 0xffff0000, v68
    v_mfma_f32_16x16x32_bf16 v[156:159], a[24:27], v[52:55], v[156:159]
    buffer_load_dwordx4 v5, s[12:15], s45 offen offset:1024 lds
    v_fma_f32 v10, v10, v2, v3
    v_mfma_f32_16x16x32_bf16 v[156:159], a[28:31], v[60:63], v[156:159]
    s_mov_b32 s45, 2883584
    ds_read_b64_tr_b16 a[60:61], v4 offset:17248
    v_fma_f32 v11, v11, v2, v3
    v_fma_f32 v10, v10, v112, v116
    v_mfma_f32_16x16x32_bf16 v[160:163], a[32:35], v[48:51], v[160:163]
    ds_read_b64_tr_b16 a[62:63], v4 offset:17760
    ds_read_b64_tr_b16 a[64:65], v4 offset:256
    v_fma_f32 v11, v11, v113, v117
    v_mfma_f32_16x16x32_bf16 v[160:163], a[36:39], v[56:59], v[160:163]
    ds_read_b64_tr_b16 a[66:67], v4 offset:768
    v_cvt_pk_bf16_f32 v68, v10, v11
    v_lshlrev_b32 v12, 16, v69
    v_mfma_f32_16x16x32_bf16 v[168:171], a[32:35], v[52:55], v[168:171]
    buffer_load_dwordx4 v5, s[12:15], s43 offen offset:2176 lds
    ds_read_b64_tr_b16 a[68:69], v4 offset:17280
    v_mfma_f32_16x16x32_bf16 v[168:171], a[36:39], v[60:63], v[168:171]
    s_mov_b32 s43, 3013632
    ds_read_b64_tr_b16 a[70:71], v4 offset:17792
    v_and_b32 v13, 0xffff0000, v69
    v_fma_f32 v12, v12, v2, v3
    v_mfma_f32_16x16x32_bf16 v[164:167], a[40:43], v[48:51], v[164:167]
    s_waitcnt lgkmcnt(8)
    ds_read_b64_tr_b16 a[72:73], v4 offset:288
    v_fma_f32 v13, v13, v2, v3
    v_fma_f32 v12, v12, v114, v118
    v_mfma_f32_16x16x32_bf16 v[164:167], a[44:47], v[56:59], v[164:167]
    ds_read_b64_tr_b16 a[74:75], v4 offset:800
    v_fma_f32 v13, v13, v115, v119
    v_cvt_pk_bf16_f32 v69, v12, v13
    v_mfma_f32_16x16x32_bf16 v[172:175], a[40:43], v[52:55], v[172:175]
    buffer_load_dwordx4 v5, s[12:15], s44 offen offset:3200 lds
    v_lshlrev_b32 v10, 16, v66
    v_mfma_f32_16x16x32_bf16 v[172:175], a[44:47], v[60:63], v[172:175]
    s_add_u32 m0, s41, 51072
    buffer_load_dword a237, v16, s[96:99], s47 offen
    ds_read_b64_tr_b16 a[76:77], v4 offset:17312
    v_mfma_f32_16x16x32_bf16 v[176:179], a[48:51], v[48:51], v[176:179]
    s_mov_b32 s47, 14
    ds_read_b64_tr_b16 a[78:79], v4 offset:17824
    v_and_b32 v11, 0xffff0000, v66
    v_fma_f32 v10, v10, v14, v15
    v_mfma_f32_16x16x32_bf16 v[176:179], a[52:55], v[56:59], v[176:179]
    s_mov_b32 s44, 2946944
    ds_read_b64_tr_b16 a[80:81], v4 offset:320
    v_fma_f32 v11, v11, v14, v15
    v_fma_f32 v10, v10, v120, v124
    v_mfma_f32_16x16x32_bf16 v[184:187], a[48:51], v[52:55], v[184:187]
    s_waitcnt lgkmcnt(8)
    buffer_load_dwordx4 v5, s[12:15], s45 offen offset:0 lds
    v_fma_f32 v11, v11, v121, v125
    v_mfma_f32_16x16x32_bf16 v[184:187], a[52:55], v[60:63], v[184:187]
    s_mov_b32 s45, 3076992
    ds_read_b64_tr_b16 a[82:83], v4 offset:832
    v_cvt_pk_bf16_f32 v66, v10, v11
    v_lshlrev_b32 v12, 16, v67
    v_mfma_f32_16x16x32_bf16 v[180:183], a[56:59], v[48:51], v[180:183]
    ds_read_b128 v[112:115], v7 offset:1792
    ds_read_b64_tr_b16 a[84:85], v4 offset:17344
    v_and_b32 v13, 0xffff0000, v67
    v_mfma_f32_16x16x32_bf16 v[180:183], a[60:63], v[56:59], v[180:183]
    ds_read_b128 v[116:119], v7 offset:1808
    ds_read_b64_tr_b16 a[86:87], v4 offset:17856
    v_fma_f32 v12, v12, v14, v15
    v_mfma_f32_16x16x32_bf16 v[188:191], a[56:59], v[52:55], v[188:191]
    buffer_load_dwordx4 v5, s[12:15], s43 offen offset:1024 lds
    v_fma_f32 v13, v13, v14, v15
    v_mfma_f32_16x16x32_bf16 v[188:191], a[60:63], v[60:63], v[188:191]
    s_waitcnt lgkmcnt(8)
    ds_read_b64_tr_b16 a[88:89], v4 offset:352
    v_fma_f32 v12, v12, v122, v126
    v_fma_f32 v13, v13, v123, v127
    v_mfma_f32_16x16x32_bf16 v[192:195], a[64:67], v[48:51], v[192:195]
    ds_read_b64_tr_b16 a[90:91], v4 offset:864
    v_cvt_pk_bf16_f32 v67, v12, v13
    v_lshlrev_b32 v10, 16, v70
    v_mfma_f32_16x16x32_bf16 v[192:195], a[68:71], v[56:59], v[192:195]
    buffer_load_dwordx4 v5, s[12:15], s44 offen offset:2176 lds
    v_and_b32 v11, 0xffff0000, v70
    v_mfma_f32_16x16x32_bf16 v[200:203], a[64:67], v[52:55], v[200:203]
    ds_read_b64_tr_b16 a[92:93], v4 offset:17376
    v_fma_f32 v10, v10, v2, v3
    v_fma_f32 v11, v11, v2, v3
    v_mfma_f32_16x16x32_bf16 v[200:203], a[68:71], v[60:63], v[200:203]
    ds_read_b64_tr_b16 a[94:95], v4 offset:17888
    ds_read_b64_tr_b16 a[96:97], v4 offset:384
    v_fma_f32 v10, v10, v120, v124
    v_mfma_f32_16x16x32_bf16 v[196:199], a[72:75], v[48:51], v[196:199]
    s_waitcnt lgkmcnt(10)
    ds_read_b64_tr_b16 a[98:99], v4 offset:896
    v_fma_f32 v11, v11, v121, v125
    v_cvt_pk_bf16_f32 v70, v10, v11
    v_mfma_f32_16x16x32_bf16 v[196:199], a[76:79], v[56:59], v[196:199]
    buffer_load_dwordx4 v5, s[12:15], s45 offen offset:3200 lds
    ds_read_b64_tr_b16 a[100:101], v4 offset:17408
    v_mfma_f32_16x16x32_bf16 v[204:207], a[72:75], v[52:55], v[204:207]
    ds_read_b64_tr_b16 a[102:103], v4 offset:17920
    v_lshlrev_b32 v12, 16, v71
    v_and_b32 v13, 0xffff0000, v71
    v_mfma_f32_16x16x32_bf16 v[204:207], a[76:79], v[60:63], v[204:207]
    s_waitcnt lgkmcnt(8)
    ds_read_b64_tr_b16 a[104:105], v4 offset:416
    v_fma_f32 v12, v12, v2, v3
    v_fma_f32 v13, v13, v2, v3
    v_mfma_f32_16x16x32_bf16 v[208:211], a[80:83], v[48:51], v[208:211]
    ds_read_b64_tr_b16 a[106:107], v4 offset:928
    v_fma_f32 v12, v12, v122, v126
    v_fma_f32 v13, v13, v123, v127
    v_mfma_f32_16x16x32_bf16 v[208:211], a[84:87], v[56:59], v[208:211]
    buffer_load_dword a241, v9, s[76:79], s54 offen
    v_cvt_pk_bf16_f32 v71, v12, v13
    v_mfma_f32_16x16x32_bf16 v[216:219], a[80:83], v[52:55], v[216:219]
    s_add_u32 s54, s54, 65536
    ds_read_b64_tr_b16 a[108:109], v4 offset:17440
    v_lshlrev_b32 v10, 16, v72
    v_and_b32 v11, 0xffff0000, v72
    v_mfma_f32_16x16x32_bf16 v[216:219], a[84:87], v[60:63], v[216:219]
    s_waitcnt lgkmcnt(9)
    ds_read_b64_tr_b16 a[110:111], v4 offset:17952
    v_fma_f32 v10, v10, v14, v15
    v_fma_f32 v11, v11, v14, v15
    v_mfma_f32_16x16x32_bf16 v[212:215], a[88:91], v[48:51], v[212:215]
    s_waitcnt lgkmcnt(8)
    ds_read_b64_tr_b16 a[112:113], v4 offset:448
    v_fma_f32 v10, v10, v112, v116
    v_fma_f32 v11, v11, v113, v117
    v_mfma_f32_16x16x32_bf16 v[212:215], a[92:95], v[56:59], v[212:215]
    ds_read_b64_tr_b16 a[114:115], v4 offset:960
    v_cvt_pk_bf16_f32 v72, v10, v11
    v_lshlrev_b32 v12, 16, v73
    v_mfma_f32_16x16x32_bf16 v[220:223], a[88:91], v[52:55], v[220:223]
    ds_read_b128 v[120:123], v7 offset:1824
    ds_read_b64_tr_b16 a[116:117], v4 offset:17472
    v_and_b32 v13, 0xffff0000, v73
    v_mfma_f32_16x16x32_bf16 v[220:223], a[92:95], v[60:63], v[220:223]
    s_waitcnt lgkmcnt(9)
    ds_read_b128 v[124:127], v7 offset:1840
    ds_read_b64_tr_b16 a[118:119], v4 offset:17984
    v_fma_f32 v12, v12, v14, v15
    v_mfma_f32_16x16x32_bf16 v[224:227], a[96:99], v[48:51], v[224:227]
    s_waitcnt lgkmcnt(10)
    ds_read_b64_tr_b16 a[120:121], v4 offset:480
    v_fma_f32 v13, v13, v14, v15
    v_fma_f32 v12, v12, v114, v118
    v_mfma_f32_16x16x32_bf16 v[224:227], a[100:103], v[56:59], v[224:227]
    ds_read_b64_tr_b16 a[122:123], v4 offset:992
    v_fma_f32 v13, v13, v115, v119
    v_cvt_pk_bf16_f32 v73, v12, v13
    v_mfma_f32_16x16x32_bf16 v[232:235], a[96:99], v[52:55], v[232:235]
    ds_read_b64_tr_b16 a[124:125], v4 offset:17504
    v_lshlrev_b32 v10, 16, v76
    v_and_b32 v11, 0xffff0000, v76
    v_mfma_f32_16x16x32_bf16 v[232:235], a[100:103], v[60:63], v[232:235]
    s_waitcnt lgkmcnt(11)
    ds_read_b64_tr_b16 a[126:127], v4 offset:18016
    v_fma_f32 v10, v10, v2, v3
    v_fma_f32 v11, v11, v2, v3
    v_mfma_f32_16x16x32_bf16 v[228:231], a[104:107], v[48:51], v[228:231]
    s_waitcnt lgkmcnt(10)
    ds_read_b64_tr_b16 a[0:1], v4 offset:34048
    ds_read_b64_tr_b16 a[2:3], v4 offset:34560
    v_fma_f32 v10, v10, v112, v116
    v_mfma_f32_16x16x32_bf16 v[228:231], a[108:111], v[56:59], v[228:231]
    ds_read_b64_tr_b16 a[4:5], v4 offset:51072
    v_fma_f32 v11, v11, v113, v117
    v_cvt_pk_bf16_f32 v76, v10, v11
    v_mfma_f32_16x16x32_bf16 v[236:239], a[104:107], v[52:55], v[236:239]
    ds_read_b64_tr_b16 a[6:7], v4 offset:51584
    v_lshlrev_b32 v12, 16, v77
    v_and_b32 v13, 0xffff0000, v77
    v_mfma_f32_16x16x32_bf16 v[236:239], a[108:111], v[60:63], v[236:239]
    s_waitcnt lgkmcnt(12)
    ds_read_b64_tr_b16 a[8:9], v4 offset:34080
    v_fma_f32 v12, v12, v2, v3
    v_fma_f32 v13, v13, v2, v3
    v_mfma_f32_16x16x32_bf16 v[240:243], a[112:115], v[48:51], v[240:243]
    s_waitcnt lgkmcnt(9)
    ds_read_b64_tr_b16 a[10:11], v4 offset:34592
    v_fma_f32 v12, v12, v114, v118
    v_fma_f32 v13, v13, v115, v119
    v_mfma_f32_16x16x32_bf16 v[240:243], a[116:119], v[56:59], v[240:243]
    ds_read_b64_tr_b16 a[12:13], v4 offset:51104
    v_cvt_pk_bf16_f32 v77, v12, v13
    v_lshlrev_b32 v10, 16, v74
    v_mfma_f32_16x16x32_bf16 v[248:251], a[112:115], v[52:55], v[248:251]
    ds_read_b64_tr_b16 a[14:15], v4 offset:51616
    v_and_b32 v11, 0xffff0000, v74
    v_fma_f32 v10, v10, v14, v15
    v_mfma_f32_16x16x32_bf16 v[248:251], a[116:119], v[60:63], v[248:251]
    s_waitcnt lgkmcnt(10)
    ds_read_b64_tr_b16 a[16:17], v4 offset:34112
    v_fma_f32 v11, v11, v14, v15
    v_fma_f32 v10, v10, v120, v124
    v_mfma_f32_16x16x32_bf16 v[244:247], a[120:123], v[48:51], v[244:247]
    s_waitcnt lgkmcnt(9)
    ds_read_b64_tr_b16 a[18:19], v4 offset:34624
    v_fma_f32 v11, v11, v121, v125
    v_cvt_pk_bf16_f32 v74, v10, v11
    v_mfma_f32_16x16x32_bf16 v[244:247], a[124:127], v[56:59], v[244:247]
    ds_read_b64_tr_b16 a[20:21], v4 offset:51136
    v_lshlrev_b32 v12, 16, v75
    v_and_b32 v13, 0xffff0000, v75
    v_mfma_f32_16x16x32_bf16 v[252:255], a[120:123], v[52:55], v[252:255]
    ds_read_b128 v[112:115], v7 offset:2048
    ds_read_b64_tr_b16 a[22:23], v4 offset:51648
    v_fma_f32 v12, v12, v14, v15
    v_mfma_f32_16x16x32_bf16 v[252:255], a[124:127], v[60:63], v[252:255]
    s_waitcnt lgkmcnt(10)
    ds_read_b128 v[116:119], v7 offset:2064
    ds_read_b64_tr_b16 a[24:25], v4 offset:34144
    v_fma_f32 v13, v13, v14, v15
    v_fma_f32 v12, v12, v122, v126
    v_fma_f32 v13, v13, v123, v127
    v_cvt_pk_bf16_f32 v75, v12, v13
    v_mfma_f32_16x16x32_bf16 v[128:131], a[0:3], v[64:67], v[128:131]
    s_waitcnt lgkmcnt(11)
    ds_read_b64_tr_b16 a[26:27], v4 offset:34656
    ds_read_b64_tr_b16 a[28:29], v4 offset:51168
    v_lshlrev_b32 v10, 16, v78
    v_mfma_f32_16x16x32_bf16 v[128:131], a[4:7], v[72:75], v[128:131]
    ds_read_b64_tr_b16 a[30:31], v4 offset:51680
    v_and_b32 v11, 0xffff0000, v78
    v_fma_f32 v10, v10, v2, v3
    v_fma_f32 v11, v11, v2, v3
    v_fma_f32 v10, v10, v120, v124
    v_fma_f32 v11, v11, v121, v125
    v_cvt_pk_bf16_f32 v78, v10, v11
    v_lshlrev_b32 v12, 16, v79
    v_and_b32 v13, 0xffff0000, v79
    v_fma_f32 v12, v12, v2, v3
    v_fma_f32 v13, v13, v2, v3
    v_fma_f32 v12, v12, v122, v126
    v_fma_f32 v13, v13, v123, v127
    v_cvt_pk_bf16_f32 v79, v12, v13
    v_mfma_f32_16x16x32_bf16 v[136:139], a[0:3], v[68:71], v[136:139]
    ds_read_b64_tr_b16 a[32:33], v4 offset:34176
    ds_read_b64_tr_b16 a[34:35], v4 offset:34688
    ds_read_b64_tr_b16 a[36:37], v4 offset:51200
    v_mfma_f32_16x16x32_bf16 v[136:139], a[4:7], v[76:79], v[136:139]
    s_waitcnt lgkmcnt(14)
    ds_read_b64_tr_b16 a[38:39], v4 offset:51712
    ds_read_b64_tr_b16 a[40:41], v4 offset:34208
    ds_read_b64_tr_b16 a[42:43], v4 offset:34720
    v_mfma_f32_16x16x32_bf16 v[132:135], a[8:11], v[64:67], v[132:135]
    s_waitcnt lgkmcnt(15)
    ds_read_b64_tr_b16 a[44:45], v4 offset:51232
    ds_read_b64_tr_b16 a[46:47], v4 offset:51744
    v_lshlrev_b32 v10, 16, v80
    v_mfma_f32_16x16x32_bf16 v[132:135], a[12:15], v[72:75], v[132:135]
    ds_read_b64_tr_b16 a[48:49], v4 offset:34240
    v_and_b32 v11, 0xffff0000, v80
    v_fma_f32 v10, v10, v14, v15
    v_mfma_f32_16x16x32_bf16 v[140:143], a[8:11], v[68:71], v[140:143]
    ds_read_b64_tr_b16 a[50:51], v4 offset:34752
    ds_read_b64_tr_b16 a[52:53], v4 offset:51264
    v_fma_f32 v11, v11, v14, v15
    v_mfma_f32_16x16x32_bf16 v[140:143], a[12:15], v[76:79], v[140:143]
    s_waitcnt lgkmcnt(15)
    ds_read_b128 v[120:123], v7 offset:2080
    ds_read_b64_tr_b16 a[54:55], v4 offset:51776
    v_lshlrev_b32 v12, 16, v81
    v_mfma_f32_16x16x32_bf16 v[144:147], a[16:19], v[64:67], v[144:147]
    v_fma_f32 v10, v10, v112, v116
    v_fma_f32 v11, v11, v113, v117
    v_cvt_pk_bf16_f32 v80, v10, v11
    v_mfma_f32_16x16x32_bf16 v[144:147], a[20:23], v[72:75], v[144:147]
    ds_read_b128 v[124:127], v7 offset:2096
    v_and_b32 v13, 0xffff0000, v81
    v_fma_f32 v12, v12, v14, v15
    v_mfma_f32_16x16x32_bf16 v[152:155], a[16:19], v[68:71], v[152:155]
    ds_read_b64_tr_b16 a[56:57], v4 offset:34272
    ds_read_b64_tr_b16 a[58:59], v4 offset:34784
    v_fma_f32 v13, v13, v14, v15
    v_mfma_f32_16x16x32_bf16 v[152:155], a[20:23], v[76:79], v[152:155]
    s_waitcnt lgkmcnt(15)
    ds_read_b64_tr_b16 a[60:61], v4 offset:51296
    v_fma_f32 v12, v12, v114, v118
    v_fma_f32 v13, v13, v115, v119
    v_mfma_f32_16x16x32_bf16 v[148:151], a[24:27], v[64:67], v[148:151]
    ds_read_b64_tr_b16 a[62:63], v4 offset:51808
    v_cvt_pk_bf16_f32 v81, v12, v13
    v_lshlrev_b32 v10, 16, v84
    v_mfma_f32_16x16x32_bf16 v[148:151], a[28:31], v[72:75], v[148:151]
    ds_read_b64_tr_b16 a[64:65], v4 offset:34304
    v_and_b32 v11, 0xffff0000, v84
    v_fma_f32 v10, v10, v2, v3
    v_mfma_f32_16x16x32_bf16 v[156:159], a[24:27], v[68:71], v[156:159]
    ds_read_b64_tr_b16 a[66:67], v4 offset:34816
    v_fma_f32 v11, v11, v2, v3
    v_fma_f32 v10, v10, v112, v116
    v_mfma_f32_16x16x32_bf16 v[156:159], a[28:31], v[76:79], v[156:159]
    s_waitcnt lgkmcnt(11)
    ds_read_b64_tr_b16 a[68:69], v4 offset:51328
    ds_read_b64_tr_b16 a[70:71], v4 offset:51840
    v_fma_f32 v11, v11, v113, v117
    v_mfma_f32_16x16x32_bf16 v[160:163], a[32:35], v[64:67], v[160:163]
    ds_read_b64_tr_b16 a[72:73], v4 offset:34336
    v_cvt_pk_bf16_f32 v84, v10, v11
    v_lshlrev_b32 v12, 16, v85
    v_mfma_f32_16x16x32_bf16 v[160:163], a[36:39], v[72:75], v[160:163]
    ds_read_b64_tr_b16 a[74:75], v4 offset:34848
    v_and_b32 v13, 0xffff0000, v85
    v_fma_f32 v12, v12, v2, v3
    v_mfma_f32_16x16x32_bf16 v[168:171], a[32:35], v[68:71], v[168:171]
    ds_read_b64_tr_b16 a[76:77], v4 offset:51360
    v_fma_f32 v13, v13, v2, v3
    v_fma_f32 v12, v12, v114, v118
    v_mfma_f32_16x16x32_bf16 v[168:171], a[36:39], v[76:79], v[168:171]
    ds_read_b64_tr_b16 a[78:79], v4 offset:51872
    v_fma_f32 v13, v13, v115, v119
    v_cvt_pk_bf16_f32 v85, v12, v13
    v_mfma_f32_16x16x32_bf16 v[164:167], a[40:43], v[64:67], v[164:167]
    ds_read_b64_tr_b16 a[80:81], v4 offset:34368
    v_lshlrev_b32 v10, 16, v82
    v_and_b32 v11, 0xffff0000, v82
    v_mfma_f32_16x16x32_bf16 v[164:167], a[44:47], v[72:75], v[164:167]
    ds_read_b64_tr_b16 a[82:83], v4 offset:34880
    v_fma_f32 v10, v10, v14, v15
    v_fma_f32 v11, v11, v14, v15
    v_mfma_f32_16x16x32_bf16 v[172:175], a[40:43], v[68:71], v[172:175]
    s_waitcnt lgkmcnt(10)
    ds_read_b64_tr_b16 a[84:85], v4 offset:51392
    v_fma_f32 v10, v10, v120, v124
    v_fma_f32 v11, v11, v121, v125
    v_mfma_f32_16x16x32_bf16 v[172:175], a[44:47], v[76:79], v[172:175]
    ds_read_b64_tr_b16 a[86:87], v4 offset:51904
    v_cvt_pk_bf16_f32 v82, v10, v11
    v_lshlrev_b32 v12, 16, v83
    v_mfma_f32_16x16x32_bf16 v[176:179], a[48:51], v[64:67], v[176:179]
    ds_read_b128 v[112:115], v7 offset:2304
    ds_read_b64_tr_b16 a[88:89], v4 offset:34400
    v_and_b32 v13, 0xffff0000, v83
    v_mfma_f32_16x16x32_bf16 v[176:179], a[52:55], v[72:75], v[176:179]
    ds_read_b128 v[116:119], v7 offset:2320
    ds_read_b64_tr_b16 a[90:91], v4 offset:34912
    v_fma_f32 v12, v12, v14, v15
    v_mfma_f32_16x16x32_bf16 v[184:187], a[48:51], v[68:71], v[184:187]
    ds_read_b64_tr_b16 a[92:93], v4 offset:51424
    v_fma_f32 v13, v13, v14, v15
    v_fma_f32 v12, v12, v122, v126
    v_mfma_f32_16x16x32_bf16 v[184:187], a[52:55], v[76:79], v[184:187]
    ds_read_b64_tr_b16 a[94:95], v4 offset:51936
    v_fma_f32 v13, v13, v123, v127
    v_cvt_pk_bf16_f32 v83, v12, v13
    v_mfma_f32_16x16x32_bf16 v[180:183], a[56:59], v[64:67], v[180:183]
    ds_read_b64_tr_b16 a[96:97], v4 offset:34432
    v_lshlrev_b32 v10, 16, v86
    v_and_b32 v11, 0xffff0000, v86
    v_mfma_f32_16x16x32_bf16 v[180:183], a[60:63], v[72:75], v[180:183]
    ds_read_b64_tr_b16 a[98:99], v4 offset:34944
    v_fma_f32 v10, v10, v2, v3
    v_fma_f32 v11, v11, v2, v3
    v_mfma_f32_16x16x32_bf16 v[188:191], a[56:59], v[68:71], v[188:191]
    ds_read_b64_tr_b16 a[100:101], v4 offset:51456
    ds_read_b64_tr_b16 a[102:103], v4 offset:51968
    v_fma_f32 v10, v10, v120, v124
    v_mfma_f32_16x16x32_bf16 v[188:191], a[60:63], v[76:79], v[188:191]
    s_waitcnt lgkmcnt(12)
    ds_read_b64_tr_b16 a[104:105], v4 offset:34464
    v_fma_f32 v11, v11, v121, v125
    v_cvt_pk_bf16_f32 v86, v10, v11
    v_mfma_f32_16x16x32_bf16 v[192:195], a[64:67], v[64:67], v[192:195]
    ds_read_b64_tr_b16 a[106:107], v4 offset:34976
    v_lshlrev_b32 v12, 16, v87
    v_and_b32 v13, 0xffff0000, v87
    v_mfma_f32_16x16x32_bf16 v[192:195], a[68:71], v[72:75], v[192:195]
    ds_read_b64_tr_b16 a[108:109], v4 offset:51488
    ds_read_b64_tr_b16 a[110:111], v4 offset:52000
    ds_read_b64_tr_b16 a[112:113], v4 offset:34496
    ds_read_b64_tr_b16 a[114:115], v4 offset:35008
    ds_read_b64_tr_b16 a[116:117], v4 offset:51520
    ds_read_b64_tr_b16 a[118:119], v4 offset:52032
    ds_read_b64_tr_b16 a[120:121], v4 offset:34528
    ds_read_b64_tr_b16 a[122:123], v4 offset:35040
    ds_read_b64_tr_b16 a[124:125], v4 offset:51552
    ds_read_b64_tr_b16 a[126:127], v4 offset:52064
    v_fma_f32 v12, v12, v2, v3
    v_fma_f32 v13, v13, v2, v3
    v_mfma_f32_16x16x32_bf16 v[200:203], a[64:67], v[68:71], v[200:203]
    v_fma_f32 v12, v12, v122, v126
    v_fma_f32 v13, v13, v123, v127
    v_cvt_pk_bf16_f32 v87, v12, v13
    v_mfma_f32_16x16x32_bf16 v[200:203], a[68:71], v[76:79], v[200:203]
    v_lshlrev_b32 v10, 16, v88
    v_and_b32 v11, 0xffff0000, v88
    v_fma_f32 v10, v10, v14, v15
    v_mfma_f32_16x16x32_bf16 v[196:199], a[72:75], v[64:67], v[196:199]
    s_waitcnt lgkmcnt(15)
    v_fma_f32 v11, v11, v14, v15
    v_fma_f32 v10, v10, v112, v116
    v_fma_f32 v11, v11, v113, v117
    v_mfma_f32_16x16x32_bf16 v[196:199], a[76:79], v[72:75], v[196:199]
    ds_read_b128 v[120:123], v7 offset:2336
    v_cvt_pk_bf16_f32 v88, v10, v11
    v_lshlrev_b32 v12, 16, v89
    v_mfma_f32_16x16x32_bf16 v[204:207], a[72:75], v[68:71], v[204:207]
    s_add_u32 m0, s41, 102144
    ds_read_b128 v[124:127], v7 offset:2352
    v_and_b32 v13, 0xffff0000, v89
    v_fma_f32 v12, v12, v14, v15
    v_mfma_f32_16x16x32_bf16 v[204:207], a[76:79], v[76:79], v[204:207]
    s_mov_b32 s43, 3145728
    v_fma_f32 v13, v13, v14, v15
    v_fma_f32 v12, v12, v114, v118
    v_fma_f32 v13, v13, v115, v119
    v_mfma_f32_16x16x32_bf16 v[208:211], a[80:83], v[64:67], v[208:211]
    s_waitcnt vmcnt(1) lgkmcnt(0)
    v_cvt_pk_bf16_f32 v89, v12, v13
    v_lshlrev_b32 v10, 16, v92
    v_and_b32 v11, 0xffff0000, v92
    v_mfma_f32_16x16x32_bf16 v[208:211], a[84:87], v[72:75], v[208:211]
    s_barrier
    v_fma_f32 v10, v10, v2, v3
    v_fma_f32 v11, v11, v2, v3
    v_fma_f32 v10, v10, v112, v116
    v_mfma_f32_16x16x32_bf16 v[216:219], a[80:83], v[68:71], v[216:219]
    s_mov_b32 s44, 3275776
    v_fma_f32 v11, v11, v113, v117
    v_cvt_pk_bf16_f32 v92, v10, v11
    v_lshlrev_b32 v12, 16, v93
    v_mfma_f32_16x16x32_bf16 v[216:219], a[84:87], v[76:79], v[216:219]
    s_mov_b32 s45, 3209088
    v_and_b32 v13, 0xffff0000, v93
    v_fma_f32 v12, v12, v2, v3
    v_fma_f32 v13, v13, v2, v3
    v_mfma_f32_16x16x32_bf16 v[212:215], a[88:91], v[64:67], v[212:215]
    v_fma_f32 v12, v12, v114, v118
    v_fma_f32 v13, v13, v115, v119
    v_cvt_pk_bf16_f32 v93, v12, v13
    v_mfma_f32_16x16x32_bf16 v[212:215], a[92:95], v[72:75], v[212:215]
    ds_read_b64_tr_b16 a[0:1], v1 offset:0
    ds_read_b64_tr_b16 a[2:3], v1 offset:512
    v_lshlrev_b32 v10, 16, v90
    v_mfma_f32_16x16x32_bf16 v[220:223], a[88:91], v[68:71], v[220:223]
    ds_read_b64_tr_b16 a[4:5], v1 offset:17024
    v_and_b32 v11, 0xffff0000, v90
    v_fma_f32 v10, v10, v14, v15
    v_mfma_f32_16x16x32_bf16 v[220:223], a[92:95], v[76:79], v[220:223]
    buffer_load_dwordx4 v5, s[12:15], s43 offen offset:0 lds
    v_fma_f32 v11, v11, v14, v15
    v_mfma_f32_16x16x32_bf16 v[224:227], a[96:99], v[64:67], v[224:227]
    s_mov_b32 s43, 3339136
    ds_read_b64_tr_b16 a[6:7], v1 offset:17536
    v_fma_f32 v10, v10, v120, v124
    v_fma_f32 v11, v11, v121, v125
    v_mfma_f32_16x16x32_bf16 v[224:227], a[100:103], v[72:75], v[224:227]
    ds_read_b64_tr_b16 a[8:9], v1 offset:32
    v_cvt_pk_bf16_f32 v90, v10, v11
    v_lshlrev_b32 v12, 16, v91
    v_mfma_f32_16x16x32_bf16 v[232:235], a[96:99], v[68:71], v[232:235]
    ds_read_b128 v[112:115], v7 offset:2560
    ds_read_b64_tr_b16 a[10:11], v1 offset:544
    v_and_b32 v13, 0xffff0000, v91
    v_mfma_f32_16x16x32_bf16 v[232:235], a[100:103], v[76:79], v[232:235]
    ds_read_b128 v[116:119], v7 offset:2576
    buffer_load_dwordx4 v5, s[12:15], s44 offen offset:1024 lds
    v_mfma_f32_16x16x32_bf16 v[228:231], a[104:107], v[64:67], v[228:231]
    s_mov_b32 s44, 3407872
    ds_read_b64_tr_b16 a[12:13], v1 offset:17056
    v_fma_f32 v12, v12, v14, v15
    v_fma_f32 v13, v13, v14, v15
    v_mfma_f32_16x16x32_bf16 v[228:231], a[108:111], v[72:75], v[228:231]
    ds_read_b64_tr_b16 a[14:15], v1 offset:17568
    v_fma_f32 v12, v12, v122, v126
    v_fma_f32 v13, v13, v123, v127
    v_mfma_f32_16x16x32_bf16 v[236:239], a[104:107], v[68:71], v[236:239]
    buffer_load_dwordx4 v5, s[12:15], s45 offen offset:2176 lds
    v_cvt_pk_bf16_f32 v91, v12, v13
    v_mfma_f32_16x16x32_bf16 v[236:239], a[108:111], v[76:79], v[236:239]
    s_mov_b32 s45, 3537920
    ds_read_b64_tr_b16 a[16:17], v1 offset:64
    v_lshlrev_b32 v10, 16, v94
    v_and_b32 v11, 0xffff0000, v94
    v_mfma_f32_16x16x32_bf16 v[240:243], a[112:115], v[64:67], v[240:243]
    ds_read_b64_tr_b16 a[18:19], v1 offset:576
    v_fma_f32 v10, v10, v2, v3
    v_fma_f32 v11, v11, v2, v3
    v_mfma_f32_16x16x32_bf16 v[240:243], a[116:119], v[72:75], v[240:243]
    ds_read_b64_tr_b16 a[20:21], v1 offset:17088
    ds_read_b64_tr_b16 a[22:23], v1 offset:17600
    v_fma_f32 v10, v10, v120, v124
    v_mfma_f32_16x16x32_bf16 v[248:251], a[112:115], v[68:71], v[248:251]
    buffer_load_dwordx4 v5, s[12:15], s43 offen offset:3200 lds
    v_fma_f32 v11, v11, v121, v125
    v_mfma_f32_16x16x32_bf16 v[248:251], a[116:119], v[76:79], v[248:251]
    s_add_u32 m0, s41, 119168
    ds_read_b64_tr_b16 a[24:25], v1 offset:96
    v_cvt_pk_bf16_f32 v94, v10, v11
    v_lshlrev_b32 v12, 16, v95
    v_mfma_f32_16x16x32_bf16 v[244:247], a[120:123], v[64:67], v[244:247]
    s_mov_b32 s43, 3471232
    ds_read_b64_tr_b16 a[26:27], v1 offset:608
    v_and_b32 v13, 0xffff0000, v95
    v_fma_f32 v12, v12, v2, v3
    v_mfma_f32_16x16x32_bf16 v[244:247], a[124:127], v[72:75], v[244:247]
    buffer_load_dwordx4 v5, s[12:15], s44 offen offset:0 lds
    v_fma_f32 v13, v13, v2, v3
    v_mfma_f32_16x16x32_bf16 v[252:255], a[120:123], v[68:71], v[252:255]
    s_mov_b32 s44, 3601280
    ds_read_b64_tr_b16 a[28:29], v1 offset:17120
    v_fma_f32 v12, v12, v122, v126
    v_fma_f32 v13, v13, v123, v127
    v_mfma_f32_16x16x32_bf16 v[252:255], a[124:127], v[76:79], v[252:255]
    s_waitcnt lgkmcnt(7)
    ds_read_b64_tr_b16 a[30:31], v1 offset:17632
    ds_read_b64_tr_b16 a[32:33], v1 offset:128
    v_cvt_pk_bf16_f32 v95, v12, v13
    v_mfma_f32_16x16x32_bf16 v[128:131], a[0:3], v[80:83], v[128:131]
    ds_read_b64_tr_b16 a[34:35], v1 offset:640
    v_lshlrev_b32 v10, 16, v96
    v_and_b32 v11, 0xffff0000, v96
    v_mfma_f32_16x16x32_bf16 v[128:131], a[4:7], v[88:91], v[128:131]
    buffer_load_dwordx4 v5, s[12:15], s45 offen offset:1024 lds
    ds_read_b64_tr_b16 a[36:37], v1 offset:17152
    v_mfma_f32_16x16x32_bf16 v[136:139], a[0:3], v[84:87], v[136:139]
    ds_read_b64_tr_b16 a[38:39], v1 offset:17664
    v_fma_f32 v10, v10, v14, v15
    v_fma_f32 v11, v11, v14, v15
    v_mfma_f32_16x16x32_bf16 v[136:139], a[4:7], v[92:95], v[136:139]
    ds_read_b64_tr_b16 a[40:41], v1 offset:160
    v_fma_f32 v10, v10, v112, v116
    v_fma_f32 v11, v11, v113, v117
    v_mfma_f32_16x16x32_bf16 v[132:135], a[8:11], v[80:83], v[132:135]
    ds_read_b128 v[120:123], v7 offset:2592
    v_cvt_pk_bf16_f32 v96, v10, v11
    v_lshlrev_b32 v12, 16, v97
    v_mfma_f32_16x16x32_bf16 v[132:135], a[12:15], v[88:91], v[132:135]
    ds_read_b128 v[124:127], v7 offset:2608
    buffer_load_dwordx4 v5, s[12:15], s43 offen offset:2176 lds
    v_mfma_f32_16x16x32_bf16 v[140:143], a[8:11], v[84:87], v[140:143]
    ds_read_b64_tr_b16 a[42:43], v1 offset:672
    v_and_b32 v13, 0xffff0000, v97
    v_fma_f32 v12, v12, v14, v15
    v_mfma_f32_16x16x32_bf16 v[140:143], a[12:15], v[92:95], v[140:143]
    s_waitcnt lgkmcnt(10)
    ds_read_b64_tr_b16 a[44:45], v1 offset:17184
    ds_read_b64_tr_b16 a[46:47], v1 offset:17696
    v_fma_f32 v13, v13, v14, v15
    v_mfma_f32_16x16x32_bf16 v[144:147], a[16:19], v[80:83], v[144:147]
    ds_read_b64_tr_b16 a[48:49], v1 offset:192
    v_fma_f32 v12, v12, v114, v118
    v_fma_f32 v13, v13, v115, v119
    v_mfma_f32_16x16x32_bf16 v[144:147], a[20:23], v[88:91], v[144:147]
    buffer_load_dwordx4 v5, s[12:15], s44 offen offset:3200 lds
    v_cvt_pk_bf16_f32 v97, v12, v13
    v_mfma_f32_16x16x32_bf16 v[152:155], a[16:19], v[84:87], v[152:155]
    s_add_u32 m0, s40, 68096
    ds_read_b64_tr_b16 a[50:51], v1 offset:704
    v_lshlrev_b32 v10, 16, v100
    v_and_b32 v11, 0xffff0000, v100
    v_mfma_f32_16x16x32_bf16 v[152:155], a[20:23], v[92:95], v[152:155]
    ds_read_b64_tr_b16 a[52:53], v1 offset:17216
    v_fma_f32 v10, v10, v2, v3
    v_fma_f32 v11, v11, v2, v3
    v_mfma_f32_16x16x32_bf16 v[148:151], a[24:27], v[80:83], v[148:151]
    s_waitcnt lgkmcnt(9)
    buffer_load_dwordx4 v6, s[4:7], s24 offen offset:0 lds
    v_fma_f32 v10, v10, v112, v116
    v_mfma_f32_16x16x32_bf16 v[148:151], a[28:31], v[88:91], v[148:151]
    ds_read_b64_tr_b16 a[54:55], v1 offset:17728
    ds_read_b64_tr_b16 a[56:57], v1 offset:224
    v_fma_f32 v11, v11, v113, v117
    v_mfma_f32_16x16x32_bf16 v[156:159], a[24:27], v[84:87], v[156:159]
    ds_read_b64_tr_b16 a[58:59], v1 offset:736
    v_cvt_pk_bf16_f32 v100, v10, v11
    v_lshlrev_b32 v12, 16, v101
    v_mfma_f32_16x16x32_bf16 v[156:159], a[28:31], v[92:95], v[156:159]
    ds_read_b128 v[16:19], v0 offset:0
    v_and_b32 v13, 0xffff0000, v101
    v_fma_f32 v12, v12, v2, v3
    v_mfma_f32_16x16x32_bf16 v[160:163], a[32:35], v[80:83], v[160:163]
    buffer_load_dwordx4 v6, s[4:7], s25 offen offset:1024 lds
    ds_read_b64_tr_b16 a[60:61], v1 offset:17248
    v_mfma_f32_16x16x32_bf16 v[160:163], a[36:39], v[88:91], v[160:163]
    ds_read_b64_tr_b16 a[62:63], v1 offset:17760
    v_fma_f32 v13, v13, v2, v3
    v_fma_f32 v12, v12, v114, v118
    v_mfma_f32_16x16x32_bf16 v[168:171], a[32:35], v[84:87], v[168:171]
    ds_read_b64_tr_b16 a[64:65], v1 offset:256
    v_fma_f32 v13, v13, v115, v119
    v_cvt_pk_bf16_f32 v101, v12, v13
    v_mfma_f32_16x16x32_bf16 v[168:171], a[36:39], v[92:95], v[168:171]
    s_waitcnt lgkmcnt(9)
    ds_read_b64_tr_b16 a[66:67], v1 offset:768
    ds_read_b64_tr_b16 a[68:69], v1 offset:17280
    v_lshlrev_b32 v10, 16, v98
    v_mfma_f32_16x16x32_bf16 v[164:167], a[40:43], v[80:83], v[164:167]
    ds_read_b128 v[20:23], v0 offset:2176
    buffer_load_dwordx4 v6, s[4:7], s26 offen offset:2064 lds
    v_mfma_f32_16x16x32_bf16 v[164:167], a[44:47], v[88:91], v[164:167]
    ds_read_b64_tr_b16 a[70:71], v1 offset:17792
    v_and_b32 v11, 0xffff0000, v98
    v_fma_f32 v10, v10, v14, v15
    v_mfma_f32_16x16x32_bf16 v[172:175], a[40:43], v[84:87], v[172:175]
    ds_read_b64_tr_b16 a[72:73], v1 offset:288
    v_fma_f32 v11, v11, v14, v15
    v_fma_f32 v10, v10, v120, v124
    v_mfma_f32_16x16x32_bf16 v[172:175], a[44:47], v[92:95], v[172:175]
    s_waitcnt lgkmcnt(10)
    ds_read_b128 v[24:27], v0 offset:64
    v_fma_f32 v11, v11, v121, v125
    v_cvt_pk_bf16_f32 v98, v10, v11
    v_mfma_f32_16x16x32_bf16 v[176:179], a[48:51], v[80:83], v[176:179]
    buffer_load_dwordx4 v6, s[4:7], s27 offen offset:3088 lds
    ds_read_b64_tr_b16 a[74:75], v1 offset:800
    v_mfma_f32_16x16x32_bf16 v[176:179], a[52:55], v[88:91], v[176:179]
    s_add_u32 m0, s40, 85120
    ds_read_b128 v[112:115], v7 offset:2816
    v_lshlrev_b32 v12, 16, v99
    v_and_b32 v13, 0xffff0000, v99
    v_mfma_f32_16x16x32_bf16 v[184:187], a[48:51], v[84:87], v[184:187]
    ds_read_b128 v[116:119], v7 offset:2832
    ds_read_b64_tr_b16 a[76:77], v1 offset:17312
    v_fma_f32 v12, v12, v14, v15
    v_mfma_f32_16x16x32_bf16 v[184:187], a[52:55], v[92:95], v[184:187]
    s_waitcnt lgkmcnt(11)
    ds_read_b64_tr_b16 a[78:79], v1 offset:17824
    v_fma_f32 v13, v13, v14, v15
    v_fma_f32 v12, v12, v122, v126
    v_mfma_f32_16x16x32_bf16 v[180:183], a[56:59], v[80:83], v[180:183]
    ds_read_b128 v[28:31], v0 offset:2240
    buffer_load_dwordx4 v6, s[4:7], s28 offen offset:0 lds
    v_mfma_f32_16x16x32_bf16 v[180:183], a[60:63], v[88:91], v[180:183]
    ds_read_b64_tr_b16 a[80:81], v1 offset:320
    v_fma_f32 v13, v13, v123, v127
    v_cvt_pk_bf16_f32 v99, v12, v13
    v_mfma_f32_16x16x32_bf16 v[188:191], a[56:59], v[84:87], v[188:191]
    ds_read_b64_tr_b16 a[82:83], v1 offset:832
    v_lshlrev_b32 v10, 16, v102
    v_and_b32 v11, 0xffff0000, v102
    v_mfma_f32_16x16x32_bf16 v[188:191], a[60:63], v[92:95], v[188:191]
    s_waitcnt lgkmcnt(10)
    ds_read_b64_tr_b16 a[84:85], v1 offset:17344
    v_fma_f32 v10, v10, v2, v3
    v_fma_f32 v11, v11, v2, v3
    v_mfma_f32_16x16x32_bf16 v[192:195], a[64:67], v[80:83], v[192:195]
    buffer_load_dwordx4 v6, s[4:7], s29 offen offset:1024 lds
    ds_read_b64_tr_b16 a[86:87], v1 offset:17856
    v_mfma_f32_16x16x32_bf16 v[192:195], a[68:71], v[88:91], v[192:195]
    ds_read_b64_tr_b16 a[88:89], v1 offset:352
    v_fma_f32 v10, v10, v120, v124
    v_fma_f32 v11, v11, v121, v125
    v_mfma_f32_16x16x32_bf16 v[200:203], a[64:67], v[84:87], v[200:203]
    ds_read_b64_tr_b16 a[90:91], v1 offset:864
    v_cvt_pk_bf16_f32 v102, v10, v11
    v_lshlrev_b32 v12, 16, v103
    v_mfma_f32_16x16x32_bf16 v[200:203], a[68:71], v[92:95], v[200:203]
    s_waitcnt lgkmcnt(10)
    buffer_load_dwordx4 v6, s[4:7], s30 offen offset:2064 lds
    v_and_b32 v13, 0xffff0000, v103
    v_mfma_f32_16x16x32_bf16 v[196:199], a[72:75], v[80:83], v[196:199]
    s_waitcnt lgkmcnt(7)
    ds_read_b64_tr_b16 a[92:93], v1 offset:17376
    v_fma_f32 v12, v12, v2, v3
    v_fma_f32 v13, v13, v2, v3
    v_mfma_f32_16x16x32_bf16 v[196:199], a[76:79], v[88:91], v[196:199]
    ds_read_b64_tr_b16 a[94:95], v1 offset:17888
    v_fma_f32 v12, v12, v122, v126
    v_fma_f32 v13, v13, v123, v127
    v_mfma_f32_16x16x32_bf16 v[204:207], a[72:75], v[84:87], v[204:207]
    ds_read_b64_tr_b16 a[96:97], v1 offset:384
    ds_read_b64_tr_b16 a[98:99], v1 offset:896
    v_cvt_pk_bf16_f32 v103, v12, v13
    v_mfma_f32_16x16x32_bf16 v[204:207], a[76:79], v[92:95], v[204:207]
    s_waitcnt lgkmcnt(8)
    buffer_load_dwordx4 v6, s[4:7], s31 offen offset:3088 lds
    ds_read_b64_tr_b16 a[100:101], v1 offset:17408
    v_mfma_f32_16x16x32_bf16 v[208:211], a[80:83], v[80:83], v[208:211]
    s_waitcnt lgkmcnt(7)
    ds_read_b64_tr_b16 a[102:103], v1 offset:17920
    v_lshlrev_b32 v10, 16, v104
    v_and_b32 v11, 0xffff0000, v104
    v_mfma_f32_16x16x32_bf16 v[208:211], a[84:87], v[88:91], v[208:211]
    v_fma_f32 v10, v10, v14, v15
    v_fma_f32 v11, v11, v14, v15
    v_add_u32 v6, 0x8000, v6
    v_mfma_f32_16x16x32_bf16 v[216:219], a[80:83], v[84:87], v[216:219]
    ds_read_b64_tr_b16 a[104:105], v1 offset:416
    v_fma_f32 v10, v10, v112, v116
    v_fma_f32 v11, v11, v113, v117
    v_mfma_f32_16x16x32_bf16 v[216:219], a[84:87], v[92:95], v[216:219]
    s_waitcnt lgkmcnt(7)
    ds_read_b64_tr_b16 a[106:107], v1 offset:928
    v_cvt_pk_bf16_f32 v104, v10, v11
    v_lshlrev_b32 v12, 16, v105
    v_mfma_f32_16x16x32_bf16 v[212:215], a[88:91], v[80:83], v[212:215]
    s_waitcnt lgkmcnt(6)
    ds_read_b128 v[120:123], v7 offset:2848
    ds_read_b64_tr_b16 a[108:109], v1 offset:17440
    v_and_b32 v13, 0xffff0000, v105
    v_mfma_f32_16x16x32_bf16 v[212:215], a[92:95], v[88:91], v[212:215]
    ds_read_b128 v[124:127], v7 offset:2864
    ds_read_b64_tr_b16 a[110:111], v1 offset:17952
    v_fma_f32 v12, v12, v14, v15
    v_mfma_f32_16x16x32_bf16 v[220:223], a[88:91], v[84:87], v[220:223]
    ds_read_b64_tr_b16 a[112:113], v1 offset:448
    v_fma_f32 v13, v13, v14, v15
    v_fma_f32 v12, v12, v114, v118
    v_mfma_f32_16x16x32_bf16 v[220:223], a[92:95], v[92:95], v[220:223]
    s_waitcnt lgkmcnt(9)
    ds_read_b64_tr_b16 a[114:115], v1 offset:960
    v_fma_f32 v13, v13, v115, v119
    v_cvt_pk_bf16_f32 v105, v12, v13
    v_mfma_f32_16x16x32_bf16 v[224:227], a[96:99], v[80:83], v[224:227]
    s_waitcnt lgkmcnt(8)
    ds_read_b64_tr_b16 a[116:117], v1 offset:17472
    v_lshlrev_b32 v10, 16, v108
    v_and_b32 v11, 0xffff0000, v108
    v_mfma_f32_16x16x32_bf16 v[224:227], a[100:103], v[88:91], v[224:227]
    ds_read_b64_tr_b16 a[118:119], v1 offset:17984
    v_fma_f32 v10, v10, v2, v3
    v_fma_f32 v11, v11, v2, v3
    v_mfma_f32_16x16x32_bf16 v[232:235], a[96:99], v[84:87], v[232:235]
    ds_read_b64_tr_b16 a[120:121], v1 offset:480
    v_fma_f32 v10, v10, v112, v116
    v_fma_f32 v11, v11, v113, v117
    v_mfma_f32_16x16x32_bf16 v[232:235], a[100:103], v[92:95], v[232:235]
    s_waitcnt lgkmcnt(9)
    ds_read_b64_tr_b16 a[122:123], v1 offset:992
    v_cvt_pk_bf16_f32 v108, v10, v11
    v_lshlrev_b32 v12, 16, v109
    v_mfma_f32_16x16x32_bf16 v[228:231], a[104:107], v[80:83], v[228:231]
    s_waitcnt lgkmcnt(6)
    ds_read_b64_tr_b16 a[124:125], v1 offset:17504
    v_and_b32 v13, 0xffff0000, v109
    v_fma_f32 v12, v12, v2, v3
    v_mfma_f32_16x16x32_bf16 v[228:231], a[108:111], v[88:91], v[228:231]
    ds_read_b64_tr_b16 a[126:127], v1 offset:18016
    v_fma_f32 v13, v13, v2, v3
    v_fma_f32 v12, v12, v114, v118
    v_mfma_f32_16x16x32_bf16 v[236:239], a[104:107], v[84:87], v[236:239]
    ds_read_b64_tr_b16 a[0:1], v1 offset:34048
    ds_read_b64_tr_b16 a[2:3], v1 offset:34560
    v_fma_f32 v13, v13, v115, v119
    v_mfma_f32_16x16x32_bf16 v[236:239], a[108:111], v[92:95], v[236:239]
    s_waitcnt lgkmcnt(8)
    ds_read_b64_tr_b16 a[4:5], v1 offset:51072
    v_cvt_pk_bf16_f32 v109, v12, v13
    v_lshlrev_b32 v10, 16, v106
    v_mfma_f32_16x16x32_bf16 v[240:243], a[112:115], v[80:83], v[240:243]
    s_waitcnt lgkmcnt(7)
    ds_read_b64_tr_b16 a[6:7], v1 offset:51584
    v_and_b32 v11, 0xffff0000, v106
    v_fma_f32 v10, v10, v14, v15
    v_mfma_f32_16x16x32_bf16 v[240:243], a[116:119], v[88:91], v[240:243]
    ds_read_b64_tr_b16 a[8:9], v1 offset:34080
    v_fma_f32 v11, v11, v14, v15
    v_fma_f32 v10, v10, v120, v124
    v_mfma_f32_16x16x32_bf16 v[248:251], a[112:115], v[84:87], v[248:251]
    ds_read_b64_tr_b16 a[10:11], v1 offset:34592
    v_fma_f32 v11, v11, v121, v125
    v_cvt_pk_bf16_f32 v106, v10, v11
    v_mfma_f32_16x16x32_bf16 v[248:251], a[116:119], v[92:95], v[248:251]
    s_waitcnt lgkmcnt(8)
    ds_read_b64_tr_b16 a[12:13], v1 offset:51104
    v_lshlrev_b32 v12, 16, v107
    v_and_b32 v13, 0xffff0000, v107
    v_mfma_f32_16x16x32_bf16 v[244:247], a[120:123], v[80:83], v[244:247]
    s_waitcnt lgkmcnt(7)
    ds_read_b128 v[112:115], v7 offset:3072
    ds_read_b64_tr_b16 a[14:15], v1 offset:51616
    v_fma_f32 v12, v12, v14, v15
    v_mfma_f32_16x16x32_bf16 v[244:247], a[124:127], v[88:91], v[244:247]
    ds_read_b128 v[116:119], v7 offset:3088
    ds_read_b64_tr_b16 a[16:17], v1 offset:34112
    v_fma_f32 v13, v13, v14, v15
    v_mfma_f32_16x16x32_bf16 v[252:255], a[120:123], v[84:87], v[252:255]
    ds_read_b64_tr_b16 a[18:19], v1 offset:34624
    v_fma_f32 v12, v12, v122, v126
    v_fma_f32 v13, v13, v123, v127
    v_mfma_f32_16x16x32_bf16 v[252:255], a[124:127], v[92:95], v[252:255]
    s_waitcnt lgkmcnt(10)
    ds_read_b64_tr_b16 a[20:21], v1 offset:51136
    v_cvt_pk_bf16_f32 v107, v12, v13
    v_lshlrev_b32 v10, 16, v110
    v_mfma_f32_16x16x32_bf16 v[128:131], a[0:3], v[96:99], v[128:131]
    s_waitcnt lgkmcnt(9)
    ds_read_b64_tr_b16 a[22:23], v1 offset:51648
    v_and_b32 v11, 0xffff0000, v110
    v_fma_f32 v10, v10, v2, v3
    v_mfma_f32_16x16x32_bf16 v[128:131], a[4:7], v[104:107], v[128:131]
    ds_read_b64_tr_b16 a[24:25], v1 offset:34144
    v_fma_f32 v11, v11, v2, v3
    v_fma_f32 v10, v10, v120, v124
    v_fma_f32 v11, v11, v121, v125
    v_cvt_pk_bf16_f32 v110, v10, v11
    v_lshlrev_b32 v12, 16, v111
    v_and_b32 v13, 0xffff0000, v111
    v_fma_f32 v12, v12, v2, v3
    v_fma_f32 v13, v13, v2, v3
    v_fma_f32 v12, v12, v122, v126
    v_fma_f32 v13, v13, v123, v127
    v_cvt_pk_bf16_f32 v111, v12, v13
    v_mfma_f32_16x16x32_bf16 v[136:139], a[0:3], v[100:103], v[136:139]
    ds_read_b64_tr_b16 a[26:27], v1 offset:34656
    ds_read_b64_tr_b16 a[28:29], v1 offset:51168
    ds_read_b64_tr_b16 a[30:31], v1 offset:51680
    v_mfma_f32_16x16x32_bf16 v[136:139], a[4:7], v[108:111], v[136:139]
    s_waitcnt lgkmcnt(12)
    ds_read_b64_tr_b16 a[32:33], v1 offset:34176
    ds_read_b64_tr_b16 a[34:35], v1 offset:34688
    ds_read_b64_tr_b16 a[36:37], v1 offset:51200
    v_mfma_f32_16x16x32_bf16 v[132:135], a[8:11], v[96:99], v[132:135]
    s_waitcnt lgkmcnt(12)
    ds_read_b64_tr_b16 a[38:39], v1 offset:51712
    v_lshlrev_b32 v10, 16, v16
    v_and_b32 v11, 0xffff0000, v16
    v_mfma_f32_16x16x32_bf16 v[132:135], a[12:15], v[104:107], v[132:135]
    ds_read_b64_tr_b16 a[40:41], v1 offset:34208
    v_fma_f32 v10, v10, v14, v15
    v_fma_f32 v11, v11, v14, v15
    v_mfma_f32_16x16x32_bf16 v[140:143], a[8:11], v[100:103], v[140:143]
    s_waitcnt lgkmcnt(13)
    ds_read_b64_tr_b16 a[42:43], v1 offset:34720
    v_fma_f32 v10, v10, v112, v116
    v_fma_f32 v11, v11, v113, v117
    v_mfma_f32_16x16x32_bf16 v[140:143], a[12:15], v[108:111], v[140:143]
    s_waitcnt lgkmcnt(12)
    ds_read_b64_tr_b16 a[44:45], v1 offset:51232
    v_cvt_pk_bf16_f32 v16, v10, v11
    v_lshlrev_b32 v12, 16, v17
    v_mfma_f32_16x16x32_bf16 v[144:147], a[16:19], v[96:99], v[144:147]
    s_waitcnt lgkmcnt(11)
    ds_read_b128 v[120:123], v7 offset:3104
    ds_read_b64_tr_b16 a[46:47], v1 offset:51744
    v_and_b32 v13, 0xffff0000, v17
    v_mfma_f32_16x16x32_bf16 v[144:147], a[20:23], v[104:107], v[144:147]
    ds_read_b128 v[124:127], v7 offset:3120
    ds_read_b64_tr_b16 a[48:49], v1 offset:34240
    v_fma_f32 v12, v12, v14, v15
    v_mfma_f32_16x16x32_bf16 v[152:155], a[16:19], v[100:103], v[152:155]
    ds_read_b64_tr_b16 a[50:51], v1 offset:34752
    v_fma_f32 v13, v13, v14, v15
    v_fma_f32 v12, v12, v114, v118
    v_mfma_f32_16x16x32_bf16 v[152:155], a[20:23], v[108:111], v[152:155]
    s_waitcnt lgkmcnt(14)
    ds_read_b64_tr_b16 a[52:53], v1 offset:51264
    v_fma_f32 v13, v13, v115, v119
    v_cvt_pk_bf16_f32 v17, v12, v13
    v_mfma_f32_16x16x32_bf16 v[148:151], a[24:27], v[96:99], v[148:151]
    s_waitcnt lgkmcnt(13)
    ds_read_b64_tr_b16 a[54:55], v1 offset:51776
    v_lshlrev_b32 v10, 16, v20
    v_and_b32 v11, 0xffff0000, v20
    v_mfma_f32_16x16x32_bf16 v[148:151], a[28:31], v[104:107], v[148:151]
    ds_read_b64_tr_b16 a[56:57], v1 offset:34272
    v_fma_f32 v10, v10, v2, v3
    v_fma_f32 v11, v11, v2, v3
    v_mfma_f32_16x16x32_bf16 v[156:159], a[24:27], v[100:103], v[156:159]
    ds_read_b64_tr_b16 a[58:59], v1 offset:34784
    v_fma_f32 v10, v10, v112, v116
    v_fma_f32 v11, v11, v113, v117
    v_mfma_f32_16x16x32_bf16 v[156:159], a[28:31], v[108:111], v[156:159]
    s_waitcnt lgkmcnt(11)
    ds_read_b64_tr_b16 a[60:61], v1 offset:51296
    v_cvt_pk_bf16_f32 v20, v10, v11
    v_lshlrev_b32 v12, 16, v21
    v_mfma_f32_16x16x32_bf16 v[160:163], a[32:35], v[96:99], v[160:163]
    ds_read_b64_tr_b16 a[62:63], v1 offset:51808
    v_and_b32 v13, 0xffff0000, v21
    v_fma_f32 v12, v12, v2, v3
    v_mfma_f32_16x16x32_bf16 v[160:163], a[36:39], v[104:107], v[160:163]
    ds_read_b64_tr_b16 a[64:65], v1 offset:34304
    ds_read_b64_tr_b16 a[66:67], v1 offset:34816
    v_fma_f32 v13, v13, v2, v3
    v_mfma_f32_16x16x32_bf16 v[168:171], a[32:35], v[100:103], v[168:171]
    ds_read_b64_tr_b16 a[68:69], v1 offset:51328
    v_fma_f32 v12, v12, v114, v118
    v_fma_f32 v13, v13, v115, v119
    v_mfma_f32_16x16x32_bf16 v[168:171], a[36:39], v[108:111], v[168:171]
    s_waitcnt lgkmcnt(10)
    ds_read_b64_tr_b16 a[70:71], v1 offset:51840
    v_cvt_pk_bf16_f32 v21, v12, v13
    v_lshlrev_b32 v10, 16, v18
    v_mfma_f32_16x16x32_bf16 v[164:167], a[40:43], v[96:99], v[164:167]
    ds_read_b64_tr_b16 a[72:73], v1 offset:34336
    v_and_b32 v11, 0xffff0000, v18
    v_fma_f32 v10, v10, v14, v15
    v_mfma_f32_16x16x32_bf16 v[164:167], a[44:47], v[104:107], v[164:167]
    ds_read_b64_tr_b16 a[74:75], v1 offset:34848
    v_fma_f32 v11, v11, v14, v15
    v_fma_f32 v10, v10, v120, v124
    v_mfma_f32_16x16x32_bf16 v[172:175], a[40:43], v[100:103], v[172:175]
    ds_read_b64_tr_b16 a[76:77], v1 offset:51360
    v_fma_f32 v11, v11, v121, v125
    v_cvt_pk_bf16_f32 v18, v10, v11
    v_mfma_f32_16x16x32_bf16 v[172:175], a[44:47], v[108:111], v[172:175]
    s_waitcnt lgkmcnt(10)
    ds_read_b64_tr_b16 a[78:79], v1 offset:51872
    v_lshlrev_b32 v12, 16, v19
    v_and_b32 v13, 0xffff0000, v19
    v_mfma_f32_16x16x32_bf16 v[176:179], a[48:51], v[96:99], v[176:179]
    ds_read_b128 v[112:115], v7 offset:3328
    ds_read_b64_tr_b16 a[80:81], v1 offset:34368
    v_fma_f32 v12, v12, v14, v15
    v_mfma_f32_16x16x32_bf16 v[176:179], a[52:55], v[104:107], v[176:179]
    ds_read_b128 v[116:119], v7 offset:3344
    ds_read_b64_tr_b16 a[82:83], v1 offset:34880
    v_fma_f32 v13, v13, v14, v15
    v_mfma_f32_16x16x32_bf16 v[184:187], a[48:51], v[100:103], v[184:187]
    ds_read_b64_tr_b16 a[84:85], v1 offset:51392
    v_fma_f32 v12, v12, v122, v126
    v_fma_f32 v13, v13, v123, v127
    v_mfma_f32_16x16x32_bf16 v[184:187], a[52:55], v[108:111], v[184:187]
    s_waitcnt lgkmcnt(11)
    ds_read_b64_tr_b16 a[86:87], v1 offset:51904
    v_cvt_pk_bf16_f32 v19, v12, v13
    v_lshlrev_b32 v10, 16, v22
    v_mfma_f32_16x16x32_bf16 v[180:183], a[56:59], v[96:99], v[180:183]
    ds_read_b64_tr_b16 a[88:89], v1 offset:34400
    v_and_b32 v11, 0xffff0000, v22
    v_fma_f32 v10, v10, v2, v3
    v_mfma_f32_16x16x32_bf16 v[180:183], a[60:63], v[104:107], v[180:183]
    ds_read_b64_tr_b16 a[90:91], v1 offset:34912
    v_fma_f32 v11, v11, v2, v3
    v_fma_f32 v10, v10, v120, v124
    v_mfma_f32_16x16x32_bf16 v[188:191], a[56:59], v[100:103], v[188:191]
    ds_read_b64_tr_b16 a[92:93], v1 offset:51424
    v_fma_f32 v11, v11, v121, v125
    v_cvt_pk_bf16_f32 v22, v10, v11
    v_mfma_f32_16x16x32_bf16 v[188:191], a[60:63], v[108:111], v[188:191]
    ds_read_b64_tr_b16 a[94:95], v1 offset:51936
    v_lshlrev_b32 v12, 16, v23
    v_and_b32 v13, 0xffff0000, v23
    v_mfma_f32_16x16x32_bf16 v[192:195], a[64:67], v[96:99], v[192:195]
    s_waitcnt lgkmcnt(11)
    ds_read_b64_tr_b16 a[96:97], v1 offset:34432
    ds_read_b64_tr_b16 a[98:99], v1 offset:34944
    v_fma_f32 v12, v12, v2, v3
    v_mfma_f32_16x16x32_bf16 v[192:195], a[68:71], v[104:107], v[192:195]
    ds_read_b64_tr_b16 a[100:101], v1 offset:51456
    ds_read_b64_tr_b16 a[102:103], v1 offset:51968
    ds_read_b64_tr_b16 a[104:105], v1 offset:34464
    ds_read_b64_tr_b16 a[106:107], v1 offset:34976
    ds_read_b64_tr_b16 a[108:109], v1 offset:51488
    ds_read_b64_tr_b16 a[110:111], v1 offset:52000
    ds_read_b64_tr_b16 a[112:113], v1 offset:34496
    ds_read_b64_tr_b16 a[114:115], v1 offset:35008
    ds_read_b64_tr_b16 a[116:117], v1 offset:51520
    ds_read_b64_tr_b16 a[118:119], v1 offset:52032
    ds_read_b64_tr_b16 a[120:121], v1 offset:34528
    ds_read_b64_tr_b16 a[122:123], v1 offset:35040
    ds_read_b64_tr_b16 a[124:125], v1 offset:51552
    ds_read_b64_tr_b16 a[126:127], v1 offset:52064
    v_fma_f32 v13, v13, v2, v3
    v_fma_f32 v12, v12, v122, v126
    v_mfma_f32_16x16x32_bf16 v[200:203], a[64:67], v[100:103], v[200:203]
    v_fma_f32 v13, v13, v123, v127
    v_cvt_pk_bf16_f32 v23, v12, v13
    v_lshlrev_b32 v10, 16, v24
    v_mfma_f32_16x16x32_bf16 v[200:203], a[68:71], v[108:111], v[200:203]
    v_and_b32 v11, 0xffff0000, v24
    v_fma_f32 v10, v10, v14, v15
    v_fma_f32 v11, v11, v14, v15
    v_mfma_f32_16x16x32_bf16 v[196:199], a[72:75], v[96:99], v[196:199]
    s_waitcnt lgkmcnt(15)
    v_fma_f32 v10, v10, v112, v116
    v_fma_f32 v11, v11, v113, v117
    v_cvt_pk_bf16_f32 v24, v10, v11
    v_mfma_f32_16x16x32_bf16 v[196:199], a[76:79], v[104:107], v[196:199]
    ds_read_b128 v[120:123], v7 offset:3360
    v_lshlrev_b32 v12, 16, v25
    v_and_b32 v13, 0xffff0000, v25
    v_mfma_f32_16x16x32_bf16 v[204:207], a[72:75], v[100:103], v[204:207]
    s_add_u32 m0, s40, 0
    ds_read_b128 v[124:127], v7 offset:3376
    v_fma_f32 v12, v12, v14, v15
    v_fma_f32 v13, v13, v14, v15
    v_mfma_f32_16x16x32_bf16 v[204:207], a[76:79], v[108:111], v[204:207]
    v_fma_f32 v12, v12, v114, v118
    v_fma_f32 v13, v13, v115, v119
    v_cvt_pk_bf16_f32 v25, v12, v13
    v_mfma_f32_16x16x32_bf16 v[208:211], a[80:83], v[96:99], v[208:211]
    s_waitcnt vmcnt(0) lgkmcnt(0)
    v_lshlrev_b32 v10, 16, v28
    v_and_b32 v11, 0xffff0000, v28
    v_fma_f32 v10, v10, v2, v3
    v_mfma_f32_16x16x32_bf16 v[208:211], a[84:87], v[104:107], v[208:211]
    s_barrier
    v_fma_f32 v11, v11, v2, v3
    v_fma_f32 v10, v10, v112, v116
    v_fma_f32 v11, v11, v113, v117
    v_mfma_f32_16x16x32_bf16 v[216:219], a[80:83], v[100:103], v[216:219]
    v_cvt_pk_bf16_f32 v28, v10, v11
    v_lshlrev_b32 v12, 16, v29
    v_and_b32 v13, 0xffff0000, v29
    v_mfma_f32_16x16x32_bf16 v[216:219], a[84:87], v[108:111], v[216:219]
    v_fma_f32 v12, v12, v2, v3
    v_fma_f32 v13, v13, v2, v3
    v_fma_f32 v12, v12, v114, v118
    v_mfma_f32_16x16x32_bf16 v[212:215], a[88:91], v[96:99], v[212:215]
    v_fma_f32 v13, v13, v115, v119
    v_cvt_pk_bf16_f32 v29, v12, v13
    v_lshlrev_b32 v10, 16, v26
    v_mfma_f32_16x16x32_bf16 v[212:215], a[92:95], v[104:107], v[212:215]
    v_and_b32 v11, 0xffff0000, v26
    v_fma_f32 v10, v10, v14, v15
    v_fma_f32 v11, v11, v14, v15
    v_mfma_f32_16x16x32_bf16 v[220:223], a[88:91], v[100:103], v[220:223]
    ds_read_b64_tr_b16 a[0:1], v4 offset:34048
    v_lshlrev_b32 v12, 16, v27
    v_and_b32 v13, 0xffff0000, v27
    v_mfma_f32_16x16x32_bf16 v[220:223], a[92:95], v[108:111], v[220:223]
    v_fma_f32 v10, v10, v120, v124
    v_fma_f32 v11, v11, v121, v125
    v_cvt_pk_bf16_f32 v26, v10, v11
    v_mfma_f32_16x16x32_bf16 v[224:227], a[96:99], v[96:99], v[224:227]
    ds_read_b64_tr_b16 a[2:3], v4 offset:34560
    ds_read_b64_tr_b16 a[4:5], v4 offset:51072
    v_fma_f32 v12, v12, v14, v15
    v_mfma_f32_16x16x32_bf16 v[224:227], a[100:103], v[104:107], v[224:227]
    buffer_load_dwordx4 v6, s[4:7], s24 offen offset:0 lds
    v_fma_f32 v13, v13, v14, v15
    v_mfma_f32_16x16x32_bf16 v[232:235], a[96:99], v[100:103], v[232:235]
    ds_read_b64_tr_b16 a[6:7], v4 offset:51584
    v_fma_f32 v12, v12, v122, v126
    v_fma_f32 v13, v13, v123, v127
    v_mfma_f32_16x16x32_bf16 v[232:235], a[100:103], v[108:111], v[232:235]
    ds_read_b64_tr_b16 a[8:9], v4 offset:34080
    v_cvt_pk_bf16_f32 v27, v12, v13
    v_lshlrev_b32 v10, 16, v30
    v_mfma_f32_16x16x32_bf16 v[228:231], a[104:107], v[96:99], v[228:231]
    buffer_load_dwordx4 v6, s[4:7], s25 offen offset:1024 lds
    v_and_b32 v11, 0xffff0000, v30
    v_mfma_f32_16x16x32_bf16 v[228:231], a[108:111], v[104:107], v[228:231]
    ds_read_b64_tr_b16 a[10:11], v4 offset:34592
    v_fma_f32 v10, v10, v2, v3
    v_fma_f32 v11, v11, v2, v3
    v_mfma_f32_16x16x32_bf16 v[236:239], a[104:107], v[100:103], v[236:239]
    ds_read_b64_tr_b16 a[12:13], v4 offset:51104
    ds_read_b64_tr_b16 a[14:15], v4 offset:51616
    v_fma_f32 v10, v10, v120, v124
    v_mfma_f32_16x16x32_bf16 v[236:239], a[108:111], v[108:111], v[236:239]
    ds_read_b64_tr_b16 a[16:17], v4 offset:34112
    v_fma_f32 v11, v11, v121, v125
    v_cvt_pk_bf16_f32 v30, v10, v11
    v_mfma_f32_16x16x32_bf16 v[240:243], a[112:115], v[96:99], v[240:243]
    buffer_load_dwordx4 v6, s[4:7], s26 offen offset:2064 lds
    v_lshlrev_b32 v12, 16, v31
    v_mfma_f32_16x16x32_bf16 v[240:243], a[116:119], v[104:107], v[240:243]
    ds_read_b64_tr_b16 a[18:19], v4 offset:34624
    v_and_b32 v13, 0xffff0000, v31
    v_fma_f32 v12, v12, v2, v3
    v_mfma_f32_16x16x32_bf16 v[248:251], a[112:115], v[100:103], v[248:251]
    ds_read_b64_tr_b16 a[20:21], v4 offset:51136
    v_fma_f32 v13, v13, v2, v3
    v_fma_f32 v12, v12, v122, v126
    v_mfma_f32_16x16x32_bf16 v[248:251], a[116:119], v[108:111], v[248:251]
    buffer_load_dwordx4 v6, s[4:7], s27 offen offset:3088 lds
    v_fma_f32 v13, v13, v123, v127
    v_mfma_f32_16x16x32_bf16 v[244:247], a[120:123], v[96:99], v[244:247]
    s_add_u32 m0, s40, 17024
    ds_read_b64_tr_b16 a[22:23], v4 offset:51648
    ds_read_b64_tr_b16 a[24:25], v4 offset:34144
    v_cvt_pk_bf16_f32 v31, v12, v13
    v_mfma_f32_16x16x32_bf16 v[244:247], a[124:127], v[104:107], v[244:247]
    ds_read_b64_tr_b16 a[26:27], v4 offset:34656
    buffer_load_dwordx4 v6, s[4:7], s28 offen offset:0 lds
    v_mfma_f32_16x16x32_bf16 v[252:255], a[120:123], v[100:103], v[252:255]
    ds_read_b64_tr_b16 a[28:29], v4 offset:51168
    ds_read_b64_tr_b16 a[30:31], v4 offset:51680
    ds_read_b64_tr_b16 a[32:33], v4 offset:34176
    v_mfma_f32_16x16x32_bf16 v[252:255], a[124:127], v[108:111], v[252:255]
    s_waitcnt lgkmcnt(11)
    ds_read_b64_tr_b16 a[34:35], v4 offset:34688
    buffer_load_dwordx4 v6, s[4:7], s29 offen offset:1024 lds
    v_mfma_f32_16x16x32_bf16 v[128:131], a[0:3], v[16:19], v[128:131]
    ds_read_b64_tr_b16 a[36:37], v4 offset:51200
    ds_read_b64_tr_b16 a[38:39], v4 offset:51712
    v_mfma_f32_16x16x32_bf16 v[128:131], a[4:7], v[24:27], v[128:131]
    s_waitcnt lgkmcnt(6)
    ds_read_b64_tr_b16 a[40:41], v4 offset:34208
    ds_read_b64_tr_b16 a[42:43], v4 offset:34720
    v_mfma_f32_16x16x32_bf16 v[132:135], a[8:11], v[16:19], v[132:135]
    s_waitcnt lgkmcnt(13)
    buffer_load_dwordx4 v6, s[4:7], s30 offen offset:2064 lds
    v_mfma_f32_16x16x32_bf16 v[132:135], a[12:15], v[24:27], v[132:135]
    s_waitcnt lgkmcnt(12)
    ds_read_b64_tr_b16 a[44:45], v4 offset:51232
    ds_read_b64_tr_b16 a[46:47], v4 offset:51744
    v_mfma_f32_16x16x32_bf16 v[144:147], a[16:19], v[16:19], v[144:147]
    s_waitcnt lgkmcnt(12)
    buffer_load_dwordx4 v6, s[4:7], s31 offen offset:3088 lds
    ds_read_b64_tr_b16 a[48:49], v4 offset:34240
    ds_read_b64_tr_b16 a[50:51], v4 offset:34752
    v_mfma_f32_16x16x32_bf16 v[144:147], a[20:23], v[24:27], v[144:147]
    s_add_u32 m0, s41, 34048
    ds_read_b64_tr_b16 a[52:53], v4 offset:51264
    ds_read_b64_tr_b16 a[54:55], v4 offset:51776
    v_accvgpr_read_b32 v2, a247
    v_add_u32 v3, 68096, v2
    v_mfma_f32_16x16x32_bf16 v[148:151], a[24:27], v[16:19], v[148:151]
    s_waitcnt lgkmcnt(12)
    ds_read_b64_tr_b16 a[56:57], v4 offset:34272
    ds_read_b64_tr_b16 a[58:59], v4 offset:34784
    v_accvgpr_read_b32 v14, a245
    v_accvgpr_read_b32 v15, a246
    v_mfma_f32_16x16x32_bf16 v[148:151], a[28:31], v[24:27], v[148:151]
    s_waitcnt lgkmcnt(12)
    ds_read_b64_tr_b16 a[60:61], v4 offset:51296
    ds_read_b64_tr_b16 a[62:63], v4 offset:51808
    v_mov_b32 v88, 0
    v_mov_b32 v89, 0
    v_mfma_f32_16x16x32_bf16 v[160:163], a[32:35], v[16:19], v[160:163]
    s_waitcnt lgkmcnt(12)
    ds_read_b64_tr_b16 a[64:65], v4 offset:34304
    ds_read_b64_tr_b16 a[66:67], v4 offset:34816
    v_mov_b32 v90, 0
    v_mov_b32 v91, 0
    v_mfma_f32_16x16x32_bf16 v[160:163], a[36:39], v[24:27], v[160:163]
    s_waitcnt lgkmcnt(12)
    buffer_load_dwordx4 v6, s[8:11], s32 offen offset:0 lds
    ds_read_b64_tr_b16 a[68:69], v4 offset:51328
    ds_read_b64_tr_b16 a[70:71], v4 offset:51840
    v_mfma_f32_16x16x32_bf16 v[164:167], a[40:43], v[16:19], v[164:167]
    s_waitcnt lgkmcnt(12)
    buffer_load_dwordx4 v6, s[8:11], s33 offen offset:1024 lds
    ds_read_b64_tr_b16 a[72:73], v4 offset:34336
    ds_read_b64_tr_b16 a[74:75], v4 offset:34848
    v_mfma_f32_16x16x32_bf16 v[164:167], a[44:47], v[24:27], v[164:167]
    s_waitcnt lgkmcnt(12)
    buffer_load_dwordx4 v6, s[8:11], s34 offen offset:2176 lds
    ds_read_b64_tr_b16 a[76:77], v4 offset:51360
    ds_read_b64_tr_b16 a[78:79], v4 offset:51872
    v_mfma_f32_16x16x32_bf16 v[176:179], a[48:51], v[16:19], v[176:179]
    s_waitcnt lgkmcnt(12)
    ds_read_b64_tr_b16 a[80:81], v4 offset:34368
    ds_read_b64_tr_b16 a[82:83], v4 offset:34880
    v_cvt_pk_bf16_f32 v128, v128, v129
    v_cvt_pk_bf16_f32 v129, v130, v131
    v_mfma_f32_16x16x32_bf16 v[176:179], a[52:55], v[24:27], v[176:179]
    s_waitcnt lgkmcnt(12)
    ds_read_b64_tr_b16 a[84:85], v4 offset:51392
    ds_read_b64_tr_b16 a[86:87], v4 offset:51904
    v_cvt_pk_bf16_f32 v130, v132, v133
    v_cvt_pk_bf16_f32 v131, v134, v135
    v_mfma_f32_16x16x32_bf16 v[180:183], a[56:59], v[16:19], v[180:183]
    s_waitcnt lgkmcnt(12)
    buffer_load_dwordx4 v6, s[8:11], s35 offen offset:3200 lds
    ds_read_b64_tr_b16 a[88:89], v4 offset:34400
    ds_read_b64_tr_b16 a[90:91], v4 offset:34912
    v_mfma_f32_16x16x32_bf16 v[180:183], a[60:63], v[24:27], v[180:183]
    s_add_u32 m0, s41, 51072
    ds_read_b64_tr_b16 a[92:93], v4 offset:51424
    ds_read_b64_tr_b16 a[94:95], v4 offset:51936
    v_permlane16_swap_b32 v128, v130
    s_waitcnt lgkmcnt(14)
    v_mfma_f32_16x16x32_bf16 v[192:195], a[64:67], v[16:19], v[192:195]
    s_waitcnt lgkmcnt(12)
    ds_read_b64_tr_b16 a[96:97], v4 offset:34432
    ds_read_b64_tr_b16 a[98:99], v4 offset:34944
    v_permlane16_swap_b32 v129, v131
    v_mfma_f32_16x16x32_bf16 v[192:195], a[68:71], v[24:27], v[192:195]
    s_waitcnt lgkmcnt(12)
    ds_read_b64_tr_b16 a[100:101], v4 offset:51456
    ds_read_b64_tr_b16 a[102:103], v4 offset:51968
    v_accvgpr_write_b32 a128, v128
    v_accvgpr_write_b32 a129, v129
    v_mfma_f32_16x16x32_bf16 v[196:199], a[72:75], v[16:19], v[196:199]
    s_waitcnt lgkmcnt(12)
    ds_read_b64_tr_b16 a[104:105], v4 offset:34464
    ds_read_b64_tr_b16 a[106:107], v4 offset:34976
    v_accvgpr_write_b32 a130, v130
    v_accvgpr_write_b32 a131, v131
    v_mfma_f32_16x16x32_bf16 v[196:199], a[76:79], v[24:27], v[196:199]
    s_waitcnt lgkmcnt(12)
    ds_read_b64_tr_b16 a[108:109], v4 offset:51488
    ds_read_b64_tr_b16 a[110:111], v4 offset:52000
    v_cvt_pk_bf16_f32 v144, v144, v145
    v_cvt_pk_bf16_f32 v145, v146, v147
    v_mfma_f32_16x16x32_bf16 v[208:211], a[80:83], v[16:19], v[208:211]
    s_waitcnt lgkmcnt(12)
    ds_read_b64_tr_b16 a[112:113], v4 offset:34496
    ds_read_b64_tr_b16 a[114:115], v4 offset:35008
    v_cvt_pk_bf16_f32 v146, v148, v149
    v_cvt_pk_bf16_f32 v147, v150, v151
    v_mfma_f32_16x16x32_bf16 v[208:211], a[84:87], v[24:27], v[208:211]
    s_waitcnt lgkmcnt(12)
    buffer_load_dwordx4 v6, s[8:11], s36 offen offset:0 lds
    ds_read_b64_tr_b16 a[116:117], v4 offset:51520
    ds_read_b64_tr_b16 a[118:119], v4 offset:52032
    v_mfma_f32_16x16x32_bf16 v[212:215], a[88:91], v[16:19], v[212:215]
    s_waitcnt lgkmcnt(12)
    ds_read_b64_tr_b16 a[120:121], v4 offset:34528
    ds_read_b64_tr_b16 a[122:123], v4 offset:35040
    v_permlane16_swap_b32 v144, v146
    v_mfma_f32_16x16x32_bf16 v[212:215], a[92:95], v[24:27], v[212:215]
    s_waitcnt lgkmcnt(12)
    ds_read_b64_tr_b16 a[124:125], v4 offset:51552
    ds_read_b64_tr_b16 a[126:127], v4 offset:52064
    v_permlane16_swap_b32 v145, v147
    v_mfma_f32_16x16x32_bf16 v[224:227], a[96:99], v[16:19], v[224:227]
    s_waitcnt lgkmcnt(12)
    v_accvgpr_write_b32 a136, v144
    v_accvgpr_write_b32 a137, v145
    v_mfma_f32_16x16x32_bf16 v[224:227], a[100:103], v[24:27], v[224:227]
    s_waitcnt lgkmcnt(10)
    v_accvgpr_write_b32 a138, v146
    v_accvgpr_write_b32 a139, v147
    v_mfma_f32_16x16x32_bf16 v[228:231], a[104:107], v[16:19], v[228:231]
    s_waitcnt lgkmcnt(8)
    v_cvt_pk_bf16_f32 v160, v160, v161
    v_cvt_pk_bf16_f32 v161, v162, v163
    v_mfma_f32_16x16x32_bf16 v[228:231], a[108:111], v[24:27], v[228:231]
    s_waitcnt lgkmcnt(6)
    v_cvt_pk_bf16_f32 v162, v164, v165
    v_cvt_pk_bf16_f32 v163, v166, v167
    v_mfma_f32_16x16x32_bf16 v[240:243], a[112:115], v[16:19], v[240:243]
    s_waitcnt lgkmcnt(4)
    buffer_load_dwordx4 v6, s[8:11], s37 offen offset:1024 lds
    v_mfma_f32_16x16x32_bf16 v[240:243], a[116:119], v[24:27], v[240:243]
    s_waitcnt lgkmcnt(2)
    v_permlane16_swap_b32 v160, v162
    v_mfma_f32_16x16x32_bf16 v[244:247], a[120:123], v[16:19], v[244:247]
    s_waitcnt lgkmcnt(0)
    v_permlane16_swap_b32 v161, v163
    v_mfma_f32_16x16x32_bf16 v[244:247], a[124:127], v[24:27], v[244:247]
    v_accvgpr_write_b32 a144, v160
    v_accvgpr_write_b32 a145, v161
    v_mfma_f32_16x16x32_bf16 v[136:139], a[0:3], v[20:23], v[136:139]
    v_accvgpr_write_b32 a146, v162
    v_accvgpr_write_b32 a147, v163
    v_mfma_f32_16x16x32_bf16 v[136:139], a[4:7], v[28:31], v[136:139]
    buffer_load_dwordx4 v6, s[8:11], s38 offen offset:2176 lds
    v_mfma_f32_16x16x32_bf16 v[140:143], a[8:11], v[20:23], v[140:143]
    v_cvt_pk_bf16_f32 v176, v176, v177
    v_cvt_pk_bf16_f32 v177, v178, v179
    v_mfma_f32_16x16x32_bf16 v[140:143], a[12:15], v[28:31], v[140:143]
    v_cvt_pk_bf16_f32 v178, v180, v181
    v_cvt_pk_bf16_f32 v179, v182, v183
    v_mfma_f32_16x16x32_bf16 v[152:155], a[16:19], v[20:23], v[152:155]
    buffer_load_dwordx4 v6, s[8:11], s39 offen offset:3200 lds
    v_mfma_f32_16x16x32_bf16 v[152:155], a[20:23], v[28:31], v[152:155]
    v_permlane16_swap_b32 v176, v178
    v_mfma_f32_16x16x32_bf16 v[156:159], a[24:27], v[20:23], v[156:159]
    v_permlane16_swap_b32 v177, v179
    v_mfma_f32_16x16x32_bf16 v[156:159], a[28:31], v[28:31], v[156:159]
    v_accvgpr_write_b32 a152, v176
    v_accvgpr_write_b32 a153, v177
    v_mfma_f32_16x16x32_bf16 v[168:171], a[32:35], v[20:23], v[168:171]
    v_accvgpr_write_b32 a154, v178
    v_accvgpr_write_b32 a155, v179
    v_mfma_f32_16x16x32_bf16 v[168:171], a[36:39], v[28:31], v[168:171]
    v_cvt_pk_bf16_f32 v192, v192, v193
    v_cvt_pk_bf16_f32 v193, v194, v195
    v_mfma_f32_16x16x32_bf16 v[172:175], a[40:43], v[20:23], v[172:175]
    v_cvt_pk_bf16_f32 v194, v196, v197
    v_cvt_pk_bf16_f32 v195, v198, v199
    v_mfma_f32_16x16x32_bf16 v[172:175], a[44:47], v[28:31], v[172:175]
    v_add_u32 v6, 0x8000, v6
    v_cvt_pk_bf16_f32 v208, v208, v209
    v_mfma_f32_16x16x32_bf16 v[184:187], a[48:51], v[20:23], v[184:187]
    v_permlane16_swap_b32 v192, v194
    v_mfma_f32_16x16x32_bf16 v[184:187], a[52:55], v[28:31], v[184:187]
    v_permlane16_swap_b32 v193, v195
    v_mfma_f32_16x16x32_bf16 v[188:191], a[56:59], v[20:23], v[188:191]
    v_accvgpr_write_b32 a160, v192
    v_accvgpr_write_b32 a161, v193
    v_mfma_f32_16x16x32_bf16 v[188:191], a[60:63], v[28:31], v[188:191]
    v_accvgpr_write_b32 a162, v194
    v_accvgpr_write_b32 a163, v195
    v_mfma_f32_16x16x32_bf16 v[200:203], a[64:67], v[20:23], v[200:203]
    buffer_load_dword a243, v9, s[76:79], s54 offen
    v_mfma_f32_16x16x32_bf16 v[200:203], a[68:71], v[28:31], v[200:203]
    s_add_u32 s54, s54, 65536
    v_cvt_pk_bf16_f32 v209, v210, v211
    v_cvt_pk_bf16_f32 v210, v212, v213
    v_mfma_f32_16x16x32_bf16 v[204:207], a[72:75], v[20:23], v[204:207]
    v_cvt_pk_bf16_f32 v211, v214, v215
    v_cvt_pk_bf16_f32 v224, v224, v225
    v_mfma_f32_16x16x32_bf16 v[204:207], a[76:79], v[28:31], v[204:207]
    v_permlane16_swap_b32 v208, v210
    v_mfma_f32_16x16x32_bf16 v[216:219], a[80:83], v[20:23], v[216:219]
    v_permlane16_swap_b32 v209, v211
    v_mfma_f32_16x16x32_bf16 v[216:219], a[84:87], v[28:31], v[216:219]
    v_accvgpr_write_b32 a168, v208
    v_accvgpr_write_b32 a169, v209
    v_mfma_f32_16x16x32_bf16 v[220:223], a[88:91], v[20:23], v[220:223]
    v_accvgpr_write_b32 a170, v210
    v_accvgpr_write_b32 a171, v211
    v_mfma_f32_16x16x32_bf16 v[220:223], a[92:95], v[28:31], v[220:223]
    v_cvt_pk_bf16_f32 v225, v226, v227
    v_cvt_pk_bf16_f32 v226, v228, v229
    v_mfma_f32_16x16x32_bf16 v[232:235], a[96:99], v[20:23], v[232:235]
    ds_read_b128 a[0:3], v3 offset:0
    v_cvt_pk_bf16_f32 v227, v230, v231
    v_cvt_pk_bf16_f32 v240, v240, v241
    v_mfma_f32_16x16x32_bf16 v[232:235], a[100:103], v[28:31], v[232:235]
    ds_read_b128 a[4:7], v3 offset:64
    v_permlane16_swap_b32 v224, v226
    v_mfma_f32_16x16x32_bf16 v[236:239], a[104:107], v[20:23], v[236:239]
    ds_read_b128 a[8:11], v3 offset:128
    v_permlane16_swap_b32 v225, v227
    v_mfma_f32_16x16x32_bf16 v[236:239], a[108:111], v[28:31], v[236:239]
    ds_read_b128 a[12:15], v3 offset:192
    v_accvgpr_write_b32 a176, v224
    v_accvgpr_write_b32 a177, v225
    v_mfma_f32_16x16x32_bf16 v[248:251], a[112:115], v[20:23], v[248:251]
    ds_read_b128 a[16:19], v3 offset:256
    v_accvgpr_write_b32 a178, v226
    v_accvgpr_write_b32 a179, v227
    v_mfma_f32_16x16x32_bf16 v[248:251], a[116:119], v[28:31], v[248:251]
    ds_read_b128 a[20:23], v3 offset:320
    v_cvt_pk_bf16_f32 v241, v242, v243
    v_cvt_pk_bf16_f32 v242, v244, v245
    v_mfma_f32_16x16x32_bf16 v[252:255], a[120:123], v[20:23], v[252:255]
    ds_read_b128 a[24:27], v3 offset:384
    v_cvt_pk_bf16_f32 v243, v246, v247
    v_cvt_pk_bf16_f32 v136, v136, v137
    v_mfma_f32_16x16x32_bf16 v[252:255], a[124:127], v[28:31], v[252:255]
    s_waitcnt lgkmcnt(6)
    ds_read_b128 a[28:31], v3 offset:448
    v_permlane16_swap_b32 v240, v242
    v_mfma_f32_16x16x32_bf16 v[16:19], a[0:3], a[128:131], 0
    s_waitcnt lgkmcnt(6)
    ds_read_b128 a[32:35], v3 offset:512
    v_permlane16_swap_b32 v241, v243
    v_mfma_f32_16x16x32_bf16 v[16:19], a[4:7], a[136:139], v[16:19]
    s_waitcnt lgkmcnt(6)
    ds_read_b128 a[36:39], v3 offset:576
    v_accvgpr_write_b32 a184, v240
    v_accvgpr_write_b32 a185, v241
    v_mfma_f32_16x16x32_bf16 v[16:19], a[8:11], a[144:147], v[16:19]
    s_waitcnt lgkmcnt(6)
    ds_read_b128 a[40:43], v3 offset:640
    v_accvgpr_write_b32 a186, v242
    v_accvgpr_write_b32 a187, v243
    v_mfma_f32_16x16x32_bf16 v[16:19], a[12:15], a[152:155], v[16:19]
    s_waitcnt lgkmcnt(6)
    ds_read_b128 a[44:47], v3 offset:704
    v_cvt_pk_bf16_f32 v137, v138, v139
    v_cvt_pk_bf16_f32 v138, v140, v141
    v_mfma_f32_16x16x32_bf16 v[16:19], a[16:19], a[160:163], v[16:19]
    s_waitcnt lgkmcnt(6)
    ds_read_b128 a[48:51], v3 offset:768
    v_cvt_pk_bf16_f32 v139, v142, v143
    v_cvt_pk_bf16_f32 v152, v152, v153
    v_mfma_f32_16x16x32_bf16 v[16:19], a[20:23], a[168:171], v[16:19]
    s_waitcnt lgkmcnt(6)
    ds_read_b128 a[52:55], v3 offset:832
    v_permlane16_swap_b32 v136, v138
    v_mfma_f32_16x16x32_bf16 v[16:19], a[24:27], a[176:179], v[16:19]
    s_waitcnt lgkmcnt(6)
    ds_read_b128 a[56:59], v3 offset:896
    v_permlane16_swap_b32 v137, v139
    v_mfma_f32_16x16x32_bf16 v[16:19], a[28:31], a[184:187], v[16:19]
    s_waitcnt lgkmcnt(6)
    ds_read_b128 a[60:63], v3 offset:960
    v_accvgpr_write_b32 a132, v136
    v_accvgpr_write_b32 a133, v137
    v_mfma_f32_16x16x32_bf16 v[20:23], a[32:35], a[128:131], 0
    s_waitcnt lgkmcnt(6)
    v_accvgpr_write_b32 a134, v138
    v_accvgpr_write_b32 a135, v139
    v_mfma_f32_16x16x32_bf16 v[20:23], a[36:39], a[136:139], v[20:23]
    s_waitcnt lgkmcnt(5)
    v_cvt_pk_bf16_f32 v153, v154, v155
    v_cvt_pk_bf16_f32 v154, v156, v157
    v_mfma_f32_16x16x32_bf16 v[20:23], a[40:43], a[144:147], v[20:23]
    s_waitcnt lgkmcnt(4)
    v_cvt_pk_bf16_f32 v155, v158, v159
    v_cvt_pk_bf16_f32 v168, v168, v169
    v_mfma_f32_16x16x32_bf16 v[20:23], a[44:47], a[152:155], v[20:23]
    s_waitcnt lgkmcnt(3)
    v_permlane16_swap_b32 v152, v154
    v_mfma_f32_16x16x32_bf16 v[20:23], a[48:51], a[160:163], v[20:23]
    s_waitcnt lgkmcnt(2)
    v_permlane16_swap_b32 v153, v155
    v_mfma_f32_16x16x32_bf16 v[20:23], a[52:55], a[168:171], v[20:23]
    s_waitcnt lgkmcnt(1)
    v_accvgpr_write_b32 a140, v152
    v_accvgpr_write_b32 a141, v153
    v_cvt_pk_bf16_f32 v169, v170, v171
    v_cvt_pk_bf16_f32 v170, v172, v173
    v_cvt_pk_bf16_f32 v171, v174, v175
    v_mfma_f32_16x16x32_bf16 v[20:23], a[56:59], a[176:179], v[20:23]
    s_waitcnt lgkmcnt(0)
    v_accvgpr_write_b32 a142, v154
    v_accvgpr_write_b32 a143, v155
    v_cvt_pk_bf16_f32 v184, v184, v185
    v_cvt_pk_bf16_f32 v185, v186, v187
    v_cvt_pk_bf16_f32 v186, v188, v189
    v_cvt_pk_bf16_f32 v187, v190, v191
    v_mfma_f32_16x16x32_bf16 v[20:23], a[60:63], a[184:187], v[20:23]
    v_permlane16_swap_b32 v168, v170
    v_permlane16_swap_b32 v169, v171
    v_cvt_pk_bf16_f32 v200, v200, v201
    v_cvt_pk_bf16_f32 v201, v202, v203
    v_cvt_pk_bf16_f32 v202, v204, v205
    v_cvt_pk_bf16_f32 v203, v206, v207
    v_mfma_f32_16x16x32_bf16 v[24:27], a[0:3], a[132:135], 0
    v_accvgpr_write_b32 a148, v168
    v_accvgpr_write_b32 a149, v169
    v_accvgpr_write_b32 a150, v170
    v_accvgpr_write_b32 a151, v171
    v_permlane16_swap_b32 v184, v186
    v_permlane16_swap_b32 v185, v187
    v_cvt_pk_bf16_f32 v216, v216, v217
    v_cvt_pk_bf16_f32 v217, v218, v219
    v_cvt_pk_bf16_f32 v218, v220, v221
    v_cvt_pk_bf16_f32 v219, v222, v223
    v_mfma_f32_16x16x32_bf16 v[24:27], a[4:7], a[140:143], v[24:27]
    v_lshrrev_b32 v110, 4, v8
    v_lshl_add_u32 v110, s48, 6, v110
    v_accvgpr_write_b32 a156, v184
    v_accvgpr_write_b32 a157, v185
    v_accvgpr_write_b32 a158, v186
    v_accvgpr_write_b32 a159, v187
    v_permlane16_swap_b32 v200, v202
    v_permlane16_swap_b32 v201, v203
    v_cvt_pk_bf16_f32 v232, v232, v233
    v_cvt_pk_bf16_f32 v233, v234, v235
    v_cvt_pk_bf16_f32 v234, v236, v237
    v_cvt_pk_bf16_f32 v235, v238, v239
    v_mfma_f32_16x16x32_bf16 v[24:27], a[8:11], a[148:151], v[24:27]
    v_mul_u32_u24 v110, 5376, v110
    v_add_u32 v111, 1376256, v110
    v_accvgpr_write_b32 a164, v200
    v_accvgpr_write_b32 a165, v201
    v_accvgpr_write_b32 a166, v202
    v_accvgpr_write_b32 a167, v203
    v_permlane16_swap_b32 v216, v218
    v_permlane16_swap_b32 v217, v219
    v_cvt_pk_bf16_f32 v248, v248, v249
    v_cvt_pk_bf16_f32 v249, v250, v251
    v_cvt_pk_bf16_f32 v250, v252, v253
    v_cvt_pk_bf16_f32 v251, v254, v255
    v_mfma_f32_16x16x32_bf16 v[24:27], a[12:15], a[156:159], v[24:27]
    buffer_load_dwordx4 v[112:115], v110, s[96:99], 0 offen
    v_accvgpr_write_b32 a172, v216
    v_accvgpr_write_b32 a173, v217
    v_accvgpr_write_b32 a174, v218
    v_accvgpr_write_b32 a175, v219
    v_permlane16_swap_b32 v232, v234
    v_permlane16_swap_b32 v233, v235
    v_mfma_f32_16x16x32_bf16 v[24:27], a[16:19], a[164:167], v[24:27]
    buffer_load_dwordx4 v[116:119], v111, s[96:99], 0 offen
    v_accvgpr_write_b32 a180, v232
    v_accvgpr_write_b32 a181, v233
    v_accvgpr_write_b32 a182, v234
    v_accvgpr_write_b32 a183, v235
    v_permlane16_swap_b32 v248, v250
    v_permlane16_swap_b32 v249, v251
    v_mfma_f32_16x16x32_bf16 v[24:27], a[20:23], a[172:175], v[24:27]
    v_accvgpr_read_b32 v92, a250
    v_accvgpr_read_b32 v94, a251
    v_accvgpr_write_b32 a188, v248
    v_accvgpr_write_b32 a189, v249
    v_accvgpr_write_b32 a190, v250
    v_accvgpr_write_b32 a191, v251
    v_mfma_f32_16x16x32_bf16 v[24:27], a[24:27], a[180:183], v[24:27]
    ds_read_b128 a[64:67], v3 offset:17024
    ds_read_b128 a[68:71], v3 offset:17088
    v_mfma_f32_16x16x32_bf16 v[24:27], a[28:31], a[188:191], v[24:27]
    ds_read_b128 a[72:75], v3 offset:17152
    v_max3_f32 v92, v16, v17, v92
    v_mfma_f32_16x16x32_bf16 v[28:31], a[32:35], a[132:135], 0
    ds_read_b128 a[76:79], v3 offset:17216
    v_max3_f32 v92, v92, v18, v19
    v_max3_f32 v92, v92, v20, v21
    v_max3_f32 v92, v92, v22, v23
    v_mov_b32 v93, v92
    v_mfma_f32_16x16x32_bf16 v[28:31], a[36:39], a[140:143], v[28:31]
    ds_read_b128 a[80:83], v3 offset:17280
    v_accvgpr_read_b32 v108, a230
    v_mfma_f32_16x16x32_bf16 v[28:31], a[40:43], a[148:151], v[28:31]
    ds_read_b128 a[84:87], v3 offset:17344
    v_max3_f32 v94, v24, v25, v94
    v_permlane32_swap_b32 v92, v93
    v_mfma_f32_16x16x32_bf16 v[28:31], a[44:47], a[156:159], v[28:31]
    ds_read_b128 a[88:91], v3 offset:17408
    v_max_f32 v92, v92, v93
    v_mov_b32 v93, v92
    v_mfma_f32_16x16x32_bf16 v[28:31], a[48:51], a[164:167], v[28:31]
    ds_read_b128 a[92:95], v3 offset:17472
    v_max3_f32 v94, v94, v26, v27
    v_mfma_f32_16x16x32_bf16 v[28:31], a[52:55], a[172:175], v[28:31]
    ds_read_b128 a[96:99], v3 offset:17536
    v_accvgpr_read_b32 v109, a231
    v_permlane16_swap_b32 v92, v93
    v_mfma_f32_16x16x32_bf16 v[28:31], a[56:59], a[180:183], v[28:31]
    s_waitcnt lgkmcnt(1)
    ds_read_b128 a[100:103], v3 offset:17600
    v_max_f32 v92, v92, v93
    v_sub_f32 v80, 0, v92
    v_sub_f32 v81, 0, v92
    v_sub_f32 v82, 0, v92
    v_sub_f32 v83, 0, v92
    v_mfma_f32_16x16x32_bf16 v[28:31], a[60:63], a[188:191], v[28:31]
    s_waitcnt lgkmcnt(9)
    ds_read_b128 a[104:107], v3 offset:17664
    ds_read_b128 a[108:111], v3 offset:17728
    v_mfma_f32_16x16x32_bf16 v[32:35], a[64:67], a[128:131], v[80:83]
    s_waitcnt lgkmcnt(10)
    ds_read_b128 a[112:115], v3 offset:17792
    ds_read_b128 a[116:119], v3 offset:17856
    v_mfma_f32_16x16x32_bf16 v[32:35], a[68:71], a[136:139], v[32:35]
    s_waitcnt lgkmcnt(11)
    ds_read_b128 a[120:123], v3 offset:17920
    ds_read_b128 a[124:127], v3 offset:17984
    v_add_f32 v16, v16, v80
    v_mfma_f32_16x16x32_bf16 v[32:35], a[72:75], a[144:147], v[32:35]
    s_waitcnt lgkmcnt(12)
    v_add_f32 v17, v17, v80
    v_max3_f32 v94, v94, v28, v29
    v_mfma_f32_16x16x32_bf16 v[32:35], a[76:79], a[152:155], v[32:35]
    s_waitcnt lgkmcnt(11)
    v_exp_f32 v16, v16
    v_mfma_f32_16x16x32_bf16 v[32:35], a[80:83], a[160:163], v[32:35]
    s_waitcnt lgkmcnt(10)
    v_exp_f32 v17, v17
    v_mfma_f32_16x16x32_bf16 v[32:35], a[84:87], a[168:171], v[32:35]
    s_waitcnt lgkmcnt(9)
    v_add_f32 v88, v88, v16
    v_add_f32 v89, v89, v17
    v_mfma_f32_16x16x32_bf16 v[32:35], a[88:91], a[176:179], v[32:35]
    s_add_u32 m0, s40, 68096
    v_max3_f32 v94, v94, v30, v31
    v_mov_b32 v95, v94
    v_mfma_f32_16x16x32_bf16 v[32:35], a[92:95], a[184:187], v[32:35]
    s_waitcnt lgkmcnt(7)
    v_cvt_pk_bf16_f32 v16, v16, v17
    v_add_f32 v18, v18, v80
    v_mfma_f32_16x16x32_bf16 v[36:39], a[96:99], a[128:131], v[80:83]
    s_waitcnt vmcnt(3) lgkmcnt(0)
    v_permlane32_swap_b32 v94, v95
    v_mfma_f32_16x16x32_bf16 v[36:39], a[100:103], a[136:139], v[36:39]
    s_barrier
    v_add_f32 v19, v19, v80
    v_max_f32 v94, v94, v95
    v_mfma_f32_16x16x32_bf16 v[36:39], a[104:107], a[144:147], v[36:39]
    ds_read_b128 a[0:3], v2 offset:0
    v_mov_b32 v95, v94
    v_mfma_f32_16x16x32_bf16 v[36:39], a[108:111], a[152:155], v[36:39]
    v_exp_f32 v18, v18
    v_mfma_f32_16x16x32_bf16 v[36:39], a[112:115], a[160:163], v[36:39]
    v_exp_f32 v19, v19
    v_mfma_f32_16x16x32_bf16 v[36:39], a[116:119], a[168:171], v[36:39]
    v_permlane16_swap_b32 v94, v95
    v_mfma_f32_16x16x32_bf16 v[36:39], a[120:123], a[176:179], v[36:39]
    v_add_f32 v88, v88, v18
    v_max_f32 v94, v94, v95
    v_sub_f32 v84, 0, v94
    v_sub_f32 v85, 0, v94
    v_sub_f32 v86, 0, v94
    v_sub_f32 v87, 0, v94
    v_mfma_f32_16x16x32_bf16 v[36:39], a[124:127], a[184:187], v[36:39]
    v_add_f32 v89, v89, v19
    v_cvt_pk_bf16_f32 v17, v18, v19
    v_mfma_f32_16x16x32_bf16 v[40:43], a[64:67], a[132:135], v[84:87]
    ds_read_b128 a[4:7], v2 offset:64
    v_add_f32 v20, v20, v80
    v_mfma_f32_16x16x32_bf16 v[40:43], a[68:71], a[140:143], v[40:43]
    buffer_load_dwordx4 v6, s[4:7], s24 offen offset:0 lds
    v_mfma_f32_16x16x32_bf16 v[40:43], a[72:75], a[148:151], v[40:43]
    ds_read_b128 a[8:11], v2 offset:128
    v_add_f32 v21, v21, v80
    v_mfma_f32_16x16x32_bf16 v[40:43], a[76:79], a[156:159], v[40:43]
    v_exp_f32 v20, v20
    v_mfma_f32_16x16x32_bf16 v[40:43], a[80:83], a[164:167], v[40:43]
    v_exp_f32 v21, v21
    v_mfma_f32_16x16x32_bf16 v[40:43], a[84:87], a[172:175], v[40:43]
    ds_read_b128 a[12:15], v2 offset:192
    v_add_f32 v88, v88, v20
    v_mfma_f32_16x16x32_bf16 v[40:43], a[88:91], a[180:183], v[40:43]
    buffer_load_dwordx4 v6, s[4:7], s25 offen offset:1024 lds
    v_mfma_f32_16x16x32_bf16 v[40:43], a[92:95], a[188:191], v[40:43]
    v_add_f32 v89, v89, v21
    v_cvt_pk_bf16_f32 v18, v20, v21
    v_mfma_f32_16x16x32_bf16 v[44:47], a[96:99], a[132:135], v[84:87]
    ds_read_b128 a[16:19], v2 offset:256
    v_add_f32 v22, v22, v80
    v_mfma_f32_16x16x32_bf16 v[44:47], a[100:103], a[140:143], v[44:47]
    ds_read_b128 a[20:23], v2 offset:320
    v_add_f32 v23, v23, v80
    v_mfma_f32_16x16x32_bf16 v[44:47], a[104:107], a[148:151], v[44:47]
    buffer_load_dwordx4 v6, s[4:7], s26 offen offset:2064 lds
    v_mfma_f32_16x16x32_bf16 v[44:47], a[108:111], a[156:159], v[44:47]
    v_exp_f32 v22, v22
    v_mfma_f32_16x16x32_bf16 v[44:47], a[112:115], a[164:167], v[44:47]
    v_exp_f32 v23, v23
    v_mfma_f32_16x16x32_bf16 v[44:47], a[116:119], a[172:175], v[44:47]
    ds_read_b128 a[24:27], v2 offset:384
    v_add_f32 v88, v88, v22
    v_mfma_f32_16x16x32_bf16 v[44:47], a[120:123], a[180:183], v[44:47]
    ds_read_b128 a[28:31], v2 offset:448
    v_add_f32 v89, v89, v23
    v_mfma_f32_16x16x32_bf16 v[44:47], a[124:127], a[188:191], v[44:47]
    s_waitcnt lgkmcnt(4)
    buffer_load_dwordx4 v6, s[4:7], s27 offen offset:3088 lds
    v_mfma_f32_16x16x32_bf16 v[48:51], a[0:3], a[128:131], v[80:83]
    s_add_u32 m0, s40, 85120
    v_cvt_pk_bf16_f32 v19, v22, v23
    v_add_f32 v24, v24, v84
    v_mfma_f32_16x16x32_bf16 v[48:51], a[4:7], a[136:139], v[48:51]
    ds_read_b128 a[32:35], v2 offset:512
    v_add_f32 v25, v25, v84
    v_mfma_f32_16x16x32_bf16 v[48:51], a[8:11], a[144:147], v[48:51]
    s_waitcnt vmcnt(5)
    ds_read_b128 a[36:39], v2 offset:576
    v_lshlrev_b32 v110, 16, v112
    v_mfma_f32_16x16x32_bf16 v[48:51], a[12:15], a[152:155], v[48:51]
    s_waitcnt lgkmcnt(4)
    v_exp_f32 v24, v24
    v_mfma_f32_16x16x32_bf16 v[48:51], a[16:19], a[160:163], v[48:51]
    buffer_load_dwordx4 v6, s[4:7], s28 offen offset:0 lds
    v_mfma_f32_16x16x32_bf16 v[48:51], a[20:23], a[168:171], v[48:51]
    s_waitcnt lgkmcnt(3)
    v_exp_f32 v25, v25
    v_mfma_f32_16x16x32_bf16 v[48:51], a[24:27], a[176:179], v[48:51]
    s_waitcnt lgkmcnt(2)
    ds_read_b128 a[40:43], v2 offset:640
    v_add_f32 v90, v90, v24
    v_mfma_f32_16x16x32_bf16 v[48:51], a[28:31], a[184:187], v[48:51]
    v_mul_f32 v120, v110, v108
    v_add_f32 v91, v91, v25
    v_mfma_f32_16x16x32_bf16 v[56:59], a[0:3], a[132:135], v[84:87]
    ds_read_b128 a[44:47], v2 offset:704
    v_cvt_pk_bf16_f32 v24, v24, v25
    v_mfma_f32_16x16x32_bf16 v[56:59], a[4:7], a[140:143], v[56:59]
    buffer_load_dwordx4 v6, s[4:7], s29 offen offset:1024 lds
    v_mfma_f32_16x16x32_bf16 v[56:59], a[8:11], a[148:151], v[56:59]
    v_and_b32 v111, 0xffff0000, v112
    v_add_f32 v26, v26, v84
    v_mfma_f32_16x16x32_bf16 v[56:59], a[12:15], a[156:159], v[56:59]
    ds_read_b128 a[48:51], v2 offset:768
    v_add_f32 v27, v27, v84
    v_mfma_f32_16x16x32_bf16 v[56:59], a[16:19], a[164:167], v[56:59]
    ds_read_b128 a[52:55], v2 offset:832
    v_mul_f32 v121, v111, v108
    v_mfma_f32_16x16x32_bf16 v[56:59], a[20:23], a[172:175], v[56:59]
    v_exp_f32 v26, v26
    v_mfma_f32_16x16x32_bf16 v[56:59], a[24:27], a[180:183], v[56:59]
    ds_read_b128 a[56:59], v2 offset:896
    v_exp_f32 v27, v27
    v_mfma_f32_16x16x32_bf16 v[56:59], a[28:31], a[188:191], v[56:59]
    s_waitcnt lgkmcnt(5)
    buffer_load_dwordx4 v6, s[4:7], s30 offen offset:2064 lds
    ds_read_b128 a[60:63], v2 offset:960
    v_mfma_f32_16x16x32_bf16 v[52:55], a[32:35], a[128:131], v[80:83]
    s_waitcnt lgkmcnt(2)
    v_lshlrev_b32 v110, 16, v113
    v_add_f32 v90, v90, v26
    v_mfma_f32_16x16x32_bf16 v[52:55], a[36:39], a[136:139], v[52:55]
    s_waitcnt lgkmcnt(5)
    v_add_f32 v91, v91, v27
    v_mul_f32 v122, v110, v108
    v_mfma_f32_16x16x32_bf16 v[52:55], a[40:43], a[144:147], v[52:55]
    s_waitcnt lgkmcnt(4)
    v_cvt_pk_bf16_f32 v25, v26, v27
    v_add_f32 v28, v28, v84
    v_mfma_f32_16x16x32_bf16 v[52:55], a[44:47], a[152:155], v[52:55]
    s_waitcnt lgkmcnt(3)
    buffer_load_dwordx4 v6, s[4:7], s31 offen offset:3088 lds
    v_mfma_f32_16x16x32_bf16 v[52:55], a[48:51], a[160:163], v[52:55]
    s_add_u32 m0, s41, 102144
    v_and_b32 v111, 0xffff0000, v113
    v_add_f32 v29, v29, v84
    v_mfma_f32_16x16x32_bf16 v[52:55], a[52:55], a[168:171], v[52:55]
    s_waitcnt lgkmcnt(1)
    ds_read_b128 a[64:67], v2 offset:17024
    v_mul_f32 v123, v111, v108
    v_mfma_f32_16x16x32_bf16 v[52:55], a[56:59], a[176:179], v[52:55]
    s_waitcnt lgkmcnt(1)
    v_exp_f32 v28, v28
    v_mfma_f32_16x16x32_bf16 v[52:55], a[60:63], a[184:187], v[52:55]
    ds_read_b128 a[68:71], v2 offset:17088
    v_add_f32 v90, v90, v28
    v_mfma_f32_16x16x32_bf16 v[60:63], a[32:35], a[132:135], v[84:87]
    v_exp_f32 v29, v29
    v_mfma_f32_16x16x32_bf16 v[60:63], a[36:39], a[140:143], v[60:63]
    buffer_load_dwordx4 v6, s[8:11], s32 offen offset:0 lds
    v_mfma_f32_16x16x32_bf16 v[60:63], a[40:43], a[148:151], v[60:63]
    ds_read_b128 a[72:75], v2 offset:17152
    v_lshlrev_b32 v110, 16, v114
    v_mfma_f32_16x16x32_bf16 v[60:63], a[44:47], a[156:159], v[60:63]
    ds_read_b128 a[76:79], v2 offset:17216
    v_add_f32 v91, v91, v29
    v_cvt_pk_bf16_f32 v26, v28, v29
    v_mfma_f32_16x16x32_bf16 v[60:63], a[48:51], a[164:167], v[60:63]
    ds_read_b128 a[80:83], v2 offset:17280
    v_mul_f32 v124, v110, v108
    v_add_f32 v30, v30, v84
    v_mfma_f32_16x16x32_bf16 v[60:63], a[52:55], a[172:175], v[60:63]
    ds_read_b128 a[84:87], v2 offset:17344
    v_add_f32 v31, v31, v84
    v_and_b32 v111, 0xffff0000, v114
    v_mfma_f32_16x16x32_bf16 v[60:63], a[56:59], a[180:183], v[60:63]
    buffer_load_dwordx4 v6, s[8:11], s33 offen offset:1024 lds
    ds_read_b128 a[88:91], v2 offset:17408
    v_mfma_f32_16x16x32_bf16 v[60:63], a[60:63], a[188:191], v[60:63]
    s_waitcnt lgkmcnt(6)
    ds_read_b128 a[92:95], v2 offset:17472
    v_exp_f32 v30, v30
    v_mfma_f32_16x16x32_bf16 v[64:67], a[64:67], a[128:131], v[80:83]
    s_waitcnt lgkmcnt(6)
    v_exp_f32 v31, v31
    v_mfma_f32_16x16x32_bf16 v[64:67], a[68:71], a[136:139], v[64:67]
    s_waitcnt lgkmcnt(5)
    v_mul_f32 v125, v111, v108
    v_add_f32 v90, v90, v30
    v_mfma_f32_16x16x32_bf16 v[64:67], a[72:75], a[144:147], v[64:67]
    s_waitcnt lgkmcnt(4)
    v_add_f32 v91, v91, v31
    v_lshlrev_b32 v110, 16, v115
    v_mfma_f32_16x16x32_bf16 v[64:67], a[76:79], a[152:155], v[64:67]
    s_waitcnt lgkmcnt(3)
    buffer_load_dwordx4 v6, s[8:11], s34 offen offset:2176 lds
    v_mfma_f32_16x16x32_bf16 v[64:67], a[80:83], a[160:163], v[64:67]
    s_waitcnt lgkmcnt(2)
    v_cvt_pk_bf16_f32 v27, v30, v31
    v_mul_f32 v126, v110, v108
    v_mfma_f32_16x16x32_bf16 v[64:67], a[84:87], a[168:171], v[64:67]
    s_waitcnt lgkmcnt(1)
    v_exp_f32 v32, v32
    v_mfma_f32_16x16x32_bf16 v[64:67], a[88:91], a[176:179], v[64:67]
    s_waitcnt lgkmcnt(0)
    v_exp_f32 v33, v33
    v_mfma_f32_16x16x32_bf16 v[64:67], a[92:95], a[184:187], v[64:67]
    v_add_f32 v88, v88, v32
    v_and_b32 v111, 0xffff0000, v115
    v_mfma_f32_16x16x32_bf16 v[72:75], a[64:67], a[132:135], v[84:87]
    buffer_load_dwordx4 v6, s[8:11], s35 offen offset:3200 lds
    ds_read_b128 a[96:99], v2 offset:17536
    v_mfma_f32_16x16x32_bf16 v[72:75], a[68:71], a[140:143], v[72:75]
    s_add_u32 m0, s41, 119168
    ds_read_b128 a[100:103], v2 offset:17600
    v_add_f32 v89, v89, v33
    v_mfma_f32_16x16x32_bf16 v[72:75], a[72:75], a[148:151], v[72:75]
    ds_read_b128 a[104:107], v2 offset:17664
    v_cvt_pk_bf16_f32 v32, v32, v33
    v_mul_f32 v127, v111, v108
    v_mfma_f32_16x16x32_bf16 v[72:75], a[76:79], a[156:159], v[72:75]
    ds_read_b128 a[108:111], v2 offset:17728
    v_exp_f32 v34, v34
    v_mfma_f32_16x16x32_bf16 v[72:75], a[80:83], a[164:167], v[72:75]
    ds_read_b128 a[112:115], v2 offset:17792
    v_exp_f32 v35, v35
    v_mfma_f32_16x16x32_bf16 v[72:75], a[84:87], a[172:175], v[72:75]
    buffer_load_dwordx4 v6, s[8:11], s36 offen offset:0 lds
    ds_read_b128 a[116:119], v2 offset:17856
    v_mfma_f32_16x16x32_bf16 v[72:75], a[88:91], a[180:183], v[72:75]
    s_waitcnt vmcnt(13)
    ds_read_b128 a[120:123], v2 offset:17920
    v_lshlrev_b32 v110, 16, v116
    v_add_f32 v88, v88, v34
    v_mfma_f32_16x16x32_bf16 v[72:75], a[92:95], a[188:191], v[72:75]
    s_waitcnt lgkmcnt(6)
    ds_read_b128 a[124:127], v2 offset:17984
    v_add_f32 v89, v89, v35
    v_fmac_f32 v120, v110, v109
    v_mfma_f32_16x16x32_bf16 v[68:71], a[96:99], a[128:131], v[80:83]
    s_waitcnt lgkmcnt(6)
    v_cvt_pk_bf16_f32 v33, v34, v35
    v_and_b32 v111, 0xffff0000, v116
    v_mfma_f32_16x16x32_bf16 v[68:71], a[100:103], a[136:139], v[68:71]
    s_waitcnt lgkmcnt(5)
    v_exp_f32 v36, v36
    v_mfma_f32_16x16x32_bf16 v[68:71], a[104:107], a[144:147], v[68:71]
    s_waitcnt lgkmcnt(4)
    buffer_load_dwordx4 v6, s[8:11], s37 offen offset:1024 lds
    v_mfma_f32_16x16x32_bf16 v[68:71], a[108:111], a[152:155], v[68:71]
    s_waitcnt lgkmcnt(3)
    v_exp_f32 v48, v48
    v_mfma_f32_16x16x32_bf16 v[68:71], a[112:115], a[160:163], v[68:71]
    s_waitcnt lgkmcnt(2)
    v_exp_f32 v37, v37
    v_mfma_f32_16x16x32_bf16 v[68:71], a[116:119], a[168:171], v[68:71]
    s_waitcnt lgkmcnt(1)
    v_exp_f32 v49, v49
    v_mfma_f32_16x16x32_bf16 v[68:71], a[120:123], a[176:179], v[68:71]
    s_waitcnt lgkmcnt(0)
    v_add_f32 v88, v88, v36
    v_fmac_f32 v121, v111, v109
    v_mfma_f32_16x16x32_bf16 v[68:71], a[124:127], a[184:187], v[68:71]
    v_add_f32 v89, v89, v37
    v_cvt_pk_bf16_f32 v34, v36, v37
    v_mfma_f32_16x16x32_bf16 v[76:79], a[96:99], a[132:135], v[84:87]
    buffer_load_dwordx4 v6, s[8:11], s38 offen offset:2176 lds
    ds_read_b64_tr_b16 a[0:1], v1 offset:34048
    ds_read_b64_tr_b16 a[2:3], v1 offset:34560
    v_mfma_f32_16x16x32_bf16 v[76:79], a[100:103], a[140:143], v[76:79]
    ds_read_b64_tr_b16 a[4:5], v1 offset:51072
    ds_read_b64_tr_b16 a[6:7], v1 offset:51584
    v_lshlrev_b32 v110, 16, v117
    v_fmac_f32 v122, v110, v109
    v_mfma_f32_16x16x32_bf16 v[76:79], a[104:107], a[148:151], v[76:79]
    v_exp_f32 v38, v38
    v_mfma_f32_16x16x32_bf16 v[76:79], a[108:111], a[156:159], v[76:79]
    v_exp_f32 v39, v39
    v_mfma_f32_16x16x32_bf16 v[76:79], a[112:115], a[164:167], v[76:79]
    ds_read_b64_tr_b16 a[8:9], v1 offset:34080
    ds_read_b64_tr_b16 a[10:11], v1 offset:34592
    v_add_f32 v88, v88, v38
    v_add_f32 v88, v88, v48
    v_mfma_f32_16x16x32_bf16 v[76:79], a[116:119], a[172:175], v[76:79]
    ds_read_b64_tr_b16 a[12:13], v1 offset:51104
    ds_read_b64_tr_b16 a[14:15], v1 offset:51616
    v_cvt_pk_bf16_f32 v48, v48, v49
    v_add_f32 v89, v89, v39
    v_mfma_f32_16x16x32_bf16 v[76:79], a[120:123], a[180:183], v[76:79]
    v_add_f32 v89, v89, v49
    v_and_b32 v111, 0xffff0000, v117
    v_mfma_f32_16x16x32_bf16 v[76:79], a[124:127], a[188:191], v[76:79]
    s_waitcnt lgkmcnt(6)
    buffer_load_dwordx4 v6, s[8:11], s39 offen offset:3200 lds
    v_cvt_pk_bf16_f32 v35, v38, v39
    v_mfma_f32_16x16x32_bf16 v[128:131], a[0:3], v[16:19], 0
    s_waitcnt lgkmcnt(4)
    ds_read_b64_tr_b16 a[16:17], v1 offset:34112
    ds_read_b64_tr_b16 a[18:19], v1 offset:34624
    v_exp_f32 v50, v50
    v_exp_f32 v40, v40
    v_exp_f32 v41, v41
    v_exp_f32 v42, v42
    v_exp_f32 v43, v43
    v_exp_f32 v44, v44
    v_exp_f32 v45, v45
    v_exp_f32 v46, v46
    v_exp_f32 v47, v47
    v_mfma_f32_16x16x32_bf16 v[128:131], a[4:7], v[32:35], v[128:131]
    ds_read_b64_tr_b16 a[20:21], v1 offset:51136
    ds_read_b64_tr_b16 a[22:23], v1 offset:51648
    v_exp_f32 v51, v51
    v_add_f32 v90, v90, v40
    v_add_f32 v91, v91, v41
    v_cvt_pk_bf16_f32 v40, v40, v41
    v_add_f32 v90, v90, v42
    v_add_f32 v91, v91, v43
    v_cvt_pk_bf16_f32 v41, v42, v43
    v_cvt_pk_bf16_f32 v42, v44, v45
    v_cvt_pk_bf16_f32 v43, v46, v47
    v_mfma_f32_16x16x32_bf16 v[136:139], a[0:3], v[24:27], 0
    v_add_u32 v6, 0x8000, v6
    v_fmac_f32 v123, v111, v109
    v_mfma_f32_16x16x32_bf16 v[136:139], a[4:7], v[40:43], v[136:139]
    s_waitcnt lgkmcnt(6)
    v_add_f32 v88, v88, v50
    v_lshlrev_b32 v110, 16, v118
    v_mfma_f32_16x16x32_bf16 v[132:135], a[8:11], v[16:19], 0
    s_waitcnt lgkmcnt(4)
    ds_read_b64_tr_b16 a[24:25], v1 offset:34144
    ds_read_b64_tr_b16 a[26:27], v1 offset:34656
    v_add_f32 v89, v89, v51
    v_fmac_f32 v124, v110, v109
    v_mfma_f32_16x16x32_bf16 v[132:135], a[12:15], v[32:35], v[132:135]
    ds_read_b64_tr_b16 a[28:29], v1 offset:51168
    ds_read_b64_tr_b16 a[30:31], v1 offset:51680
    v_cvt_pk_bf16_f32 v49, v50, v51
    v_and_b32 v111, 0xffff0000, v118
    v_mfma_f32_16x16x32_bf16 v[140:143], a[8:11], v[24:27], 0
    v_exp_f32 v56, v56
    v_mfma_f32_16x16x32_bf16 v[140:143], a[12:15], v[40:43], v[140:143]
    s_waitcnt lgkmcnt(6)
    v_exp_f32 v57, v57
    v_mfma_f32_16x16x32_bf16 v[144:147], a[16:19], v[16:19], 0
    s_waitcnt lgkmcnt(4)
    ds_read_b64_tr_b16 a[32:33], v1 offset:34176
    ds_read_b64_tr_b16 a[34:35], v1 offset:34688
    v_fmac_f32 v125, v111, v109
    v_lshlrev_b32 v110, 16, v119
    v_mfma_f32_16x16x32_bf16 v[144:147], a[20:23], v[32:35], v[144:147]
    ds_read_b64_tr_b16 a[36:37], v1 offset:51200
    ds_read_b64_tr_b16 a[38:39], v1 offset:51712
    v_add_f32 v90, v90, v44
    v_fmac_f32 v126, v110, v109
    v_mfma_f32_16x16x32_bf16 v[152:155], a[16:19], v[24:27], 0
    v_add_f32 v91, v91, v45
    v_and_b32 v111, 0xffff0000, v119
    v_mfma_f32_16x16x32_bf16 v[152:155], a[20:23], v[40:43], v[152:155]
    s_waitcnt lgkmcnt(6)
    v_exp_f32 v58, v58
    v_mfma_f32_16x16x32_bf16 v[148:151], a[24:27], v[16:19], 0
    s_waitcnt lgkmcnt(4)
    ds_read_b64_tr_b16 a[40:41], v1 offset:34208
    ds_read_b64_tr_b16 a[42:43], v1 offset:34720
    v_exp_f32 v59, v59
    v_mfma_f32_16x16x32_bf16 v[148:151], a[28:31], v[32:35], v[148:151]
    ds_read_b64_tr_b16 a[44:45], v1 offset:51232
    ds_read_b64_tr_b16 a[46:47], v1 offset:51744
    v_fmac_f32 v127, v111, v109
    v_add_f32 v90, v90, v46
    v_mfma_f32_16x16x32_bf16 v[156:159], a[24:27], v[24:27], 0
    v_add_f32 v90, v90, v56
    v_cvt_pk_bf16_f32 v56, v56, v57
    v_mfma_f32_16x16x32_bf16 v[156:159], a[28:31], v[40:43], v[156:159]
    s_waitcnt lgkmcnt(6)
    v_add_f32 v90, v90, v58
    v_add_f32 v91, v91, v47
    v_mfma_f32_16x16x32_bf16 v[160:163], a[32:35], v[16:19], 0
    s_waitcnt lgkmcnt(4)
    ds_read_b64_tr_b16 a[48:49], v1 offset:34240
    ds_read_b64_tr_b16 a[50:51], v1 offset:34752
    v_add_f32 v91, v91, v57
    v_lshrrev_b32 v110, 3, v8
    v_mfma_f32_16x16x32_bf16 v[160:163], a[36:39], v[32:35], v[160:163]
    ds_read_b64_tr_b16 a[52:53], v1 offset:51264
    ds_read_b64_tr_b16 a[54:55], v1 offset:51776
    v_add_f32 v91, v91, v59
    v_and_b32 v110, 0x60, v110
    v_mfma_f32_16x16x32_bf16 v[168:171], a[32:35], v[24:27], 0
    v_cvt_pk_bf16_f32 v57, v58, v59
    v_add_u32 v110, s56, v110
    v_mfma_f32_16x16x32_bf16 v[168:171], a[36:39], v[40:43], v[168:171]
    s_waitcnt lgkmcnt(6)
    v_exp_f32 v52, v52
    v_mfma_f32_16x16x32_bf16 v[164:167], a[40:43], v[16:19], 0
    s_waitcnt lgkmcnt(4)
    ds_read_b64_tr_b16 a[56:57], v1 offset:34272
    ds_read_b64_tr_b16 a[58:59], v1 offset:34784
    v_exp_f32 v53, v53
    v_mfma_f32_16x16x32_bf16 v[164:167], a[44:47], v[32:35], v[164:167]
    ds_read_b64_tr_b16 a[60:61], v1 offset:51296
    ds_read_b64_tr_b16 a[62:63], v1 offset:51808
    v_and_b32 v111, 0x70, v8
    v_add_f32 v88, v88, v52
    v_mfma_f32_16x16x32_bf16 v[172:175], a[40:43], v[24:27], 0
    v_add_u32 v111, 156864, v111
    v_add_f32 v89, v89, v53
    v_mfma_f32_16x16x32_bf16 v[172:175], a[44:47], v[40:43], v[172:175]
    s_waitcnt lgkmcnt(6)
    ds_read_b64_tr_b16 a[64:65], v1 offset:34304
    ds_read_b64_tr_b16 a[66:67], v1 offset:34816
    v_mfma_f32_16x16x32_bf16 v[176:179], a[48:51], v[16:19], 0
    s_waitcnt lgkmcnt(6)
    v_permlane32_swap_b32 v120, v124
    v_mfma_f32_16x16x32_bf16 v[176:179], a[52:55], v[32:35], v[176:179]
    ds_read_b64_tr_b16 a[68:69], v1 offset:51328
    ds_read_b64_tr_b16 a[70:71], v1 offset:51840
    v_cvt_pk_bf16_f32 v50, v52, v53
    v_permlane32_swap_b32 v121, v125
    v_permlane32_swap_b32 v122, v126
    v_permlane32_swap_b32 v123, v127
    v_mfma_f32_16x16x32_bf16 v[184:187], a[48:51], v[24:27], 0
    v_exp_f32 v54, v54
    v_add_f32 v120, v120, v124
    v_add_f32 v121, v121, v125
    v_add_f32 v122, v122, v126
    v_add_f32 v123, v123, v127
    v_mfma_f32_16x16x32_bf16 v[184:187], a[52:55], v[40:43], v[184:187]
    s_waitcnt lgkmcnt(6)
    ds_read_b64_tr_b16 a[72:73], v1 offset:34336
    ds_read_b64_tr_b16 a[74:75], v1 offset:34848
    v_mfma_f32_16x16x32_bf16 v[180:183], a[56:59], v[16:19], 0
    s_waitcnt lgkmcnt(6)
    v_exp_f32 v55, v55
    v_permlane16_swap_b32 v120, v122
    v_permlane16_swap_b32 v121, v123
    v_mfma_f32_16x16x32_bf16 v[180:183], a[60:63], v[32:35], v[180:183]
    ds_read_b64_tr_b16 a[76:77], v1 offset:51360
    ds_read_b64_tr_b16 a[78:79], v1 offset:51872
    v_add_f32 v88, v88, v54
    v_add_f32 v120, v120, v122
    v_add_f32 v121, v121, v123
    v_mfma_f32_16x16x32_bf16 v[188:191], a[56:59], v[24:27], 0
    ds_read_b64_tr_b16 a[80:81], v1 offset:34368
    v_add_f32 v89, v89, v55
    v_mfma_f32_16x16x32_bf16 v[188:191], a[60:63], v[40:43], v[188:191]
    s_waitcnt lgkmcnt(7)
    ds_read_b64_tr_b16 a[82:83], v1 offset:34880
    v_cvt_pk_bf16_f32 v51, v54, v55
    v_add_f32_dpp v120, v120, v120 row_ror:8 row_mask:0xf bank_mask:0xf
    v_add_f32_dpp v121, v121, v121 row_ror:8 row_mask:0xf bank_mask:0xf
    v_mfma_f32_16x16x32_bf16 v[192:195], a[64:67], v[16:19], 0
    s_waitcnt lgkmcnt(6)
    ds_read_b64_tr_b16 a[84:85], v1 offset:51392
    ds_read_b64_tr_b16 a[86:87], v1 offset:51904
    v_mfma_f32_16x16x32_bf16 v[192:195], a[68:71], v[32:35], v[192:195]
    ds_read_b64_tr_b16 a[88:89], v1 offset:34400
    ds_read_b64_tr_b16 a[90:91], v1 offset:34912
    ds_read_b64_tr_b16 a[92:93], v1 offset:51424
    ds_read_b64_tr_b16 a[94:95], v1 offset:51936
    ds_read_b64_tr_b16 a[96:97], v1 offset:34432
    ds_read_b64_tr_b16 a[98:99], v1 offset:34944
    ds_read_b64_tr_b16 a[100:101], v1 offset:51456
    ds_read_b64_tr_b16 a[102:103], v1 offset:51968
    ds_read_b64_tr_b16 a[104:105], v1 offset:34464
    ds_read_b64_tr_b16 a[106:107], v1 offset:34976
    ds_read_b64_tr_b16 a[108:109], v1 offset:51488
    ds_read_b64_tr_b16 a[110:111], v1 offset:52000
    ds_read_b64_tr_b16 a[112:113], v1 offset:34496
    ds_read_b64_tr_b16 a[114:115], v1 offset:35008
    ds_read_b64_tr_b16 a[116:117], v1 offset:51520
    ds_read_b64_tr_b16 a[118:119], v1 offset:52032
    ds_read_b64_tr_b16 a[120:121], v1 offset:34528
    ds_read_b64_tr_b16 a[122:123], v1 offset:35040
    ds_read_b64_tr_b16 a[124:125], v1 offset:51552
    ds_read_b64_tr_b16 a[126:127], v1 offset:52064
    v_exp_f32 v60, v60
    v_add_f32_dpp v120, v120, v120 row_ror:4 row_mask:0xf bank_mask:0xf
    v_add_f32_dpp v121, v121, v121 row_ror:4 row_mask:0xf bank_mask:0xf
    v_mfma_f32_16x16x32_bf16 v[200:203], a[64:67], v[24:27], 0
    v_exp_f32 v61, v61
    v_mfma_f32_16x16x32_bf16 v[200:203], a[68:71], v[40:43], v[200:203]
    s_waitcnt lgkmcnt(15)
    v_add_f32 v90, v90, v60
    v_add_f32 v91, v91, v61
    v_add_f32_dpp v120, v120, v120 row_ror:2 row_mask:0xf bank_mask:0xf
    v_add_f32_dpp v121, v121, v121 row_ror:2 row_mask:0xf bank_mask:0xf
    v_mfma_f32_16x16x32_bf16 v[196:199], a[72:75], v[16:19], 0
    v_cvt_pk_bf16_f32 v58, v60, v61
    v_add_u32 v110, 3648, v110
    v_mfma_f32_16x16x32_bf16 v[196:199], a[76:79], v[32:35], v[196:199]
    v_exp_f32 v62, v62
    v_add_f32_dpp v120, v120, v120 row_ror:1 row_mask:0xf bank_mask:0xf
    v_add_f32_dpp v121, v121, v121 row_ror:1 row_mask:0xf bank_mask:0xf
    v_mfma_f32_16x16x32_bf16 v[204:207], a[72:75], v[24:27], 0
    s_add_u32 m0, s40, 0
    ds_write2_b32 v110, v120, v121 offset0:0 offset1:4
    v_exp_f32 v63, v63
    v_mfma_f32_16x16x32_bf16 v[204:207], a[76:79], v[40:43], v[204:207]
    v_add_f32 v90, v90, v62
    v_add_f32 v91, v91, v63
    v_mfma_f32_16x16x32_bf16 v[208:211], a[80:83], v[16:19], 0
    s_waitcnt vmcnt(0) lgkmcnt(0)
    v_cvt_pk_bf16_f32 v59, v62, v63
    v_mfma_f32_16x16x32_bf16 v[208:211], a[84:87], v[32:35], v[208:211]
    s_barrier
    v_exp_f32 v64, v64
    v_mfma_f32_16x16x32_bf16 v[216:219], a[80:83], v[24:27], 0
    v_exp_f32 v65, v65
    v_mfma_f32_16x16x32_bf16 v[216:219], a[84:87], v[40:43], v[216:219]
    v_add_f32 v88, v88, v64
    v_add_f32 v89, v89, v65
    v_mfma_f32_16x16x32_bf16 v[212:215], a[88:91], v[16:19], 0
    ds_read_b128 a[0:3], v3 offset:0
    v_cvt_pk_bf16_f32 v64, v64, v65
    v_mfma_f32_16x16x32_bf16 v[212:215], a[92:95], v[32:35], v[212:215]
    v_exp_f32 v66, v66
    v_mfma_f32_16x16x32_bf16 v[220:223], a[88:91], v[24:27], 0
    v_exp_f32 v67, v67
    v_mfma_f32_16x16x32_bf16 v[220:223], a[92:95], v[40:43], v[220:223]
    v_add_f32 v88, v88, v66
    v_add_f32 v89, v89, v67
    v_mfma_f32_16x16x32_bf16 v[224:227], a[96:99], v[16:19], 0
    buffer_load_dwordx4 v6, s[4:7], s24 offen offset:0 lds
    v_mfma_f32_16x16x32_bf16 v[224:227], a[100:103], v[32:35], v[224:227]
    ds_read_b128 a[4:7], v3 offset:64
    v_cvt_pk_bf16_f32 v65, v66, v67
    v_mfma_f32_16x16x32_bf16 v[232:235], a[96:99], v[24:27], 0
    ds_read_b128 v[124:127], v111
    v_and_b32 v110, 0x40, v8
    v_mfma_f32_16x16x32_bf16 v[232:235], a[100:103], v[40:43], v[232:235]
    ds_read_b128 a[8:11], v3 offset:128
    v_bfe_u32 v111, v8, 4, 2
    v_mfma_f32_16x16x32_bf16 v[228:231], a[104:107], v[16:19], 0
    v_exp_f32 v72, v72
    v_mfma_f32_16x16x32_bf16 v[228:231], a[108:111], v[32:35], v[228:231]
    buffer_load_dwordx4 v6, s[4:7], s25 offen offset:1024 lds
    v_mfma_f32_16x16x32_bf16 v[236:239], a[104:107], v[24:27], 0
    ds_read_b128 a[12:15], v3 offset:192
    v_add_f32 v90, v90, v72
    v_mfma_f32_16x16x32_bf16 v[236:239], a[108:111], v[40:43], v[236:239]
    v_exp_f32 v73, v73
    v_mfma_f32_16x16x32_bf16 v[240:243], a[112:115], v[16:19], 0
    ds_read_b128 a[16:19], v3 offset:256
    v_add_f32 v91, v91, v73
    v_mfma_f32_16x16x32_bf16 v[240:243], a[116:119], v[32:35], v[240:243]
    buffer_load_dwordx4 v6, s[4:7], s26 offen offset:2064 lds
    v_mfma_f32_16x16x32_bf16 v[248:251], a[112:115], v[24:27], 0
    ds_read_b128 a[20:23], v3 offset:320
    v_cvt_pk_bf16_f32 v72, v72, v73
    v_mfma_f32_16x16x32_bf16 v[248:251], a[116:119], v[40:43], v[248:251]
    s_waitcnt lgkmcnt(4)
    v_add_f32 v124, v124, v125
    v_add_f32 v126, v126, v127
    v_mfma_f32_16x16x32_bf16 v[244:247], a[120:123], v[16:19], 0
    v_add_f32 v120, v124, v126
    v_cvt_pk_bf16_f32 v120, 0, v120
    v_mfma_f32_16x16x32_bf16 v[244:247], a[124:127], v[32:35], v[244:247]
    ds_read_b128 a[24:27], v3 offset:384
    v_add_f32 v120, s46, v120
    v_mfma_f32_16x16x32_bf16 v[252:255], a[120:123], v[24:27], 0
    v_exp_f32 v74, v74
    v_mfma_f32_16x16x32_bf16 v[252:255], a[124:127], v[40:43], v[252:255]
    buffer_load_dwordx4 v6, s[4:7], s27 offen offset:3088 lds
    ds_read_b128 a[28:31], v3 offset:448
    v_mfma_f32_16x16x32_bf16 v[16:19], a[0:3], a[128:131], v[80:83]
    v_exp_f32 v75, v75
    v_mfma_f32_16x16x32_bf16 v[16:19], a[4:7], a[136:139], v[16:19]
    s_add_u32 m0, s40, 17024
    ds_read_b128 a[32:35], v3 offset:512
    v_cvt_pk_bf16_f32 v120, 0, v120
    s_waitcnt lgkmcnt(5)
    v_mfma_f32_16x16x32_bf16 v[16:19], a[8:11], a[144:147], v[16:19]
    s_max_i32 s44, s57, 0
    ds_read_b128 a[36:39], v3 offset:576
    v_add_f32 v90, v90, v74
    v_mfma_f32_16x16x32_bf16 v[16:19], a[12:15], a[152:155], v[16:19]
    s_add_u32 s57, s57, 2048
    ds_read_b128 a[40:43], v3 offset:640
    v_add_f32 v91, v91, v75
    s_waitcnt lgkmcnt(6)
    v_mfma_f32_16x16x32_bf16 v[16:19], a[16:19], a[160:163], v[16:19]
    s_waitcnt lgkmcnt(5)
    buffer_load_dwordx4 v6, s[4:7], s28 offen offset:0 lds
    v_mfma_f32_16x16x32_bf16 v[16:19], a[20:23], a[168:171], v[16:19]
    s_waitcnt lgkmcnt(4)
    ds_read_b128 a[44:47], v3 offset:704
    v_cvt_pk_bf16_f32 v73, v74, v75
    v_mfma_f32_16x16x32_bf16 v[16:19], a[24:27], a[176:179], v[16:19]
    s_waitcnt lgkmcnt(4)
    ds_read_b128 a[48:51], v3 offset:768
    v_lshrrev_b32 v110, 1, v110
    v_mfma_f32_16x16x32_bf16 v[16:19], a[28:31], a[184:187], v[16:19]
    v_exp_f32 v68, v68
    v_mfma_f32_16x16x32_bf16 v[24:27], a[0:3], a[132:135], v[84:87]
    buffer_load_dwordx4 v6, s[4:7], s29 offen offset:1024 lds
    v_mfma_f32_16x16x32_bf16 v[24:27], a[4:7], a[140:143], v[24:27]
    v_exp_f32 v69, v69
    v_mfma_f32_16x16x32_bf16 v[24:27], a[8:11], a[148:151], v[24:27]
    v_lshl_add_u32 v110, v111, 2, v110
    v_add_f32 v88, v88, v68
    v_mfma_f32_16x16x32_bf16 v[24:27], a[12:15], a[156:159], v[24:27]
    ds_read_b128 a[52:55], v3 offset:832
    v_add_f32 v89, v89, v69
    v_mfma_f32_16x16x32_bf16 v[24:27], a[16:19], a[164:167], v[24:27]
    buffer_load_dwordx4 v6, s[4:7], s30 offen offset:2064 lds
    v_mfma_f32_16x16x32_bf16 v[24:27], a[20:23], a[172:175], v[24:27]
    ds_read_b128 a[56:59], v3 offset:896
    v_cvt_pk_bf16_f32 v66, v68, v69
    v_mfma_f32_16x16x32_bf16 v[24:27], a[24:27], a[180:183], v[24:27]
    ds_read_b128 a[60:63], v3 offset:960
    v_accvgpr_read_b32 v104, a253
    v_mfma_f32_16x16x32_bf16 v[24:27], a[28:31], a[188:191], v[24:27]
    s_waitcnt lgkmcnt(4)
    buffer_store_dword v120, v110, s[20:23], s74 offen sc1
    v_mfma_f32_16x16x32_bf16 v[20:23], a[32:35], a[128:131], v[80:83]
    v_exp_f32 v70, v70
    v_mfma_f32_16x16x32_bf16 v[20:23], a[36:39], a[136:139], v[20:23]
    buffer_load_dwordx4 v6, s[4:7], s31 offen offset:3088 lds
    v_mfma_f32_16x16x32_bf16 v[20:23], a[40:43], a[144:147], v[20:23]
    s_add_u32 m0, s41, 34048
    v_exp_f32 v71, v71
    v_mfma_f32_16x16x32_bf16 v[20:23], a[44:47], a[152:155], v[20:23]
    s_waitcnt lgkmcnt(3)
    ds_read_b128 a[64:67], v3 offset:17024
    v_add_f32 v88, v88, v70
    v_mfma_f32_16x16x32_bf16 v[20:23], a[48:51], a[160:163], v[20:23]
    s_waitcnt lgkmcnt(3)
    ds_read_b128 a[68:71], v3 offset:17088
    v_add_f32 v89, v89, v71
    v_mfma_f32_16x16x32_bf16 v[20:23], a[52:55], a[168:171], v[20:23]
    s_waitcnt lgkmcnt(3)
    buffer_load_dwordx4 v6, s[8:11], s32 offen offset:0 lds
    v_mfma_f32_16x16x32_bf16 v[20:23], a[56:59], a[176:179], v[20:23]
    s_waitcnt lgkmcnt(2)
    ds_read_b128 a[72:75], v3 offset:17152
    v_cvt_pk_bf16_f32 v67, v70, v71
    v_mfma_f32_16x16x32_bf16 v[20:23], a[60:63], a[184:187], v[20:23]
    ds_read_b128 a[76:79], v3 offset:17216
    v_mfma_f32_16x16x32_bf16 v[28:31], a[32:35], a[132:135], v[84:87]
    v_exp_f32 v76, v76
    v_mfma_f32_16x16x32_bf16 v[28:31], a[36:39], a[140:143], v[28:31]
    buffer_load_dwordx4 v6, s[8:11], s33 offen offset:1024 lds
    v_mfma_f32_16x16x32_bf16 v[28:31], a[40:43], a[148:151], v[28:31]
    ds_read_b128 a[80:83], v3 offset:17280
    ds_read_b128 a[84:87], v3 offset:17344
    v_mfma_f32_16x16x32_bf16 v[28:31], a[44:47], a[156:159], v[28:31]
    v_exp_f32 v77, v77
    v_mfma_f32_16x16x32_bf16 v[28:31], a[48:51], a[164:167], v[28:31]
    v_add_f32 v90, v90, v76
    v_add_f32 v91, v91, v77
    v_mfma_f32_16x16x32_bf16 v[28:31], a[52:55], a[172:175], v[28:31]
    buffer_load_dwordx4 v6, s[8:11], s34 offen offset:2176 lds
    v_mfma_f32_16x16x32_bf16 v[28:31], a[56:59], a[180:183], v[28:31]
    ds_read_b128 a[88:91], v3 offset:17408
    v_cvt_pk_bf16_f32 v74, v76, v77
    v_mfma_f32_16x16x32_bf16 v[28:31], a[60:63], a[188:191], v[28:31]
    s_waitcnt lgkmcnt(5)
    ds_read_b128 a[92:95], v3 offset:17472
    v_mfma_f32_16x16x32_bf16 v[32:35], a[64:67], a[128:131], v[80:83]
    v_exp_f32 v78, v78
    v_mfma_f32_16x16x32_bf16 v[32:35], a[68:71], a[136:139], v[32:35]
    s_waitcnt lgkmcnt(4)
    buffer_load_dwordx4 v6, s[8:11], s35 offen offset:3200 lds
    v_mfma_f32_16x16x32_bf16 v[32:35], a[72:75], a[144:147], v[32:35]
    s_add_u32 m0, s41, 51072
    ds_read_b128 a[96:99], v3 offset:17536
    v_add_f32 v90, v90, v78
    v_mfma_f32_16x16x32_bf16 v[32:35], a[76:79], a[152:155], v[32:35]
    s_waitcnt lgkmcnt(4)
    v_exp_f32 v79, v79
    v_mfma_f32_16x16x32_bf16 v[32:35], a[80:83], a[160:163], v[32:35]
    s_waitcnt lgkmcnt(3)
    ds_read_b128 a[100:103], v3 offset:17600
    v_add_f32 v91, v91, v79
    v_mfma_f32_16x16x32_bf16 v[32:35], a[84:87], a[168:171], v[32:35]
    s_waitcnt lgkmcnt(3)
    ds_read_b128 a[104:107], v3 offset:17664
    v_cvt_pk_bf16_f32 v75, v78, v79
    v_mfma_f32_16x16x32_bf16 v[32:35], a[88:91], a[176:179], v[32:35]
    s_waitcnt lgkmcnt(3)
    buffer_load_dwordx4 v6, s[8:11], s36 offen offset:0 lds
    v_mfma_f32_16x16x32_bf16 v[32:35], a[92:95], a[184:187], v[32:35]
    ds_read_b128 a[108:111], v3 offset:17728
    ds_read_b64_tr_b16 a[0:1], v4 offset:34048
    v_mfma_f32_16x16x32_bf16 v[40:43], a[64:67], a[132:135], v[84:87]
    ds_read_b128 a[112:115], v3 offset:17792
    ds_read_b64_tr_b16 a[2:3], v4 offset:34560
    v_mfma_f32_16x16x32_bf16 v[40:43], a[68:71], a[140:143], v[40:43]
    buffer_load_dwordx4 v6, s[8:11], s37 offen offset:1024 lds
    v_mfma_f32_16x16x32_bf16 v[40:43], a[72:75], a[148:151], v[40:43]
    v_exp_f32 v16, v16
    v_mfma_f32_16x16x32_bf16 v[40:43], a[76:79], a[156:159], v[40:43]
    ds_read_b128 a[116:119], v3 offset:17856
    ds_read_b128 a[120:123], v3 offset:17920
    v_mfma_f32_16x16x32_bf16 v[40:43], a[80:83], a[164:167], v[40:43]
    v_exp_f32 v17, v17
    v_mfma_f32_16x16x32_bf16 v[40:43], a[84:87], a[172:175], v[40:43]
    v_add_f32 v88, v88, v16
    v_add_f32 v89, v89, v17
    v_mfma_f32_16x16x32_bf16 v[40:43], a[88:91], a[180:183], v[40:43]
    buffer_load_dwordx4 v6, s[8:11], s38 offen offset:2176 lds
    v_mfma_f32_16x16x32_bf16 v[40:43], a[92:95], a[188:191], v[40:43]
    s_waitcnt lgkmcnt(6)
    ds_read_b128 a[124:127], v3 offset:17984
    v_cvt_pk_bf16_f32 v16, v16, v17
    v_mfma_f32_16x16x32_bf16 v[36:39], a[96:99], a[128:131], v[80:83]
    buffer_load_dwordx4 v6, s[8:11], s39 offen offset:3200 lds
    v_mfma_f32_16x16x32_bf16 v[36:39], a[100:103], a[136:139], v[36:39]
    v_exp_f32 v18, v18
    v_mfma_f32_16x16x32_bf16 v[36:39], a[104:107], a[144:147], v[36:39]
    s_waitcnt lgkmcnt(3)
    ds_read_b64_tr_b16 a[4:5], v4 offset:51072
    ds_read_b64_tr_b16 a[6:7], v4 offset:51584
    v_mfma_f32_16x16x32_bf16 v[36:39], a[108:111], a[152:155], v[36:39]
    s_waitcnt lgkmcnt(2)
    v_exp_f32 v19, v19
    v_mfma_f32_16x16x32_bf16 v[36:39], a[112:115], a[160:163], v[36:39]
    s_waitcnt lgkmcnt(4)
    ds_read_b64_tr_b16 a[8:9], v4 offset:34080
    v_add_u32 v6, 0x8000, v6
    v_mfma_f32_16x16x32_bf16 v[36:39], a[116:119], a[168:171], v[36:39]
    s_waitcnt lgkmcnt(4)
    buffer_load_dword a244, v9, s[76:79], s54 offen
    v_mfma_f32_16x16x32_bf16 v[36:39], a[120:123], a[176:179], v[36:39]
    s_add_u32 s54, s54, 65536
    ds_read_b64_tr_b16 a[10:11], v4 offset:34592
    v_add_f32 v88, v88, v18
    v_mfma_f32_16x16x32_bf16 v[36:39], a[124:127], a[184:187], v[36:39]
    ds_read_b64_tr_b16 a[12:13], v4 offset:51104
    v_add_f32 v89, v89, v19
    v_mfma_f32_16x16x32_bf16 v[44:47], a[96:99], a[132:135], v[84:87]
    ds_read_b64_tr_b16 a[14:15], v4 offset:51616
    v_cvt_pk_bf16_f32 v17, v18, v19
    v_mfma_f32_16x16x32_bf16 v[44:47], a[100:103], a[140:143], v[44:47]
    ds_read_b64_tr_b16 a[16:17], v4 offset:34112
    ds_read_b64_tr_b16 a[18:19], v4 offset:34624
    v_mfma_f32_16x16x32_bf16 v[44:47], a[104:107], a[148:151], v[44:47]
    buffer_load_dword a238, v9, s[16:19], s44 offen
    v_mfma_f32_16x16x32_bf16 v[44:47], a[108:111], a[156:159], v[44:47]
    v_exp_f32 v24, v24
    v_mfma_f32_16x16x32_bf16 v[44:47], a[112:115], a[164:167], v[44:47]
    ds_read_b64_tr_b16 a[20:21], v4 offset:51136
    ds_read_b64_tr_b16 a[22:23], v4 offset:51648
    v_mfma_f32_16x16x32_bf16 v[44:47], a[116:119], a[172:175], v[44:47]
    v_exp_f32 v25, v25
    v_mfma_f32_16x16x32_bf16 v[44:47], a[120:123], a[180:183], v[44:47]
    ds_read_b64_tr_b16 a[24:25], v4 offset:34144
    v_add_f32 v90, v90, v24
    v_mfma_f32_16x16x32_bf16 v[44:47], a[124:127], a[188:191], v[44:47]
    ds_read_b64_tr_b16 a[26:27], v4 offset:34656
    v_add_f32 v91, v91, v25
    v_mfma_f32_16x16x32_bf16 v[128:131], a[0:3], v[48:51], v[128:131]
    s_waitcnt lgkmcnt(8)
    ds_read_b64_tr_b16 a[28:29], v4 offset:51168
    ds_read_b64_tr_b16 a[30:31], v4 offset:51680
    v_mfma_f32_16x16x32_bf16 v[128:131], a[4:7], v[64:67], v[128:131]
    ds_read_b64_tr_b16 a[32:33], v4 offset:34176
    v_cvt_pk_bf16_f32 v24, v24, v25
    v_mfma_f32_16x16x32_bf16 v[136:139], a[0:3], v[56:59], v[136:139]
    ds_read_b64_tr_b16 a[34:35], v4 offset:34688
    ds_read_b64_tr_b16 a[36:37], v4 offset:51200
    v_mfma_f32_16x16x32_bf16 v[136:139], a[4:7], v[72:75], v[136:139]
    v_exp_f32 v26, v26
    v_mfma_f32_16x16x32_bf16 v[132:135], a[8:11], v[48:51], v[132:135]
    s_waitcnt lgkmcnt(9)
    ds_read_b64_tr_b16 a[38:39], v4 offset:51712
    ds_read_b64_tr_b16 a[40:41], v4 offset:34208
    v_mfma_f32_16x16x32_bf16 v[132:135], a[12:15], v[64:67], v[132:135]
    v_exp_f32 v27, v27
    v_mfma_f32_16x16x32_bf16 v[140:143], a[8:11], v[56:59], v[140:143]
    ds_read_b64_tr_b16 a[42:43], v4 offset:34720
    v_add_f32 v90, v90, v26
    v_mfma_f32_16x16x32_bf16 v[140:143], a[12:15], v[72:75], v[140:143]
    ds_read_b64_tr_b16 a[44:45], v4 offset:51232
    v_add_f32 v91, v91, v27
    v_mfma_f32_16x16x32_bf16 v[144:147], a[16:19], v[48:51], v[144:147]
    s_waitcnt lgkmcnt(10)
    ds_read_b64_tr_b16 a[46:47], v4 offset:51744
    ds_read_b64_tr_b16 a[48:49], v4 offset:34240
    v_mfma_f32_16x16x32_bf16 v[144:147], a[20:23], v[64:67], v[144:147]
    ds_read_b64_tr_b16 a[50:51], v4 offset:34752
    v_cvt_pk_bf16_f32 v25, v26, v27
    v_mfma_f32_16x16x32_bf16 v[152:155], a[16:19], v[56:59], v[152:155]
    ds_read_b64_tr_b16 a[52:53], v4 offset:51264
    ds_read_b64_tr_b16 a[54:55], v4 offset:51776
    v_mfma_f32_16x16x32_bf16 v[152:155], a[20:23], v[72:75], v[152:155]
    s_waitcnt lgkmcnt(11)
    v_exp_f32 v20, v20
    v_mfma_f32_16x16x32_bf16 v[148:151], a[24:27], v[48:51], v[148:151]
    v_exp_f32 v21, v21
    v_mfma_f32_16x16x32_bf16 v[148:151], a[28:31], v[64:67], v[148:151]
    ds_read_b64_tr_b16 a[56:57], v4 offset:34272
    ds_read_b64_tr_b16 a[58:59], v4 offset:34784
    v_mfma_f32_16x16x32_bf16 v[156:159], a[24:27], v[56:59], v[156:159]
    ds_read_b64_tr_b16 a[60:61], v4 offset:51296
    v_add_f32 v88, v88, v20
    v_mfma_f32_16x16x32_bf16 v[156:159], a[28:31], v[72:75], v[156:159]
    s_waitcnt lgkmcnt(10)
    ds_read_b64_tr_b16 a[62:63], v4 offset:51808
    v_add_f32 v89, v89, v21
    v_mfma_f32_16x16x32_bf16 v[160:163], a[32:35], v[48:51], v[160:163]
    ds_read_b64_tr_b16 a[64:65], v4 offset:34304
    ds_read_b64_tr_b16 a[66:67], v4 offset:34816
    v_mfma_f32_16x16x32_bf16 v[160:163], a[36:39], v[64:67], v[160:163]
    ds_read_b64_tr_b16 a[68:69], v4 offset:51328
    v_cvt_pk_bf16_f32 v18, v20, v21
    v_mfma_f32_16x16x32_bf16 v[168:171], a[32:35], v[56:59], v[168:171]
    ds_read_b64_tr_b16 a[70:71], v4 offset:51840
    ds_read_b64_tr_b16 a[72:73], v4 offset:34336
    v_mfma_f32_16x16x32_bf16 v[168:171], a[36:39], v[72:75], v[168:171]
    s_waitcnt lgkmcnt(11)
    v_exp_f32 v22, v22
    v_mfma_f32_16x16x32_bf16 v[164:167], a[40:43], v[48:51], v[164:167]
    v_exp_f32 v23, v23
    v_mfma_f32_16x16x32_bf16 v[164:167], a[44:47], v[64:67], v[164:167]
    ds_read_b64_tr_b16 a[74:75], v4 offset:34848
    ds_read_b64_tr_b16 a[76:77], v4 offset:51360
    v_mfma_f32_16x16x32_bf16 v[172:175], a[40:43], v[56:59], v[172:175]
    ds_read_b64_tr_b16 a[78:79], v4 offset:51872
    v_add_f32 v88, v88, v22
    v_mfma_f32_16x16x32_bf16 v[172:175], a[44:47], v[72:75], v[172:175]
    ds_read_b64_tr_b16 a[80:81], v4 offset:34368
    v_add_f32 v89, v89, v23
    v_mfma_f32_16x16x32_bf16 v[176:179], a[48:51], v[48:51], v[176:179]
    s_waitcnt lgkmcnt(10)
    ds_read_b64_tr_b16 a[82:83], v4 offset:34880
    v_cvt_pk_bf16_f32 v19, v22, v23
    v_mfma_f32_16x16x32_bf16 v[176:179], a[52:55], v[64:67], v[176:179]
    ds_read_b64_tr_b16 a[84:85], v4 offset:51392
    ds_read_b64_tr_b16 a[86:87], v4 offset:51904
    v_mfma_f32_16x16x32_bf16 v[184:187], a[48:51], v[56:59], v[184:187]
    v_exp_f32 v28, v28
    v_mfma_f32_16x16x32_bf16 v[184:187], a[52:55], v[72:75], v[184:187]
    ds_read_b64_tr_b16 a[88:89], v4 offset:34400
    ds_read_b64_tr_b16 a[90:91], v4 offset:34912
    v_mfma_f32_16x16x32_bf16 v[180:183], a[56:59], v[48:51], v[180:183]
    s_waitcnt lgkmcnt(9)
    v_exp_f32 v29, v29
    v_mfma_f32_16x16x32_bf16 v[180:183], a[60:63], v[64:67], v[180:183]
    ds_read_b64_tr_b16 a[92:93], v4 offset:51424
    v_add_f32 v90, v90, v28
    v_mfma_f32_16x16x32_bf16 v[188:191], a[56:59], v[56:59], v[188:191]
    ds_read_b64_tr_b16 a[94:95], v4 offset:51936
    v_add_f32 v91, v91, v29
    v_mfma_f32_16x16x32_bf16 v[188:191], a[60:63], v[72:75], v[188:191]
    ds_read_b64_tr_b16 a[96:97], v4 offset:34432
    ds_read_b64_tr_b16 a[98:99], v4 offset:34944
    v_mfma_f32_16x16x32_bf16 v[192:195], a[64:67], v[48:51], v[192:195]
    ds_read_b64_tr_b16 a[100:101], v4 offset:51456
    v_cvt_pk_bf16_f32 v26, v28, v29
    v_mfma_f32_16x16x32_bf16 v[192:195], a[68:71], v[64:67], v[192:195]
    ds_read_b64_tr_b16 a[102:103], v4 offset:51968
    ds_read_b64_tr_b16 a[104:105], v4 offset:34464
    ds_read_b64_tr_b16 a[106:107], v4 offset:34976
    ds_read_b64_tr_b16 a[108:109], v4 offset:51488
    ds_read_b64_tr_b16 a[110:111], v4 offset:52000
    ds_read_b64_tr_b16 a[112:113], v4 offset:34496
    ds_read_b64_tr_b16 a[114:115], v4 offset:35008
    ds_read_b64_tr_b16 a[116:117], v4 offset:51520
    ds_read_b64_tr_b16 a[118:119], v4 offset:52032
    ds_read_b64_tr_b16 a[120:121], v4 offset:34528
    ds_read_b64_tr_b16 a[122:123], v4 offset:35040
    ds_read_b64_tr_b16 a[124:125], v4 offset:51552
    ds_read_b64_tr_b16 a[126:127], v4 offset:52064
    v_mfma_f32_16x16x32_bf16 v[200:203], a[64:67], v[56:59], v[200:203]
    v_exp_f32 v30, v30
    v_mfma_f32_16x16x32_bf16 v[200:203], a[68:71], v[72:75], v[200:203]
    s_waitcnt lgkmcnt(15)
    v_exp_f32 v31, v31
    v_mfma_f32_16x16x32_bf16 v[196:199], a[72:75], v[48:51], v[196:199]
    v_add_f32 v90, v90, v30
    v_add_f32 v91, v91, v31
    v_mfma_f32_16x16x32_bf16 v[196:199], a[76:79], v[64:67], v[196:199]
    v_cvt_pk_bf16_f32 v27, v30, v31
    v_mfma_f32_16x16x32_bf16 v[204:207], a[72:75], v[56:59], v[204:207]
    s_add_u32 m0, s40, 68096
    v_exp_f32 v32, v32
    v_mfma_f32_16x16x32_bf16 v[204:207], a[76:79], v[72:75], v[204:207]
    v_exp_f32 v33, v33
    v_mfma_f32_16x16x32_bf16 v[208:211], a[80:83], v[48:51], v[208:211]
    s_waitcnt vmcnt(2) lgkmcnt(0)
    v_add_f32 v88, v88, v32
    v_add_f32 v89, v89, v33
    v_mfma_f32_16x16x32_bf16 v[208:211], a[84:87], v[64:67], v[208:211]
    s_barrier
    ds_read_b128 a[0:3], v2 offset:0
    v_cvt_pk_bf16_f32 v32, v32, v33
    v_mfma_f32_16x16x32_bf16 v[216:219], a[80:83], v[56:59], v[216:219]
    v_exp_f32 v34, v34
    v_mfma_f32_16x16x32_bf16 v[216:219], a[84:87], v[72:75], v[216:219]
    s_waitcnt vmcnt(2)
    v_exp_f32 v35, v35
    v_mfma_f32_16x16x32_bf16 v[212:215], a[88:91], v[48:51], v[212:215]
    v_add_f32 v88, v88, v34
    v_add_f32 v89, v89, v35
    v_mfma_f32_16x16x32_bf16 v[212:215], a[92:95], v[64:67], v[212:215]
    buffer_load_dwordx4 v6, s[4:7], s24 offen offset:0 lds
    v_mfma_f32_16x16x32_bf16 v[220:223], a[88:91], v[56:59], v[220:223]
    ds_read_b128 a[4:7], v2 offset:64
    v_cvt_pk_bf16_f32 v33, v34, v35
    v_mfma_f32_16x16x32_bf16 v[220:223], a[92:95], v[72:75], v[220:223]
    buffer_store_dword v104, off, s[20:23], s75 sc1
    v_mfma_f32_16x16x32_bf16 v[224:227], a[96:99], v[48:51], v[224:227]
    ds_read_b128 a[8:11], v2 offset:128
    v_mfma_f32_16x16x32_bf16 v[224:227], a[100:103], v[64:67], v[224:227]
    v_exp_f32 v40, v40
    v_mfma_f32_16x16x32_bf16 v[232:235], a[96:99], v[56:59], v[232:235]
    buffer_load_dwordx4 v6, s[4:7], s25 offen offset:1024 lds
    v_mfma_f32_16x16x32_bf16 v[232:235], a[100:103], v[72:75], v[232:235]
    ds_read_b128 a[12:15], v2 offset:192
    v_add_f32 v90, v90, v40
    v_mfma_f32_16x16x32_bf16 v[228:231], a[104:107], v[48:51], v[228:231]
    v_exp_f32 v41, v41
    v_mfma_f32_16x16x32_bf16 v[228:231], a[108:111], v[64:67], v[228:231]
    ds_read_b128 a[16:19], v2 offset:256
    v_add_f32 v91, v91, v41
    v_mfma_f32_16x16x32_bf16 v[236:239], a[104:107], v[56:59], v[236:239]
    buffer_load_dwordx4 v6, s[4:7], s26 offen offset:2064 lds
    v_mfma_f32_16x16x32_bf16 v[236:239], a[108:111], v[72:75], v[236:239]
    ds_read_b128 a[20:23], v2 offset:320
    v_cvt_pk_bf16_f32 v40, v40, v41
    v_mfma_f32_16x16x32_bf16 v[240:243], a[112:115], v[48:51], v[240:243]
    ds_read_b128 a[24:27], v2 offset:384
    v_mfma_f32_16x16x32_bf16 v[240:243], a[116:119], v[64:67], v[240:243]
    v_exp_f32 v42, v42
    v_mfma_f32_16x16x32_bf16 v[248:251], a[112:115], v[56:59], v[248:251]
    buffer_load_dwordx4 v6, s[4:7], s27 offen offset:3088 lds
    v_mfma_f32_16x16x32_bf16 v[248:251], a[116:119], v[72:75], v[248:251]
    s_add_u32 m0, s40, 85120
    ds_read_b128 a[28:31], v2 offset:448
    v_add_f32 v90, v90, v42
    v_mfma_f32_16x16x32_bf16 v[244:247], a[120:123], v[48:51], v[244:247]
    v_exp_f32 v43, v43
    v_mfma_f32_16x16x32_bf16 v[244:247], a[124:127], v[64:67], v[244:247]
    ds_read_b128 a[32:35], v2 offset:512
    v_add_f32 v91, v91, v43
    v_mfma_f32_16x16x32_bf16 v[252:255], a[120:123], v[56:59], v[252:255]
    ds_read_b128 a[36:39], v2 offset:576
    v_cvt_pk_bf16_f32 v41, v42, v43
    v_mfma_f32_16x16x32_bf16 v[252:255], a[124:127], v[72:75], v[252:255]
    s_waitcnt lgkmcnt(5)
    buffer_load_dwordx4 v6, s[4:7], s28 offen offset:0 lds
    v_mfma_f32_16x16x32_bf16 v[48:51], a[0:3], a[128:131], v[80:83]
    ds_read_b128 a[40:43], v2 offset:640
    v_mfma_f32_16x16x32_bf16 v[48:51], a[4:7], a[136:139], v[48:51]
    ds_read_b128 a[44:47], v2 offset:704
    v_mfma_f32_16x16x32_bf16 v[48:51], a[8:11], a[144:147], v[48:51]
    v_exp_f32 v36, v36
    v_mfma_f32_16x16x32_bf16 v[48:51], a[12:15], a[152:155], v[48:51]
    buffer_load_dwordx4 v6, s[4:7], s29 offen offset:1024 lds
    v_mfma_f32_16x16x32_bf16 v[48:51], a[16:19], a[160:163], v[48:51]
    s_waitcnt lgkmcnt(5)
    v_exp_f32 v37, v37
    v_mfma_f32_16x16x32_bf16 v[48:51], a[20:23], a[168:171], v[48:51]
    ds_read_b128 a[48:51], v2 offset:768
    v_add_f32 v88, v88, v36
    v_mfma_f32_16x16x32_bf16 v[48:51], a[24:27], a[176:179], v[48:51]
    s_waitcnt lgkmcnt(5)
    ds_read_b128 a[52:55], v2 offset:832
    v_add_f32 v89, v89, v37
    v_mfma_f32_16x16x32_bf16 v[48:51], a[28:31], a[184:187], v[48:51]
    buffer_load_dwordx4 v6, s[4:7], s30 offen offset:2064 lds
    v_mfma_f32_16x16x32_bf16 v[56:59], a[0:3], a[132:135], v[84:87]
    ds_read_b128 a[56:59], v2 offset:896
    v_cvt_pk_bf16_f32 v34, v36, v37
    v_mfma_f32_16x16x32_bf16 v[56:59], a[4:7], a[140:143], v[56:59]
    ds_read_b128 a[60:63], v2 offset:960
    v_mfma_f32_16x16x32_bf16 v[56:59], a[8:11], a[148:151], v[56:59]
    v_exp_f32 v38, v38
    v_mfma_f32_16x16x32_bf16 v[56:59], a[12:15], a[156:159], v[56:59]
    buffer_load_dwordx4 v6, s[4:7], s31 offen offset:3088 lds
    v_mfma_f32_16x16x32_bf16 v[56:59], a[16:19], a[164:167], v[56:59]
    s_add_u32 m0, s41, 102144
    v_exp_f32 v39, v39
    v_mfma_f32_16x16x32_bf16 v[56:59], a[20:23], a[172:175], v[56:59]
    ds_read_b128 a[64:67], v2 offset:17024
    v_add_f32 v88, v88, v38
    v_mfma_f32_16x16x32_bf16 v[56:59], a[24:27], a[180:183], v[56:59]
    ds_read_b128 a[68:71], v2 offset:17088
    v_add_f32 v89, v89, v39
    v_mfma_f32_16x16x32_bf16 v[56:59], a[28:31], a[188:191], v[56:59]
    s_waitcnt lgkmcnt(5)
    buffer_load_dwordx4 v6, s[8:11], s32 offen offset:0 lds
    v_mfma_f32_16x16x32_bf16 v[52:55], a[32:35], a[128:131], v[80:83]
    ds_read_b128 a[72:75], v2 offset:17152
    v_cvt_pk_bf16_f32 v35, v38, v39
    v_mfma_f32_16x16x32_bf16 v[52:55], a[36:39], a[136:139], v[52:55]
    ds_read_b128 a[76:79], v2 offset:17216
    v_mfma_f32_16x16x32_bf16 v[52:55], a[40:43], a[144:147], v[52:55]
    v_exp_f32 v44, v44
    v_mfma_f32_16x16x32_bf16 v[52:55], a[44:47], a[152:155], v[52:55]
    buffer_load_dwordx4 v6, s[8:11], s33 offen offset:1024 lds
    v_mfma_f32_16x16x32_bf16 v[52:55], a[48:51], a[160:163], v[52:55]
    s_waitcnt lgkmcnt(4)
    ds_read_b128 a[80:83], v2 offset:17280
    v_add_f32 v90, v90, v44
    v_mfma_f32_16x16x32_bf16 v[52:55], a[52:55], a[168:171], v[52:55]
    v_exp_f32 v45, v45
    v_mfma_f32_16x16x32_bf16 v[52:55], a[56:59], a[176:179], v[52:55]
    ds_read_b128 a[84:87], v2 offset:17344
    v_add_f32 v91, v91, v45
    v_mfma_f32_16x16x32_bf16 v[52:55], a[60:63], a[184:187], v[52:55]
    buffer_load_dwordx4 v6, s[8:11], s34 offen offset:2176 lds
    v_mfma_f32_16x16x32_bf16 v[60:63], a[32:35], a[132:135], v[84:87]
    ds_read_b128 a[88:91], v2 offset:17408
    v_cvt_pk_bf16_f32 v42, v44, v45
    v_mfma_f32_16x16x32_bf16 v[60:63], a[36:39], a[140:143], v[60:63]
    ds_read_b128 a[92:95], v2 offset:17472
    v_mfma_f32_16x16x32_bf16 v[60:63], a[40:43], a[148:151], v[60:63]
    v_exp_f32 v46, v46
    v_mfma_f32_16x16x32_bf16 v[60:63], a[44:47], a[156:159], v[60:63]
    buffer_load_dwordx4 v6, s[8:11], s35 offen offset:3200 lds
    v_mfma_f32_16x16x32_bf16 v[60:63], a[48:51], a[164:167], v[60:63]
    s_add_u32 m0, s41, 119168
    ds_read_b128 a[96:99], v2 offset:17536
    v_add_f32 v90, v90, v46
    v_mfma_f32_16x16x32_bf16 v[60:63], a[52:55], a[172:175], v[60:63]
    v_exp_f32 v47, v47
    v_mfma_f32_16x16x32_bf16 v[60:63], a[56:59], a[180:183], v[60:63]
    ds_read_b128 a[100:103], v2 offset:17600
    v_add_f32 v91, v91, v47
    v_mfma_f32_16x16x32_bf16 v[60:63], a[60:63], a[188:191], v[60:63]
    s_waitcnt lgkmcnt(5)
    ds_read_b128 a[104:107], v2 offset:17664
    v_cvt_pk_bf16_f32 v43, v46, v47
    v_mfma_f32_16x16x32_bf16 v[64:67], a[64:67], a[128:131], v[80:83]
    buffer_load_dwordx4 v6, s[8:11], s36 offen offset:0 lds
    v_mfma_f32_16x16x32_bf16 v[64:67], a[68:71], a[136:139], v[64:67]
    ds_read_b128 a[108:111], v2 offset:17728
    v_mfma_f32_16x16x32_bf16 v[64:67], a[72:75], a[144:147], v[64:67]
    ds_read_b128 a[112:115], v2 offset:17792
    v_mfma_f32_16x16x32_bf16 v[64:67], a[76:79], a[152:155], v[64:67]
    buffer_load_dwordx4 v6, s[8:11], s37 offen offset:1024 lds
    v_mfma_f32_16x16x32_bf16 v[64:67], a[80:83], a[160:163], v[64:67]
    s_waitcnt lgkmcnt(5)
    v_exp_f32 v48, v48
    v_mfma_f32_16x16x32_bf16 v[64:67], a[84:87], a[168:171], v[64:67]
    ds_read_b128 a[116:119], v2 offset:17856
    v_add_f32 v88, v88, v48
    v_mfma_f32_16x16x32_bf16 v[64:67], a[88:91], a[176:179], v[64:67]
    v_exp_f32 v49, v49
    v_mfma_f32_16x16x32_bf16 v[64:67], a[92:95], a[184:187], v[64:67]
    ds_read_b128 a[120:123], v2 offset:17920
    v_add_f32 v89, v89, v49
    v_mfma_f32_16x16x32_bf16 v[72:75], a[64:67], a[132:135], v[84:87]
    buffer_load_dwordx4 v6, s[8:11], s38 offen offset:2176 lds
    v_mfma_f32_16x16x32_bf16 v[72:75], a[68:71], a[140:143], v[72:75]
    ds_read_b128 a[124:127], v2 offset:17984
    v_cvt_pk_bf16_f32 v48, v48, v49
    v_mfma_f32_16x16x32_bf16 v[72:75], a[72:75], a[148:151], v[72:75]
    ds_read_b64_tr_b16 a[0:1], v1 offset:34048
    ds_read_b64_tr_b16 a[2:3], v1 offset:34560
    v_mfma_f32_16x16x32_bf16 v[72:75], a[76:79], a[156:159], v[72:75]
    buffer_load_dwordx4 v6, s[8:11], s39 offen offset:3200 lds
    v_mfma_f32_16x16x32_bf16 v[72:75], a[80:83], a[164:167], v[72:75]
    v_exp_f32 v50, v50
    v_mfma_f32_16x16x32_bf16 v[72:75], a[84:87], a[172:175], v[72:75]
    ds_read_b64_tr_b16 a[4:5], v1 offset:51072
    ds_read_b64_tr_b16 a[6:7], v1 offset:51584
    v_mfma_f32_16x16x32_bf16 v[72:75], a[88:91], a[180:183], v[72:75]
    v_exp_f32 v51, v51
    v_mfma_f32_16x16x32_bf16 v[72:75], a[92:95], a[188:191], v[72:75]
    s_waitcnt lgkmcnt(6)
    ds_read_b64_tr_b16 a[8:9], v1 offset:34080
    v_add_u32 v6, 0x8000, v6
    v_mfma_f32_16x16x32_bf16 v[68:71], a[96:99], a[128:131], v[80:83]
    ds_read_b64_tr_b16 a[10:11], v1 offset:34592
    v_add_f32 v88, v88, v50
    v_mfma_f32_16x16x32_bf16 v[68:71], a[100:103], a[136:139], v[68:71]
    ds_read_b64_tr_b16 a[12:13], v1 offset:51104
    v_add_f32 v89, v89, v51
    v_mfma_f32_16x16x32_bf16 v[68:71], a[104:107], a[144:147], v[68:71]
    ds_read_b64_tr_b16 a[14:15], v1 offset:51616
    v_cvt_pk_bf16_f32 v49, v50, v51
    v_mfma_f32_16x16x32_bf16 v[68:71], a[108:111], a[152:155], v[68:71]
    ds_read_b64_tr_b16 a[16:17], v1 offset:34112
    ds_read_b64_tr_b16 a[18:19], v1 offset:34624
    v_mfma_f32_16x16x32_bf16 v[68:71], a[112:115], a[160:163], v[68:71]
    v_exp_f32 v56, v56
    v_mfma_f32_16x16x32_bf16 v[68:71], a[116:119], a[168:171], v[68:71]
    s_waitcnt lgkmcnt(8)
    ds_read_b64_tr_b16 a[20:21], v1 offset:51136
    ds_read_b64_tr_b16 a[22:23], v1 offset:51648
    v_mfma_f32_16x16x32_bf16 v[68:71], a[120:123], a[176:179], v[68:71]
    v_exp_f32 v57, v57
    v_mfma_f32_16x16x32_bf16 v[68:71], a[124:127], a[184:187], v[68:71]
    ds_read_b64_tr_b16 a[24:25], v1 offset:34144
    v_add_f32 v90, v90, v56
    v_mfma_f32_16x16x32_bf16 v[76:79], a[96:99], a[132:135], v[84:87]
    ds_read_b64_tr_b16 a[26:27], v1 offset:34656
    v_add_f32 v91, v91, v57
    v_mfma_f32_16x16x32_bf16 v[76:79], a[100:103], a[140:143], v[76:79]
    ds_read_b64_tr_b16 a[28:29], v1 offset:51168
    ds_read_b64_tr_b16 a[30:31], v1 offset:51680
    v_mfma_f32_16x16x32_bf16 v[76:79], a[104:107], a[148:151], v[76:79]
    ds_read_b64_tr_b16 a[32:33], v1 offset:34176
    v_cvt_pk_bf16_f32 v56, v56, v57
    v_mfma_f32_16x16x32_bf16 v[76:79], a[108:111], a[156:159], v[76:79]
    ds_read_b64_tr_b16 a[34:35], v1 offset:34688
    ds_read_b64_tr_b16 a[36:37], v1 offset:51200
    v_mfma_f32_16x16x32_bf16 v[76:79], a[112:115], a[164:167], v[76:79]
    v_exp_f32 v58, v58
    v_mfma_f32_16x16x32_bf16 v[76:79], a[116:119], a[172:175], v[76:79]
    ds_read_b64_tr_b16 a[38:39], v1 offset:51712
    ds_read_b64_tr_b16 a[40:41], v1 offset:34208
    v_mfma_f32_16x16x32_bf16 v[76:79], a[120:123], a[180:183], v[76:79]
    v_exp_f32 v59, v59
    v_mfma_f32_16x16x32_bf16 v[76:79], a[124:127], a[188:191], v[76:79]
    ds_read_b64_tr_b16 a[42:43], v1 offset:34720
    v_add_f32 v90, v90, v58
    v_mfma_f32_16x16x32_bf16 v[128:131], a[0:3], v[16:19], v[128:131]
    s_waitcnt lgkmcnt(10)
    ds_read_b64_tr_b16 a[44:45], v1 offset:51232
    v_add_f32 v91, v91, v59
    v_mfma_f32_16x16x32_bf16 v[128:131], a[4:7], v[32:35], v[128:131]
    ds_read_b64_tr_b16 a[46:47], v1 offset:51744
    ds_read_b64_tr_b16 a[48:49], v1 offset:34240
    v_mfma_f32_16x16x32_bf16 v[136:139], a[0:3], v[24:27], v[136:139]
    ds_read_b64_tr_b16 a[50:51], v1 offset:34752
    v_cvt_pk_bf16_f32 v57, v58, v59
    v_mfma_f32_16x16x32_bf16 v[136:139], a[4:7], v[40:43], v[136:139]
    ds_read_b64_tr_b16 a[52:53], v1 offset:51264
    ds_read_b64_tr_b16 a[54:55], v1 offset:51776
    v_mfma_f32_16x16x32_bf16 v[132:135], a[8:11], v[16:19], v[132:135]
    v_exp_f32 v52, v52
    v_mfma_f32_16x16x32_bf16 v[132:135], a[12:15], v[32:35], v[132:135]
    v_exp_f32 v53, v53
    v_mfma_f32_16x16x32_bf16 v[140:143], a[8:11], v[24:27], v[140:143]
    ds_read_b64_tr_b16 a[56:57], v1 offset:34272
    ds_read_b64_tr_b16 a[58:59], v1 offset:34784
    v_mfma_f32_16x16x32_bf16 v[140:143], a[12:15], v[40:43], v[140:143]
    ds_read_b64_tr_b16 a[60:61], v1 offset:51296
    v_add_f32 v88, v88, v52
    v_mfma_f32_16x16x32_bf16 v[144:147], a[16:19], v[16:19], v[144:147]
    ds_read_b64_tr_b16 a[62:63], v1 offset:51808
    v_add_f32 v89, v89, v53
    v_mfma_f32_16x16x32_bf16 v[144:147], a[20:23], v[32:35], v[144:147]
    ds_read_b64_tr_b16 a[64:65], v1 offset:34304
    ds_read_b64_tr_b16 a[66:67], v1 offset:34816
    v_mfma_f32_16x16x32_bf16 v[152:155], a[16:19], v[24:27], v[152:155]
    ds_read_b64_tr_b16 a[68:69], v1 offset:51328
    v_cvt_pk_bf16_f32 v50, v52, v53
    v_mfma_f32_16x16x32_bf16 v[152:155], a[20:23], v[40:43], v[152:155]
    s_waitcnt lgkmcnt(10)
    ds_read_b64_tr_b16 a[70:71], v1 offset:51840
    ds_read_b64_tr_b16 a[72:73], v1 offset:34336
    v_mfma_f32_16x16x32_bf16 v[148:151], a[24:27], v[16:19], v[148:151]
    v_exp_f32 v54, v54
    v_mfma_f32_16x16x32_bf16 v[148:151], a[28:31], v[32:35], v[148:151]
    v_exp_f32 v55, v55
    v_mfma_f32_16x16x32_bf16 v[156:159], a[24:27], v[24:27], v[156:159]
    ds_read_b64_tr_b16 a[74:75], v1 offset:34848
    ds_read_b64_tr_b16 a[76:77], v1 offset:51360
    v_mfma_f32_16x16x32_bf16 v[156:159], a[28:31], v[40:43], v[156:159]
    ds_read_b64_tr_b16 a[78:79], v1 offset:51872
    v_add_f32 v88, v88, v54
    v_mfma_f32_16x16x32_bf16 v[160:163], a[32:35], v[16:19], v[160:163]
    ds_read_b64_tr_b16 a[80:81], v1 offset:34368
    v_add_f32 v89, v89, v55
    v_mfma_f32_16x16x32_bf16 v[160:163], a[36:39], v[32:35], v[160:163]
    ds_read_b64_tr_b16 a[82:83], v1 offset:34880
    v_cvt_pk_bf16_f32 v51, v54, v55
    v_mfma_f32_16x16x32_bf16 v[168:171], a[32:35], v[24:27], v[168:171]
    ds_read_b64_tr_b16 a[84:85], v1 offset:51392
    ds_read_b64_tr_b16 a[86:87], v1 offset:51904
    v_mfma_f32_16x16x32_bf16 v[168:171], a[36:39], v[40:43], v[168:171]
    v_exp_f32 v60, v60
    v_mfma_f32_16x16x32_bf16 v[164:167], a[40:43], v[16:19], v[164:167]
    ds_read_b64_tr_b16 a[88:89], v1 offset:34400
    ds_read_b64_tr_b16 a[90:91], v1 offset:34912
    v_mfma_f32_16x16x32_bf16 v[164:167], a[44:47], v[32:35], v[164:167]
    v_exp_f32 v61, v61
    v_mfma_f32_16x16x32_bf16 v[172:175], a[40:43], v[24:27], v[172:175]
    ds_read_b64_tr_b16 a[92:93], v1 offset:51424
    v_add_f32 v90, v90, v60
    v_mfma_f32_16x16x32_bf16 v[172:175], a[44:47], v[40:43], v[172:175]
    s_waitcnt lgkmcnt(10)
    ds_read_b64_tr_b16 a[94:95], v1 offset:51936
    v_add_f32 v91, v91, v61
    v_mfma_f32_16x16x32_bf16 v[176:179], a[48:51], v[16:19], v[176:179]
    ds_read_b64_tr_b16 a[96:97], v1 offset:34432
    ds_read_b64_tr_b16 a[98:99], v1 offset:34944
    v_mfma_f32_16x16x32_bf16 v[176:179], a[52:55], v[32:35], v[176:179]
    ds_read_b64_tr_b16 a[100:101], v1 offset:51456
    v_cvt_pk_bf16_f32 v58, v60, v61
    v_mfma_f32_16x16x32_bf16 v[184:187], a[48:51], v[24:27], v[184:187]
    ds_read_b64_tr_b16 a[102:103], v1 offset:51968
    ds_read_b64_tr_b16 a[104:105], v1 offset:34464
    v_mfma_f32_16x16x32_bf16 v[184:187], a[52:55], v[40:43], v[184:187]
    v_exp_f32 v62, v62
    v_mfma_f32_16x16x32_bf16 v[180:183], a[56:59], v[16:19], v[180:183]
    ds_read_b64_tr_b16 a[106:107], v1 offset:34976
    ds_read_b64_tr_b16 a[108:109], v1 offset:51488
    v_mfma_f32_16x16x32_bf16 v[180:183], a[60:63], v[32:35], v[180:183]
    v_exp_f32 v63, v63
    v_mfma_f32_16x16x32_bf16 v[188:191], a[56:59], v[24:27], v[188:191]
    ds_read_b64_tr_b16 a[110:111], v1 offset:52000
    v_add_f32 v90, v90, v62
    v_mfma_f32_16x16x32_bf16 v[188:191], a[60:63], v[40:43], v[188:191]
    ds_read_b64_tr_b16 a[112:113], v1 offset:34496
    v_add_f32 v91, v91, v63
    v_mfma_f32_16x16x32_bf16 v[192:195], a[64:67], v[16:19], v[192:195]
    ds_read_b64_tr_b16 a[114:115], v1 offset:35008
    ds_read_b64_tr_b16 a[116:117], v1 offset:51520
    v_mfma_f32_16x16x32_bf16 v[192:195], a[68:71], v[32:35], v[192:195]
    ds_read_b64_tr_b16 a[118:119], v1 offset:52032
    ds_read_b64_tr_b16 a[120:121], v1 offset:34528
    ds_read_b64_tr_b16 a[122:123], v1 offset:35040
    ds_read_b64_tr_b16 a[124:125], v1 offset:51552
    ds_read_b64_tr_b16 a[126:127], v1 offset:52064
    v_cvt_pk_bf16_f32 v59, v62, v63
    v_mfma_f32_16x16x32_bf16 v[200:203], a[64:67], v[24:27], v[200:203]
    v_exp_f32 v64, v64
    v_mfma_f32_16x16x32_bf16 v[200:203], a[68:71], v[40:43], v[200:203]
    s_waitcnt lgkmcnt(13)
    v_exp_f32 v65, v65
    v_mfma_f32_16x16x32_bf16 v[196:199], a[72:75], v[16:19], v[196:199]
    v_add_f32 v88, v88, v64
    v_add_f32 v89, v89, v65
    v_mfma_f32_16x16x32_bf16 v[196:199], a[76:79], v[32:35], v[196:199]
    v_cvt_pk_bf16_f32 v64, v64, v65
    v_mfma_f32_16x16x32_bf16 v[204:207], a[72:75], v[24:27], v[204:207]
    s_add_u32 m0, s40, 0
    v_exp_f32 v66, v66
    v_mfma_f32_16x16x32_bf16 v[204:207], a[76:79], v[40:43], v[204:207]
    v_exp_f32 v67, v67
    v_mfma_f32_16x16x32_bf16 v[208:211], a[80:83], v[16:19], v[208:211]
    s_waitcnt vmcnt(0) lgkmcnt(0)
    v_add_f32 v88, v88, v66
    v_add_f32 v89, v89, v67
    v_mfma_f32_16x16x32_bf16 v[208:211], a[84:87], v[32:35], v[208:211]
    s_barrier
    ds_read_b128 a[0:3], v3 offset:0
    v_cvt_pk_bf16_f32 v65, v66, v67
    v_mfma_f32_16x16x32_bf16 v[216:219], a[80:83], v[24:27], v[216:219]
    buffer_load_dwordx4 v6, s[4:7], s24 offen offset:0 lds
    v_mfma_f32_16x16x32_bf16 v[216:219], a[84:87], v[40:43], v[216:219]
    ds_read_b128 a[4:7], v3 offset:64
    v_mfma_f32_16x16x32_bf16 v[212:215], a[88:91], v[16:19], v[212:215]
    ds_read_b128 a[8:11], v3 offset:128
    v_mfma_f32_16x16x32_bf16 v[212:215], a[92:95], v[32:35], v[212:215]
    v_exp_f32 v72, v72
    v_mfma_f32_16x16x32_bf16 v[220:223], a[88:91], v[24:27], v[220:223]
    buffer_load_dwordx4 v6, s[4:7], s25 offen offset:1024 lds
    v_mfma_f32_16x16x32_bf16 v[220:223], a[92:95], v[40:43], v[220:223]
    ds_read_b128 a[12:15], v3 offset:192
    v_add_f32 v90, v90, v72
    v_mfma_f32_16x16x32_bf16 v[224:227], a[96:99], v[16:19], v[224:227]
    v_exp_f32 v73, v73
    v_mfma_f32_16x16x32_bf16 v[224:227], a[100:103], v[32:35], v[224:227]
    ds_read_b128 a[16:19], v3 offset:256
    v_add_f32 v91, v91, v73
    v_mfma_f32_16x16x32_bf16 v[232:235], a[96:99], v[24:27], v[232:235]
    buffer_load_dwordx4 v6, s[4:7], s26 offen offset:2064 lds
    v_mfma_f32_16x16x32_bf16 v[232:235], a[100:103], v[40:43], v[232:235]
    ds_read_b128 a[20:23], v3 offset:320
    v_cvt_pk_bf16_f32 v72, v72, v73
    v_mfma_f32_16x16x32_bf16 v[228:231], a[104:107], v[16:19], v[228:231]
    ds_read_b128 a[24:27], v3 offset:384
    v_mfma_f32_16x16x32_bf16 v[228:231], a[108:111], v[32:35], v[228:231]
    v_exp_f32 v74, v74
    v_mfma_f32_16x16x32_bf16 v[236:239], a[104:107], v[24:27], v[236:239]
    buffer_load_dwordx4 v6, s[4:7], s27 offen offset:3088 lds
    v_mfma_f32_16x16x32_bf16 v[236:239], a[108:111], v[40:43], v[236:239]
    s_add_u32 m0, s40, 17024
    ds_read_b128 a[28:31], v3 offset:448
    v_add_f32 v90, v90, v74
    v_mfma_f32_16x16x32_bf16 v[240:243], a[112:115], v[16:19], v[240:243]
    v_exp_f32 v75, v75
    v_mfma_f32_16x16x32_bf16 v[240:243], a[116:119], v[32:35], v[240:243]
    ds_read_b128 a[32:35], v3 offset:512
    v_add_f32 v91, v91, v75
    v_mfma_f32_16x16x32_bf16 v[248:251], a[112:115], v[24:27], v[248:251]
    ds_read_b128 a[36:39], v3 offset:576
    v_cvt_pk_bf16_f32 v73, v74, v75
    v_mfma_f32_16x16x32_bf16 v[248:251], a[116:119], v[40:43], v[248:251]
    buffer_load_dwordx4 v6, s[4:7], s28 offen offset:0 lds
    v_mfma_f32_16x16x32_bf16 v[244:247], a[120:123], v[16:19], v[244:247]
    ds_read_b128 a[40:43], v3 offset:640
    v_mfma_f32_16x16x32_bf16 v[244:247], a[124:127], v[32:35], v[244:247]
    s_waitcnt lgkmcnt(5)
    ds_read_b128 a[44:47], v3 offset:704
    v_mfma_f32_16x16x32_bf16 v[252:255], a[120:123], v[24:27], v[252:255]
    s_sub_u32 s47, s47, 1
    v_exp_f32 v68, v68
    v_mfma_f32_16x16x32_bf16 v[252:255], a[124:127], v[40:43], v[252:255]
    s_cmp_lg_u32 s47, 0
    buffer_load_dwordx4 v6, s[4:7], s29 offen offset:1024 lds
    v_mfma_f32_16x16x32_bf16 v[16:19], a[0:3], a[128:131], v[80:83]
    v_exp_f32 v69, v69
    v_mfma_f32_16x16x32_bf16 v[16:19], a[4:7], a[136:139], v[16:19]
    s_max_i32 s44, s57, 0
    ds_read_b128 a[48:51], v3 offset:768
    v_add_f32 v88, v88, v68
    v_mfma_f32_16x16x32_bf16 v[16:19], a[8:11], a[144:147], v[16:19]
    s_add_u32 s57, s57, 2048
    ds_read_b128 a[52:55], v3 offset:832
    v_add_f32 v89, v89, v69
    v_mfma_f32_16x16x32_bf16 v[16:19], a[12:15], a[152:155], v[16:19]
    buffer_load_dwordx4 v6, s[4:7], s30 offen offset:2064 lds
    v_mfma_f32_16x16x32_bf16 v[16:19], a[16:19], a[160:163], v[16:19]
    ds_read_b128 a[56:59], v3 offset:896
    v_cvt_pk_bf16_f32 v66, v68, v69
    v_mfma_f32_16x16x32_bf16 v[16:19], a[20:23], a[168:171], v[16:19]
    s_waitcnt lgkmcnt(5)
    ds_read_b128 a[60:63], v3 offset:960
    v_mfma_f32_16x16x32_bf16 v[16:19], a[24:27], a[176:179], v[16:19]
    v_exp_f32 v70, v70
    v_mfma_f32_16x16x32_bf16 v[16:19], a[28:31], a[184:187], v[16:19]
    buffer_load_dwordx4 v6, s[4:7], s31 offen offset:3088 lds
    v_mfma_f32_16x16x32_bf16 v[24:27], a[0:3], a[132:135], v[84:87]
    s_add_u32 m0, s41, 34048
    v_exp_f32 v71, v71
    v_mfma_f32_16x16x32_bf16 v[24:27], a[4:7], a[140:143], v[24:27]
    ds_read_b128 a[64:67], v3 offset:17024
    v_add_f32 v88, v88, v70
    v_mfma_f32_16x16x32_bf16 v[24:27], a[8:11], a[148:151], v[24:27]
    ds_read_b128 a[68:71], v3 offset:17088
    v_add_f32 v89, v89, v71
    v_mfma_f32_16x16x32_bf16 v[24:27], a[12:15], a[156:159], v[24:27]
    buffer_load_dwordx4 v6, s[8:11], s32 offen offset:0 lds
    v_mfma_f32_16x16x32_bf16 v[24:27], a[16:19], a[164:167], v[24:27]
    ds_read_b128 a[72:75], v3 offset:17152
    v_cvt_pk_bf16_f32 v67, v70, v71
    v_mfma_f32_16x16x32_bf16 v[24:27], a[20:23], a[172:175], v[24:27]
    ds_read_b128 a[76:79], v3 offset:17216
    v_mfma_f32_16x16x32_bf16 v[24:27], a[24:27], a[180:183], v[24:27]
    v_exp_f32 v76, v76
    v_mfma_f32_16x16x32_bf16 v[24:27], a[28:31], a[188:191], v[24:27]
    buffer_load_dwordx4 v6, s[8:11], s33 offen offset:1024 lds
    v_mfma_f32_16x16x32_bf16 v[20:23], a[32:35], a[128:131], v[80:83]
    ds_read_b128 a[80:83], v3 offset:17280
    v_add_f32 v90, v90, v76
    v_mfma_f32_16x16x32_bf16 v[20:23], a[36:39], a[136:139], v[20:23]
    s_waitcnt lgkmcnt(5)
    v_exp_f32 v77, v77
    v_mfma_f32_16x16x32_bf16 v[20:23], a[40:43], a[144:147], v[20:23]
    ds_read_b128 a[84:87], v3 offset:17344
    v_add_f32 v91, v91, v77
    v_mfma_f32_16x16x32_bf16 v[20:23], a[44:47], a[152:155], v[20:23]
    buffer_load_dwordx4 v6, s[8:11], s34 offen offset:2176 lds
    v_mfma_f32_16x16x32_bf16 v[20:23], a[48:51], a[160:163], v[20:23]
    ds_read_b128 a[88:91], v3 offset:17408
    v_cvt_pk_bf16_f32 v74, v76, v77
    v_mfma_f32_16x16x32_bf16 v[20:23], a[52:55], a[168:171], v[20:23]
    ds_read_b128 a[92:95], v3 offset:17472
    v_mfma_f32_16x16x32_bf16 v[20:23], a[56:59], a[176:179], v[20:23]
    v_exp_f32 v78, v78
    v_mfma_f32_16x16x32_bf16 v[20:23], a[60:63], a[184:187], v[20:23]
    buffer_load_dwordx4 v6, s[8:11], s35 offen offset:3200 lds
    v_mfma_f32_16x16x32_bf16 v[28:31], a[32:35], a[132:135], v[84:87]
    s_add_u32 m0, s41, 51072
    ds_read_b128 a[96:99], v3 offset:17536
    v_add_f32 v90, v90, v78
    v_mfma_f32_16x16x32_bf16 v[28:31], a[36:39], a[140:143], v[28:31]
    v_exp_f32 v79, v79
    v_mfma_f32_16x16x32_bf16 v[28:31], a[40:43], a[148:151], v[28:31]
    ds_read_b128 a[100:103], v3 offset:17600
    v_add_f32 v91, v91, v79
    v_mfma_f32_16x16x32_bf16 v[28:31], a[44:47], a[156:159], v[28:31]
    ds_read_b128 a[104:107], v3 offset:17664
    v_cvt_pk_bf16_f32 v75, v78, v79
    v_mfma_f32_16x16x32_bf16 v[28:31], a[48:51], a[164:167], v[28:31]
    buffer_load_dwordx4 v6, s[8:11], s36 offen offset:0 lds
    v_mfma_f32_16x16x32_bf16 v[28:31], a[52:55], a[172:175], v[28:31]
    ds_read_b128 a[108:111], v3 offset:17728
    v_mfma_f32_16x16x32_bf16 v[28:31], a[56:59], a[180:183], v[28:31]
    ds_read_b128 a[112:115], v3 offset:17792
    v_mfma_f32_16x16x32_bf16 v[28:31], a[60:63], a[188:191], v[28:31]
    s_waitcnt lgkmcnt(5)
    buffer_load_dwordx4 v6, s[8:11], s37 offen offset:1024 lds
    v_mfma_f32_16x16x32_bf16 v[32:35], a[64:67], a[128:131], v[80:83]
    v_exp_f32 v16, v16
    v_mfma_f32_16x16x32_bf16 v[32:35], a[68:71], a[136:139], v[32:35]
    ds_read_b128 a[116:119], v3 offset:17856
    v_add_f32 v88, v88, v16
    v_mfma_f32_16x16x32_bf16 v[32:35], a[72:75], a[144:147], v[32:35]
    v_exp_f32 v17, v17
    v_mfma_f32_16x16x32_bf16 v[32:35], a[76:79], a[152:155], v[32:35]
    ds_read_b128 a[120:123], v3 offset:17920
    v_add_f32 v89, v89, v17
    v_mfma_f32_16x16x32_bf16 v[32:35], a[80:83], a[160:163], v[32:35]
    buffer_load_dwordx4 v6, s[8:11], s38 offen offset:2176 lds
    v_mfma_f32_16x16x32_bf16 v[32:35], a[84:87], a[168:171], v[32:35]
    ds_read_b128 a[124:127], v3 offset:17984
    v_cvt_pk_bf16_f32 v16, v16, v17
    v_mfma_f32_16x16x32_bf16 v[32:35], a[88:91], a[176:179], v[32:35]
    ds_read_b64_tr_b16 a[0:1], v4 offset:34048
    ds_read_b64_tr_b16 a[2:3], v4 offset:34560
    v_mfma_f32_16x16x32_bf16 v[32:35], a[92:95], a[184:187], v[32:35]
    buffer_load_dwordx4 v6, s[8:11], s39 offen offset:3200 lds
    v_mfma_f32_16x16x32_bf16 v[40:43], a[64:67], a[132:135], v[84:87]
    v_exp_f32 v18, v18
    v_mfma_f32_16x16x32_bf16 v[40:43], a[68:71], a[140:143], v[40:43]
    ds_read_b64_tr_b16 a[4:5], v4 offset:51072
    ds_read_b64_tr_b16 a[6:7], v4 offset:51584
    v_mfma_f32_16x16x32_bf16 v[40:43], a[72:75], a[148:151], v[40:43]
    v_exp_f32 v19, v19
    v_mfma_f32_16x16x32_bf16 v[40:43], a[76:79], a[156:159], v[40:43]
    ds_read_b64_tr_b16 a[8:9], v4 offset:34080
    v_add_u32 v6, 0x8000, v6
    v_mfma_f32_16x16x32_bf16 v[40:43], a[80:83], a[164:167], v[40:43]
    buffer_load_dword a244, v9, s[76:79], s54 offen
    v_mfma_f32_16x16x32_bf16 v[40:43], a[84:87], a[172:175], v[40:43]
    s_add_u32 s54, s54, 65536
    ds_read_b64_tr_b16 a[10:11], v4 offset:34592
    v_add_f32 v88, v88, v18
    v_mfma_f32_16x16x32_bf16 v[40:43], a[88:91], a[180:183], v[40:43]
    ds_read_b64_tr_b16 a[12:13], v4 offset:51104
    v_add_f32 v89, v89, v19
    v_mfma_f32_16x16x32_bf16 v[40:43], a[92:95], a[188:191], v[40:43]
    s_waitcnt lgkmcnt(7)
    ds_read_b64_tr_b16 a[14:15], v4 offset:51616
    v_cvt_pk_bf16_f32 v17, v18, v19
    v_mfma_f32_16x16x32_bf16 v[36:39], a[96:99], a[128:131], v[80:83]
    ds_read_b64_tr_b16 a[16:17], v4 offset:34112
    ds_read_b64_tr_b16 a[18:19], v4 offset:34624
    v_mfma_f32_16x16x32_bf16 v[36:39], a[100:103], a[136:139], v[36:39]
    buffer_load_dword a238, v9, s[16:19], s44 offen
    v_mfma_f32_16x16x32_bf16 v[36:39], a[104:107], a[144:147], v[36:39]
    v_exp_f32 v24, v24
    v_mfma_f32_16x16x32_bf16 v[36:39], a[108:111], a[152:155], v[36:39]
    ds_read_b64_tr_b16 a[20:21], v4 offset:51136
    ds_read_b64_tr_b16 a[22:23], v4 offset:51648
    v_mfma_f32_16x16x32_bf16 v[36:39], a[112:115], a[160:163], v[36:39]
    v_exp_f32 v25, v25
    v_mfma_f32_16x16x32_bf16 v[36:39], a[116:119], a[168:171], v[36:39]
    ds_read_b64_tr_b16 a[24:25], v4 offset:34144
    v_add_f32 v90, v90, v24
    v_mfma_f32_16x16x32_bf16 v[36:39], a[120:123], a[176:179], v[36:39]
    ds_read_b64_tr_b16 a[26:27], v4 offset:34656
    v_add_f32 v91, v91, v25
    v_mfma_f32_16x16x32_bf16 v[36:39], a[124:127], a[184:187], v[36:39]
    ds_read_b64_tr_b16 a[28:29], v4 offset:51168
    ds_read_b64_tr_b16 a[30:31], v4 offset:51680
    v_mfma_f32_16x16x32_bf16 v[44:47], a[96:99], a[132:135], v[84:87]
    ds_read_b64_tr_b16 a[32:33], v4 offset:34176
    v_cvt_pk_bf16_f32 v24, v24, v25
    v_mfma_f32_16x16x32_bf16 v[44:47], a[100:103], a[140:143], v[44:47]
    ds_read_b64_tr_b16 a[34:35], v4 offset:34688
    ds_read_b64_tr_b16 a[36:37], v4 offset:51200
    v_mfma_f32_16x16x32_bf16 v[44:47], a[104:107], a[148:151], v[44:47]
    v_exp_f32 v26, v26
    v_mfma_f32_16x16x32_bf16 v[44:47], a[108:111], a[156:159], v[44:47]
    ds_read_b64_tr_b16 a[38:39], v4 offset:51712
    ds_read_b64_tr_b16 a[40:41], v4 offset:34208
    v_mfma_f32_16x16x32_bf16 v[44:47], a[112:115], a[164:167], v[44:47]
    v_exp_f32 v27, v27
    v_mfma_f32_16x16x32_bf16 v[44:47], a[116:119], a[172:175], v[44:47]
    ds_read_b64_tr_b16 a[42:43], v4 offset:34720
    v_add_f32 v90, v90, v26
    v_mfma_f32_16x16x32_bf16 v[44:47], a[120:123], a[180:183], v[44:47]
    ds_read_b64_tr_b16 a[44:45], v4 offset:51232
    v_add_f32 v91, v91, v27
    v_mfma_f32_16x16x32_bf16 v[44:47], a[124:127], a[188:191], v[44:47]
    s_waitcnt lgkmcnt(10)
    ds_read_b64_tr_b16 a[46:47], v4 offset:51744
    ds_read_b64_tr_b16 a[48:49], v4 offset:34240
    v_mfma_f32_16x16x32_bf16 v[128:131], a[0:3], v[48:51], v[128:131]
    ds_read_b64_tr_b16 a[50:51], v4 offset:34752
    v_cvt_pk_bf16_f32 v25, v26, v27
    v_mfma_f32_16x16x32_bf16 v[128:131], a[4:7], v[64:67], v[128:131]
    ds_read_b64_tr_b16 a[52:53], v4 offset:51264
    ds_read_b64_tr_b16 a[54:55], v4 offset:51776
    v_mfma_f32_16x16x32_bf16 v[136:139], a[0:3], v[56:59], v[136:139]
    v_exp_f32 v20, v20
    v_mfma_f32_16x16x32_bf16 v[136:139], a[4:7], v[72:75], v[136:139]
    v_exp_f32 v21, v21
    v_mfma_f32_16x16x32_bf16 v[132:135], a[8:11], v[48:51], v[132:135]
    ds_read_b64_tr_b16 a[56:57], v4 offset:34272
    ds_read_b64_tr_b16 a[58:59], v4 offset:34784
    v_mfma_f32_16x16x32_bf16 v[132:135], a[12:15], v[64:67], v[132:135]
    ds_read_b64_tr_b16 a[60:61], v4 offset:51296
    v_add_f32 v88, v88, v20
    v_mfma_f32_16x16x32_bf16 v[140:143], a[8:11], v[56:59], v[140:143]
    ds_read_b64_tr_b16 a[62:63], v4 offset:51808
    v_add_f32 v89, v89, v21
    v_mfma_f32_16x16x32_bf16 v[140:143], a[12:15], v[72:75], v[140:143]
    ds_read_b64_tr_b16 a[64:65], v4 offset:34304
    ds_read_b64_tr_b16 a[66:67], v4 offset:34816
    v_mfma_f32_16x16x32_bf16 v[144:147], a[16:19], v[48:51], v[144:147]
    ds_read_b64_tr_b16 a[68:69], v4 offset:51328
    v_cvt_pk_bf16_f32 v18, v20, v21
    v_mfma_f32_16x16x32_bf16 v[144:147], a[20:23], v[64:67], v[144:147]
    ds_read_b64_tr_b16 a[70:71], v4 offset:51840
    ds_read_b64_tr_b16 a[72:73], v4 offset:34336
    v_mfma_f32_16x16x32_bf16 v[152:155], a[16:19], v[56:59], v[152:155]
    v_exp_f32 v22, v22
    v_mfma_f32_16x16x32_bf16 v[152:155], a[20:23], v[72:75], v[152:155]
    s_waitcnt lgkmcnt(9)
    v_exp_f32 v23, v23
    v_mfma_f32_16x16x32_bf16 v[148:151], a[24:27], v[48:51], v[148:151]
    ds_read_b64_tr_b16 a[74:75], v4 offset:34848
    ds_read_b64_tr_b16 a[76:77], v4 offset:51360
    v_mfma_f32_16x16x32_bf16 v[148:151], a[28:31], v[64:67], v[148:151]
    ds_read_b64_tr_b16 a[78:79], v4 offset:51872
    v_add_f32 v88, v88, v22
    v_mfma_f32_16x16x32_bf16 v[156:159], a[24:27], v[56:59], v[156:159]
    ds_read_b64_tr_b16 a[80:81], v4 offset:34368
    v_add_f32 v89, v89, v23
    v_mfma_f32_16x16x32_bf16 v[156:159], a[28:31], v[72:75], v[156:159]
    ds_read_b64_tr_b16 a[82:83], v4 offset:34880
    v_cvt_pk_bf16_f32 v19, v22, v23
    v_mfma_f32_16x16x32_bf16 v[160:163], a[32:35], v[48:51], v[160:163]
    ds_read_b64_tr_b16 a[84:85], v4 offset:51392
    ds_read_b64_tr_b16 a[86:87], v4 offset:51904
    v_mfma_f32_16x16x32_bf16 v[160:163], a[36:39], v[64:67], v[160:163]
    v_exp_f32 v28, v28
    v_mfma_f32_16x16x32_bf16 v[168:171], a[32:35], v[56:59], v[168:171]
    ds_read_b64_tr_b16 a[88:89], v4 offset:34400
    ds_read_b64_tr_b16 a[90:91], v4 offset:34912
    v_mfma_f32_16x16x32_bf16 v[168:171], a[36:39], v[72:75], v[168:171]
    v_exp_f32 v29, v29
    v_mfma_f32_16x16x32_bf16 v[164:167], a[40:43], v[48:51], v[164:167]
    ds_read_b64_tr_b16 a[92:93], v4 offset:51424
    v_add_f32 v90, v90, v28
    v_mfma_f32_16x16x32_bf16 v[164:167], a[44:47], v[64:67], v[164:167]
    ds_read_b64_tr_b16 a[94:95], v4 offset:51936
    v_add_f32 v91, v91, v29
    v_mfma_f32_16x16x32_bf16 v[172:175], a[40:43], v[56:59], v[172:175]
    ds_read_b64_tr_b16 a[96:97], v4 offset:34432
    ds_read_b64_tr_b16 a[98:99], v4 offset:34944
    v_mfma_f32_16x16x32_bf16 v[172:175], a[44:47], v[72:75], v[172:175]
    ds_read_b64_tr_b16 a[100:101], v4 offset:51456
    v_cvt_pk_bf16_f32 v26, v28, v29
    v_mfma_f32_16x16x32_bf16 v[176:179], a[48:51], v[48:51], v[176:179]
    ds_read_b64_tr_b16 a[102:103], v4 offset:51968
    ds_read_b64_tr_b16 a[104:105], v4 offset:34464
    v_mfma_f32_16x16x32_bf16 v[176:179], a[52:55], v[64:67], v[176:179]
    v_exp_f32 v30, v30
    v_mfma_f32_16x16x32_bf16 v[184:187], a[48:51], v[56:59], v[184:187]
    ds_read_b64_tr_b16 a[106:107], v4 offset:34976
    ds_read_b64_tr_b16 a[108:109], v4 offset:51488
    v_mfma_f32_16x16x32_bf16 v[184:187], a[52:55], v[72:75], v[184:187]
    s_waitcnt lgkmcnt(11)
    v_exp_f32 v31, v31
    v_mfma_f32_16x16x32_bf16 v[180:183], a[56:59], v[48:51], v[180:183]
    ds_read_b64_tr_b16 a[110:111], v4 offset:52000
    v_add_f32 v90, v90, v30
    v_mfma_f32_16x16x32_bf16 v[180:183], a[60:63], v[64:67], v[180:183]
    ds_read_b64_tr_b16 a[112:113], v4 offset:34496
    v_add_f32 v91, v91, v31
    v_mfma_f32_16x16x32_bf16 v[188:191], a[56:59], v[56:59], v[188:191]
    ds_read_b64_tr_b16 a[114:115], v4 offset:35008
    ds_read_b64_tr_b16 a[116:117], v4 offset:51520
    v_mfma_f32_16x16x32_bf16 v[188:191], a[60:63], v[72:75], v[188:191]
    ds_read_b64_tr_b16 a[118:119], v4 offset:52032
    v_cvt_pk_bf16_f32 v27, v30, v31
    v_mfma_f32_16x16x32_bf16 v[192:195], a[64:67], v[48:51], v[192:195]
    ds_read_b64_tr_b16 a[120:121], v4 offset:34528
    ds_read_b64_tr_b16 a[122:123], v4 offset:35040
    v_mfma_f32_16x16x32_bf16 v[192:195], a[68:71], v[64:67], v[192:195]
    ds_read_b64_tr_b16 a[124:125], v4 offset:51552
    ds_read_b64_tr_b16 a[126:127], v4 offset:52064
    v_exp_f32 v32, v32
    v_mfma_f32_16x16x32_bf16 v[200:203], a[64:67], v[56:59], v[200:203]
    v_exp_f32 v33, v33
    v_mfma_f32_16x16x32_bf16 v[200:203], a[68:71], v[72:75], v[200:203]
    v_add_f32 v88, v88, v32
    v_add_f32 v89, v89, v33
    v_mfma_f32_16x16x32_bf16 v[196:199], a[72:75], v[48:51], v[196:199]
    v_cvt_pk_bf16_f32 v32, v32, v33
    v_mfma_f32_16x16x32_bf16 v[196:199], a[76:79], v[64:67], v[196:199]
    v_exp_f32 v34, v34
    v_mfma_f32_16x16x32_bf16 v[204:207], a[72:75], v[56:59], v[204:207]
    s_add_u32 m0, s40, 68096
    v_exp_f32 v35, v35
    v_mfma_f32_16x16x32_bf16 v[204:207], a[76:79], v[72:75], v[204:207]
    v_add_f32 v88, v88, v34
    v_add_f32 v89, v89, v35
    v_mfma_f32_16x16x32_bf16 v[208:211], a[80:83], v[48:51], v[208:211]
    s_waitcnt vmcnt(2) lgkmcnt(0)
    v_exp_f32 v40, v40
    v_mfma_f32_16x16x32_bf16 v[208:211], a[84:87], v[64:67], v[208:211]
    s_barrier
    ds_read_b128 a[0:3], v2 offset:0
    v_cvt_pk_bf16_f32 v33, v34, v35
    v_mfma_f32_16x16x32_bf16 v[216:219], a[80:83], v[56:59], v[216:219]
    buffer_load_dwordx4 v6, s[4:7], s24 offen offset:0 lds
    v_mfma_f32_16x16x32_bf16 v[216:219], a[84:87], v[72:75], v[216:219]
    ds_read_b128 a[4:7], v2 offset:64
    v_add_f32 v90, v90, v40
    v_mfma_f32_16x16x32_bf16 v[212:215], a[88:91], v[48:51], v[212:215]
    ds_read_b128 a[8:11], v2 offset:128
    v_mfma_f32_16x16x32_bf16 v[212:215], a[92:95], v[64:67], v[212:215]
    v_exp_f32 v41, v41
    v_mfma_f32_16x16x32_bf16 v[220:223], a[88:91], v[56:59], v[220:223]
    buffer_load_dwordx4 v6, s[4:7], s25 offen offset:1024 lds
    v_mfma_f32_16x16x32_bf16 v[220:223], a[92:95], v[72:75], v[220:223]
    ds_read_b128 a[12:15], v2 offset:192
    v_add_f32 v91, v91, v41
    v_mfma_f32_16x16x32_bf16 v[224:227], a[96:99], v[48:51], v[224:227]
    ds_read_b128 a[16:19], v2 offset:256
    v_cvt_pk_bf16_f32 v40, v40, v41
    v_mfma_f32_16x16x32_bf16 v[224:227], a[100:103], v[64:67], v[224:227]
    v_exp_f32 v42, v42
    v_mfma_f32_16x16x32_bf16 v[232:235], a[96:99], v[56:59], v[232:235]
    buffer_load_dwordx4 v6, s[4:7], s26 offen offset:2064 lds
    v_mfma_f32_16x16x32_bf16 v[232:235], a[100:103], v[72:75], v[232:235]
    ds_read_b128 a[20:23], v2 offset:320
    v_add_f32 v90, v90, v42
    v_mfma_f32_16x16x32_bf16 v[228:231], a[104:107], v[48:51], v[228:231]
    ds_read_b128 a[24:27], v2 offset:384
    v_mfma_f32_16x16x32_bf16 v[228:231], a[108:111], v[64:67], v[228:231]
    v_exp_f32 v43, v43
    v_mfma_f32_16x16x32_bf16 v[236:239], a[104:107], v[56:59], v[236:239]
    buffer_load_dwordx4 v6, s[4:7], s27 offen offset:3088 lds
    v_mfma_f32_16x16x32_bf16 v[236:239], a[108:111], v[72:75], v[236:239]
    s_add_u32 m0, s40, 85120
    ds_read_b128 a[28:31], v2 offset:448
    v_add_f32 v91, v91, v43
    v_mfma_f32_16x16x32_bf16 v[240:243], a[112:115], v[48:51], v[240:243]
    ds_read_b128 a[32:35], v2 offset:512
    v_cvt_pk_bf16_f32 v41, v42, v43
    v_mfma_f32_16x16x32_bf16 v[240:243], a[116:119], v[64:67], v[240:243]
    ds_read_b128 a[36:39], v2 offset:576
    v_mfma_f32_16x16x32_bf16 v[248:251], a[112:115], v[56:59], v[248:251]
    buffer_load_dwordx4 v6, s[4:7], s28 offen offset:0 lds
    v_mfma_f32_16x16x32_bf16 v[248:251], a[116:119], v[72:75], v[248:251]
    ds_read_b128 a[40:43], v2 offset:640
    v_mfma_f32_16x16x32_bf16 v[244:247], a[120:123], v[48:51], v[244:247]
    v_exp_f32 v36, v36
    v_mfma_f32_16x16x32_bf16 v[244:247], a[124:127], v[64:67], v[244:247]
    ds_read_b128 a[44:47], v2 offset:704
    v_add_f32 v88, v88, v36
    v_mfma_f32_16x16x32_bf16 v[252:255], a[120:123], v[56:59], v[252:255]
    buffer_load_dwordx4 v6, s[4:7], s29 offen offset:1024 lds
    v_mfma_f32_16x16x32_bf16 v[252:255], a[124:127], v[72:75], v[252:255]
    s_waitcnt lgkmcnt(5)
    v_exp_f32 v37, v37
    v_mfma_f32_16x16x32_bf16 v[48:51], a[0:3], a[128:131], v[80:83]
    ds_read_b128 a[48:51], v2 offset:768
    v_add_f32 v89, v89, v37
    v_mfma_f32_16x16x32_bf16 v[48:51], a[4:7], a[136:139], v[48:51]
    ds_read_b128 a[52:55], v2 offset:832
    v_cvt_pk_bf16_f32 v34, v36, v37
    v_mfma_f32_16x16x32_bf16 v[48:51], a[8:11], a[144:147], v[48:51]
    buffer_load_dwordx4 v6, s[4:7], s30 offen offset:2064 lds
    v_mfma_f32_16x16x32_bf16 v[48:51], a[12:15], a[152:155], v[48:51]
    ds_read_b128 a[56:59], v2 offset:896
    v_mfma_f32_16x16x32_bf16 v[48:51], a[16:19], a[160:163], v[48:51]
    v_exp_f32 v38, v38
    v_mfma_f32_16x16x32_bf16 v[48:51], a[20:23], a[168:171], v[48:51]
    ds_read_b128 a[60:63], v2 offset:960
    v_add_f32 v88, v88, v38
    v_mfma_f32_16x16x32_bf16 v[48:51], a[24:27], a[176:179], v[48:51]
    s_waitcnt lgkmcnt(5)
    buffer_load_dwordx4 v6, s[4:7], s31 offen offset:3088 lds
    v_mfma_f32_16x16x32_bf16 v[48:51], a[28:31], a[184:187], v[48:51]
    s_add_u32 m0, s41, 102144
    v_exp_f32 v39, v39
    v_mfma_f32_16x16x32_bf16 v[56:59], a[0:3], a[132:135], v[84:87]
    ds_read_b128 a[64:67], v2 offset:17024
    v_add_f32 v89, v89, v39
    v_mfma_f32_16x16x32_bf16 v[56:59], a[4:7], a[140:143], v[56:59]
    ds_read_b128 a[68:71], v2 offset:17088
    v_cvt_pk_bf16_f32 v35, v38, v39
    v_mfma_f32_16x16x32_bf16 v[56:59], a[8:11], a[148:151], v[56:59]
    buffer_load_dwordx4 v6, s[8:11], s32 offen offset:0 lds
    v_mfma_f32_16x16x32_bf16 v[56:59], a[12:15], a[156:159], v[56:59]
    ds_read_b128 a[72:75], v2 offset:17152
    v_mfma_f32_16x16x32_bf16 v[56:59], a[16:19], a[164:167], v[56:59]
    ds_read_b128 a[76:79], v2 offset:17216
    v_mfma_f32_16x16x32_bf16 v[56:59], a[20:23], a[172:175], v[56:59]
    v_exp_f32 v44, v44
    v_mfma_f32_16x16x32_bf16 v[56:59], a[24:27], a[180:183], v[56:59]
    buffer_load_dwordx4 v6, s[8:11], s33 offen offset:1024 lds
    v_mfma_f32_16x16x32_bf16 v[56:59], a[28:31], a[188:191], v[56:59]
    ds_read_b128 a[80:83], v2 offset:17280
    v_add_f32 v90, v90, v44
    v_mfma_f32_16x16x32_bf16 v[52:55], a[32:35], a[128:131], v[80:83]
    v_exp_f32 v45, v45
    v_mfma_f32_16x16x32_bf16 v[52:55], a[36:39], a[136:139], v[52:55]
    ds_read_b128 a[84:87], v2 offset:17344
    v_add_f32 v91, v91, v45
    v_mfma_f32_16x16x32_bf16 v[52:55], a[40:43], a[144:147], v[52:55]
    s_waitcnt lgkmcnt(5)
    buffer_load_dwordx4 v6, s[8:11], s34 offen offset:2176 lds
    v_mfma_f32_16x16x32_bf16 v[52:55], a[44:47], a[152:155], v[52:55]
    ds_read_b128 a[88:91], v2 offset:17408
    v_cvt_pk_bf16_f32 v42, v44, v45
    v_mfma_f32_16x16x32_bf16 v[52:55], a[48:51], a[160:163], v[52:55]
    ds_read_b128 a[92:95], v2 offset:17472
    v_mfma_f32_16x16x32_bf16 v[52:55], a[52:55], a[168:171], v[52:55]
    v_exp_f32 v46, v46
    v_mfma_f32_16x16x32_bf16 v[52:55], a[56:59], a[176:179], v[52:55]
    buffer_load_dwordx4 v6, s[8:11], s35 offen offset:3200 lds
    v_mfma_f32_16x16x32_bf16 v[52:55], a[60:63], a[184:187], v[52:55]
    s_add_u32 m0, s41, 119168
    ds_read_b128 a[96:99], v2 offset:17536
    v_add_f32 v90, v90, v46
    v_mfma_f32_16x16x32_bf16 v[60:63], a[32:35], a[132:135], v[84:87]
    v_exp_f32 v47, v47
    v_mfma_f32_16x16x32_bf16 v[60:63], a[36:39], a[140:143], v[60:63]
    ds_read_b128 a[100:103], v2 offset:17600
    v_add_f32 v91, v91, v47
    v_mfma_f32_16x16x32_bf16 v[60:63], a[40:43], a[148:151], v[60:63]
    ds_read_b128 a[104:107], v2 offset:17664
    v_cvt_pk_bf16_f32 v43, v46, v47
    v_mfma_f32_16x16x32_bf16 v[60:63], a[44:47], a[156:159], v[60:63]
    buffer_load_dwordx4 v6, s[8:11], s36 offen offset:0 lds
    v_mfma_f32_16x16x32_bf16 v[60:63], a[48:51], a[164:167], v[60:63]
    ds_read_b128 a[108:111], v2 offset:17728
    v_mfma_f32_16x16x32_bf16 v[60:63], a[52:55], a[172:175], v[60:63]
    ds_read_b128 a[112:115], v2 offset:17792
    v_mfma_f32_16x16x32_bf16 v[60:63], a[56:59], a[180:183], v[60:63]
    buffer_load_dwordx4 v6, s[8:11], s37 offen offset:1024 lds
    v_mfma_f32_16x16x32_bf16 v[60:63], a[60:63], a[188:191], v[60:63]
    v_exp_f32 v48, v48
    v_mfma_f32_16x16x32_bf16 v[64:67], a[64:67], a[128:131], v[80:83]
    s_waitcnt lgkmcnt(5)
    ds_read_b128 a[116:119], v2 offset:17856
    v_add_f32 v88, v88, v48
    v_mfma_f32_16x16x32_bf16 v[64:67], a[68:71], a[136:139], v[64:67]
    v_exp_f32 v49, v49
    v_mfma_f32_16x16x32_bf16 v[64:67], a[72:75], a[144:147], v[64:67]
    ds_read_b128 a[120:123], v2 offset:17920
    v_add_f32 v89, v89, v49
    v_mfma_f32_16x16x32_bf16 v[64:67], a[76:79], a[152:155], v[64:67]
    buffer_load_dwordx4 v6, s[8:11], s38 offen offset:2176 lds
    v_mfma_f32_16x16x32_bf16 v[64:67], a[80:83], a[160:163], v[64:67]
    ds_read_b128 a[124:127], v2 offset:17984
    v_cvt_pk_bf16_f32 v48, v48, v49
    v_mfma_f32_16x16x32_bf16 v[64:67], a[84:87], a[168:171], v[64:67]
    ds_read_b64_tr_b16 a[0:1], v1 offset:34048
    ds_read_b64_tr_b16 a[2:3], v1 offset:34560
    v_mfma_f32_16x16x32_bf16 v[64:67], a[88:91], a[176:179], v[64:67]
    buffer_load_dwordx4 v6, s[8:11], s39 offen offset:3200 lds
    v_mfma_f32_16x16x32_bf16 v[64:67], a[92:95], a[184:187], v[64:67]
    v_exp_f32 v50, v50
    v_mfma_f32_16x16x32_bf16 v[72:75], a[64:67], a[132:135], v[84:87]
    ds_read_b64_tr_b16 a[4:5], v1 offset:51072
    ds_read_b64_tr_b16 a[6:7], v1 offset:51584
    v_mfma_f32_16x16x32_bf16 v[72:75], a[68:71], a[140:143], v[72:75]
    v_exp_f32 v51, v51
    v_mfma_f32_16x16x32_bf16 v[72:75], a[72:75], a[148:151], v[72:75]
    ds_read_b64_tr_b16 a[8:9], v1 offset:34080
    v_add_u32 v6, 0x8000, v6
    v_mfma_f32_16x16x32_bf16 v[72:75], a[76:79], a[156:159], v[72:75]
    ds_read_b64_tr_b16 a[10:11], v1 offset:34592
    v_add_f32 v88, v88, v50
    v_mfma_f32_16x16x32_bf16 v[72:75], a[80:83], a[164:167], v[72:75]
    ds_read_b64_tr_b16 a[12:13], v1 offset:51104
    v_add_f32 v89, v89, v51
    v_mfma_f32_16x16x32_bf16 v[72:75], a[84:87], a[172:175], v[72:75]
    ds_read_b64_tr_b16 a[14:15], v1 offset:51616
    v_cvt_pk_bf16_f32 v49, v50, v51
    v_mfma_f32_16x16x32_bf16 v[72:75], a[88:91], a[180:183], v[72:75]
    ds_read_b64_tr_b16 a[16:17], v1 offset:34112
    ds_read_b64_tr_b16 a[18:19], v1 offset:34624
    v_mfma_f32_16x16x32_bf16 v[72:75], a[92:95], a[188:191], v[72:75]
    s_waitcnt lgkmcnt(8)
    v_exp_f32 v56, v56
    v_mfma_f32_16x16x32_bf16 v[68:71], a[96:99], a[128:131], v[80:83]
    ds_read_b64_tr_b16 a[20:21], v1 offset:51136
    ds_read_b64_tr_b16 a[22:23], v1 offset:51648
    v_mfma_f32_16x16x32_bf16 v[68:71], a[100:103], a[136:139], v[68:71]
    v_exp_f32 v57, v57
    v_mfma_f32_16x16x32_bf16 v[68:71], a[104:107], a[144:147], v[68:71]
    ds_read_b64_tr_b16 a[24:25], v1 offset:34144
    v_add_f32 v90, v90, v56
    v_mfma_f32_16x16x32_bf16 v[68:71], a[108:111], a[152:155], v[68:71]
    ds_read_b64_tr_b16 a[26:27], v1 offset:34656
    v_add_f32 v91, v91, v57
    v_mfma_f32_16x16x32_bf16 v[68:71], a[112:115], a[160:163], v[68:71]
    ds_read_b64_tr_b16 a[28:29], v1 offset:51168
    ds_read_b64_tr_b16 a[30:31], v1 offset:51680
    v_mfma_f32_16x16x32_bf16 v[68:71], a[116:119], a[168:171], v[68:71]
    ds_read_b64_tr_b16 a[32:33], v1 offset:34176
    v_cvt_pk_bf16_f32 v56, v56, v57
    v_mfma_f32_16x16x32_bf16 v[68:71], a[120:123], a[176:179], v[68:71]
    ds_read_b64_tr_b16 a[34:35], v1 offset:34688
    ds_read_b64_tr_b16 a[36:37], v1 offset:51200
    v_mfma_f32_16x16x32_bf16 v[68:71], a[124:127], a[184:187], v[68:71]
    v_exp_f32 v58, v58
    v_mfma_f32_16x16x32_bf16 v[76:79], a[96:99], a[132:135], v[84:87]
    ds_read_b64_tr_b16 a[38:39], v1 offset:51712
    ds_read_b64_tr_b16 a[40:41], v1 offset:34208
    v_mfma_f32_16x16x32_bf16 v[76:79], a[100:103], a[140:143], v[76:79]
    v_exp_f32 v59, v59
    v_mfma_f32_16x16x32_bf16 v[76:79], a[104:107], a[148:151], v[76:79]
    ds_read_b64_tr_b16 a[42:43], v1 offset:34720
    v_add_f32 v90, v90, v58
    v_mfma_f32_16x16x32_bf16 v[76:79], a[108:111], a[156:159], v[76:79]
    ds_read_b64_tr_b16 a[44:45], v1 offset:51232
    v_add_f32 v91, v91, v59
    v_mfma_f32_16x16x32_bf16 v[76:79], a[112:115], a[164:167], v[76:79]
    ds_read_b64_tr_b16 a[46:47], v1 offset:51744
    ds_read_b64_tr_b16 a[48:49], v1 offset:34240
    v_mfma_f32_16x16x32_bf16 v[76:79], a[116:119], a[172:175], v[76:79]
    ds_read_b64_tr_b16 a[50:51], v1 offset:34752
    v_cvt_pk_bf16_f32 v57, v58, v59
    v_mfma_f32_16x16x32_bf16 v[76:79], a[120:123], a[180:183], v[76:79]
    ds_read_b64_tr_b16 a[52:53], v1 offset:51264
    ds_read_b64_tr_b16 a[54:55], v1 offset:51776
    v_mfma_f32_16x16x32_bf16 v[76:79], a[124:127], a[188:191], v[76:79]
    v_exp_f32 v52, v52
    v_mfma_f32_16x16x32_bf16 v[128:131], a[0:3], v[16:19], v[128:131]
    s_waitcnt lgkmcnt(9)
    v_exp_f32 v53, v53
    v_mfma_f32_16x16x32_bf16 v[128:131], a[4:7], v[32:35], v[128:131]
    ds_read_b64_tr_b16 a[56:57], v1 offset:34272
    ds_read_b64_tr_b16 a[58:59], v1 offset:34784
    v_mfma_f32_16x16x32_bf16 v[136:139], a[0:3], v[24:27], v[136:139]
    ds_read_b64_tr_b16 a[60:61], v1 offset:51296
    v_add_f32 v88, v88, v52
    v_mfma_f32_16x16x32_bf16 v[136:139], a[4:7], v[40:43], v[136:139]
    ds_read_b64_tr_b16 a[62:63], v1 offset:51808
    v_add_f32 v89, v89, v53
    v_mfma_f32_16x16x32_bf16 v[132:135], a[8:11], v[16:19], v[132:135]
    ds_read_b64_tr_b16 a[64:65], v1 offset:34304
    ds_read_b64_tr_b16 a[66:67], v1 offset:34816
    v_mfma_f32_16x16x32_bf16 v[132:135], a[12:15], v[32:35], v[132:135]
    ds_read_b64_tr_b16 a[68:69], v1 offset:51328
    v_cvt_pk_bf16_f32 v50, v52, v53
    v_mfma_f32_16x16x32_bf16 v[140:143], a[8:11], v[24:27], v[140:143]
    ds_read_b64_tr_b16 a[70:71], v1 offset:51840
    ds_read_b64_tr_b16 a[72:73], v1 offset:34336
    v_mfma_f32_16x16x32_bf16 v[140:143], a[12:15], v[40:43], v[140:143]
    v_exp_f32 v54, v54
    v_mfma_f32_16x16x32_bf16 v[144:147], a[16:19], v[16:19], v[144:147]
    v_exp_f32 v55, v55
    v_mfma_f32_16x16x32_bf16 v[144:147], a[20:23], v[32:35], v[144:147]
    ds_read_b64_tr_b16 a[74:75], v1 offset:34848
    ds_read_b64_tr_b16 a[76:77], v1 offset:51360
    v_mfma_f32_16x16x32_bf16 v[152:155], a[16:19], v[24:27], v[152:155]
    ds_read_b64_tr_b16 a[78:79], v1 offset:51872
    v_add_f32 v88, v88, v54
    v_mfma_f32_16x16x32_bf16 v[152:155], a[20:23], v[40:43], v[152:155]
    ds_read_b64_tr_b16 a[80:81], v1 offset:34368
    v_add_f32 v89, v89, v55
    v_mfma_f32_16x16x32_bf16 v[148:151], a[24:27], v[16:19], v[148:151]
    ds_read_b64_tr_b16 a[82:83], v1 offset:34880
    v_cvt_pk_bf16_f32 v51, v54, v55
    v_mfma_f32_16x16x32_bf16 v[148:151], a[28:31], v[32:35], v[148:151]
    ds_read_b64_tr_b16 a[84:85], v1 offset:51392
    ds_read_b64_tr_b16 a[86:87], v1 offset:51904
    v_mfma_f32_16x16x32_bf16 v[156:159], a[24:27], v[24:27], v[156:159]
    v_exp_f32 v60, v60
    v_mfma_f32_16x16x32_bf16 v[156:159], a[28:31], v[40:43], v[156:159]
    ds_read_b64_tr_b16 a[88:89], v1 offset:34400
    ds_read_b64_tr_b16 a[90:91], v1 offset:34912
    v_mfma_f32_16x16x32_bf16 v[160:163], a[32:35], v[16:19], v[160:163]
    s_waitcnt lgkmcnt(9)
    v_exp_f32 v61, v61
    v_mfma_f32_16x16x32_bf16 v[160:163], a[36:39], v[32:35], v[160:163]
    ds_read_b64_tr_b16 a[92:93], v1 offset:51424
    v_add_f32 v90, v90, v60
    v_mfma_f32_16x16x32_bf16 v[168:171], a[32:35], v[24:27], v[168:171]
    ds_read_b64_tr_b16 a[94:95], v1 offset:51936
    v_add_f32 v91, v91, v61
    v_mfma_f32_16x16x32_bf16 v[168:171], a[36:39], v[40:43], v[168:171]
    ds_read_b64_tr_b16 a[96:97], v1 offset:34432
    ds_read_b64_tr_b16 a[98:99], v1 offset:34944
    v_mfma_f32_16x16x32_bf16 v[164:167], a[40:43], v[16:19], v[164:167]
    ds_read_b64_tr_b16 a[100:101], v1 offset:51456
    v_cvt_pk_bf16_f32 v58, v60, v61
    v_mfma_f32_16x16x32_bf16 v[164:167], a[44:47], v[32:35], v[164:167]
    ds_read_b64_tr_b16 a[102:103], v1 offset:51968
    ds_read_b64_tr_b16 a[104:105], v1 offset:34464
    v_mfma_f32_16x16x32_bf16 v[172:175], a[40:43], v[24:27], v[172:175]
    v_exp_f32 v62, v62
    v_mfma_f32_16x16x32_bf16 v[172:175], a[44:47], v[40:43], v[172:175]
    ds_read_b64_tr_b16 a[106:107], v1 offset:34976
    ds_read_b64_tr_b16 a[108:109], v1 offset:51488
    v_mfma_f32_16x16x32_bf16 v[176:179], a[48:51], v[16:19], v[176:179]
    v_exp_f32 v63, v63
    v_mfma_f32_16x16x32_bf16 v[176:179], a[52:55], v[32:35], v[176:179]
    ds_read_b64_tr_b16 a[110:111], v1 offset:52000
    v_add_f32 v90, v90, v62
    v_mfma_f32_16x16x32_bf16 v[184:187], a[48:51], v[24:27], v[184:187]
    ds_read_b64_tr_b16 a[112:113], v1 offset:34496
    v_add_f32 v91, v91, v63
    v_mfma_f32_16x16x32_bf16 v[184:187], a[52:55], v[40:43], v[184:187]
    ds_read_b64_tr_b16 a[114:115], v1 offset:35008
    ds_read_b64_tr_b16 a[116:117], v1 offset:51520
    v_mfma_f32_16x16x32_bf16 v[180:183], a[56:59], v[16:19], v[180:183]
    ds_read_b64_tr_b16 a[118:119], v1 offset:52032
    v_cvt_pk_bf16_f32 v59, v62, v63
    v_mfma_f32_16x16x32_bf16 v[180:183], a[60:63], v[32:35], v[180:183]
    ds_read_b64_tr_b16 a[120:121], v1 offset:34528
    v_mfma_f32_16x16x32_bf16 v[188:191], a[56:59], v[24:27], v[188:191]
    v_exp_f32 v64, v64
    v_mfma_f32_16x16x32_bf16 v[188:191], a[60:63], v[40:43], v[188:191]
    ds_read_b64_tr_b16 a[122:123], v1 offset:35040
    ds_read_b64_tr_b16 a[124:125], v1 offset:51552
    v_mfma_f32_16x16x32_bf16 v[192:195], a[64:67], v[16:19], v[192:195]
    v_exp_f32 v65, v65
    v_mfma_f32_16x16x32_bf16 v[192:195], a[68:71], v[32:35], v[192:195]
    ds_read_b64_tr_b16 a[126:127], v1 offset:52064
    v_add_f32 v88, v88, v64
    v_mfma_f32_16x16x32_bf16 v[200:203], a[64:67], v[24:27], v[200:203]
    v_add_f32 v89, v89, v65
    v_cvt_pk_bf16_f32 v64, v64, v65
    v_mfma_f32_16x16x32_bf16 v[200:203], a[68:71], v[40:43], v[200:203]
    s_waitcnt lgkmcnt(8)
    v_exp_f32 v66, v66
    v_mfma_f32_16x16x32_bf16 v[196:199], a[72:75], v[16:19], v[196:199]
    v_exp_f32 v67, v67
    v_mfma_f32_16x16x32_bf16 v[196:199], a[76:79], v[32:35], v[196:199]
    v_add_f32 v88, v88, v66
    v_add_f32 v89, v89, v67
    v_mfma_f32_16x16x32_bf16 v[204:207], a[72:75], v[24:27], v[204:207]
    s_add_u32 m0, s40, 0
    v_exp_f32 v72, v72
    v_mfma_f32_16x16x32_bf16 v[204:207], a[76:79], v[40:43], v[204:207]
    v_cvt_pk_bf16_f32 v65, v66, v67
    v_add_f32 v90, v90, v72
    v_mfma_f32_16x16x32_bf16 v[208:211], a[80:83], v[16:19], v[208:211]
    s_waitcnt vmcnt(0) lgkmcnt(0)
    v_exp_f32 v73, v73
    v_mfma_f32_16x16x32_bf16 v[208:211], a[84:87], v[32:35], v[208:211]
    s_barrier
    ds_read_b128 a[0:3], v3 offset:0
    v_add_f32 v91, v91, v73
    v_mfma_f32_16x16x32_bf16 v[216:219], a[80:83], v[24:27], v[216:219]
    buffer_load_dwordx4 v6, s[4:7], s24 offen offset:0 lds
    v_mfma_f32_16x16x32_bf16 v[216:219], a[84:87], v[40:43], v[216:219]
    ds_read_b128 a[4:7], v3 offset:64
    v_cvt_pk_bf16_f32 v72, v72, v73
    v_mfma_f32_16x16x32_bf16 v[212:215], a[88:91], v[16:19], v[212:215]
    ds_read_b128 a[8:11], v3 offset:128
    v_mfma_f32_16x16x32_bf16 v[212:215], a[92:95], v[32:35], v[212:215]
    v_exp_f32 v74, v74
    v_mfma_f32_16x16x32_bf16 v[220:223], a[88:91], v[24:27], v[220:223]
    buffer_load_dwordx4 v6, s[4:7], s25 offen offset:1024 lds
    v_mfma_f32_16x16x32_bf16 v[220:223], a[92:95], v[40:43], v[220:223]
    ds_read_b128 a[12:15], v3 offset:192
    v_add_f32 v90, v90, v74
    v_mfma_f32_16x16x32_bf16 v[224:227], a[96:99], v[16:19], v[224:227]
    ds_read_b128 a[16:19], v3 offset:256
    v_mfma_f32_16x16x32_bf16 v[224:227], a[100:103], v[32:35], v[224:227]
    v_exp_f32 v75, v75
    v_mfma_f32_16x16x32_bf16 v[232:235], a[96:99], v[24:27], v[232:235]
    buffer_load_dwordx4 v6, s[4:7], s26 offen offset:2064 lds
    v_mfma_f32_16x16x32_bf16 v[232:235], a[100:103], v[40:43], v[232:235]
    ds_read_b128 a[20:23], v3 offset:320
    v_add_f32 v91, v91, v75
    v_mfma_f32_16x16x32_bf16 v[228:231], a[104:107], v[16:19], v[228:231]
    ds_read_b128 a[24:27], v3 offset:384
    v_cvt_pk_bf16_f32 v73, v74, v75
    v_mfma_f32_16x16x32_bf16 v[228:231], a[108:111], v[32:35], v[228:231]
    v_exp_f32 v68, v68
    v_mfma_f32_16x16x32_bf16 v[236:239], a[104:107], v[24:27], v[236:239]
    buffer_load_dwordx4 v6, s[4:7], s27 offen offset:3088 lds
    v_mfma_f32_16x16x32_bf16 v[236:239], a[108:111], v[40:43], v[236:239]
    s_add_u32 m0, s40, 17024
    ds_read_b128 a[28:31], v3 offset:448
    v_add_f32 v88, v88, v68
    v_mfma_f32_16x16x32_bf16 v[240:243], a[112:115], v[16:19], v[240:243]
    ds_read_b128 a[32:35], v3 offset:512
    v_mfma_f32_16x16x32_bf16 v[240:243], a[116:119], v[32:35], v[240:243]
    ds_read_b128 a[36:39], v3 offset:576
    v_mfma_f32_16x16x32_bf16 v[248:251], a[112:115], v[24:27], v[248:251]
    buffer_load_dwordx4 v6, s[4:7], s28 offen offset:0 lds
    v_mfma_f32_16x16x32_bf16 v[248:251], a[116:119], v[40:43], v[248:251]
    ds_read_b128 a[40:43], v3 offset:640
    v_mfma_f32_16x16x32_bf16 v[244:247], a[120:123], v[16:19], v[244:247]
    v_exp_f32 v69, v69
    v_mfma_f32_16x16x32_bf16 v[244:247], a[124:127], v[32:35], v[244:247]
    s_waitcnt lgkmcnt(5)
    ds_read_b128 a[44:47], v3 offset:704
    v_add_f32 v89, v89, v69
    v_mfma_f32_16x16x32_bf16 v[252:255], a[120:123], v[24:27], v[252:255]
    s_sub_u32 s47, s47, 1
    buffer_load_dwordx4 v6, s[4:7], s29 offen offset:1024 lds
    v_mfma_f32_16x16x32_bf16 v[252:255], a[124:127], v[40:43], v[252:255]
    s_cmp_lg_u32 s47, 0
    ds_read_b128 a[48:51], v3 offset:768
    v_cvt_pk_bf16_f32 v66, v68, v69
    v_mfma_f32_16x16x32_bf16 v[16:19], a[0:3], a[128:131], v[80:83]
L2_loop:
    v_exp_f32 v70, v70
    v_mfma_f32_16x16x32_bf16 v[16:19], a[4:7], a[136:139], v[16:19]
    s_max_i32 s44, s57, 0
    ds_read_b128 a[52:55], v3 offset:832
    v_add_f32 v88, v88, v70
    v_mfma_f32_16x16x32_bf16 v[16:19], a[8:11], a[144:147], v[16:19]
    s_add_u32 s57, s57, 2048
    buffer_load_dwordx4 v6, s[4:7], s30 offen offset:2064 lds
    v_mfma_f32_16x16x32_bf16 v[16:19], a[12:15], a[152:155], v[16:19]
    ds_read_b128 a[56:59], v3 offset:896
    v_mfma_f32_16x16x32_bf16 v[16:19], a[16:19], a[160:163], v[16:19]
    v_exp_f32 v71, v71
    v_mfma_f32_16x16x32_bf16 v[16:19], a[20:23], a[168:171], v[16:19]
    s_waitcnt lgkmcnt(4)
    ds_read_b128 a[60:63], v3 offset:960
    v_add_f32 v89, v89, v71
    v_mfma_f32_16x16x32_bf16 v[16:19], a[24:27], a[176:179], v[16:19]
    buffer_load_dwordx4 v6, s[4:7], s31 offen offset:3088 lds
    v_mfma_f32_16x16x32_bf16 v[16:19], a[28:31], a[184:187], v[16:19]
    s_add_u32 m0, s41, 34048
    ds_read_b128 a[64:67], v3 offset:17024
    v_cvt_pk_bf16_f32 v67, v70, v71
    v_mfma_f32_16x16x32_bf16 v[24:27], a[0:3], a[132:135], v[84:87]
    ds_read_b128 a[68:71], v3 offset:17088
    v_mfma_f32_16x16x32_bf16 v[24:27], a[4:7], a[140:143], v[24:27]
    v_exp_f32 v76, v76
    v_mfma_f32_16x16x32_bf16 v[24:27], a[8:11], a[148:151], v[24:27]
    buffer_load_dwordx4 v6, s[8:11], s32 offen offset:0 lds
    v_mfma_f32_16x16x32_bf16 v[24:27], a[12:15], a[156:159], v[24:27]
    ds_read_b128 a[72:75], v3 offset:17152
    v_add_f32 v90, v90, v76
    v_mfma_f32_16x16x32_bf16 v[24:27], a[16:19], a[164:167], v[24:27]
    ds_read_b128 a[76:79], v3 offset:17216
    v_mfma_f32_16x16x32_bf16 v[24:27], a[20:23], a[172:175], v[24:27]
    v_exp_f32 v77, v77
    v_mfma_f32_16x16x32_bf16 v[24:27], a[24:27], a[180:183], v[24:27]
    buffer_load_dwordx4 v6, s[8:11], s33 offen offset:1024 lds
    v_mfma_f32_16x16x32_bf16 v[24:27], a[28:31], a[188:191], v[24:27]
    ds_read_b128 a[80:83], v3 offset:17280
    v_add_f32 v91, v91, v77
    v_mfma_f32_16x16x32_bf16 v[20:23], a[32:35], a[128:131], v[80:83]
    ds_read_b128 a[84:87], v3 offset:17344
    v_cvt_pk_bf16_f32 v74, v76, v77
    v_mfma_f32_16x16x32_bf16 v[20:23], a[36:39], a[136:139], v[20:23]
    v_exp_f32 v78, v78
    v_mfma_f32_16x16x32_bf16 v[20:23], a[40:43], a[144:147], v[20:23]
    s_waitcnt lgkmcnt(4)
    buffer_load_dwordx4 v6, s[8:11], s34 offen offset:2176 lds
    v_mfma_f32_16x16x32_bf16 v[20:23], a[44:47], a[152:155], v[20:23]
    ds_read_b128 a[88:91], v3 offset:17408
    v_add_f32 v90, v90, v78
    v_mfma_f32_16x16x32_bf16 v[20:23], a[48:51], a[160:163], v[20:23]
    ds_read_b128 a[92:95], v3 offset:17472
    v_mfma_f32_16x16x32_bf16 v[20:23], a[52:55], a[168:171], v[20:23]
    v_exp_f32 v79, v79
    v_mfma_f32_16x16x32_bf16 v[20:23], a[56:59], a[176:179], v[20:23]
    buffer_load_dwordx4 v6, s[8:11], s35 offen offset:3200 lds
    v_mfma_f32_16x16x32_bf16 v[20:23], a[60:63], a[184:187], v[20:23]
    s_add_u32 m0, s41, 51072
    ds_read_b128 a[96:99], v3 offset:17536
    v_add_f32 v91, v91, v79
    v_mfma_f32_16x16x32_bf16 v[28:31], a[32:35], a[132:135], v[84:87]
    ds_read_b128 a[100:103], v3 offset:17600
    v_cvt_pk_bf16_f32 v75, v78, v79
    v_mfma_f32_16x16x32_bf16 v[28:31], a[36:39], a[140:143], v[28:31]
    ds_read_b128 a[104:107], v3 offset:17664
    v_mfma_f32_16x16x32_bf16 v[28:31], a[40:43], a[148:151], v[28:31]
    buffer_load_dwordx4 v6, s[8:11], s36 offen offset:0 lds
    v_mfma_f32_16x16x32_bf16 v[28:31], a[44:47], a[156:159], v[28:31]
    ds_read_b128 a[108:111], v3 offset:17728
    v_mfma_f32_16x16x32_bf16 v[28:31], a[48:51], a[164:167], v[28:31]
    v_exp_f32 v16, v16
    v_mfma_f32_16x16x32_bf16 v[28:31], a[52:55], a[172:175], v[28:31]
    ds_read_b128 a[112:115], v3 offset:17792
    v_add_f32 v88, v88, v16
    v_mfma_f32_16x16x32_bf16 v[28:31], a[56:59], a[180:183], v[28:31]
    buffer_load_dwordx4 v6, s[8:11], s37 offen offset:1024 lds
    v_mfma_f32_16x16x32_bf16 v[28:31], a[60:63], a[188:191], v[28:31]
    ds_read_b128 a[116:119], v3 offset:17856
    v_mfma_f32_16x16x32_bf16 v[32:35], a[64:67], a[128:131], v[80:83]
    v_exp_f32 v17, v17
    v_mfma_f32_16x16x32_bf16 v[32:35], a[68:71], a[136:139], v[32:35]
    s_waitcnt lgkmcnt(5)
    ds_read_b128 a[120:123], v3 offset:17920
    v_add_f32 v89, v89, v17
    v_mfma_f32_16x16x32_bf16 v[32:35], a[72:75], a[144:147], v[32:35]
    buffer_load_dwordx4 v6, s[8:11], s38 offen offset:2176 lds
    v_mfma_f32_16x16x32_bf16 v[32:35], a[76:79], a[152:155], v[32:35]
    ds_read_b128 a[124:127], v3 offset:17984
    v_cvt_pk_bf16_f32 v16, v16, v17
    v_mfma_f32_16x16x32_bf16 v[32:35], a[80:83], a[160:163], v[32:35]
    v_exp_f32 v18, v18
    v_mfma_f32_16x16x32_bf16 v[32:35], a[84:87], a[168:171], v[32:35]
    ds_read_b64_tr_b16 a[0:1], v4 offset:34048
    ds_read_b64_tr_b16 a[2:3], v4 offset:34560
    v_mfma_f32_16x16x32_bf16 v[32:35], a[88:91], a[176:179], v[32:35]
    buffer_load_dwordx4 v6, s[8:11], s39 offen offset:3200 lds
    v_mfma_f32_16x16x32_bf16 v[32:35], a[92:95], a[184:187], v[32:35]
    ds_read_b64_tr_b16 a[4:5], v4 offset:51072
    ds_read_b64_tr_b16 a[6:7], v4 offset:51584
    v_mfma_f32_16x16x32_bf16 v[40:43], a[64:67], a[132:135], v[84:87]
    v_exp_f32 v19, v19
    v_mfma_f32_16x16x32_bf16 v[40:43], a[68:71], a[140:143], v[40:43]
    ds_read_b64_tr_b16 a[8:9], v4 offset:34080
    v_add_u32 v6, 0x8000, v6
    v_mfma_f32_16x16x32_bf16 v[40:43], a[72:75], a[148:151], v[40:43]
    buffer_load_dword a244, v9, s[76:79], s54 offen
    v_mfma_f32_16x16x32_bf16 v[40:43], a[76:79], a[156:159], v[40:43]
    s_add_u32 s54, s54, 65536
    ds_read_b64_tr_b16 a[10:11], v4 offset:34592
    v_add_f32 v88, v88, v18
    v_mfma_f32_16x16x32_bf16 v[40:43], a[80:83], a[164:167], v[40:43]
    ds_read_b64_tr_b16 a[12:13], v4 offset:51104
    v_add_f32 v89, v89, v19
    v_mfma_f32_16x16x32_bf16 v[40:43], a[84:87], a[172:175], v[40:43]
    ds_read_b64_tr_b16 a[14:15], v4 offset:51616
    v_cvt_pk_bf16_f32 v17, v18, v19
    v_mfma_f32_16x16x32_bf16 v[40:43], a[88:91], a[180:183], v[40:43]
    ds_read_b64_tr_b16 a[16:17], v4 offset:34112
    ds_read_b64_tr_b16 a[18:19], v4 offset:34624
    v_mfma_f32_16x16x32_bf16 v[40:43], a[92:95], a[188:191], v[40:43]
    buffer_load_dword a238, v9, s[16:19], s44 offen
    v_mfma_f32_16x16x32_bf16 v[36:39], a[96:99], a[128:131], v[80:83]
    s_waitcnt lgkmcnt(8)
    v_exp_f32 v24, v24
    v_mfma_f32_16x16x32_bf16 v[36:39], a[100:103], a[136:139], v[36:39]
    ds_read_b64_tr_b16 a[20:21], v4 offset:51136
    ds_read_b64_tr_b16 a[22:23], v4 offset:51648
    v_mfma_f32_16x16x32_bf16 v[36:39], a[104:107], a[144:147], v[36:39]
    v_exp_f32 v25, v25
    v_mfma_f32_16x16x32_bf16 v[36:39], a[108:111], a[152:155], v[36:39]
    ds_read_b64_tr_b16 a[24:25], v4 offset:34144
    v_add_f32 v90, v90, v24
    v_mfma_f32_16x16x32_bf16 v[36:39], a[112:115], a[160:163], v[36:39]
    ds_read_b64_tr_b16 a[26:27], v4 offset:34656
    v_add_f32 v91, v91, v25
    v_mfma_f32_16x16x32_bf16 v[36:39], a[116:119], a[168:171], v[36:39]
    ds_read_b64_tr_b16 a[28:29], v4 offset:51168
    ds_read_b64_tr_b16 a[30:31], v4 offset:51680
    v_mfma_f32_16x16x32_bf16 v[36:39], a[120:123], a[176:179], v[36:39]
    ds_read_b64_tr_b16 a[32:33], v4 offset:34176
    v_cvt_pk_bf16_f32 v24, v24, v25
    v_mfma_f32_16x16x32_bf16 v[36:39], a[124:127], a[184:187], v[36:39]
    ds_read_b64_tr_b16 a[34:35], v4 offset:34688
    ds_read_b64_tr_b16 a[36:37], v4 offset:51200
    v_mfma_f32_16x16x32_bf16 v[44:47], a[96:99], a[132:135], v[84:87]
    v_exp_f32 v26, v26
    v_mfma_f32_16x16x32_bf16 v[44:47], a[100:103], a[140:143], v[44:47]
    ds_read_b64_tr_b16 a[38:39], v4 offset:51712
    ds_read_b64_tr_b16 a[40:41], v4 offset:34208
    v_mfma_f32_16x16x32_bf16 v[44:47], a[104:107], a[148:151], v[44:47]
    v_exp_f32 v27, v27
    v_mfma_f32_16x16x32_bf16 v[44:47], a[108:111], a[156:159], v[44:47]
    ds_read_b64_tr_b16 a[42:43], v4 offset:34720
    v_add_f32 v90, v90, v26
    v_mfma_f32_16x16x32_bf16 v[44:47], a[112:115], a[164:167], v[44:47]
    ds_read_b64_tr_b16 a[44:45], v4 offset:51232
    v_add_f32 v91, v91, v27
    v_mfma_f32_16x16x32_bf16 v[44:47], a[116:119], a[172:175], v[44:47]
    ds_read_b64_tr_b16 a[46:47], v4 offset:51744
    ds_read_b64_tr_b16 a[48:49], v4 offset:34240
    v_mfma_f32_16x16x32_bf16 v[44:47], a[120:123], a[180:183], v[44:47]
    ds_read_b64_tr_b16 a[50:51], v4 offset:34752
    v_cvt_pk_bf16_f32 v25, v26, v27
    v_mfma_f32_16x16x32_bf16 v[44:47], a[124:127], a[188:191], v[44:47]
    ds_read_b64_tr_b16 a[52:53], v4 offset:51264
    ds_read_b64_tr_b16 a[54:55], v4 offset:51776
    v_mfma_f32_16x16x32_bf16 v[128:131], a[0:3], v[48:51], v[128:131]
    s_waitcnt lgkmcnt(11)
    v_exp_f32 v20, v20
    v_mfma_f32_16x16x32_bf16 v[128:131], a[4:7], v[64:67], v[128:131]
    v_exp_f32 v21, v21
    v_mfma_f32_16x16x32_bf16 v[136:139], a[0:3], v[56:59], v[136:139]
    ds_read_b64_tr_b16 a[56:57], v4 offset:34272
    ds_read_b64_tr_b16 a[58:59], v4 offset:34784
    v_mfma_f32_16x16x32_bf16 v[136:139], a[4:7], v[72:75], v[136:139]
    ds_read_b64_tr_b16 a[60:61], v4 offset:51296
    v_add_f32 v88, v88, v20
    v_mfma_f32_16x16x32_bf16 v[132:135], a[8:11], v[48:51], v[132:135]
    ds_read_b64_tr_b16 a[62:63], v4 offset:51808
    v_add_f32 v89, v89, v21
    v_mfma_f32_16x16x32_bf16 v[132:135], a[12:15], v[64:67], v[132:135]
    ds_read_b64_tr_b16 a[64:65], v4 offset:34304
    ds_read_b64_tr_b16 a[66:67], v4 offset:34816
    v_mfma_f32_16x16x32_bf16 v[140:143], a[8:11], v[56:59], v[140:143]
    ds_read_b64_tr_b16 a[68:69], v4 offset:51328
    v_cvt_pk_bf16_f32 v18, v20, v21
    v_mfma_f32_16x16x32_bf16 v[140:143], a[12:15], v[72:75], v[140:143]
    ds_read_b64_tr_b16 a[70:71], v4 offset:51840
    ds_read_b64_tr_b16 a[72:73], v4 offset:34336
    v_mfma_f32_16x16x32_bf16 v[144:147], a[16:19], v[48:51], v[144:147]
    v_exp_f32 v22, v22
    v_mfma_f32_16x16x32_bf16 v[144:147], a[20:23], v[64:67], v[144:147]
    v_exp_f32 v23, v23
    v_mfma_f32_16x16x32_bf16 v[152:155], a[16:19], v[56:59], v[152:155]
    ds_read_b64_tr_b16 a[74:75], v4 offset:34848
    ds_read_b64_tr_b16 a[76:77], v4 offset:51360
    v_mfma_f32_16x16x32_bf16 v[152:155], a[20:23], v[72:75], v[152:155]
    ds_read_b64_tr_b16 a[78:79], v4 offset:51872
    v_add_f32 v88, v88, v22
    v_mfma_f32_16x16x32_bf16 v[148:151], a[24:27], v[48:51], v[148:151]
    ds_read_b64_tr_b16 a[80:81], v4 offset:34368
    v_add_f32 v89, v89, v23
    v_mfma_f32_16x16x32_bf16 v[148:151], a[28:31], v[64:67], v[148:151]
    ds_read_b64_tr_b16 a[82:83], v4 offset:34880
    v_cvt_pk_bf16_f32 v19, v22, v23
    v_mfma_f32_16x16x32_bf16 v[156:159], a[24:27], v[56:59], v[156:159]
    ds_read_b64_tr_b16 a[84:85], v4 offset:51392
    ds_read_b64_tr_b16 a[86:87], v4 offset:51904
    v_mfma_f32_16x16x32_bf16 v[156:159], a[28:31], v[72:75], v[156:159]
    s_waitcnt lgkmcnt(10)
    v_exp_f32 v28, v28
    v_mfma_f32_16x16x32_bf16 v[160:163], a[32:35], v[48:51], v[160:163]
    ds_read_b64_tr_b16 a[88:89], v4 offset:34400
    ds_read_b64_tr_b16 a[90:91], v4 offset:34912
    v_mfma_f32_16x16x32_bf16 v[160:163], a[36:39], v[64:67], v[160:163]
    v_exp_f32 v29, v29
    v_mfma_f32_16x16x32_bf16 v[168:171], a[32:35], v[56:59], v[168:171]
    ds_read_b64_tr_b16 a[92:93], v4 offset:51424
    v_add_f32 v90, v90, v28
    v_mfma_f32_16x16x32_bf16 v[168:171], a[36:39], v[72:75], v[168:171]
    ds_read_b64_tr_b16 a[94:95], v4 offset:51936
    v_add_f32 v91, v91, v29
    v_mfma_f32_16x16x32_bf16 v[164:167], a[40:43], v[48:51], v[164:167]
    ds_read_b64_tr_b16 a[96:97], v4 offset:34432
    ds_read_b64_tr_b16 a[98:99], v4 offset:34944
    v_mfma_f32_16x16x32_bf16 v[164:167], a[44:47], v[64:67], v[164:167]
    ds_read_b64_tr_b16 a[100:101], v4 offset:51456
    v_cvt_pk_bf16_f32 v26, v28, v29
    v_mfma_f32_16x16x32_bf16 v[172:175], a[40:43], v[56:59], v[172:175]
    ds_read_b64_tr_b16 a[102:103], v4 offset:51968
    ds_read_b64_tr_b16 a[104:105], v4 offset:34464
    v_mfma_f32_16x16x32_bf16 v[172:175], a[44:47], v[72:75], v[172:175]
    v_exp_f32 v30, v30
    v_mfma_f32_16x16x32_bf16 v[176:179], a[48:51], v[48:51], v[176:179]
    ds_read_b64_tr_b16 a[106:107], v4 offset:34976
    ds_read_b64_tr_b16 a[108:109], v4 offset:51488
    v_mfma_f32_16x16x32_bf16 v[176:179], a[52:55], v[64:67], v[176:179]
    v_exp_f32 v31, v31
    v_mfma_f32_16x16x32_bf16 v[184:187], a[48:51], v[56:59], v[184:187]
    ds_read_b64_tr_b16 a[110:111], v4 offset:52000
    v_add_f32 v90, v90, v30
    v_mfma_f32_16x16x32_bf16 v[184:187], a[52:55], v[72:75], v[184:187]
    ds_read_b64_tr_b16 a[112:113], v4 offset:34496
    v_add_f32 v91, v91, v31
    v_mfma_f32_16x16x32_bf16 v[180:183], a[56:59], v[48:51], v[180:183]
    ds_read_b64_tr_b16 a[114:115], v4 offset:35008
    ds_read_b64_tr_b16 a[116:117], v4 offset:51520
    v_mfma_f32_16x16x32_bf16 v[180:183], a[60:63], v[64:67], v[180:183]
    ds_read_b64_tr_b16 a[118:119], v4 offset:52032
    v_cvt_pk_bf16_f32 v27, v30, v31
    v_mfma_f32_16x16x32_bf16 v[188:191], a[56:59], v[56:59], v[188:191]
    ds_read_b64_tr_b16 a[120:121], v4 offset:34528
    ds_read_b64_tr_b16 a[122:123], v4 offset:35040
    v_mfma_f32_16x16x32_bf16 v[188:191], a[60:63], v[72:75], v[188:191]
    v_exp_f32 v32, v32
    v_mfma_f32_16x16x32_bf16 v[192:195], a[64:67], v[48:51], v[192:195]
    s_waitcnt lgkmcnt(9)
    v_exp_f32 v33, v33
    v_mfma_f32_16x16x32_bf16 v[192:195], a[68:71], v[64:67], v[192:195]
    ds_read_b64_tr_b16 a[124:125], v4 offset:51552
    ds_read_b64_tr_b16 a[126:127], v4 offset:52064
    v_mfma_f32_16x16x32_bf16 v[200:203], a[64:67], v[56:59], v[200:203]
    v_add_f32 v88, v88, v32
    v_add_f32 v89, v89, v33
    v_mfma_f32_16x16x32_bf16 v[200:203], a[68:71], v[72:75], v[200:203]
    v_exp_f32 v34, v34
    v_mfma_f32_16x16x32_bf16 v[196:199], a[72:75], v[48:51], v[196:199]
    v_cvt_pk_bf16_f32 v32, v32, v33
    v_add_f32 v88, v88, v34
    v_mfma_f32_16x16x32_bf16 v[196:199], a[76:79], v[64:67], v[196:199]
    v_exp_f32 v35, v35
    v_mfma_f32_16x16x32_bf16 v[204:207], a[72:75], v[56:59], v[204:207]
    s_add_u32 m0, s40, 68096
    v_add_f32 v89, v89, v35
    v_cvt_pk_bf16_f32 v33, v34, v35
    v_mfma_f32_16x16x32_bf16 v[204:207], a[76:79], v[72:75], v[204:207]
    v_exp_f32 v40, v40
    v_mfma_f32_16x16x32_bf16 v[208:211], a[80:83], v[48:51], v[208:211]
    s_waitcnt vmcnt(2) lgkmcnt(0)
    v_exp_f32 v41, v41
    v_mfma_f32_16x16x32_bf16 v[208:211], a[84:87], v[64:67], v[208:211]
    s_barrier
    ds_read_b128 a[0:3], v2 offset:0
    v_add_f32 v90, v90, v40
    v_mfma_f32_16x16x32_bf16 v[216:219], a[80:83], v[56:59], v[216:219]
    buffer_load_dwordx4 v6, s[4:7], s24 offen offset:0 lds
    v_mfma_f32_16x16x32_bf16 v[216:219], a[84:87], v[72:75], v[216:219]
    ds_read_b128 a[4:7], v2 offset:64
    v_add_f32 v91, v91, v41
    v_mfma_f32_16x16x32_bf16 v[212:215], a[88:91], v[48:51], v[212:215]
    ds_read_b128 a[8:11], v2 offset:128
    v_cvt_pk_bf16_f32 v40, v40, v41
    v_mfma_f32_16x16x32_bf16 v[212:215], a[92:95], v[64:67], v[212:215]
    v_exp_f32 v42, v42
    v_mfma_f32_16x16x32_bf16 v[220:223], a[88:91], v[56:59], v[220:223]
    buffer_load_dwordx4 v6, s[4:7], s25 offen offset:1024 lds
    v_mfma_f32_16x16x32_bf16 v[220:223], a[92:95], v[72:75], v[220:223]
    ds_read_b128 a[12:15], v2 offset:192
    v_add_f32 v90, v90, v42
    v_mfma_f32_16x16x32_bf16 v[224:227], a[96:99], v[48:51], v[224:227]
    ds_read_b128 a[16:19], v2 offset:256
    v_mfma_f32_16x16x32_bf16 v[224:227], a[100:103], v[64:67], v[224:227]
    v_exp_f32 v43, v43
    v_mfma_f32_16x16x32_bf16 v[232:235], a[96:99], v[56:59], v[232:235]
    buffer_load_dwordx4 v6, s[4:7], s26 offen offset:2064 lds
    v_mfma_f32_16x16x32_bf16 v[232:235], a[100:103], v[72:75], v[232:235]
    ds_read_b128 a[20:23], v2 offset:320
    v_add_f32 v91, v91, v43
    v_mfma_f32_16x16x32_bf16 v[228:231], a[104:107], v[48:51], v[228:231]
    ds_read_b128 a[24:27], v2 offset:384
    v_cvt_pk_bf16_f32 v41, v42, v43
    v_mfma_f32_16x16x32_bf16 v[228:231], a[108:111], v[64:67], v[228:231]
    v_exp_f32 v36, v36
    v_mfma_f32_16x16x32_bf16 v[236:239], a[104:107], v[56:59], v[236:239]
    buffer_load_dwordx4 v6, s[4:7], s27 offen offset:3088 lds
    v_mfma_f32_16x16x32_bf16 v[236:239], a[108:111], v[72:75], v[236:239]
    s_add_u32 m0, s40, 85120
    ds_read_b128 a[28:31], v2 offset:448
    v_add_f32 v88, v88, v36
    v_mfma_f32_16x16x32_bf16 v[240:243], a[112:115], v[48:51], v[240:243]
    ds_read_b128 a[32:35], v2 offset:512
    v_mfma_f32_16x16x32_bf16 v[240:243], a[116:119], v[64:67], v[240:243]
    ds_read_b128 a[36:39], v2 offset:576
    v_mfma_f32_16x16x32_bf16 v[248:251], a[112:115], v[56:59], v[248:251]
    buffer_load_dwordx4 v6, s[4:7], s28 offen offset:0 lds
    v_mfma_f32_16x16x32_bf16 v[248:251], a[116:119], v[72:75], v[248:251]
    ds_read_b128 a[40:43], v2 offset:640
    v_mfma_f32_16x16x32_bf16 v[244:247], a[120:123], v[48:51], v[244:247]
    v_exp_f32 v37, v37
    v_mfma_f32_16x16x32_bf16 v[244:247], a[124:127], v[64:67], v[244:247]
    ds_read_b128 a[44:47], v2 offset:704
    v_add_f32 v89, v89, v37
    v_mfma_f32_16x16x32_bf16 v[252:255], a[120:123], v[56:59], v[252:255]
    buffer_load_dwordx4 v6, s[4:7], s29 offen offset:1024 lds
    v_mfma_f32_16x16x32_bf16 v[252:255], a[124:127], v[72:75], v[252:255]
    s_waitcnt lgkmcnt(5)
    ds_read_b128 a[48:51], v2 offset:768
    v_cvt_pk_bf16_f32 v34, v36, v37
    v_mfma_f32_16x16x32_bf16 v[48:51], a[0:3], a[128:131], v[80:83]
    v_exp_f32 v38, v38
    v_mfma_f32_16x16x32_bf16 v[48:51], a[4:7], a[136:139], v[48:51]
    ds_read_b128 a[52:55], v2 offset:832
    v_add_f32 v88, v88, v38
    v_mfma_f32_16x16x32_bf16 v[48:51], a[8:11], a[144:147], v[48:51]
    buffer_load_dwordx4 v6, s[4:7], s30 offen offset:2064 lds
    v_mfma_f32_16x16x32_bf16 v[48:51], a[12:15], a[152:155], v[48:51]
    ds_read_b128 a[56:59], v2 offset:896
    v_mfma_f32_16x16x32_bf16 v[48:51], a[16:19], a[160:163], v[48:51]
    v_exp_f32 v39, v39
    v_mfma_f32_16x16x32_bf16 v[48:51], a[20:23], a[168:171], v[48:51]
    ds_read_b128 a[60:63], v2 offset:960
    v_add_f32 v89, v89, v39
    v_mfma_f32_16x16x32_bf16 v[48:51], a[24:27], a[176:179], v[48:51]
    s_waitcnt lgkmcnt(5)
    buffer_load_dwordx4 v6, s[4:7], s31 offen offset:3088 lds
    v_mfma_f32_16x16x32_bf16 v[48:51], a[28:31], a[184:187], v[48:51]
    s_add_u32 m0, s41, 102144
    ds_read_b128 a[64:67], v2 offset:17024
    v_cvt_pk_bf16_f32 v35, v38, v39
    v_mfma_f32_16x16x32_bf16 v[56:59], a[0:3], a[132:135], v[84:87]
    ds_read_b128 a[68:71], v2 offset:17088
    v_mfma_f32_16x16x32_bf16 v[56:59], a[4:7], a[140:143], v[56:59]
    v_exp_f32 v44, v44
    v_mfma_f32_16x16x32_bf16 v[56:59], a[8:11], a[148:151], v[56:59]
    buffer_load_dwordx4 v6, s[8:11], s32 offen offset:0 lds
    v_mfma_f32_16x16x32_bf16 v[56:59], a[12:15], a[156:159], v[56:59]
    ds_read_b128 a[72:75], v2 offset:17152
    v_add_f32 v90, v90, v44
    v_mfma_f32_16x16x32_bf16 v[56:59], a[16:19], a[164:167], v[56:59]
    ds_read_b128 a[76:79], v2 offset:17216
    v_mfma_f32_16x16x32_bf16 v[56:59], a[20:23], a[172:175], v[56:59]
    v_exp_f32 v45, v45
    v_mfma_f32_16x16x32_bf16 v[56:59], a[24:27], a[180:183], v[56:59]
    buffer_load_dwordx4 v6, s[8:11], s33 offen offset:1024 lds
    v_mfma_f32_16x16x32_bf16 v[56:59], a[28:31], a[188:191], v[56:59]
    ds_read_b128 a[80:83], v2 offset:17280
    v_add_f32 v91, v91, v45
    v_mfma_f32_16x16x32_bf16 v[52:55], a[32:35], a[128:131], v[80:83]
    ds_read_b128 a[84:87], v2 offset:17344
    v_cvt_pk_bf16_f32 v42, v44, v45
    v_mfma_f32_16x16x32_bf16 v[52:55], a[36:39], a[136:139], v[52:55]
    v_exp_f32 v46, v46
    v_mfma_f32_16x16x32_bf16 v[52:55], a[40:43], a[144:147], v[52:55]
    s_waitcnt lgkmcnt(4)
    buffer_load_dwordx4 v6, s[8:11], s34 offen offset:2176 lds
    v_mfma_f32_16x16x32_bf16 v[52:55], a[44:47], a[152:155], v[52:55]
    ds_read_b128 a[88:91], v2 offset:17408
    v_add_f32 v90, v90, v46
    v_mfma_f32_16x16x32_bf16 v[52:55], a[48:51], a[160:163], v[52:55]
    ds_read_b128 a[92:95], v2 offset:17472
    v_mfma_f32_16x16x32_bf16 v[52:55], a[52:55], a[168:171], v[52:55]
    v_exp_f32 v47, v47
    v_mfma_f32_16x16x32_bf16 v[52:55], a[56:59], a[176:179], v[52:55]
    buffer_load_dwordx4 v6, s[8:11], s35 offen offset:3200 lds
    v_mfma_f32_16x16x32_bf16 v[52:55], a[60:63], a[184:187], v[52:55]
    s_add_u32 m0, s41, 119168
    ds_read_b128 a[96:99], v2 offset:17536
    v_add_f32 v91, v91, v47
    v_mfma_f32_16x16x32_bf16 v[60:63], a[32:35], a[132:135], v[84:87]
    ds_read_b128 a[100:103], v2 offset:17600
    v_cvt_pk_bf16_f32 v43, v46, v47
    v_mfma_f32_16x16x32_bf16 v[60:63], a[36:39], a[140:143], v[60:63]
    ds_read_b128 a[104:107], v2 offset:17664
    v_mfma_f32_16x16x32_bf16 v[60:63], a[40:43], a[148:151], v[60:63]
    buffer_load_dwordx4 v6, s[8:11], s36 offen offset:0 lds
    v_mfma_f32_16x16x32_bf16 v[60:63], a[44:47], a[156:159], v[60:63]
    ds_read_b128 a[108:111], v2 offset:17728
    v_mfma_f32_16x16x32_bf16 v[60:63], a[48:51], a[164:167], v[60:63]
    v_exp_f32 v48, v48
    v_mfma_f32_16x16x32_bf16 v[60:63], a[52:55], a[172:175], v[60:63]
    ds_read_b128 a[112:115], v2 offset:17792
    v_add_f32 v88, v88, v48
    v_mfma_f32_16x16x32_bf16 v[60:63], a[56:59], a[180:183], v[60:63]
    buffer_load_dwordx4 v6, s[8:11], s37 offen offset:1024 lds
    v_mfma_f32_16x16x32_bf16 v[60:63], a[60:63], a[188:191], v[60:63]
    ds_read_b128 a[116:119], v2 offset:17856
    v_mfma_f32_16x16x32_bf16 v[64:67], a[64:67], a[128:131], v[80:83]
    v_exp_f32 v49, v49
    v_mfma_f32_16x16x32_bf16 v[64:67], a[68:71], a[136:139], v[64:67]
    s_waitcnt lgkmcnt(5)
    ds_read_b128 a[120:123], v2 offset:17920
    v_add_f32 v89, v89, v49
    v_mfma_f32_16x16x32_bf16 v[64:67], a[72:75], a[144:147], v[64:67]
    buffer_load_dwordx4 v6, s[8:11], s38 offen offset:2176 lds
    v_mfma_f32_16x16x32_bf16 v[64:67], a[76:79], a[152:155], v[64:67]
    ds_read_b128 a[124:127], v2 offset:17984
    v_cvt_pk_bf16_f32 v48, v48, v49
    v_mfma_f32_16x16x32_bf16 v[64:67], a[80:83], a[160:163], v[64:67]
    v_exp_f32 v50, v50
    v_mfma_f32_16x16x32_bf16 v[64:67], a[84:87], a[168:171], v[64:67]
    ds_read_b64_tr_b16 a[0:1], v1 offset:34048
    ds_read_b64_tr_b16 a[2:3], v1 offset:34560
    v_mfma_f32_16x16x32_bf16 v[64:67], a[88:91], a[176:179], v[64:67]
    buffer_load_dwordx4 v6, s[8:11], s39 offen offset:3200 lds
    v_mfma_f32_16x16x32_bf16 v[64:67], a[92:95], a[184:187], v[64:67]
    ds_read_b64_tr_b16 a[4:5], v1 offset:51072
    ds_read_b64_tr_b16 a[6:7], v1 offset:51584
    v_mfma_f32_16x16x32_bf16 v[72:75], a[64:67], a[132:135], v[84:87]
    v_exp_f32 v51, v51
    v_mfma_f32_16x16x32_bf16 v[72:75], a[68:71], a[140:143], v[72:75]
    ds_read_b64_tr_b16 a[8:9], v1 offset:34080
    v_add_u32 v6, 0x8000, v6
    v_mfma_f32_16x16x32_bf16 v[72:75], a[72:75], a[148:151], v[72:75]
    ds_read_b64_tr_b16 a[10:11], v1 offset:34592
    v_add_f32 v88, v88, v50
    v_mfma_f32_16x16x32_bf16 v[72:75], a[76:79], a[156:159], v[72:75]
    ds_read_b64_tr_b16 a[12:13], v1 offset:51104
    v_add_f32 v89, v89, v51
    v_mfma_f32_16x16x32_bf16 v[72:75], a[80:83], a[164:167], v[72:75]
    ds_read_b64_tr_b16 a[14:15], v1 offset:51616
    v_cvt_pk_bf16_f32 v49, v50, v51
    v_mfma_f32_16x16x32_bf16 v[72:75], a[84:87], a[172:175], v[72:75]
    ds_read_b64_tr_b16 a[16:17], v1 offset:34112
    ds_read_b64_tr_b16 a[18:19], v1 offset:34624
    v_mfma_f32_16x16x32_bf16 v[72:75], a[88:91], a[180:183], v[72:75]
    v_exp_f32 v56, v56
    v_mfma_f32_16x16x32_bf16 v[72:75], a[92:95], a[188:191], v[72:75]
    ds_read_b64_tr_b16 a[20:21], v1 offset:51136
    ds_read_b64_tr_b16 a[22:23], v1 offset:51648
    v_mfma_f32_16x16x32_bf16 v[68:71], a[96:99], a[128:131], v[80:83]
    s_waitcnt lgkmcnt(10)
    v_exp_f32 v57, v57
    v_mfma_f32_16x16x32_bf16 v[68:71], a[100:103], a[136:139], v[68:71]
    ds_read_b64_tr_b16 a[24:25], v1 offset:34144
    v_add_f32 v90, v90, v56
    v_mfma_f32_16x16x32_bf16 v[68:71], a[104:107], a[144:147], v[68:71]
    ds_read_b64_tr_b16 a[26:27], v1 offset:34656
    v_add_f32 v91, v91, v57
    v_mfma_f32_16x16x32_bf16 v[68:71], a[108:111], a[152:155], v[68:71]
    ds_read_b64_tr_b16 a[28:29], v1 offset:51168
    ds_read_b64_tr_b16 a[30:31], v1 offset:51680
    v_mfma_f32_16x16x32_bf16 v[68:71], a[112:115], a[160:163], v[68:71]
    ds_read_b64_tr_b16 a[32:33], v1 offset:34176
    v_cvt_pk_bf16_f32 v56, v56, v57
    v_mfma_f32_16x16x32_bf16 v[68:71], a[116:119], a[168:171], v[68:71]
    ds_read_b64_tr_b16 a[34:35], v1 offset:34688
    ds_read_b64_tr_b16 a[36:37], v1 offset:51200
    v_mfma_f32_16x16x32_bf16 v[68:71], a[120:123], a[176:179], v[68:71]
    v_exp_f32 v58, v58
    v_mfma_f32_16x16x32_bf16 v[68:71], a[124:127], a[184:187], v[68:71]
    ds_read_b64_tr_b16 a[38:39], v1 offset:51712
    ds_read_b64_tr_b16 a[40:41], v1 offset:34208
    v_mfma_f32_16x16x32_bf16 v[76:79], a[96:99], a[132:135], v[84:87]
    v_exp_f32 v59, v59
    v_mfma_f32_16x16x32_bf16 v[76:79], a[100:103], a[140:143], v[76:79]
    ds_read_b64_tr_b16 a[42:43], v1 offset:34720
    v_add_f32 v90, v90, v58
    v_mfma_f32_16x16x32_bf16 v[76:79], a[104:107], a[148:151], v[76:79]
    ds_read_b64_tr_b16 a[44:45], v1 offset:51232
    v_add_f32 v91, v91, v59
    v_mfma_f32_16x16x32_bf16 v[76:79], a[108:111], a[156:159], v[76:79]
    ds_read_b64_tr_b16 a[46:47], v1 offset:51744
    ds_read_b64_tr_b16 a[48:49], v1 offset:34240
    v_mfma_f32_16x16x32_bf16 v[76:79], a[112:115], a[164:167], v[76:79]
    ds_read_b64_tr_b16 a[50:51], v1 offset:34752
    v_cvt_pk_bf16_f32 v57, v58, v59
    v_mfma_f32_16x16x32_bf16 v[76:79], a[116:119], a[172:175], v[76:79]
    ds_read_b64_tr_b16 a[52:53], v1 offset:51264
    v_mfma_f32_16x16x32_bf16 v[76:79], a[120:123], a[180:183], v[76:79]
    v_exp_f32 v52, v52
    v_mfma_f32_16x16x32_bf16 v[76:79], a[124:127], a[188:191], v[76:79]
    ds_read_b64_tr_b16 a[54:55], v1 offset:51776
    ds_read_b64_tr_b16 a[56:57], v1 offset:34272
    v_mfma_f32_16x16x32_bf16 v[128:131], a[0:3], v[16:19], v[128:131]
    s_waitcnt lgkmcnt(10)
    v_exp_f32 v53, v53
    v_mfma_f32_16x16x32_bf16 v[128:131], a[4:7], v[32:35], v[128:131]
    ds_read_b64_tr_b16 a[58:59], v1 offset:34784
    v_add_f32 v88, v88, v52
    v_mfma_f32_16x16x32_bf16 v[136:139], a[0:3], v[24:27], v[136:139]
    ds_read_b64_tr_b16 a[60:61], v1 offset:51296
    v_add_f32 v89, v89, v53
    v_mfma_f32_16x16x32_bf16 v[136:139], a[4:7], v[40:43], v[136:139]
    ds_read_b64_tr_b16 a[62:63], v1 offset:51808
    ds_read_b64_tr_b16 a[64:65], v1 offset:34304
    v_mfma_f32_16x16x32_bf16 v[132:135], a[8:11], v[16:19], v[132:135]
    ds_read_b64_tr_b16 a[66:67], v1 offset:34816
    v_cvt_pk_bf16_f32 v50, v52, v53
    v_mfma_f32_16x16x32_bf16 v[132:135], a[12:15], v[32:35], v[132:135]
    ds_read_b64_tr_b16 a[68:69], v1 offset:51328
    ds_read_b64_tr_b16 a[70:71], v1 offset:51840
    v_mfma_f32_16x16x32_bf16 v[140:143], a[8:11], v[24:27], v[140:143]
    v_exp_f32 v54, v54
    v_mfma_f32_16x16x32_bf16 v[140:143], a[12:15], v[40:43], v[140:143]
    ds_read_b64_tr_b16 a[72:73], v1 offset:34336
    ds_read_b64_tr_b16 a[74:75], v1 offset:34848
    v_mfma_f32_16x16x32_bf16 v[144:147], a[16:19], v[16:19], v[144:147]
    v_exp_f32 v55, v55
    v_mfma_f32_16x16x32_bf16 v[144:147], a[20:23], v[32:35], v[144:147]
    ds_read_b64_tr_b16 a[76:77], v1 offset:51360
    v_add_f32 v88, v88, v54
    v_mfma_f32_16x16x32_bf16 v[152:155], a[16:19], v[24:27], v[152:155]
    ds_read_b64_tr_b16 a[78:79], v1 offset:51872
    v_add_f32 v89, v89, v55
    v_mfma_f32_16x16x32_bf16 v[152:155], a[20:23], v[40:43], v[152:155]
    ds_read_b64_tr_b16 a[80:81], v1 offset:34368
    ds_read_b64_tr_b16 a[82:83], v1 offset:34880
    v_mfma_f32_16x16x32_bf16 v[148:151], a[24:27], v[16:19], v[148:151]
    ds_read_b64_tr_b16 a[84:85], v1 offset:51392
    v_cvt_pk_bf16_f32 v51, v54, v55
    v_mfma_f32_16x16x32_bf16 v[148:151], a[28:31], v[32:35], v[148:151]
    ds_read_b64_tr_b16 a[86:87], v1 offset:51904
    v_mfma_f32_16x16x32_bf16 v[156:159], a[24:27], v[24:27], v[156:159]
    v_exp_f32 v60, v60
    v_mfma_f32_16x16x32_bf16 v[156:159], a[28:31], v[40:43], v[156:159]
    ds_read_b64_tr_b16 a[88:89], v1 offset:34400
    ds_read_b64_tr_b16 a[90:91], v1 offset:34912
    v_mfma_f32_16x16x32_bf16 v[160:163], a[32:35], v[16:19], v[160:163]
    s_waitcnt lgkmcnt(10)
    v_exp_f32 v61, v61
    v_mfma_f32_16x16x32_bf16 v[160:163], a[36:39], v[32:35], v[160:163]
    ds_read_b64_tr_b16 a[92:93], v1 offset:51424
    v_add_f32 v90, v90, v60
    v_mfma_f32_16x16x32_bf16 v[168:171], a[32:35], v[24:27], v[168:171]
    ds_read_b64_tr_b16 a[94:95], v1 offset:51936
    v_add_f32 v91, v91, v61
    v_mfma_f32_16x16x32_bf16 v[168:171], a[36:39], v[40:43], v[168:171]
    ds_read_b64_tr_b16 a[96:97], v1 offset:34432
    ds_read_b64_tr_b16 a[98:99], v1 offset:34944
    v_mfma_f32_16x16x32_bf16 v[164:167], a[40:43], v[16:19], v[164:167]
    ds_read_b64_tr_b16 a[100:101], v1 offset:51456
    v_cvt_pk_bf16_f32 v58, v60, v61
    v_mfma_f32_16x16x32_bf16 v[164:167], a[44:47], v[32:35], v[164:167]
    ds_read_b64_tr_b16 a[102:103], v1 offset:51968
    ds_read_b64_tr_b16 a[104:105], v1 offset:34464
    v_mfma_f32_16x16x32_bf16 v[172:175], a[40:43], v[24:27], v[172:175]
    v_exp_f32 v62, v62
    v_mfma_f32_16x16x32_bf16 v[172:175], a[44:47], v[40:43], v[172:175]
    ds_read_b64_tr_b16 a[106:107], v1 offset:34976
    ds_read_b64_tr_b16 a[108:109], v1 offset:51488
    v_mfma_f32_16x16x32_bf16 v[176:179], a[48:51], v[16:19], v[176:179]
    v_exp_f32 v63, v63
    v_mfma_f32_16x16x32_bf16 v[176:179], a[52:55], v[32:35], v[176:179]
    ds_read_b64_tr_b16 a[110:111], v1 offset:52000
    v_add_f32 v90, v90, v62
    v_mfma_f32_16x16x32_bf16 v[184:187], a[48:51], v[24:27], v[184:187]
    ds_read_b64_tr_b16 a[112:113], v1 offset:34496
    v_add_f32 v91, v91, v63
    v_mfma_f32_16x16x32_bf16 v[184:187], a[52:55], v[40:43], v[184:187]
    ds_read_b64_tr_b16 a[114:115], v1 offset:35008
    ds_read_b64_tr_b16 a[116:117], v1 offset:51520
    v_mfma_f32_16x16x32_bf16 v[180:183], a[56:59], v[16:19], v[180:183]
    ds_read_b64_tr_b16 a[118:119], v1 offset:52032
    v_cvt_pk_bf16_f32 v59, v62, v63
    v_mfma_f32_16x16x32_bf16 v[180:183], a[60:63], v[32:35], v[180:183]
    ds_read_b64_tr_b16 a[120:121], v1 offset:34528
    v_mfma_f32_16x16x32_bf16 v[188:191], a[56:59], v[24:27], v[188:191]
    v_exp_f32 v64, v64
    v_mfma_f32_16x16x32_bf16 v[188:191], a[60:63], v[40:43], v[188:191]
    ds_read_b64_tr_b16 a[122:123], v1 offset:35040
    ds_read_b64_tr_b16 a[124:125], v1 offset:51552
    v_mfma_f32_16x16x32_bf16 v[192:195], a[64:67], v[16:19], v[192:195]
    v_exp_f32 v65, v65
    v_mfma_f32_16x16x32_bf16 v[192:195], a[68:71], v[32:35], v[192:195]
    ds_read_b64_tr_b16 a[126:127], v1 offset:52064
    v_add_f32 v88, v88, v64
    v_mfma_f32_16x16x32_bf16 v[200:203], a[64:67], v[24:27], v[200:203]
    v_add_f32 v89, v89, v65
    v_cvt_pk_bf16_f32 v64, v64, v65
    v_mfma_f32_16x16x32_bf16 v[200:203], a[68:71], v[40:43], v[200:203]
    s_waitcnt lgkmcnt(8)
    v_exp_f32 v66, v66
    v_mfma_f32_16x16x32_bf16 v[196:199], a[72:75], v[16:19], v[196:199]
    v_exp_f32 v67, v67
    v_mfma_f32_16x16x32_bf16 v[196:199], a[76:79], v[32:35], v[196:199]
    v_add_f32 v88, v88, v66
    v_add_f32 v89, v89, v67
    v_mfma_f32_16x16x32_bf16 v[204:207], a[72:75], v[24:27], v[204:207]
    s_add_u32 m0, s40, 0
    v_exp_f32 v72, v72
    v_mfma_f32_16x16x32_bf16 v[204:207], a[76:79], v[40:43], v[204:207]
    v_cvt_pk_bf16_f32 v65, v66, v67
    v_add_f32 v90, v90, v72
    v_mfma_f32_16x16x32_bf16 v[208:211], a[80:83], v[16:19], v[208:211]
    s_waitcnt vmcnt(0) lgkmcnt(0)
    v_exp_f32 v73, v73
    v_mfma_f32_16x16x32_bf16 v[208:211], a[84:87], v[32:35], v[208:211]
    s_barrier
    ds_read_b128 a[0:3], v3 offset:0
    v_add_f32 v91, v91, v73
    v_mfma_f32_16x16x32_bf16 v[216:219], a[80:83], v[24:27], v[216:219]
    buffer_load_dwordx4 v6, s[4:7], s24 offen offset:0 lds
    v_mfma_f32_16x16x32_bf16 v[216:219], a[84:87], v[40:43], v[216:219]
    ds_read_b128 a[4:7], v3 offset:64
    v_cvt_pk_bf16_f32 v72, v72, v73
    v_mfma_f32_16x16x32_bf16 v[212:215], a[88:91], v[16:19], v[212:215]
    ds_read_b128 a[8:11], v3 offset:128
    v_mfma_f32_16x16x32_bf16 v[212:215], a[92:95], v[32:35], v[212:215]
    v_exp_f32 v74, v74
    v_mfma_f32_16x16x32_bf16 v[220:223], a[88:91], v[24:27], v[220:223]
    buffer_load_dwordx4 v6, s[4:7], s25 offen offset:1024 lds
    v_mfma_f32_16x16x32_bf16 v[220:223], a[92:95], v[40:43], v[220:223]
    ds_read_b128 a[12:15], v3 offset:192
    v_add_f32 v90, v90, v74
    v_mfma_f32_16x16x32_bf16 v[224:227], a[96:99], v[16:19], v[224:227]
    ds_read_b128 a[16:19], v3 offset:256
    v_mfma_f32_16x16x32_bf16 v[224:227], a[100:103], v[32:35], v[224:227]
    v_exp_f32 v75, v75
    v_mfma_f32_16x16x32_bf16 v[232:235], a[96:99], v[24:27], v[232:235]
    buffer_load_dwordx4 v6, s[4:7], s26 offen offset:2064 lds
    v_mfma_f32_16x16x32_bf16 v[232:235], a[100:103], v[40:43], v[232:235]
    ds_read_b128 a[20:23], v3 offset:320
    v_add_f32 v91, v91, v75
    v_mfma_f32_16x16x32_bf16 v[228:231], a[104:107], v[16:19], v[228:231]
    ds_read_b128 a[24:27], v3 offset:384
    v_cvt_pk_bf16_f32 v73, v74, v75
    v_mfma_f32_16x16x32_bf16 v[228:231], a[108:111], v[32:35], v[228:231]
    v_exp_f32 v68, v68
    v_mfma_f32_16x16x32_bf16 v[236:239], a[104:107], v[24:27], v[236:239]
    buffer_load_dwordx4 v6, s[4:7], s27 offen offset:3088 lds
    v_mfma_f32_16x16x32_bf16 v[236:239], a[108:111], v[40:43], v[236:239]
    s_add_u32 m0, s40, 17024
    ds_read_b128 a[28:31], v3 offset:448
    v_add_f32 v88, v88, v68
    v_mfma_f32_16x16x32_bf16 v[240:243], a[112:115], v[16:19], v[240:243]
    ds_read_b128 a[32:35], v3 offset:512
    v_mfma_f32_16x16x32_bf16 v[240:243], a[116:119], v[32:35], v[240:243]
    ds_read_b128 a[36:39], v3 offset:576
    v_mfma_f32_16x16x32_bf16 v[248:251], a[112:115], v[24:27], v[248:251]
    buffer_load_dwordx4 v6, s[4:7], s28 offen offset:0 lds
    v_mfma_f32_16x16x32_bf16 v[248:251], a[116:119], v[40:43], v[248:251]
    ds_read_b128 a[40:43], v3 offset:640
    v_mfma_f32_16x16x32_bf16 v[244:247], a[120:123], v[16:19], v[244:247]
    v_exp_f32 v69, v69
    v_mfma_f32_16x16x32_bf16 v[244:247], a[124:127], v[32:35], v[244:247]
    s_waitcnt lgkmcnt(5)
    ds_read_b128 a[44:47], v3 offset:704
    v_add_f32 v89, v89, v69
    v_mfma_f32_16x16x32_bf16 v[252:255], a[120:123], v[24:27], v[252:255]
    s_sub_u32 s47, s47, 1
    buffer_load_dwordx4 v6, s[4:7], s29 offen offset:1024 lds
    v_mfma_f32_16x16x32_bf16 v[252:255], a[124:127], v[40:43], v[252:255]
    s_cmp_lg_u32 s47, 0
    ds_read_b128 a[48:51], v3 offset:768
    v_cvt_pk_bf16_f32 v66, v68, v69
    v_mfma_f32_16x16x32_bf16 v[16:19], a[0:3], a[128:131], v[80:83]
    s_cbranch_scc1 L2_loop
    v_exp_f32 v70, v70
    v_mfma_f32_16x16x32_bf16 v[16:19], a[4:7], a[136:139], v[16:19]
    s_mov_b32 s75, 4243456
    ds_read_b128 a[52:55], v3 offset:832
    v_add_f32 v88, v88, v70
    v_mfma_f32_16x16x32_bf16 v[16:19], a[8:11], a[144:147], v[16:19]
    buffer_load_dwordx4 v6, s[4:7], s30 offen offset:2064 lds
    v_mfma_f32_16x16x32_bf16 v[16:19], a[12:15], a[152:155], v[16:19]
    ds_read_b128 a[56:59], v3 offset:896
    v_min_u32 v100, 880, v8
    v_mfma_f32_16x16x32_bf16 v[16:19], a[16:19], a[160:163], v[16:19]
    v_exp_f32 v71, v71
    v_mfma_f32_16x16x32_bf16 v[16:19], a[20:23], a[168:171], v[16:19]
    s_waitcnt lgkmcnt(4)
    ds_read_b128 a[60:63], v3 offset:960
    v_add_f32 v89, v89, v71
    v_mfma_f32_16x16x32_bf16 v[16:19], a[24:27], a[176:179], v[16:19]
    buffer_load_dwordx4 v6, s[4:7], s31 offen offset:3088 lds
    v_mfma_f32_16x16x32_bf16 v[16:19], a[28:31], a[184:187], v[16:19]
    s_add_u32 m0, s41, 34048
    ds_read_b128 a[64:67], v3 offset:17024
    v_cvt_pk_bf16_f32 v67, v70, v71
    v_mfma_f32_16x16x32_bf16 v[24:27], a[0:3], a[132:135], v[84:87]
    ds_read_b128 a[68:71], v3 offset:17088
    v_mfma_f32_16x16x32_bf16 v[24:27], a[4:7], a[140:143], v[24:27]
    v_exp_f32 v76, v76
    v_mfma_f32_16x16x32_bf16 v[24:27], a[8:11], a[148:151], v[24:27]
    buffer_load_dwordx4 v6, s[8:11], s32 offen offset:0 lds
    v_mfma_f32_16x16x32_bf16 v[24:27], a[12:15], a[156:159], v[24:27]
    ds_read_b128 a[72:75], v3 offset:17152
    v_add_f32 v90, v90, v76
    v_mfma_f32_16x16x32_bf16 v[24:27], a[16:19], a[164:167], v[24:27]
    ds_read_b128 a[76:79], v3 offset:17216
    v_mfma_f32_16x16x32_bf16 v[24:27], a[20:23], a[172:175], v[24:27]
    v_exp_f32 v77, v77
    v_mfma_f32_16x16x32_bf16 v[24:27], a[24:27], a[180:183], v[24:27]
    buffer_load_dwordx4 v6, s[8:11], s33 offen offset:1024 lds
    v_mfma_f32_16x16x32_bf16 v[24:27], a[28:31], a[188:191], v[24:27]
    ds_read_b128 a[80:83], v3 offset:17280
    v_add_f32 v91, v91, v77
    v_mfma_f32_16x16x32_bf16 v[20:23], a[32:35], a[128:131], v[80:83]
    ds_read_b128 a[84:87], v3 offset:17344
    v_cvt_pk_bf16_f32 v74, v76, v77
    v_mfma_f32_16x16x32_bf16 v[20:23], a[36:39], a[136:139], v[20:23]
    v_exp_f32 v78, v78
    v_mfma_f32_16x16x32_bf16 v[20:23], a[40:43], a[144:147], v[20:23]
    s_waitcnt lgkmcnt(4)
    buffer_load_dwordx4 v6, s[8:11], s34 offen offset:2176 lds
    v_mfma_f32_16x16x32_bf16 v[20:23], a[44:47], a[152:155], v[20:23]
    ds_read_b128 a[88:91], v3 offset:17408
    v_add_f32 v90, v90, v78
    v_mfma_f32_16x16x32_bf16 v[20:23], a[48:51], a[160:163], v[20:23]
    ds_read_b128 a[92:95], v3 offset:17472
    v_lshrrev_b32 v104, 8, v8
    v_mfma_f32_16x16x32_bf16 v[20:23], a[52:55], a[168:171], v[20:23]
    v_exp_f32 v79, v79
    v_mfma_f32_16x16x32_bf16 v[20:23], a[56:59], a[176:179], v[20:23]
    buffer_load_dwordx4 v6, s[8:11], s35 offen offset:3200 lds
    v_mfma_f32_16x16x32_bf16 v[20:23], a[60:63], a[184:187], v[20:23]
    s_add_u32 m0, s41, 51072
    ds_read_b128 a[96:99], v3 offset:17536
    v_add_f32 v91, v91, v79
    v_mfma_f32_16x16x32_bf16 v[28:31], a[32:35], a[132:135], v[84:87]
    ds_read_b128 a[100:103], v3 offset:17600
    v_cvt_pk_bf16_f32 v75, v78, v79
    v_mfma_f32_16x16x32_bf16 v[28:31], a[36:39], a[140:143], v[28:31]
    ds_read_b128 a[104:107], v3 offset:17664
    v_mul_u32_u24 v104, 3584, v104
    v_mfma_f32_16x16x32_bf16 v[28:31], a[40:43], a[148:151], v[28:31]
    buffer_load_dwordx4 v6, s[8:11], s36 offen offset:0 lds
    v_mfma_f32_16x16x32_bf16 v[28:31], a[44:47], a[156:159], v[28:31]
    ds_read_b128 a[108:111], v3 offset:17728
    v_lshlrev_b32 v105, 3, v8
    v_mfma_f32_16x16x32_bf16 v[28:31], a[48:51], a[164:167], v[28:31]
    v_exp_f32 v16, v16
    v_mfma_f32_16x16x32_bf16 v[28:31], a[52:55], a[172:175], v[28:31]
    ds_read_b128 a[112:115], v3 offset:17792
    v_add_f32 v88, v88, v16
    v_mfma_f32_16x16x32_bf16 v[28:31], a[56:59], a[180:183], v[28:31]
    buffer_load_dwordx4 v6, s[8:11], s37 offen offset:1024 lds
    v_mfma_f32_16x16x32_bf16 v[28:31], a[60:63], a[188:191], v[28:31]
    ds_read_b128 a[116:119], v3 offset:17856
    v_and_b32 v106, 0x780, v105
    v_mfma_f32_16x16x32_bf16 v[32:35], a[64:67], a[128:131], v[80:83]
    v_exp_f32 v17, v17
    v_mfma_f32_16x16x32_bf16 v[32:35], a[68:71], a[136:139], v[32:35]
    s_waitcnt lgkmcnt(5)
    ds_read_b128 a[120:123], v3 offset:17920
    v_add_f32 v89, v89, v17
    v_mfma_f32_16x16x32_bf16 v[32:35], a[72:75], a[144:147], v[32:35]
    buffer_load_dwordx4 v6, s[8:11], s38 offen offset:2176 lds
    v_mfma_f32_16x16x32_bf16 v[32:35], a[76:79], a[152:155], v[32:35]
    ds_read_b128 a[124:127], v3 offset:17984
    v_cvt_pk_bf16_f32 v16, v16, v17
    v_mfma_f32_16x16x32_bf16 v[32:35], a[80:83], a[160:163], v[32:35]
    v_exp_f32 v18, v18
    v_mfma_f32_16x16x32_bf16 v[32:35], a[84:87], a[168:171], v[32:35]
    ds_read_b64_tr_b16 a[0:1], v4 offset:34048
    ds_read_b64_tr_b16 a[2:3], v4 offset:34560
    v_mfma_f32_16x16x32_bf16 v[32:35], a[88:91], a[176:179], v[32:35]
    buffer_load_dwordx4 v6, s[8:11], s39 offen offset:3200 lds
    v_mfma_f32_16x16x32_bf16 v[32:35], a[92:95], a[184:187], v[32:35]
    ds_read_b64_tr_b16 a[4:5], v4 offset:51072
    ds_read_b64_tr_b16 a[6:7], v4 offset:51584
    v_mfma_f32_16x16x32_bf16 v[40:43], a[64:67], a[132:135], v[84:87]
    v_exp_f32 v19, v19
    v_mfma_f32_16x16x32_bf16 v[40:43], a[68:71], a[140:143], v[40:43]
    v_add_u32 v6, 0x8000, v6
    v_add_u32 v104, v104, v106
    v_mfma_f32_16x16x32_bf16 v[40:43], a[72:75], a[148:151], v[40:43]
    ds_read_b64_tr_b16 a[8:9], v4 offset:34080
    v_add_f32 v88, v88, v18
    v_mfma_f32_16x16x32_bf16 v[40:43], a[76:79], a[156:159], v[40:43]
    ds_read_b64_tr_b16 a[10:11], v4 offset:34592
    v_add_f32 v89, v89, v19
    v_mfma_f32_16x16x32_bf16 v[40:43], a[80:83], a[164:167], v[40:43]
    ds_read_b64_tr_b16 a[12:13], v4 offset:51104
    ds_read_b64_tr_b16 a[14:15], v4 offset:51616
    v_mfma_f32_16x16x32_bf16 v[40:43], a[84:87], a[172:175], v[40:43]
    ds_read_b64_tr_b16 a[16:17], v4 offset:34112
    v_cvt_pk_bf16_f32 v17, v18, v19
    v_mfma_f32_16x16x32_bf16 v[40:43], a[88:91], a[180:183], v[40:43]
    ds_read_b64_tr_b16 a[18:19], v4 offset:34624
    ds_read_b64_tr_b16 a[20:21], v4 offset:51136
    v_mfma_f32_16x16x32_bf16 v[40:43], a[92:95], a[188:191], v[40:43]
    v_exp_f32 v24, v24
    v_mfma_f32_16x16x32_bf16 v[36:39], a[96:99], a[128:131], v[80:83]
    s_waitcnt lgkmcnt(9)
    v_exp_f32 v25, v25
    v_mfma_f32_16x16x32_bf16 v[36:39], a[100:103], a[136:139], v[36:39]
    ds_read_b64_tr_b16 a[22:23], v4 offset:51648
    ds_read_b64_tr_b16 a[24:25], v4 offset:34144
    v_mfma_f32_16x16x32_bf16 v[36:39], a[104:107], a[144:147], v[36:39]
    buffer_load_dwordx4 v[96:99], v100, s[20:23], s75 offen sc1
    v_mfma_f32_16x16x32_bf16 v[36:39], a[108:111], a[152:155], v[36:39]
    ds_read_b64_tr_b16 a[26:27], v4 offset:34656
    v_add_f32 v90, v90, v24
    v_mfma_f32_16x16x32_bf16 v[36:39], a[112:115], a[160:163], v[36:39]
    ds_read_b64_tr_b16 a[28:29], v4 offset:51168
    v_add_f32 v91, v91, v25
    v_mfma_f32_16x16x32_bf16 v[36:39], a[116:119], a[168:171], v[36:39]
    ds_read_b64_tr_b16 a[30:31], v4 offset:51680
    v_cvt_pk_bf16_f32 v24, v24, v25
    v_mfma_f32_16x16x32_bf16 v[36:39], a[120:123], a[176:179], v[36:39]
    ds_read_b64_tr_b16 a[32:33], v4 offset:34176
    ds_read_b64_tr_b16 a[34:35], v4 offset:34688
    v_mfma_f32_16x16x32_bf16 v[36:39], a[124:127], a[184:187], v[36:39]
    ds_read_b64_tr_b16 a[36:37], v4 offset:51200
    ds_read_b64_tr_b16 a[38:39], v4 offset:51712
    v_mfma_f32_16x16x32_bf16 v[44:47], a[96:99], a[132:135], v[84:87]
    v_exp_f32 v26, v26
    v_mfma_f32_16x16x32_bf16 v[44:47], a[100:103], a[140:143], v[44:47]
    v_exp_f32 v27, v27
    v_mfma_f32_16x16x32_bf16 v[44:47], a[104:107], a[148:151], v[44:47]
    ds_read_b64_tr_b16 a[40:41], v4 offset:34208
    ds_read_b64_tr_b16 a[42:43], v4 offset:34720
    v_mfma_f32_16x16x32_bf16 v[44:47], a[108:111], a[156:159], v[44:47]
    buffer_load_dword a235, v104, s[60:63], s72 offen
    v_mfma_f32_16x16x32_bf16 v[44:47], a[112:115], a[164:167], v[44:47]
    ds_read_b64_tr_b16 a[44:45], v4 offset:51232
    v_add_f32 v90, v90, v26
    v_mfma_f32_16x16x32_bf16 v[44:47], a[116:119], a[172:175], v[44:47]
    ds_read_b64_tr_b16 a[46:47], v4 offset:51744
    v_add_f32 v91, v91, v27
    v_mfma_f32_16x16x32_bf16 v[44:47], a[120:123], a[180:183], v[44:47]
    ds_read_b64_tr_b16 a[48:49], v4 offset:34240
    v_cvt_pk_bf16_f32 v25, v26, v27
    v_mfma_f32_16x16x32_bf16 v[44:47], a[124:127], a[188:191], v[44:47]
    ds_read_b64_tr_b16 a[50:51], v4 offset:34752
    ds_read_b64_tr_b16 a[52:53], v4 offset:51264
    v_mfma_f32_16x16x32_bf16 v[128:131], a[0:3], v[48:51], v[128:131]
    s_waitcnt lgkmcnt(9)
    buffer_load_dword a236, v104, s[64:67], s72 offen
    v_mfma_f32_16x16x32_bf16 v[128:131], a[4:7], v[64:67], v[128:131]
    v_exp_f32 v20, v20
    v_mfma_f32_16x16x32_bf16 v[136:139], a[0:3], v[56:59], v[136:139]
    ds_read_b64_tr_b16 a[54:55], v4 offset:51776
    ds_read_b64_tr_b16 a[56:57], v4 offset:34272
    v_mfma_f32_16x16x32_bf16 v[136:139], a[4:7], v[72:75], v[136:139]
    v_exp_f32 v21, v21
    v_mfma_f32_16x16x32_bf16 v[132:135], a[8:11], v[48:51], v[132:135]
    ds_read_b64_tr_b16 a[58:59], v4 offset:34784
    v_add_f32 v88, v88, v20
    v_mfma_f32_16x16x32_bf16 v[132:135], a[12:15], v[64:67], v[132:135]
    ds_read_b64_tr_b16 a[60:61], v4 offset:51296
    v_add_f32 v89, v89, v21
    v_mfma_f32_16x16x32_bf16 v[140:143], a[8:11], v[56:59], v[140:143]
    ds_read_b64_tr_b16 a[62:63], v4 offset:51808
    ds_read_b64_tr_b16 a[64:65], v4 offset:34304
    v_mfma_f32_16x16x32_bf16 v[140:143], a[12:15], v[72:75], v[140:143]
    ds_read_b64_tr_b16 a[66:67], v4 offset:34816
    v_cvt_pk_bf16_f32 v18, v20, v21
    v_mfma_f32_16x16x32_bf16 v[144:147], a[16:19], v[48:51], v[144:147]
    ds_read_b64_tr_b16 a[68:69], v4 offset:51328
    ds_read_b64_tr_b16 a[70:71], v4 offset:51840
    v_mfma_f32_16x16x32_bf16 v[144:147], a[20:23], v[64:67], v[144:147]
    v_exp_f32 v22, v22
    v_mfma_f32_16x16x32_bf16 v[152:155], a[16:19], v[56:59], v[152:155]
    ds_read_b64_tr_b16 a[72:73], v4 offset:34336
    ds_read_b64_tr_b16 a[74:75], v4 offset:34848
    v_mfma_f32_16x16x32_bf16 v[152:155], a[20:23], v[72:75], v[152:155]
    v_exp_f32 v23, v23
    v_mfma_f32_16x16x32_bf16 v[148:151], a[24:27], v[48:51], v[148:151]
    ds_read_b64_tr_b16 a[76:77], v4 offset:51360
    v_add_f32 v88, v88, v22
    v_mfma_f32_16x16x32_bf16 v[148:151], a[28:31], v[64:67], v[148:151]
    ds_read_b64_tr_b16 a[78:79], v4 offset:51872
    v_add_f32 v89, v89, v23
    v_mfma_f32_16x16x32_bf16 v[156:159], a[24:27], v[56:59], v[156:159]
    ds_read_b64_tr_b16 a[80:81], v4 offset:34368
    ds_read_b64_tr_b16 a[82:83], v4 offset:34880
    v_mfma_f32_16x16x32_bf16 v[156:159], a[28:31], v[72:75], v[156:159]
    ds_read_b64_tr_b16 a[84:85], v4 offset:51392
    v_cvt_pk_bf16_f32 v19, v22, v23
    v_mfma_f32_16x16x32_bf16 v[160:163], a[32:35], v[48:51], v[160:163]
    s_waitcnt lgkmcnt(10)
    ds_read_b64_tr_b16 a[86:87], v4 offset:51904
    ds_read_b64_tr_b16 a[88:89], v4 offset:34400
    v_mfma_f32_16x16x32_bf16 v[160:163], a[36:39], v[64:67], v[160:163]
    v_exp_f32 v28, v28
    v_mfma_f32_16x16x32_bf16 v[168:171], a[32:35], v[56:59], v[168:171]
    v_exp_f32 v29, v29
    v_mfma_f32_16x16x32_bf16 v[168:171], a[36:39], v[72:75], v[168:171]
    ds_read_b64_tr_b16 a[90:91], v4 offset:34912
    ds_read_b64_tr_b16 a[92:93], v4 offset:51424
    v_mfma_f32_16x16x32_bf16 v[164:167], a[40:43], v[48:51], v[164:167]
    buffer_load_dword a239, v9, s[92:95], s73 offen
    v_mfma_f32_16x16x32_bf16 v[164:167], a[44:47], v[64:67], v[164:167]
    ds_read_b64_tr_b16 a[94:95], v4 offset:51936
    v_add_f32 v90, v90, v28
    v_mfma_f32_16x16x32_bf16 v[172:175], a[40:43], v[56:59], v[172:175]
    ds_read_b64_tr_b16 a[96:97], v4 offset:34432
    v_add_f32 v91, v91, v29
    v_mfma_f32_16x16x32_bf16 v[172:175], a[44:47], v[72:75], v[172:175]
    ds_read_b64_tr_b16 a[98:99], v4 offset:34944
    ds_read_b64_tr_b16 a[100:101], v4 offset:51456
    v_mfma_f32_16x16x32_bf16 v[176:179], a[48:51], v[48:51], v[176:179]
    ds_read_b64_tr_b16 a[102:103], v4 offset:51968
    v_cvt_pk_bf16_f32 v26, v28, v29
    v_mfma_f32_16x16x32_bf16 v[176:179], a[52:55], v[64:67], v[176:179]
    ds_read_b64_tr_b16 a[104:105], v4 offset:34464
    ds_read_b64_tr_b16 a[106:107], v4 offset:34976
    v_mfma_f32_16x16x32_bf16 v[184:187], a[48:51], v[56:59], v[184:187]
    v_exp_f32 v30, v30
    v_mfma_f32_16x16x32_bf16 v[184:187], a[52:55], v[72:75], v[184:187]
    v_exp_f32 v31, v31
    v_mfma_f32_16x16x32_bf16 v[180:183], a[56:59], v[48:51], v[180:183]
    ds_read_b64_tr_b16 a[108:109], v4 offset:51488
    ds_read_b64_tr_b16 a[110:111], v4 offset:52000
    v_mfma_f32_16x16x32_bf16 v[180:183], a[60:63], v[64:67], v[180:183]
    ds_read_b64_tr_b16 a[112:113], v4 offset:34496
    v_add_f32 v90, v90, v30
    v_mfma_f32_16x16x32_bf16 v[188:191], a[56:59], v[56:59], v[188:191]
    ds_read_b64_tr_b16 a[114:115], v4 offset:35008
    v_add_f32 v91, v91, v31
    v_mfma_f32_16x16x32_bf16 v[188:191], a[60:63], v[72:75], v[188:191]
    s_waitcnt lgkmcnt(10)
    ds_read_b64_tr_b16 a[116:117], v4 offset:51520
    v_cvt_pk_bf16_f32 v27, v30, v31
    v_mfma_f32_16x16x32_bf16 v[192:195], a[64:67], v[48:51], v[192:195]
    ds_read_b64_tr_b16 a[118:119], v4 offset:52032
    ds_read_b64_tr_b16 a[120:121], v4 offset:34528
    v_mfma_f32_16x16x32_bf16 v[192:195], a[68:71], v[64:67], v[192:195]
    ds_read_b64_tr_b16 a[122:123], v4 offset:35040
    ds_read_b64_tr_b16 a[124:125], v4 offset:51552
    ds_read_b64_tr_b16 a[126:127], v4 offset:52064
    v_exp_f32 v32, v32
    v_mfma_f32_16x16x32_bf16 v[200:203], a[64:67], v[56:59], v[200:203]
    v_exp_f32 v33, v33
    v_mfma_f32_16x16x32_bf16 v[200:203], a[68:71], v[72:75], v[200:203]
    v_add_f32 v88, v88, v32
    v_add_f32 v89, v89, v33
    v_mfma_f32_16x16x32_bf16 v[196:199], a[72:75], v[48:51], v[196:199]
    v_accvgpr_read_b32 v101, a253
    v_cvt_pk_bf16_f32 v32, v32, v33
    v_mfma_f32_16x16x32_bf16 v[196:199], a[76:79], v[64:67], v[196:199]
    v_exp_f32 v34, v34
    v_mfma_f32_16x16x32_bf16 v[204:207], a[72:75], v[56:59], v[204:207]
    s_add_u32 m0, s41, 102144
    v_exp_f32 v35, v35
    v_mfma_f32_16x16x32_bf16 v[204:207], a[76:79], v[72:75], v[204:207]
    s_mov_b32 s45, 0
    v_add_f32 v88, v88, v34
    v_add_f32 v89, v89, v35
    v_mfma_f32_16x16x32_bf16 v[208:211], a[80:83], v[48:51], v[208:211]
    s_waitcnt vmcnt(4) lgkmcnt(0)
    v_exp_f32 v40, v40
    v_mfma_f32_16x16x32_bf16 v[208:211], a[84:87], v[64:67], v[208:211]
    s_barrier
    ds_read_b128 a[0:3], v2 offset:0
    v_cvt_pk_bf16_f32 v33, v34, v35
    v_mfma_f32_16x16x32_bf16 v[216:219], a[80:83], v[56:59], v[216:219]
    s_mov_b32 s43, 6144
    buffer_load_dwordx4 v6, s[8:11], s32 offen offset:0 lds
    v_mfma_f32_16x16x32_bf16 v[216:219], a[84:87], v[72:75], v[216:219]
    s_mov_b32 s44, 12288
    ds_read_b128 a[4:7], v2 offset:64
    v_add_f32 v90, v90, v40
    v_mfma_f32_16x16x32_bf16 v[212:215], a[88:91], v[48:51], v[212:215]
    ds_read_b128 a[8:11], v2 offset:128
    v_mfma_f32_16x16x32_bf16 v[212:215], a[92:95], v[64:67], v[212:215]
    v_exp_f32 v41, v41
    v_mfma_f32_16x16x32_bf16 v[220:223], a[88:91], v[56:59], v[220:223]
    buffer_load_dwordx4 v6, s[8:11], s33 offen offset:1024 lds
    v_mfma_f32_16x16x32_bf16 v[220:223], a[92:95], v[72:75], v[220:223]
    ds_read_b128 a[12:15], v2 offset:192
    v_add_f32 v91, v91, v41
    v_mfma_f32_16x16x32_bf16 v[224:227], a[96:99], v[48:51], v[224:227]
    ds_read_b128 a[16:19], v2 offset:256
    v_cvt_pk_bf16_f32 v40, v40, v41
    v_mfma_f32_16x16x32_bf16 v[224:227], a[100:103], v[64:67], v[224:227]
    v_exp_f32 v42, v42
    v_mfma_f32_16x16x32_bf16 v[232:235], a[96:99], v[56:59], v[232:235]
    buffer_load_dwordx4 v6, s[8:11], s34 offen offset:2176 lds
    v_mfma_f32_16x16x32_bf16 v[232:235], a[100:103], v[72:75], v[232:235]
    ds_read_b128 a[20:23], v2 offset:320
    v_add_f32 v90, v90, v42
    v_mfma_f32_16x16x32_bf16 v[228:231], a[104:107], v[48:51], v[228:231]
    ds_read_b128 a[24:27], v2 offset:384
    v_mfma_f32_16x16x32_bf16 v[228:231], a[108:111], v[64:67], v[228:231]
    v_exp_f32 v43, v43
    v_mfma_f32_16x16x32_bf16 v[236:239], a[104:107], v[56:59], v[236:239]
    buffer_load_dwordx4 v6, s[8:11], s35 offen offset:3200 lds
    v_mfma_f32_16x16x32_bf16 v[236:239], a[108:111], v[72:75], v[236:239]
    s_add_u32 m0, s41, 119168
    ds_read_b128 a[28:31], v2 offset:448
    v_add_f32 v91, v91, v43
    v_mfma_f32_16x16x32_bf16 v[240:243], a[112:115], v[48:51], v[240:243]
    ds_read_b128 a[32:35], v2 offset:512
    v_cvt_pk_bf16_f32 v41, v42, v43
    v_mfma_f32_16x16x32_bf16 v[240:243], a[116:119], v[64:67], v[240:243]
    ds_read_b128 a[36:39], v2 offset:576
    v_mfma_f32_16x16x32_bf16 v[248:251], a[112:115], v[56:59], v[248:251]
    buffer_load_dwordx4 v6, s[8:11], s36 offen offset:0 lds
    v_mfma_f32_16x16x32_bf16 v[248:251], a[116:119], v[72:75], v[248:251]
    ds_read_b128 a[40:43], v2 offset:640
    v_mfma_f32_16x16x32_bf16 v[244:247], a[120:123], v[48:51], v[244:247]
    v_exp_f32 v36, v36
    v_mfma_f32_16x16x32_bf16 v[244:247], a[124:127], v[64:67], v[244:247]
    ds_read_b128 a[44:47], v2 offset:704
    v_add_f32 v88, v88, v36
    v_mfma_f32_16x16x32_bf16 v[252:255], a[120:123], v[56:59], v[252:255]
    buffer_load_dwordx4 v6, s[8:11], s37 offen offset:1024 lds
    v_mfma_f32_16x16x32_bf16 v[252:255], a[124:127], v[72:75], v[252:255]
    s_waitcnt lgkmcnt(5)
    v_exp_f32 v37, v37
    v_mfma_f32_16x16x32_bf16 v[48:51], a[0:3], a[128:131], v[80:83]
    ds_read_b128 a[48:51], v2 offset:768
    v_add_f32 v89, v89, v37
    v_mfma_f32_16x16x32_bf16 v[48:51], a[4:7], a[136:139], v[48:51]
    ds_read_b128 a[52:55], v2 offset:832
    v_cvt_pk_bf16_f32 v34, v36, v37
    v_mfma_f32_16x16x32_bf16 v[48:51], a[8:11], a[144:147], v[48:51]
    buffer_load_dwordx4 v6, s[8:11], s38 offen offset:2176 lds
    v_mfma_f32_16x16x32_bf16 v[48:51], a[12:15], a[152:155], v[48:51]
    s_waitcnt vmcnt(10)
    ds_read_b128 a[56:59], v2 offset:896
    v_xor_b32 v96, v96, v101
    v_mfma_f32_16x16x32_bf16 v[48:51], a[16:19], a[160:163], v[48:51]
    v_exp_f32 v38, v38
    v_mfma_f32_16x16x32_bf16 v[48:51], a[20:23], a[168:171], v[48:51]
    ds_read_b128 a[60:63], v2 offset:960
    v_add_f32 v88, v88, v38
    v_mfma_f32_16x16x32_bf16 v[48:51], a[24:27], a[176:179], v[48:51]
    s_waitcnt lgkmcnt(5)
    buffer_load_dwordx4 v6, s[8:11], s39 offen offset:3200 lds
    v_mfma_f32_16x16x32_bf16 v[48:51], a[28:31], a[184:187], v[48:51]
    s_add_u32 m0, s42, 68096
    v_exp_f32 v39, v39
    v_mfma_f32_16x16x32_bf16 v[56:59], a[0:3], a[132:135], v[84:87]
    ds_read_b128 a[64:67], v2 offset:17024
    v_add_f32 v89, v89, v39
    v_mfma_f32_16x16x32_bf16 v[56:59], a[4:7], a[140:143], v[56:59]
    ds_read_b128 a[68:71], v2 offset:17088
    v_xor_b32 v97, v97, v101
    v_mfma_f32_16x16x32_bf16 v[56:59], a[8:11], a[148:151], v[56:59]
    buffer_load_dwordx4 v14, s[16:19], s45 offen offset:0 lds
    v_mfma_f32_16x16x32_bf16 v[56:59], a[12:15], a[156:159], v[56:59]
    s_mov_b32 s45, 18432
    ds_read_b128 a[72:75], v2 offset:17152
    v_xor_b32 v98, v98, v101
    v_mfma_f32_16x16x32_bf16 v[56:59], a[16:19], a[164:167], v[56:59]
    v_xor_b32 v99, v99, v101
    v_or3_b32 v96, v96, v97, v98
    v_mfma_f32_16x16x32_bf16 v[56:59], a[20:23], a[172:175], v[56:59]
    v_or_b32 v96, v96, v99
    v_cmp_ne_u32 vcc, 0, v96
    v_mfma_f32_16x16x32_bf16 v[56:59], a[24:27], a[180:183], v[56:59]
    ds_read_b128 a[76:79], v2 offset:17216
    v_cvt_pk_bf16_f32 v35, v38, v39
    v_mfma_f32_16x16x32_bf16 v[56:59], a[28:31], a[188:191], v[56:59]
    v_exp_f32 v44, v44
    v_mfma_f32_16x16x32_bf16 v[52:55], a[32:35], a[128:131], v[80:83]
    buffer_load_dwordx4 v14, s[16:19], s43 offen offset:1024 lds
    v_mfma_f32_16x16x32_bf16 v[52:55], a[36:39], a[136:139], v[52:55]
    s_mov_b32 s43, 28672
    ds_read_b128 a[80:83], v2 offset:17280
    v_add_f32 v90, v90, v44
    v_mfma_f32_16x16x32_bf16 v[52:55], a[40:43], a[144:147], v[52:55]
    s_waitcnt lgkmcnt(4)
    v_exp_f32 v45, v45
    v_mfma_f32_16x16x32_bf16 v[52:55], a[44:47], a[152:155], v[52:55]
    ds_read_b128 a[84:87], v2 offset:17344
    v_add_f32 v91, v91, v45
    v_mfma_f32_16x16x32_bf16 v[52:55], a[48:51], a[160:163], v[52:55]
    buffer_load_dwordx4 v14, s[16:19], s44 offen offset:2048 lds
    v_mfma_f32_16x16x32_bf16 v[52:55], a[52:55], a[168:171], v[52:55]
    s_mov_b32 s44, 34816
    ds_read_b128 a[88:91], v2 offset:17408
    v_cvt_pk_bf16_f32 v42, v44, v45
    v_mfma_f32_16x16x32_bf16 v[52:55], a[56:59], a[176:179], v[52:55]
    s_cmp_lg_u64 vcc, 0
    s_cbranch_scc1 L2_mw
L2_mwb:
    ds_read_b128 a[92:95], v2 offset:17472
    v_mfma_f32_16x16x32_bf16 v[52:55], a[60:63], a[184:187], v[52:55]
    s_waitcnt lgkmcnt(1)
    v_exp_f32 v48, v48
    v_mfma_f32_16x16x32_bf16 v[60:63], a[32:35], a[132:135], v[84:87]
    s_waitcnt lgkmcnt(2)
    v_exp_f32 v49, v49
    v_mfma_f32_16x16x32_bf16 v[60:63], a[36:39], a[140:143], v[60:63]
    s_waitcnt lgkmcnt(3)
    v_exp_f32 v46, v46
    v_mfma_f32_16x16x32_bf16 v[60:63], a[40:43], a[148:151], v[60:63]
    s_waitcnt lgkmcnt(4)
    buffer_load_dwordx4 v14, s[16:19], s45 offen offset:3072 lds
    v_mfma_f32_16x16x32_bf16 v[60:63], a[44:47], a[156:159], v[60:63]
    s_add_u32 m0, s42, 72192
    ds_read_b128 a[96:99], v2 offset:17536
    v_add_f32 v88, v88, v48
    v_mfma_f32_16x16x32_bf16 v[60:63], a[48:51], a[164:167], v[60:63]
    s_mov_b32 s45, 40960
    v_exp_f32 v47, v47
    v_mfma_f32_16x16x32_bf16 v[60:63], a[52:55], a[172:175], v[60:63]
    s_add_u32 s55, s51, 14336
    ds_read_b128 a[100:103], v2 offset:17600
    v_add_f32 v89, v89, v49
    v_mfma_f32_16x16x32_bf16 v[60:63], a[56:59], a[180:183], v[60:63]
    s_lshl2_add_u32 s75, s2, s48
    ds_read_b128 a[104:107], v2 offset:17664
    v_add_f32 v90, v90, v46
    v_mfma_f32_16x16x32_bf16 v[60:63], a[60:63], a[188:191], v[60:63]
    s_min_u32 s75, s75, 6
    v_cvt_pk_bf16_f32 v48, v48, v49
    v_add_f32 v91, v91, v47
    v_mfma_f32_16x16x32_bf16 v[64:67], a[64:67], a[128:131], v[80:83]
    s_lshl_b32 s75, s75, 13
    buffer_load_dwordx4 v14, s[16:19], s43 offen offset:0 lds
    v_mfma_f32_16x16x32_bf16 v[64:67], a[68:71], a[136:139], v[64:67]
    s_mov_b32 s43, 47104
    v_exp_f32 v50, v50
    v_mfma_f32_16x16x32_bf16 v[64:67], a[72:75], a[144:147], v[64:67]
    s_add_u32 s75, s75, 4456448
    ds_read_b128 a[108:111], v2 offset:17728
    v_cvt_pk_bf16_f32 v43, v46, v47
    v_mfma_f32_16x16x32_bf16 v[64:67], a[76:79], a[152:155], v[64:67]
    s_mov_b32 s74, s2
    v_exp_f32 v51, v51
    v_mfma_f32_16x16x32_bf16 v[64:67], a[80:83], a[160:163], v[64:67]
    s_lshl2_add_u32 s74, s74, s48
    ds_read_b128 a[112:115], v2 offset:17792
    v_add_f32 v88, v88, v50
    v_mfma_f32_16x16x32_bf16 v[64:67], a[84:87], a[168:171], v[64:67]
    s_mul_i32 s74, s74, 1792
    buffer_load_dwordx4 v14, s[16:19], s44 offen offset:1024 lds
    v_mfma_f32_16x16x32_bf16 v[64:67], a[88:91], a[176:179], v[64:67]
    s_add_u32 s73, s74, 2097152
    ds_read_b128 a[116:119], v2 offset:17856
    v_add_f32 v89, v89, v51
    s_waitcnt lgkmcnt(5)
    v_mfma_f32_16x16x32_bf16 v[64:67], a[92:95], a[184:187], v[64:67]
    s_add_u32 s74, s74, 6291456
    ds_read_b128 a[120:123], v2 offset:17920
    v_cvt_pk_bf16_f32 v49, v50, v51
    v_mfma_f32_16x16x32_bf16 v[72:75], a[64:67], a[132:135], v[84:87]
    v_exp_f32 v56, v56
    v_mfma_f32_16x16x32_bf16 v[72:75], a[68:71], a[140:143], v[72:75]
    v_exp_f32 v57, v57
    v_mfma_f32_16x16x32_bf16 v[72:75], a[72:75], a[148:151], v[72:75]
    buffer_load_dwordx4 v14, s[16:19], s45 offen offset:2048 lds
    v_mfma_f32_16x16x32_bf16 v[72:75], a[76:79], a[156:159], v[72:75]
    ds_read_b128 a[124:127], v2 offset:17984
    v_add_f32 v90, v90, v56
    v_mfma_f32_16x16x32_bf16 v[72:75], a[80:83], a[164:167], v[72:75]
    v_add_f32 v91, v91, v57
    v_cvt_pk_bf16_f32 v56, v56, v57
    v_mfma_f32_16x16x32_bf16 v[72:75], a[84:87], a[172:175], v[72:75]
    ds_read_b64_tr_b16 a[0:1], v1 offset:34048
    ds_read_b64_tr_b16 a[2:3], v1 offset:34560
    v_mfma_f32_16x16x32_bf16 v[72:75], a[88:91], a[180:183], v[72:75]
    buffer_load_dwordx4 v14, s[16:19], s43 offen offset:3072 lds
    v_mfma_f32_16x16x32_bf16 v[72:75], a[92:95], a[188:191], v[72:75]
    v_exp_f32 v58, v58
    v_mfma_f32_16x16x32_bf16 v[68:71], a[96:99], a[128:131], v[80:83]
    s_waitcnt lgkmcnt(4)
    ds_read_b64_tr_b16 a[4:5], v1 offset:51072
    ds_read_b64_tr_b16 a[6:7], v1 offset:51584
    v_mfma_f32_16x16x32_bf16 v[68:71], a[100:103], a[136:139], v[68:71]
    v_add_u32 v6, 0x8000, v6
    v_lshlrev_b32 v100, 3, v8
    v_mfma_f32_16x16x32_bf16 v[68:71], a[104:107], a[144:147], v[68:71]
    v_exp_f32 v59, v59
    v_mfma_f32_16x16x32_bf16 v[68:71], a[108:111], a[152:155], v[68:71]
    ds_read_b64_tr_b16 a[8:9], v1 offset:34080
    v_add_f32 v90, v90, v58
    v_mfma_f32_16x16x32_bf16 v[68:71], a[112:115], a[160:163], v[68:71]
    ds_read_b64_tr_b16 a[10:11], v1 offset:34592
    v_add_f32 v91, v91, v59
    v_mfma_f32_16x16x32_bf16 v[68:71], a[116:119], a[168:171], v[68:71]
    s_waitcnt lgkmcnt(6)
    ds_read_b64_tr_b16 a[12:13], v1 offset:51104
    v_cvt_pk_bf16_f32 v57, v58, v59
    v_mfma_f32_16x16x32_bf16 v[68:71], a[120:123], a[176:179], v[68:71]
    ds_read_b64_tr_b16 a[14:15], v1 offset:51616
    ds_read_b64_tr_b16 a[16:17], v1 offset:34112
    v_mfma_f32_16x16x32_bf16 v[68:71], a[124:127], a[184:187], v[68:71]
    v_exp_f32 v52, v52
    v_mfma_f32_16x16x32_bf16 v[76:79], a[96:99], a[132:135], v[84:87]
    ds_read_b64_tr_b16 a[18:19], v1 offset:34624
    v_lshrrev_b32 v101, 2, v8
    v_mfma_f32_16x16x32_bf16 v[76:79], a[100:103], a[140:143], v[76:79]
    v_mul_u32_u24 v101, 3, v101
    v_accvgpr_write_b32 a192, -1
    v_mfma_f32_16x16x32_bf16 v[76:79], a[104:107], a[148:151], v[76:79]
    v_accvgpr_write_b32 a193, -1
    v_accvgpr_write_b32 a194, -1
    v_mfma_f32_16x16x32_bf16 v[76:79], a[108:111], a[156:159], v[76:79]
    ds_read_b64_tr_b16 a[20:21], v1 offset:51136
    v_accvgpr_write_b32 a195, -1
    v_mfma_f32_16x16x32_bf16 v[76:79], a[112:115], a[164:167], v[76:79]
    v_exp_f32 v53, v53
    v_mfma_f32_16x16x32_bf16 v[76:79], a[116:119], a[172:175], v[76:79]
    ds_read_b64_tr_b16 a[22:23], v1 offset:51648
    v_add_f32 v88, v88, v52
    v_mfma_f32_16x16x32_bf16 v[76:79], a[120:123], a[180:183], v[76:79]
    ds_read_b64_tr_b16 a[24:25], v1 offset:34144
    v_add_f32 v89, v89, v53
    v_mfma_f32_16x16x32_bf16 v[76:79], a[124:127], a[188:191], v[76:79]
    s_waitcnt lgkmcnt(6)
    ds_read_b64_tr_b16 a[26:27], v1 offset:34656
    v_cvt_pk_bf16_f32 v50, v52, v53
    v_mfma_f32_16x16x32_bf16 v[128:131], a[0:3], v[16:19], v[128:131]
    ds_read_b64_tr_b16 a[28:29], v1 offset:51168
    ds_read_b64_tr_b16 a[30:31], v1 offset:51680
    v_mfma_f32_16x16x32_bf16 v[128:131], a[4:7], v[32:35], v[128:131]
    v_exp_f32 v54, v54
    v_mfma_f32_16x16x32_bf16 v[136:139], a[0:3], v[24:27], v[136:139]
    v_exp_f32 v55, v55
    v_mfma_f32_16x16x32_bf16 v[136:139], a[4:7], v[40:43], v[136:139]
    ds_read_b64_tr_b16 a[32:33], v1 offset:34176
    ds_read_b64_tr_b16 a[34:35], v1 offset:34688
    v_mfma_f32_16x16x32_bf16 v[132:135], a[8:11], v[16:19], v[132:135]
    s_waitcnt lgkmcnt(8)
    ds_read_b64_tr_b16 a[36:37], v1 offset:51200
    v_add_f32 v88, v88, v54
    v_mfma_f32_16x16x32_bf16 v[132:135], a[12:15], v[32:35], v[132:135]
    ds_read_b64_tr_b16 a[38:39], v1 offset:51712
    v_add_f32 v89, v89, v55
    v_mfma_f32_16x16x32_bf16 v[140:143], a[8:11], v[24:27], v[140:143]
    ds_read_b64_tr_b16 a[40:41], v1 offset:34208
    v_cvt_pk_bf16_f32 v51, v54, v55
    v_mfma_f32_16x16x32_bf16 v[140:143], a[12:15], v[40:43], v[140:143]
    buffer_load_dword a248, v100, s[20:23], s75 offen sc1
    v_mfma_f32_16x16x32_bf16 v[144:147], a[16:19], v[16:19], v[144:147]
    s_waitcnt lgkmcnt(8)
    ds_read_b64_tr_b16 a[42:43], v1 offset:34720
    ds_read_b64_tr_b16 a[44:45], v1 offset:51232
    v_mfma_f32_16x16x32_bf16 v[144:147], a[20:23], v[32:35], v[144:147]
    v_exp_f32 v60, v60
    v_mfma_f32_16x16x32_bf16 v[152:155], a[16:19], v[24:27], v[152:155]
    v_exp_f32 v61, v61
    v_mfma_f32_16x16x32_bf16 v[152:155], a[20:23], v[40:43], v[152:155]
    s_waitcnt lgkmcnt(7)
    ds_read_b64_tr_b16 a[46:47], v1 offset:51744
    ds_read_b64_tr_b16 a[48:49], v1 offset:34240
    v_mfma_f32_16x16x32_bf16 v[148:151], a[24:27], v[16:19], v[148:151]
    ds_read_b64_tr_b16 a[50:51], v1 offset:34752
    v_add_f32 v90, v90, v60
    v_mfma_f32_16x16x32_bf16 v[148:151], a[28:31], v[32:35], v[148:151]
    ds_read_b64_tr_b16 a[52:53], v1 offset:51264
    v_add_f32 v91, v91, v61
    v_mfma_f32_16x16x32_bf16 v[156:159], a[24:27], v[24:27], v[156:159]
    ds_read_b64_tr_b16 a[54:55], v1 offset:51776
    v_cvt_pk_bf16_f32 v58, v60, v61
    v_mfma_f32_16x16x32_bf16 v[156:159], a[28:31], v[40:43], v[156:159]
    s_waitcnt lgkmcnt(8)
    v_exp_f32 v62, v62
    v_mfma_f32_16x16x32_bf16 v[160:163], a[32:35], v[16:19], v[160:163]
    ds_read_b64_tr_b16 a[56:57], v1 offset:34272
    ds_read_b64_tr_b16 a[58:59], v1 offset:34784
    v_mfma_f32_16x16x32_bf16 v[160:163], a[36:39], v[32:35], v[160:163]
    v_exp_f32 v63, v63
    v_mfma_f32_16x16x32_bf16 v[168:171], a[32:35], v[24:27], v[168:171]
    ds_read_b64_tr_b16 a[60:61], v1 offset:51296
    v_add_f32 v90, v90, v62
    v_mfma_f32_16x16x32_bf16 v[168:171], a[36:39], v[40:43], v[168:171]
    s_waitcnt lgkmcnt(8)
    buffer_store_dwordx4 a[192:195], v8, s[20:23], s74 offen sc1
    v_mfma_f32_16x16x32_bf16 v[164:167], a[40:43], v[16:19], v[164:167]
    s_waitcnt lgkmcnt(7)
    ds_read_b64_tr_b16 a[62:63], v1 offset:51808
    v_add_f32 v91, v91, v63
    v_mfma_f32_16x16x32_bf16 v[164:167], a[44:47], v[32:35], v[164:167]
    ds_read_b64_tr_b16 a[64:65], v1 offset:34304
    ds_read_b64_tr_b16 a[66:67], v1 offset:34816
    v_mfma_f32_16x16x32_bf16 v[172:175], a[40:43], v[24:27], v[172:175]
    ds_read_b64_tr_b16 a[68:69], v1 offset:51328
    v_cvt_pk_bf16_f32 v59, v62, v63
    v_mfma_f32_16x16x32_bf16 v[172:175], a[44:47], v[40:43], v[172:175]
    s_waitcnt lgkmcnt(8)
    v_add_u32 v96, 0, v15
    v_xor_b32 v97, 32, v96
    v_mfma_f32_16x16x32_bf16 v[176:179], a[48:51], v[16:19], v[176:179]
    s_waitcnt lgkmcnt(7)
    v_xor_b32 v98, 64, v96
    v_xor_b32 v99, 96, v96
    v_mfma_f32_16x16x32_bf16 v[176:179], a[52:55], v[32:35], v[176:179]
    ds_read_b64_tr_b16 a[70:71], v1 offset:51840
    v_add_u32 v100, 68096, v15
    v_xor_b32 v102, 64, v100
    v_mfma_f32_16x16x32_bf16 v[184:187], a[48:51], v[24:27], v[184:187]
    ds_read_b64_tr_b16 a[72:73], v1 offset:34336
    v_xor_b32 v103, 96, v100
    v_mfma_f32_16x16x32_bf16 v[184:187], a[52:55], v[40:43], v[184:187]
    s_waitcnt lgkmcnt(7)
    buffer_store_dwordx3 a[192:194], v101, s[20:23], s74 offen offset:1024 sc1
    v_mfma_f32_16x16x32_bf16 v[180:183], a[56:59], v[16:19], v[180:183]
    s_waitcnt lgkmcnt(5)
    ds_read_b64_tr_b16 a[74:75], v1 offset:34848
    v_exp_f32 v64, v64
    v_mfma_f32_16x16x32_bf16 v[180:183], a[60:63], v[32:35], v[180:183]
    s_waitcnt lgkmcnt(0)
    ds_read_b64_tr_b16 a[76:77], v1 offset:51360
    ds_read_b64_tr_b16 a[78:79], v1 offset:51872
    v_exp_f32 v65, v65
    v_mfma_f32_16x16x32_bf16 v[188:191], a[56:59], v[24:27], v[188:191]
    s_waitcnt lgkmcnt(4)
    v_add_f32 v88, v88, v64
    v_add_f32 v89, v89, v65
    v_mfma_f32_16x16x32_bf16 v[188:191], a[60:63], v[40:43], v[188:191]
    s_waitcnt lgkmcnt(6)
    buffer_store_dwordx4 a[192:195], v8, s[20:23], s73 offen sc1
    v_mfma_f32_16x16x32_bf16 v[192:195], a[64:67], v[16:19], v[192:195]
    s_mov_b32 s76, s3
    ds_read_b64_tr_b16 a[80:81], v1 offset:34368
    ds_read_b64_tr_b16 a[82:83], v1 offset:34880
    v_cvt_pk_bf16_f32 v64, v64, v65
    v_mfma_f32_16x16x32_bf16 v[192:195], a[68:71], v[32:35], v[192:195]
    s_mov_b32 s77, s52
    ds_read_b64_tr_b16 a[84:85], v1 offset:51392
    ds_read_b64_tr_b16 a[86:87], v1 offset:51904
    ds_read_b64_tr_b16 a[88:89], v1 offset:34400
    ds_read_b64_tr_b16 a[90:91], v1 offset:34912
    ds_read_b64_tr_b16 a[92:93], v1 offset:51424
    ds_read_b64_tr_b16 a[94:95], v1 offset:51936
    ds_read_b64_tr_b16 a[96:97], v1 offset:34432
    ds_read_b64_tr_b16 a[98:99], v1 offset:34944
    ds_read_b64_tr_b16 a[100:101], v1 offset:51456
    ds_read_b64_tr_b16 a[102:103], v1 offset:51968
    ds_read_b64_tr_b16 a[104:105], v1 offset:34464
    ds_read_b64_tr_b16 a[106:107], v1 offset:34976
    ds_read_b64_tr_b16 a[108:109], v1 offset:51488
    ds_read_b64_tr_b16 a[110:111], v1 offset:52000
    ds_read_b64_tr_b16 a[112:113], v1 offset:34496
    ds_read_b64_tr_b16 a[114:115], v1 offset:35008
    ds_read_b64_tr_b16 a[116:117], v1 offset:51520
    ds_read_b64_tr_b16 a[118:119], v1 offset:52032
    ds_read_b64_tr_b16 a[120:121], v1 offset:34528
    ds_read_b64_tr_b16 a[122:123], v1 offset:35040
    ds_read_b64_tr_b16 a[124:125], v1 offset:51552
    ds_read_b64_tr_b16 a[126:127], v1 offset:52064
    v_exp_f32 v66, v66
    v_mfma_f32_16x16x32_bf16 v[200:203], a[64:67], v[24:27], v[200:203]
    s_mov_b32 s78, 1835008
    v_exp_f32 v67, v67
    v_mfma_f32_16x16x32_bf16 v[200:203], a[68:71], v[40:43], v[200:203]
    s_mov_b32 s72, s2
    buffer_store_dwordx3 a[192:194], v101, s[20:23], s73 offen offset:1024 sc1
    v_mfma_f32_16x16x32_bf16 v[196:199], a[72:75], v[16:19], v[196:199]
    s_lshl2_add_u32 s75, s72, s48
    v_xor_b32 v101, 32, v100
    v_add_f32 v88, v88, v66
    s_waitcnt lgkmcnt(15)
    v_mfma_f32_16x16x32_bf16 v[196:199], a[76:79], v[32:35], v[196:199]
    s_mul_i32 s75, s75, 1792
    v_bfe_u32 v10, v8, 5, 3
    v_mul_u32_u24 v10, 1792, v10
    v_mfma_f32_16x16x32_bf16 v[204:207], a[72:75], v[24:27], v[204:207]
    s_add_u32 m0, s42, 0
    v_lshrrev_b32 v11, 8, v8
    v_lshl_add_u32 v10, v11, 5, v10
    v_mfma_f32_16x16x32_bf16 v[204:207], a[76:79], v[40:43], v[204:207]
    s_mov_b32 s44, 128
    v_and_b32 v11, 16, v8
    v_add_u32 v10, v10, v11
    v_mfma_f32_16x16x32_bf16 v[208:211], a[80:83], v[16:19], v[208:211]
    s_waitcnt vmcnt(5) lgkmcnt(0)
    v_add_f32 v89, v89, v67
    v_cvt_pk_bf16_f32 v65, v66, v67
    v_mfma_f32_16x16x32_bf16 v[208:211], a[84:87], v[32:35], v[208:211]
    s_barrier
    v_exp_f32 v72, v72
    v_mfma_f32_16x16x32_bf16 v[216:219], a[80:83], v[24:27], v[216:219]
    s_mov_b32 s45, 6272
    v_exp_f32 v73, v73
    v_mfma_f32_16x16x32_bf16 v[216:219], a[84:87], v[40:43], v[216:219]
    s_mov_b32 s43, 12416
    v_add_f32 v90, v90, v72
    v_add_f32 v91, v91, v73
    v_mfma_f32_16x16x32_bf16 v[212:215], a[88:91], v[16:19], v[212:215]
    s_mov_b32 s74, 1839104
    ds_read_b64_tr_b16 a[0:1], v4 offset:34048
    v_cvt_pk_bf16_f32 v72, v72, v73
    v_mfma_f32_16x16x32_bf16 v[212:215], a[92:95], v[32:35], v[212:215]
    s_lshr_b32 s72, s72, 2
    v_exp_f32 v74, v74
    v_mfma_f32_16x16x32_bf16 v[220:223], a[88:91], v[24:27], v[220:223]
    s_lshl_b32 s72, s72, 7
    v_exp_f32 v75, v75
    v_mfma_f32_16x16x32_bf16 v[220:223], a[92:95], v[40:43], v[220:223]
    s_add_u32 s72, s72, 4456448
    v_add_f32 v90, v90, v74
    v_add_f32 v91, v91, v75
    v_mfma_f32_16x16x32_bf16 v[224:227], a[96:99], v[16:19], v[224:227]
    s_mov_b32 s73, 1843200
    ds_read_b64_tr_b16 a[2:3], v4 offset:34560
    v_cvt_pk_bf16_f32 v73, v74, v75
    v_mfma_f32_16x16x32_bf16 v[224:227], a[100:103], v[32:35], v[224:227]
    v_exp_f32 v68, v68
    v_mfma_f32_16x16x32_bf16 v[232:235], a[96:99], v[24:27], v[232:235]
    v_exp_f32 v69, v69
    v_mfma_f32_16x16x32_bf16 v[232:235], a[100:103], v[40:43], v[232:235]
    v_add_f32 v88, v88, v68
    v_add_f32 v89, v89, v69
    v_mfma_f32_16x16x32_bf16 v[228:231], a[104:107], v[16:19], v[228:231]
    ds_read_b64_tr_b16 a[4:5], v4 offset:51072
    v_cvt_pk_bf16_f32 v66, v68, v69
    v_mfma_f32_16x16x32_bf16 v[228:231], a[108:111], v[32:35], v[228:231]
    v_exp_f32 v70, v70
    v_mfma_f32_16x16x32_bf16 v[236:239], a[104:107], v[24:27], v[236:239]
    v_exp_f32 v71, v71
    v_mfma_f32_16x16x32_bf16 v[236:239], a[108:111], v[40:43], v[236:239]
    v_add_f32 v88, v88, v70
    v_add_f32 v89, v89, v71
    v_mfma_f32_16x16x32_bf16 v[240:243], a[112:115], v[16:19], v[240:243]
    ds_read_b64_tr_b16 a[6:7], v4 offset:51584
    v_cvt_pk_bf16_f32 v67, v70, v71
    v_mfma_f32_16x16x32_bf16 v[240:243], a[116:119], v[32:35], v[240:243]
    buffer_load_dwordx4 v14, s[16:19], s44 offen offset:0 lds
    v_mfma_f32_16x16x32_bf16 v[248:251], a[112:115], v[24:27], v[248:251]
    s_mov_b32 s44, 18560
    v_exp_f32 v76, v76
    v_mfma_f32_16x16x32_bf16 v[248:251], a[116:119], v[40:43], v[248:251]
    v_exp_f32 v77, v77
    v_mfma_f32_16x16x32_bf16 v[244:247], a[120:123], v[16:19], v[244:247]
    s_waitcnt lgkmcnt(0)
    ds_read_b64_tr_b16 a[8:9], v4 offset:34080
    ds_read_b64_tr_b16 a[10:11], v4 offset:34592
    v_mfma_f32_16x16x32_bf16 v[244:247], a[124:127], v[32:35], v[244:247]
    s_waitcnt lgkmcnt(4)
    buffer_load_dwordx4 v14, s[16:19], s45 offen offset:1024 lds
    ds_read_b64_tr_b16 a[12:13], v4 offset:51104
    ds_read_b64_tr_b16 a[14:15], v4 offset:51616
    v_mfma_f32_16x16x32_bf16 v[252:255], a[120:123], v[24:27], v[252:255]
    s_sub_u32 s47, s47, 1
    v_add_f32 v90, v90, v76
    v_add_f32 v91, v91, v77
    v_mfma_f32_16x16x32_bf16 v[252:255], a[124:127], v[40:43], v[252:255]
    s_cmp_lg_u32 s47, 0
    ds_read_b64_tr_b16 a[16:17], v4 offset:34112
    v_cvt_pk_bf16_f32 v74, v76, v77
    v_mfma_f32_16x16x32_bf16 v[128:131], a[0:3], v[48:51], v[128:131]
    s_mov_b32 s45, 28800
    buffer_load_dwordx4 v14, s[16:19], s43 offen offset:2048 lds
    ds_read_b64_tr_b16 a[18:19], v4 offset:34624
    v_exp_f32 v78, v78
    v_exp_f32 v79, v79
    v_mfma_f32_16x16x32_bf16 v[128:131], a[4:7], v[64:67], v[128:131]
    s_mov_b32 s43, 34944
    ds_read_b64_tr_b16 a[20:21], v4 offset:51136
    ds_read_b64_tr_b16 a[22:23], v4 offset:51648
    v_cvt_pk_bf16_f32 v75, v78, v79
    v_mfma_f32_16x16x32_bf16 v[136:139], a[0:3], v[56:59], v[136:139]
    s_waitcnt lgkmcnt(6)
    buffer_load_dwordx4 v14, s[16:19], s44 offen offset:3072 lds
    v_mfma_f32_16x16x32_bf16 v[136:139], a[4:7], v[72:75], v[136:139]
    s_add_u32 m0, s42, 4096
    ds_read_b64_tr_b16 a[24:25], v4 offset:34144
    v_add_f32 v90, v90, v78
    v_mfma_f32_16x16x32_bf16 v[132:135], a[8:11], v[48:51], v[132:135]
    s_mov_b32 s44, 41088
    ds_read_b64_tr_b16 a[26:27], v4 offset:34656
    v_add_f32 v91, v91, v79
    s_waitcnt lgkmcnt(6)
    v_mfma_f32_16x16x32_bf16 v[132:135], a[12:15], v[64:67], v[132:135]
    s_waitcnt lgkmcnt(2)
    buffer_load_dwordx4 v14, s[16:19], s45 offen offset:0 lds
    ds_read_b64_tr_b16 a[28:29], v4 offset:51168
    ds_read_b64_tr_b16 a[30:31], v4 offset:51680
    v_mfma_f32_16x16x32_bf16 v[140:143], a[8:11], v[56:59], v[140:143]
    s_mov_b32 s45, 47232
    ds_read_b64_tr_b16 a[32:33], v4 offset:34176
    ds_read_b64_tr_b16 a[34:35], v4 offset:34688
    v_mfma_f32_16x16x32_bf16 v[140:143], a[12:15], v[72:75], v[140:143]
    s_waitcnt lgkmcnt(8)
    buffer_load_dwordx4 v14, s[16:19], s43 offen offset:1024 lds
    v_mfma_f32_16x16x32_bf16 v[144:147], a[16:19], v[48:51], v[144:147]
    s_mov_b32 s43, 256
    ds_read_b64_tr_b16 a[36:37], v4 offset:51200
    ds_read_b64_tr_b16 a[38:39], v4 offset:51712
    v_mfma_f32_16x16x32_bf16 v[144:147], a[20:23], v[64:67], v[144:147]
    ds_read_b64_tr_b16 a[40:41], v4 offset:34208
    ds_read_b64_tr_b16 a[42:43], v4 offset:34720
    v_mfma_f32_16x16x32_bf16 v[152:155], a[16:19], v[56:59], v[152:155]
    s_waitcnt lgkmcnt(8)
    buffer_load_dwordx4 v14, s[16:19], s44 offen offset:2048 lds
    v_mfma_f32_16x16x32_bf16 v[152:155], a[20:23], v[72:75], v[152:155]
    s_mov_b32 s44, 6400
    ds_read_b64_tr_b16 a[44:45], v4 offset:51232
    ds_read_b64_tr_b16 a[46:47], v4 offset:51744
    v_mfma_f32_16x16x32_bf16 v[148:151], a[24:27], v[48:51], v[148:151]
    s_waitcnt lgkmcnt(8)
    ds_read_b64_tr_b16 a[48:49], v4 offset:34240
    v_add_u32 v113, 0x100, v8
    v_mfma_f32_16x16x32_bf16 v[148:151], a[28:31], v[64:67], v[148:151]
    s_waitcnt lgkmcnt(7)
    buffer_load_dwordx4 v14, s[16:19], s45 offen offset:3072 lds
    v_mfma_f32_16x16x32_bf16 v[156:159], a[24:27], v[56:59], v[156:159]
    s_add_u32 m0, s42, 34048
    ds_read_b64_tr_b16 a[50:51], v4 offset:34752
    v_lshlrev_b32 v113, 21, v113
    v_mfma_f32_16x16x32_bf16 v[156:159], a[28:31], v[72:75], v[156:159]
    s_mov_b32 s45, 12544
    ds_read_b64_tr_b16 a[52:53], v4 offset:51264
    v_and_b32 v113, 0x80000000, v113
    v_mfma_f32_16x16x32_bf16 v[160:163], a[32:35], v[48:51], v[160:163]
    s_waitcnt lgkmcnt(7)
    ds_read_b64_tr_b16 a[54:55], v4 offset:51776
    v_or_b32 v108, v113, v8
    v_mfma_f32_16x16x32_bf16 v[160:163], a[36:39], v[64:67], v[160:163]
    buffer_load_dwordx4 v14, s[16:19], s43 offen offset:0 lds
    v_mfma_f32_16x16x32_bf16 v[168:171], a[32:35], v[56:59], v[168:171]
    s_mov_b32 s43, 18688
    ds_read_b64_tr_b16 a[56:57], v4 offset:34272
    v_bfe_u32 v109, v8, 4, 1
    v_mfma_f32_16x16x32_bf16 v[168:171], a[36:39], v[72:75], v[168:171]
    s_waitcnt lgkmcnt(7)
    ds_read_b64_tr_b16 a[58:59], v4 offset:34784
    v_mul_u32_u24 v109, 896, v109
    v_mfma_f32_16x16x32_bf16 v[164:167], a[40:43], v[48:51], v[164:167]
    s_waitcnt lgkmcnt(6)
    ds_read_b64_tr_b16 a[60:61], v4 offset:51296
    v_lshrrev_b32 v111, 7, v8
    v_mfma_f32_16x16x32_bf16 v[164:167], a[44:47], v[64:67], v[164:167]
    buffer_load_dwordx4 v14, s[16:19], s44 offen offset:1024 lds
    ds_read_b64_tr_b16 a[62:63], v4 offset:51808
    v_mfma_f32_16x16x32_bf16 v[172:175], a[40:43], v[56:59], v[172:175]
    s_mov_b32 s44, 28928
    v_lshl_add_u32 v109, v111, 6, v109
    v_bfe_u32 v111, v8, 5, 2
    v_mfma_f32_16x16x32_bf16 v[172:175], a[44:47], v[72:75], v[172:175]
    s_waitcnt lgkmcnt(6)
    ds_read_b64_tr_b16 a[64:65], v4 offset:34304
    ds_read_b64_tr_b16 a[66:67], v4 offset:34816
    v_mfma_f32_16x16x32_bf16 v[176:179], a[48:51], v[48:51], v[176:179]
    s_waitcnt lgkmcnt(6)
    ds_read_b64_tr_b16 a[68:69], v4 offset:51328
    v_lshl_add_u32 v109, v111, 3, v109
    v_mfma_f32_16x16x32_bf16 v[176:179], a[52:55], v[64:67], v[176:179]
    buffer_load_dwordx4 v14, s[16:19], s45 offen offset:2048 lds
    ds_read_b64_tr_b16 a[70:71], v4 offset:51840
    v_mfma_f32_16x16x32_bf16 v[184:187], a[48:51], v[56:59], v[184:187]
    s_mov_b32 s45, 35072
    v_or_b32 v110, v113, v109
    v_and_b32 v111, 0x3e0, v8
    v_mfma_f32_16x16x32_bf16 v[184:187], a[52:55], v[72:75], v[184:187]
    s_waitcnt lgkmcnt(6)
    ds_read_b64_tr_b16 a[72:73], v4 offset:34336
    v_cvt_pk_bf16_f32 v128, v128, v129
    v_mfma_f32_16x16x32_bf16 v[180:183], a[56:59], v[48:51], v[180:183]
    s_waitcnt lgkmcnt(5)
    ds_read_b64_tr_b16 a[74:75], v4 offset:34848
    v_cvt_pk_bf16_f32 v129, v130, v131
    v_cvt_pk_bf16_f32 v130, v132, v133
    v_mfma_f32_16x16x32_bf16 v[180:183], a[60:63], v[64:67], v[180:183]
    ds_read_b64_tr_b16 a[76:77], v4 offset:51360
    ds_read_b64_tr_b16 a[78:79], v4 offset:51872
    v_cvt_pk_bf16_f32 v131, v134, v135
    v_cvt_pk_bf16_f32 v136, v136, v137
    v_mfma_f32_16x16x32_bf16 v[188:191], a[56:59], v[56:59], v[188:191]
    v_cvt_pk_bf16_f32 v137, v138, v139
    v_cvt_pk_bf16_f32 v138, v140, v141
    v_mfma_f32_16x16x32_bf16 v[188:191], a[60:63], v[72:75], v[188:191]
    s_waitcnt lgkmcnt(6)
    v_cvt_pk_bf16_f32 v139, v142, v143
    v_or_b32 v112, v113, v111
    v_mfma_f32_16x16x32_bf16 v[192:195], a[64:67], v[48:51], v[192:195]
    s_waitcnt lgkmcnt(4)
    buffer_load_dwordx4 v14, s[16:19], s43 offen offset:3072 lds
    ds_read_b64_tr_b16 a[80:81], v4 offset:34368
    ds_read_b64_tr_b16 a[82:83], v4 offset:34880
    v_mfma_f32_16x16x32_bf16 v[192:195], a[68:71], v[64:67], v[192:195]
    s_add_u32 m0, s42, 38144
    ds_read_b64_tr_b16 a[84:85], v4 offset:51392
    ds_read_b64_tr_b16 a[86:87], v4 offset:51904
    v_add_u32 v115, 0x300, v8
    v_add_f32 v88, v88, v89
    v_mfma_f32_16x16x32_bf16 v[200:203], a[64:67], v[56:59], v[200:203]
    s_mov_b32 s43, 41216
    v_lshlrev_b32 v115, 21, v115
    v_mov_b32 v89, v88
    v_mfma_f32_16x16x32_bf16 v[200:203], a[68:71], v[72:75], v[200:203]
    s_waitcnt lgkmcnt(6)
    v_and_b32 v115, 0x80000000, v115
    v_lshrrev_b32 v114, 4, v8
    v_mfma_f32_16x16x32_bf16 v[196:199], a[72:75], v[48:51], v[196:199]
    s_waitcnt lgkmcnt(4)
    ds_read_b64_tr_b16 a[88:89], v4 offset:34400
    ds_read_b64_tr_b16 a[90:91], v4 offset:34912
    v_permlane32_swap_b32 v88, v89
    v_mfma_f32_16x16x32_bf16 v[196:199], a[76:79], v[64:67], v[196:199]
    buffer_load_dwordx4 v14, s[16:19], s44 offen offset:0 lds
    ds_read_b64_tr_b16 a[92:93], v4 offset:51424
    ds_read_b64_tr_b16 a[94:95], v4 offset:51936
    v_mfma_f32_16x16x32_bf16 v[204:207], a[72:75], v[56:59], v[204:207]
    s_mov_b32 s44, 47360
    v_add_f32 v88, v88, v89
    v_lshl_or_b32 v116, v114, 3, v115
    v_mfma_f32_16x16x32_bf16 v[204:207], a[76:79], v[72:75], v[204:207]
    s_waitcnt lgkmcnt(6)
    v_mov_b32 v89, v88
    v_lshl_or_b32 v114, v114, 3, v115
    v_mfma_f32_16x16x32_bf16 v[208:211], a[80:83], v[48:51], v[208:211]
    s_waitcnt lgkmcnt(4)
    buffer_load_dwordx4 v14, s[16:19], s45 offen offset:1024 lds
    ds_read_b64_tr_b16 a[96:97], v4 offset:34432
    ds_read_b64_tr_b16 a[98:99], v4 offset:34944
    v_mfma_f32_16x16x32_bf16 v[208:211], a[84:87], v[64:67], v[208:211]
    ds_read_b64_tr_b16 a[100:101], v4 offset:51456
    ds_read_b64_tr_b16 a[102:103], v4 offset:51968
    v_permlane16_swap_b32 v88, v89
    v_mfma_f32_16x16x32_bf16 v[216:219], a[80:83], v[56:59], v[216:219]
    v_add_f32 v88, v88, v89
    v_cvt_pk_bf16_f32 v144, v144, v145
    v_mfma_f32_16x16x32_bf16 v[216:219], a[84:87], v[72:75], v[216:219]
    s_waitcnt lgkmcnt(6)
    v_cvt_pk_bf16_f32 v145, v146, v147
    v_cvt_pk_bf16_f32 v146, v148, v149
    v_mfma_f32_16x16x32_bf16 v[212:215], a[88:91], v[48:51], v[212:215]
    s_waitcnt lgkmcnt(4)
    ds_read_b64_tr_b16 a[104:105], v4 offset:34464
    ds_read_b64_tr_b16 a[106:107], v4 offset:34976
    v_cvt_pk_bf16_f32 v147, v150, v151
    v_cvt_pk_bf16_f32 v152, v152, v153
    v_mfma_f32_16x16x32_bf16 v[212:215], a[92:95], v[64:67], v[212:215]
    ds_read_b64_tr_b16 a[108:109], v4 offset:51488
    ds_read_b64_tr_b16 a[110:111], v4 offset:52000
    v_cvt_pk_bf16_f32 v153, v154, v155
    v_cvt_pk_bf16_f32 v154, v156, v157
    v_mfma_f32_16x16x32_bf16 v[220:223], a[88:91], v[56:59], v[220:223]
    v_cvt_pk_bf16_f32 v155, v158, v159
    v_add_f32 v90, v90, v91
    v_mfma_f32_16x16x32_bf16 v[220:223], a[92:95], v[72:75], v[220:223]
    s_waitcnt lgkmcnt(6)
    v_rcp_f32 v89, v88
    v_mfma_f32_16x16x32_bf16 v[224:227], a[96:99], v[48:51], v[224:227]
    s_waitcnt lgkmcnt(4)
    buffer_load_dwordx4 v14, s[16:19], s43 offen offset:2048 lds
    ds_read_b64_tr_b16 a[112:113], v4 offset:34496
    ds_read_b64_tr_b16 a[114:115], v4 offset:35008
    v_mfma_f32_16x16x32_bf16 v[224:227], a[100:103], v[64:67], v[224:227]
    ds_read_b64_tr_b16 a[116:117], v4 offset:51520
    ds_read_b64_tr_b16 a[118:119], v4 offset:52032
    v_mov_b32 v91, v90
    v_mov_b32 v95, 153216
    v_mfma_f32_16x16x32_bf16 v[232:235], a[96:99], v[56:59], v[232:235]
    buffer_load_dwordx4 v14, s[16:19], s44 offen offset:3072 lds
    v_mfma_f32_16x16x32_bf16 v[232:235], a[100:103], v[72:75], v[232:235]
    s_waitcnt lgkmcnt(6)
    v_permlane32_swap_b32 v90, v91
    v_mfma_f32_16x16x32_bf16 v[228:231], a[104:107], v[48:51], v[228:231]
    s_waitcnt lgkmcnt(4)
    ds_read_b64_tr_b16 a[120:121], v4 offset:34528
    ds_read_b64_tr_b16 a[122:123], v4 offset:35040
    v_add_f32 v90, v90, v91
    v_mov_b32 v91, v90
    v_mfma_f32_16x16x32_bf16 v[228:231], a[108:111], v[64:67], v[228:231]
    ds_read_b64_tr_b16 a[124:125], v4 offset:51552
    ds_read_b64_tr_b16 a[126:127], v4 offset:52064
    v_cvt_pk_bf16_f32 v160, v160, v161
    v_cvt_pk_bf16_f32 v161, v162, v163
    v_mfma_f32_16x16x32_bf16 v[236:239], a[104:107], v[56:59], v[236:239]
    v_permlane16_swap_b32 v90, v91
    v_mfma_f32_16x16x32_bf16 v[236:239], a[108:111], v[72:75], v[236:239]
    s_waitcnt lgkmcnt(6)
    v_add_f32 v90, v90, v91
    v_cvt_pk_bf16_f32 v162, v164, v165
    v_mfma_f32_16x16x32_bf16 v[240:243], a[112:115], v[48:51], v[240:243]
    s_waitcnt lgkmcnt(4)
    ds_read_b64_tr_b16 a[0:1], v100 offset:0
    ds_read_b64_tr_b16 a[2:3], v100 offset:2048
    v_cvt_pk_bf16_f32 v163, v166, v167
    v_cvt_pk_bf16_f32 v168, v168, v169
    v_mfma_f32_16x16x32_bf16 v[240:243], a[116:119], v[64:67], v[240:243]
    ds_read_b64_tr_b16 a[4:5], v100 offset:4096
    ds_read_b64_tr_b16 a[6:7], v100 offset:6144
    v_cvt_pk_bf16_f32 v169, v170, v171
    v_cvt_pk_bf16_f32 v170, v172, v173
    v_mfma_f32_16x16x32_bf16 v[248:251], a[112:115], v[56:59], v[248:251]
    ds_read_b64_tr_b16 a[8:9], v100 offset:8192
    ds_read_b64_tr_b16 a[10:11], v100 offset:10240
    v_cvt_pk_bf16_f32 v171, v174, v175
    v_add_f32 v93, v88, v90
    v_mfma_f32_16x16x32_bf16 v[248:251], a[116:119], v[72:75], v[248:251]
    s_waitcnt lgkmcnt(8)
    buffer_load_dwordx2 v[132:133], v109, s[76:79], s75 offen offset:0
    ds_read_b64_tr_b16 a[12:13], v100 offset:12288
    ds_read_b64_tr_b16 a[14:15], v100 offset:14336
    v_mfma_f32_16x16x32_bf16 v[244:247], a[120:123], v[48:51], v[244:247]
    s_waitcnt lgkmcnt(8)
    ds_read_b64_tr_b16 a[16:17], v100 offset:16384
    ds_read_b64_tr_b16 a[18:19], v100 offset:18432
    v_rcp_f32 v91, v90
    v_mfma_f32_16x16x32_bf16 v[244:247], a[124:127], v[64:67], v[244:247]
    ds_read_b64_tr_b16 a[20:21], v100 offset:20480
    ds_read_b64_tr_b16 a[22:23], v100 offset:22528
    v_cmp_ngt_f32 vcc, 0x5f800000, v93
    v_mov_b32 v94, s56
    v_mfma_f32_16x16x32_bf16 v[252:255], a[120:123], v[56:59], v[252:255]
    s_or_b32 s53, vcc_lo, vcc_hi
    buffer_load_dwordx2 v[134:135], v109, s[76:79], s75 offen offset:32
    ds_read_b64_tr_b16 a[24:25], v100 offset:24576
    ds_read_b64_tr_b16 a[26:27], v100 offset:26624
    v_mfma_f32_16x16x32_bf16 v[252:255], a[124:127], v[72:75], v[252:255]
    s_waitcnt lgkmcnt(12)
    ds_read_b64_tr_b16 a[28:29], v100 offset:28672
    ds_read_b64_tr_b16 a[30:31], v100 offset:30720
    v_mov_b32 v93, s53
    v_cvt_pk_bf16_f32 v176, v176, v177
    v_mfma_f32_16x16x32_bf16 v[16:19], a[0:3], v[128:131], 0
    s_waitcnt lgkmcnt(12)
    buffer_load_dwordx2 v[140:141], v110, s[76:79], s75 offen offset:512
    v_mfma_f32_16x16x32_bf16 v[16:19], a[4:7], v[144:147], v[16:19]
    s_waitcnt lgkmcnt(10)
    ds_write_b32 v94, v93
    v_cvt_pk_bf16_f32 v177, v178, v179
    v_cvt_pk_bf16_f32 v178, v180, v181
    v_cvt_pk_bf16_f32 v179, v182, v183
    v_mfma_f32_16x16x32_bf16 v[16:19], a[8:11], v[160:163], v[16:19]
    s_waitcnt lgkmcnt(9)
    v_cvt_pk_bf16_f32 v184, v184, v185
    v_cvt_pk_bf16_f32 v185, v186, v187
    v_cvt_pk_bf16_f32 v192, v192, v193
    v_cvt_pk_bf16_f32 v193, v194, v195
    v_cvt_pk_bf16_f32 v194, v196, v197
    v_cvt_pk_bf16_f32 v195, v198, v199
    v_mfma_f32_16x16x32_bf16 v[16:19], a[12:15], v[176:179], v[16:19]
    s_waitcnt lgkmcnt(7)
    v_cvt_pk_bf16_f32 v186, v188, v189
    v_cvt_pk_bf16_f32 v187, v190, v191
    v_cvt_pk_bf16_f32 v208, v208, v209
    v_cvt_pk_bf16_f32 v209, v210, v211
    v_cvt_pk_bf16_f32 v210, v212, v213
    v_cvt_pk_bf16_f32 v211, v214, v215
    v_mfma_f32_16x16x32_bf16 v[16:19], a[16:19], v[192:195], v[16:19]
    s_waitcnt lgkmcnt(5)
    buffer_load_dwordx2 v[142:143], v110, s[76:79], s75 offen offset:544
    v_cvt_pk_bf16_f32 v224, v224, v225
    v_cvt_pk_bf16_f32 v225, v226, v227
    v_cvt_pk_bf16_f32 v226, v228, v229
    v_cvt_pk_bf16_f32 v227, v230, v231
    v_mfma_f32_16x16x32_bf16 v[16:19], a[20:23], v[208:211], v[16:19]
    s_waitcnt lgkmcnt(3)
    buffer_load_dwordx4 v[148:151], v111, s[20:23], s74 offen offset:0
    v_cvt_pk_bf16_f32 v240, v240, v241
    v_cvt_pk_bf16_f32 v241, v242, v243
    v_cvt_pk_bf16_f32 v242, v244, v245
    v_cvt_pk_bf16_f32 v243, v246, v247
    v_mfma_f32_16x16x32_bf16 v[16:19], a[24:27], v[224:227], v[16:19]
    s_waitcnt lgkmcnt(1)
    buffer_load_dwordx4 v[156:159], v111, s[20:23], s74 offen offset:16
    v_mfma_f32_16x16x32_bf16 v[16:19], a[28:31], v[240:243], v[16:19]
    v_cvt_pk_bf16_f32 v200, v200, v201
    v_cvt_pk_bf16_f32 v201, v202, v203
    v_mfma_f32_16x16x32_bf16 v[24:27], a[0:3], v[136:139], 0
    ds_read_b64_tr_b16 a[32:33], v101 offset:0
    ds_read_b64_tr_b16 a[34:35], v101 offset:2048
    v_cvt_pk_bf16_f32 v202, v204, v205
    v_cvt_pk_bf16_f32 v203, v206, v207
    v_mfma_f32_16x16x32_bf16 v[24:27], a[4:7], v[152:155], v[24:27]
    buffer_load_dwordx4 v[164:167], v112, s[20:23], s74 offen offset:1024
    ds_read_b64_tr_b16 a[36:37], v101 offset:4096
    ds_read_b64_tr_b16 a[38:39], v101 offset:6144
    v_mfma_f32_16x16x32_bf16 v[24:27], a[8:11], v[168:171], v[24:27]
    buffer_load_dwordx4 v[172:175], v112, s[20:23], s74 offen offset:1040
    ds_read_b64_tr_b16 a[40:41], v101 offset:8192
    ds_read_b64_tr_b16 a[42:43], v101 offset:10240
    v_mfma_f32_16x16x32_bf16 v[24:27], a[12:15], v[184:187], v[24:27]
    ds_read_b64_tr_b16 a[44:45], v101 offset:12288
    ds_read_b64_tr_b16 a[46:47], v101 offset:14336
    v_cvt_pk_bf16_f32 v216, v216, v217
    v_cvt_pk_bf16_f32 v217, v218, v219
    v_cvt_pk_bf16_f32 v218, v220, v221
    v_cvt_pk_bf16_f32 v219, v222, v223
    v_mfma_f32_16x16x32_bf16 v[24:27], a[16:19], v[200:203], v[24:27]
    buffer_load_dwordx4 v[180:183], v111, s[20:23], s74 offen offset:1792
    ds_read_b64_tr_b16 a[48:49], v101 offset:16384
    ds_read_b64_tr_b16 a[50:51], v101 offset:18432
    v_cvt_pk_bf16_f32 v232, v232, v233
    v_cvt_pk_bf16_f32 v233, v234, v235
    v_cvt_pk_bf16_f32 v234, v236, v237
    v_cvt_pk_bf16_f32 v235, v238, v239
    v_mfma_f32_16x16x32_bf16 v[24:27], a[20:23], v[216:219], v[24:27]
    buffer_load_dwordx4 v[188:191], v111, s[20:23], s74 offen offset:1808
    ds_read_b64_tr_b16 a[52:53], v101 offset:20480
    ds_read_b64_tr_b16 a[54:55], v101 offset:22528
    v_cvt_pk_bf16_f32 v248, v248, v249
    v_cvt_pk_bf16_f32 v249, v250, v251
    v_cvt_pk_bf16_f32 v250, v252, v253
    v_cvt_pk_bf16_f32 v251, v254, v255
    v_mfma_f32_16x16x32_bf16 v[24:27], a[24:27], v[232:235], v[24:27]
    buffer_load_dwordx4 v[196:199], v112, s[20:23], s74 offen offset:2816
    ds_read_b64_tr_b16 a[56:57], v101 offset:24576
    ds_read_b64_tr_b16 a[58:59], v101 offset:26624
    v_mfma_f32_16x16x32_bf16 v[24:27], a[28:31], v[248:251], v[24:27]
    s_waitcnt lgkmcnt(12)
    buffer_load_dwordx4 v[204:207], v112, s[20:23], s74 offen offset:2832
    ds_read_b64_tr_b16 a[60:61], v101 offset:28672
    ds_read_b64_tr_b16 a[62:63], v101 offset:30720
    v_mfma_f32_16x16x32_bf16 v[20:23], a[32:35], v[128:131], 0
    s_waitcnt lgkmcnt(12)
    buffer_load_dwordx4 v[212:215], v111, s[20:23], s74 offen offset:3584
    v_mfma_f32_16x16x32_bf16 v[20:23], a[36:39], v[144:147], v[20:23]
    s_waitcnt lgkmcnt(10)
    buffer_load_dwordx4 v[220:223], v111, s[20:23], s74 offen offset:3600
    v_mfma_f32_16x16x32_bf16 v[20:23], a[40:43], v[160:163], v[20:23]
    s_waitcnt lgkmcnt(8)
    ds_read_b64_tr_b16 a[64:65], v102 offset:0
    ds_read_b64_tr_b16 a[66:67], v102 offset:2048
    v_mfma_f32_16x16x32_bf16 v[20:23], a[44:47], v[176:179], v[20:23]
    s_waitcnt lgkmcnt(8)
    ds_read_b64_tr_b16 a[68:69], v102 offset:4096
    ds_read_b64_tr_b16 a[70:71], v102 offset:6144
    v_mfma_f32_16x16x32_bf16 v[20:23], a[48:51], v[192:195], v[20:23]
    s_waitcnt lgkmcnt(8)
    buffer_load_dwordx4 v[228:231], v112, s[20:23], s73 offen offset:512
    v_mfma_f32_16x16x32_bf16 v[20:23], a[52:55], v[208:211], v[20:23]
    s_waitcnt lgkmcnt(6)
    ds_read_b64_tr_b16 a[72:73], v102 offset:8192
    ds_read_b64_tr_b16 a[74:75], v102 offset:10240
    v_mfma_f32_16x16x32_bf16 v[20:23], a[56:59], v[224:227], v[20:23]
    s_waitcnt lgkmcnt(6)
    buffer_load_dwordx4 v[236:239], v112, s[20:23], s73 offen offset:528
    v_mfma_f32_16x16x32_bf16 v[20:23], a[60:63], v[240:243], v[20:23]
    ds_read_b64_tr_b16 a[76:77], v102 offset:12288
    ds_read_b64_tr_b16 a[78:79], v102 offset:14336
    v_mfma_f32_16x16x32_bf16 v[28:31], a[32:35], v[136:139], 0
    ds_read_b64_tr_b16 a[80:81], v102 offset:16384
    ds_read_b64_tr_b16 a[82:83], v102 offset:18432
    v_mfma_f32_16x16x32_bf16 v[28:31], a[36:39], v[152:155], v[28:31]
    ds_read_b64_tr_b16 a[84:85], v102 offset:20480
    v_mul_f32 v16, v16, v89
    v_mfma_f32_16x16x32_bf16 v[28:31], a[40:43], v[168:171], v[28:31]
    v_mul_f32 v17, v17, v89
    v_mul_f32 v18, v18, v89
    v_mfma_f32_16x16x32_bf16 v[28:31], a[44:47], v[184:187], v[28:31]
    ds_read_b64_tr_b16 a[86:87], v102 offset:22528
    v_mul_f32 v19, v19, v89
    v_mfma_f32_16x16x32_bf16 v[28:31], a[48:51], v[200:203], v[28:31]
    ds_read_b64_tr_b16 a[88:89], v102 offset:24576
    ds_read_b64_tr_b16 a[90:91], v102 offset:26624
    v_mfma_f32_16x16x32_bf16 v[28:31], a[52:55], v[216:219], v[28:31]
    ds_read_b64_tr_b16 a[92:93], v102 offset:28672
    ds_read_b64_tr_b16 a[94:95], v102 offset:30720
    v_mfma_f32_16x16x32_bf16 v[28:31], a[56:59], v[232:235], v[28:31]
    ds_read_b64_tr_b16 a[96:97], v103 offset:0
    ds_read_b64_tr_b16 a[98:99], v103 offset:2048
    v_mfma_f32_16x16x32_bf16 v[28:31], a[60:63], v[248:251], v[28:31]
    s_waitcnt lgkmcnt(12)
    ds_read_b64_tr_b16 a[100:101], v103 offset:4096
    ds_read_b64_tr_b16 a[102:103], v103 offset:6144
    v_mfma_f32_16x16x32_bf16 v[32:35], a[64:67], v[128:131], 0
    v_mul_f32 v24, v24, v91
    v_mul_f32 v25, v25, v91
    v_mfma_f32_16x16x32_bf16 v[32:35], a[68:71], v[144:147], v[32:35]
    ds_read_b64_tr_b16 a[104:105], v103 offset:8192
    ds_read_b64_tr_b16 a[106:107], v103 offset:10240
    ds_read_b64_tr_b16 a[108:109], v103 offset:12288
    ds_read_b64_tr_b16 a[110:111], v103 offset:14336
    ds_read_b64_tr_b16 a[112:113], v103 offset:16384
    ds_read_b64_tr_b16 a[114:115], v103 offset:18432
    ds_read_b64_tr_b16 a[116:117], v103 offset:20480
    ds_read_b64_tr_b16 a[118:119], v103 offset:22528
    ds_read_b64_tr_b16 a[120:121], v103 offset:24576
    ds_read_b64_tr_b16 a[122:123], v103 offset:26624
    ds_read_b64_tr_b16 a[124:125], v103 offset:28672
    ds_read_b64_tr_b16 a[126:127], v103 offset:30720
    v_mul_f32 v26, v26, v91
    v_mul_f32 v27, v27, v91
    v_mfma_f32_16x16x32_bf16 v[32:35], a[72:75], v[160:163], v[32:35]
    s_waitcnt lgkmcnt(15)
    v_mul_f32 v20, v20, v89
    v_mul_f32 v21, v21, v89
    v_mfma_f32_16x16x32_bf16 v[32:35], a[76:79], v[176:179], v[32:35]
    v_mul_f32 v22, v22, v89
    v_mul_f32 v23, v23, v89
    v_mfma_f32_16x16x32_bf16 v[32:35], a[80:83], v[192:195], v[32:35]
    v_cvt_pk_bf16_f32 v16, v16, v17
    v_cvt_pk_bf16_f32 v17, v18, v19
    v_mfma_f32_16x16x32_bf16 v[32:35], a[84:87], v[208:211], v[32:35]
    v_cvt_pk_bf16_f32 v18, v20, v21
    v_cvt_pk_bf16_f32 v19, v22, v23
    v_mfma_f32_16x16x32_bf16 v[32:35], a[88:91], v[224:227], v[32:35]
    s_add_u32 m0, s42, 68096
    buffer_store_dwordx4 v[16:19], v10, s[20:23], s51 offen offset:0 sc1
    v_mfma_f32_16x16x32_bf16 v[32:35], a[92:95], v[240:243], v[32:35]
    s_mov_b32 s45, 384
    v_mul_f32 v28, v28, v91
    v_mul_f32 v29, v29, v91
    v_mfma_f32_16x16x32_bf16 v[40:43], a[64:67], v[136:139], 0
    s_waitcnt vmcnt(17) lgkmcnt(0)
    v_mul_f32 v30, v30, v91
    v_mul_f32 v31, v31, v91
    v_mfma_f32_16x16x32_bf16 v[40:43], a[68:71], v[152:155], v[40:43]
    s_barrier
    v_cvt_pk_bf16_f32 v24, v24, v25
    v_cvt_pk_bf16_f32 v25, v26, v27
    v_mfma_f32_16x16x32_bf16 v[40:43], a[72:75], v[168:171], v[40:43]
    s_mov_b32 s43, 6528
    v_cvt_pk_bf16_f32 v26, v28, v29
    v_cvt_pk_bf16_f32 v27, v30, v31
    v_mfma_f32_16x16x32_bf16 v[40:43], a[76:79], v[184:187], v[40:43]
    s_mov_b32 s44, 12672
    buffer_store_dwordx4 v[24:27], v10, s[20:23], s55 offen offset:0 sc1
    v_mfma_f32_16x16x32_bf16 v[40:43], a[80:83], v[200:203], v[40:43]
    ds_read_b64_tr_b16 a[0:1], v96 offset:0
    ds_read_b64_tr_b16 a[2:3], v96 offset:2048
    v_mfma_f32_16x16x32_bf16 v[40:43], a[84:87], v[216:219], v[40:43]
    buffer_load_dwordx4 v14, s[16:19], s45 offen offset:0 lds
    v_mfma_f32_16x16x32_bf16 v[40:43], a[88:91], v[232:235], v[40:43]
    s_mov_b32 s45, 18816
    ds_read_b64_tr_b16 a[4:5], v96 offset:4096
    ds_read_b64_tr_b16 a[6:7], v96 offset:6144
    v_mfma_f32_16x16x32_bf16 v[40:43], a[92:95], v[248:251], v[40:43]
    v_mul_f32 v32, v32, v89
    v_mul_f32 v33, v33, v89
    v_mfma_f32_16x16x32_bf16 v[36:39], a[96:99], v[128:131], 0
    v_mul_f32 v34, v34, v89
    v_mul_f32 v35, v35, v89
    v_mfma_f32_16x16x32_bf16 v[36:39], a[100:103], v[144:147], v[36:39]
    ds_read_b64_tr_b16 a[8:9], v96 offset:8192
    ds_read_b64_tr_b16 a[10:11], v96 offset:10240
    v_mfma_f32_16x16x32_bf16 v[36:39], a[104:107], v[160:163], v[36:39]
    buffer_load_dwordx4 v14, s[16:19], s43 offen offset:1024 lds
    v_mfma_f32_16x16x32_bf16 v[36:39], a[108:111], v[176:179], v[36:39]
    s_mov_b32 s43, 29056
    ds_read_b64_tr_b16 a[12:13], v96 offset:12288
    ds_read_b64_tr_b16 a[14:15], v96 offset:14336
    v_mfma_f32_16x16x32_bf16 v[36:39], a[112:115], v[192:195], v[36:39]
    buffer_load_dwordx4 v14, s[16:19], s44 offen offset:2048 lds
    v_mfma_f32_16x16x32_bf16 v[36:39], a[116:119], v[208:211], v[36:39]
    s_mov_b32 s44, 35200
    ds_read_b64_tr_b16 a[16:17], v96 offset:16384
    ds_read_b64_tr_b16 a[18:19], v96 offset:18432
    v_mfma_f32_16x16x32_bf16 v[36:39], a[120:123], v[224:227], v[36:39]
    ds_read_b128 v[104:107], v95
    ds_read_b64_tr_b16 a[20:21], v96 offset:20480
    v_mfma_f32_16x16x32_bf16 v[36:39], a[124:127], v[240:243], v[36:39]
    buffer_load_dwordx4 v14, s[16:19], s45 offen offset:3072 lds
    v_mfma_f32_16x16x32_bf16 v[44:47], a[96:99], v[136:139], 0
    s_add_u32 m0, s42, 72192
    ds_read_b64_tr_b16 a[22:23], v96 offset:22528
    v_mul_f32 v40, v40, v91
    v_mfma_f32_16x16x32_bf16 v[44:47], a[100:103], v[152:155], v[44:47]
    s_mov_b32 s45, 41344
    v_mul_f32 v41, v41, v91
    v_mul_f32 v42, v42, v91
    v_mfma_f32_16x16x32_bf16 v[44:47], a[104:107], v[168:171], v[44:47]
    ds_read_b64_tr_b16 a[24:25], v96 offset:24576
    v_mul_f32 v43, v43, v91
    v_mfma_f32_16x16x32_bf16 v[44:47], a[108:111], v[184:187], v[44:47]
    ds_read_b64_tr_b16 a[26:27], v96 offset:26624
    ds_read_b64_tr_b16 a[28:29], v96 offset:28672
    v_mfma_f32_16x16x32_bf16 v[44:47], a[112:115], v[200:203], v[44:47]
    buffer_load_dwordx4 v14, s[16:19], s43 offen offset:0 lds
    v_mfma_f32_16x16x32_bf16 v[44:47], a[116:119], v[216:219], v[44:47]
    s_mov_b32 s43, 47488
    ds_read_b64_tr_b16 a[30:31], v96 offset:30720
    ds_read_b64_tr_b16 a[32:33], v97 offset:0
    v_mfma_f32_16x16x32_bf16 v[44:47], a[120:123], v[232:235], v[44:47]
    ds_read_b64_tr_b16 a[34:35], v97 offset:2048
    ds_read_b64_tr_b16 a[36:37], v97 offset:4096
    v_mfma_f32_16x16x32_bf16 v[44:47], a[124:127], v[248:251], v[44:47]
    s_waitcnt lgkmcnt(10)
    buffer_load_dwordx4 v14, s[16:19], s44 offen offset:1024 lds
    v_mfma_f32_16x16x32_bf16 v[48:51], a[0:3], v[128:131], 0
    s_mov_b32 s44, 512
    ds_read_b64_tr_b16 a[38:39], v97 offset:6144
    ds_read_b64_tr_b16 a[40:41], v97 offset:8192
    v_mfma_f32_16x16x32_bf16 v[48:51], a[4:7], v[144:147], v[48:51]
    v_mul_f32 v36, v36, v89
    v_mul_f32 v37, v37, v89
    v_mfma_f32_16x16x32_bf16 v[48:51], a[8:11], v[160:163], v[48:51]
    v_mul_f32 v38, v38, v89
    v_mul_f32 v39, v39, v89
    v_mfma_f32_16x16x32_bf16 v[48:51], a[12:15], v[176:179], v[48:51]
    s_waitcnt lgkmcnt(5)
    v_cvt_pk_bf16_f32 v32, v32, v33
    v_cvt_pk_bf16_f32 v33, v34, v35
    v_mfma_f32_16x16x32_bf16 v[48:51], a[16:19], v[192:195], v[48:51]
    s_waitcnt lgkmcnt(8)
    v_cvt_pk_bf16_f32 v34, v36, v37
    v_cvt_pk_bf16_f32 v35, v38, v39
    v_mfma_f32_16x16x32_bf16 v[48:51], a[20:23], v[208:211], v[48:51]
    s_waitcnt lgkmcnt(6)
    buffer_load_dwordx4 v14, s[16:19], s45 offen offset:2048 lds
    v_mfma_f32_16x16x32_bf16 v[48:51], a[24:27], v[224:227], v[48:51]
    s_mov_b32 s45, 6656
    ds_read_b64_tr_b16 a[42:43], v97 offset:10240
    ds_read_b64_tr_b16 a[44:45], v97 offset:12288
    v_mfma_f32_16x16x32_bf16 v[48:51], a[28:31], v[240:243], v[48:51]
    ds_read_b64_tr_b16 a[46:47], v97 offset:14336
    ds_read_b64_tr_b16 a[48:49], v97 offset:16384
    v_mfma_f32_16x16x32_bf16 v[56:59], a[0:3], v[136:139], 0
    buffer_store_dwordx4 v[32:35], v10, s[20:23], s51 offen offset:128 sc1
    v_mfma_f32_16x16x32_bf16 v[56:59], a[4:7], v[152:155], v[56:59]
    buffer_load_dwordx4 v14, s[16:19], s43 offen offset:3072 lds
    v_mfma_f32_16x16x32_bf16 v[56:59], a[8:11], v[168:171], v[56:59]
    s_add_u32 m0, s42, 102144
    ds_read_b64_tr_b16 a[50:51], v97 offset:18432
    ds_read_b64_tr_b16 a[52:53], v97 offset:20480
    v_mfma_f32_16x16x32_bf16 v[56:59], a[12:15], v[184:187], v[56:59]
    s_mov_b32 s43, 12800
    buffer_load_dwordx4 v14, s[16:19], s44 offen offset:0 lds
    v_mfma_f32_16x16x32_bf16 v[56:59], a[16:19], v[200:203], v[56:59]
    s_mov_b32 s44, 18944
    ds_read_b64_tr_b16 a[54:55], v97 offset:22528
    ds_read_b64_tr_b16 a[56:57], v97 offset:24576
    v_mfma_f32_16x16x32_bf16 v[56:59], a[20:23], v[216:219], v[56:59]
    v_mul_f32 v44, v44, v91
    v_mul_f32 v45, v45, v91
    v_mfma_f32_16x16x32_bf16 v[56:59], a[24:27], v[232:235], v[56:59]
    ds_read_b64_tr_b16 a[58:59], v97 offset:26624
    v_mul_f32 v46, v46, v91
    v_mul_f32 v47, v47, v91
    v_mfma_f32_16x16x32_bf16 v[56:59], a[28:31], v[248:251], v[56:59]
    s_waitcnt lgkmcnt(9)
    ds_read_b64_tr_b16 a[60:61], v97 offset:28672
    ds_read_b64_tr_b16 a[62:63], v97 offset:30720
    v_cvt_pk_bf16_f32 v40, v40, v41
    v_cvt_pk_bf16_f32 v41, v42, v43
    v_mfma_f32_16x16x32_bf16 v[52:55], a[32:35], v[128:131], 0
    s_waitcnt lgkmcnt(2)
    v_cvt_pk_bf16_f32 v42, v44, v45
    v_cvt_pk_bf16_f32 v43, v46, v47
    v_mfma_f32_16x16x32_bf16 v[52:55], a[36:39], v[144:147], v[52:55]
    s_waitcnt lgkmcnt(7)
    buffer_load_dwordx4 v14, s[16:19], s45 offen offset:1024 lds
    v_mfma_f32_16x16x32_bf16 v[52:55], a[40:43], v[160:163], v[52:55]
    s_mov_b32 s45, 29184
    buffer_store_dwordx4 v[40:43], v10, s[20:23], s55 offen offset:128 sc1
    v_mfma_f32_16x16x32_bf16 v[52:55], a[44:47], v[176:179], v[52:55]
    s_waitcnt lgkmcnt(6)
    ds_read_b64_tr_b16 a[64:65], v98 offset:0
    ds_read_b64_tr_b16 a[66:67], v98 offset:2048
    v_mfma_f32_16x16x32_bf16 v[52:55], a[48:51], v[192:195], v[52:55]
    s_waitcnt lgkmcnt(6)
    buffer_load_dwordx4 v14, s[16:19], s43 offen offset:2048 lds
    v_mfma_f32_16x16x32_bf16 v[52:55], a[52:55], v[208:211], v[52:55]
    s_mov_b32 s43, 35328
    ds_read_b64_tr_b16 a[68:69], v98 offset:4096
    ds_read_b64_tr_b16 a[70:71], v98 offset:6144
    v_mfma_f32_16x16x32_bf16 v[52:55], a[56:59], v[224:227], v[52:55]
    s_waitcnt lgkmcnt(4)
    ds_read_b64_tr_b16 a[72:73], v98 offset:8192
    ds_read_b64_tr_b16 a[74:75], v98 offset:10240
    v_mfma_f32_16x16x32_bf16 v[52:55], a[60:63], v[240:243], v[52:55]
    buffer_load_dwordx4 v14, s[16:19], s44 offen offset:3072 lds
    v_mfma_f32_16x16x32_bf16 v[60:63], a[32:35], v[136:139], 0
    s_add_u32 m0, s42, 106240
    ds_read_b64_tr_b16 a[76:77], v98 offset:12288
    v_mul_f32 v48, v48, v89
    v_mfma_f32_16x16x32_bf16 v[60:63], a[36:39], v[152:155], v[60:63]
    s_mov_b32 s44, 41472
    v_mul_f32 v49, v49, v89
    v_mul_f32 v50, v50, v89
    v_mfma_f32_16x16x32_bf16 v[60:63], a[40:43], v[168:171], v[60:63]
    ds_read_b64_tr_b16 a[78:79], v98 offset:14336
    v_mul_f32 v51, v51, v89
    v_mfma_f32_16x16x32_bf16 v[60:63], a[44:47], v[184:187], v[60:63]
    buffer_load_dwordx4 v14, s[16:19], s45 offen offset:0 lds
    v_mfma_f32_16x16x32_bf16 v[60:63], a[48:51], v[200:203], v[60:63]
    s_mov_b32 s45, 47616
    ds_read_b64_tr_b16 a[80:81], v98 offset:16384
    ds_read_b64_tr_b16 a[82:83], v98 offset:18432
    v_mfma_f32_16x16x32_bf16 v[60:63], a[52:55], v[216:219], v[60:63]
    ds_read_b64_tr_b16 a[84:85], v98 offset:20480
    ds_read_b64_tr_b16 a[86:87], v98 offset:22528
    v_mfma_f32_16x16x32_bf16 v[60:63], a[56:59], v[232:235], v[60:63]
    buffer_load_dwordx4 v14, s[16:19], s43 offen offset:1024 lds
    ds_read_b64_tr_b16 a[88:89], v98 offset:24576
    ds_read_b64_tr_b16 a[90:91], v98 offset:26624
    v_mfma_f32_16x16x32_bf16 v[60:63], a[60:63], v[248:251], v[60:63]
    s_waitcnt lgkmcnt(10)
    buffer_load_dwordx4 v14, s[16:19], s44 offen offset:2048 lds
    ds_read_b64_tr_b16 a[92:93], v98 offset:28672
    ds_read_b64_tr_b16 a[94:95], v98 offset:30720
    v_mfma_f32_16x16x32_bf16 v[64:67], a[64:67], v[128:131], 0
    v_mul_f32 v56, v56, v91
    v_mul_f32 v57, v57, v91
    v_mfma_f32_16x16x32_bf16 v[64:67], a[68:71], v[144:147], v[64:67]
    s_waitcnt lgkmcnt(10)
    v_mul_f32 v58, v58, v91
    v_mul_f32 v59, v59, v91
    v_mfma_f32_16x16x32_bf16 v[64:67], a[72:75], v[160:163], v[64:67]
    s_waitcnt lgkmcnt(8)
    ds_read_b64_tr_b16 a[96:97], v99 offset:0
    ds_read_b64_tr_b16 a[98:99], v99 offset:2048
    v_mfma_f32_16x16x32_bf16 v[64:67], a[76:79], v[176:179], v[64:67]
    s_waitcnt lgkmcnt(8)
    buffer_load_dwordx4 v14, s[16:19], s45 offen offset:3072 lds
    v_mfma_f32_16x16x32_bf16 v[64:67], a[80:83], v[192:195], v[64:67]
    s_waitcnt lgkmcnt(6)
    ds_read_b64_tr_b16 a[100:101], v99 offset:4096
    ds_read_b64_tr_b16 a[102:103], v99 offset:6144
    v_mfma_f32_16x16x32_bf16 v[64:67], a[84:87], v[208:211], v[64:67]
    s_waitcnt lgkmcnt(6)
    ds_read_b64_tr_b16 a[104:105], v99 offset:8192
    ds_read_b64_tr_b16 a[106:107], v99 offset:10240
    v_mfma_f32_16x16x32_bf16 v[64:67], a[88:91], v[224:227], v[64:67]
    s_waitcnt lgkmcnt(6)
    ds_read_b64_tr_b16 a[108:109], v99 offset:12288
    ds_read_b64_tr_b16 a[110:111], v99 offset:14336
    v_mfma_f32_16x16x32_bf16 v[64:67], a[92:95], v[240:243], v[64:67]
    v_mul_f32 v52, v52, v89
    v_mul_f32 v53, v53, v89
    v_mfma_f32_16x16x32_bf16 v[72:75], a[64:67], v[136:139], 0
    v_mul_f32 v54, v54, v89
    v_mul_f32 v55, v55, v89
    v_mfma_f32_16x16x32_bf16 v[72:75], a[68:71], v[152:155], v[72:75]
    v_cvt_pk_bf16_f32 v48, v48, v49
    v_cvt_pk_bf16_f32 v49, v50, v51
    v_mfma_f32_16x16x32_bf16 v[72:75], a[72:75], v[168:171], v[72:75]
    v_cvt_pk_bf16_f32 v50, v52, v53
    v_cvt_pk_bf16_f32 v51, v54, v55
    v_mfma_f32_16x16x32_bf16 v[72:75], a[76:79], v[184:187], v[72:75]
    ds_read_b64_tr_b16 a[112:113], v99 offset:16384
    ds_read_b64_tr_b16 a[114:115], v99 offset:18432
    v_mfma_f32_16x16x32_bf16 v[72:75], a[80:83], v[200:203], v[72:75]
    ds_read_b64_tr_b16 a[116:117], v99 offset:20480
    ds_read_b64_tr_b16 a[118:119], v99 offset:22528
    v_mfma_f32_16x16x32_bf16 v[72:75], a[84:87], v[216:219], v[72:75]
    buffer_store_dwordx4 v[48:51], v10, s[20:23], s51 offen offset:256 sc1
    v_mfma_f32_16x16x32_bf16 v[72:75], a[88:91], v[232:235], v[72:75]
    ds_read_b64_tr_b16 a[120:121], v99 offset:24576
    ds_read_b64_tr_b16 a[122:123], v99 offset:26624
    v_mfma_f32_16x16x32_bf16 v[72:75], a[92:95], v[248:251], v[72:75]
    s_waitcnt lgkmcnt(8)
    ds_read_b64_tr_b16 a[124:125], v99 offset:28672
    ds_read_b64_tr_b16 a[126:127], v99 offset:30720
    v_mfma_f32_16x16x32_bf16 v[68:71], a[96:99], v[128:131], 0
    v_mul_f32 v60, v60, v91
    v_mul_f32 v61, v61, v91
    v_mfma_f32_16x16x32_bf16 v[68:71], a[100:103], v[144:147], v[68:71]
    v_mul_f32 v62, v62, v91
    v_mul_f32 v63, v63, v91
    v_mfma_f32_16x16x32_bf16 v[68:71], a[104:107], v[160:163], v[68:71]
    s_waitcnt lgkmcnt(8)
    v_cvt_pk_bf16_f32 v56, v56, v57
    v_cvt_pk_bf16_f32 v57, v58, v59
    v_mfma_f32_16x16x32_bf16 v[68:71], a[108:111], v[176:179], v[68:71]
    s_waitcnt lgkmcnt(6)
    v_cvt_pk_bf16_f32 v58, v60, v61
    v_cvt_pk_bf16_f32 v59, v62, v63
    v_mfma_f32_16x16x32_bf16 v[68:71], a[112:115], v[192:195], v[68:71]
    s_waitcnt lgkmcnt(4)
    ds_read_b64_tr_b16 a[0:1], v96 offset:34048
    ds_read_b64_tr_b16 a[2:3], v96 offset:36096
    v_mfma_f32_16x16x32_bf16 v[68:71], a[116:119], v[208:211], v[68:71]
    s_waitcnt lgkmcnt(4)
    ds_read_b64_tr_b16 a[4:5], v96 offset:38144
    ds_read_b64_tr_b16 a[6:7], v96 offset:40192
    v_mfma_f32_16x16x32_bf16 v[68:71], a[120:123], v[224:227], v[68:71]
    s_waitcnt lgkmcnt(4)
    buffer_store_dwordx4 v[56:59], v10, s[20:23], s55 offen offset:256 sc1
    v_mfma_f32_16x16x32_bf16 v[68:71], a[124:127], v[240:243], v[68:71]
    ds_read_b64_tr_b16 a[8:9], v96 offset:42240
    ds_read_b64_tr_b16 a[10:11], v96 offset:44288
    v_mfma_f32_16x16x32_bf16 v[76:79], a[96:99], v[136:139], 0
    ds_read_b64_tr_b16 a[12:13], v96 offset:46336
    ds_read_b64_tr_b16 a[14:15], v96 offset:48384
    v_mfma_f32_16x16x32_bf16 v[76:79], a[100:103], v[152:155], v[76:79]
    v_mul_f32 v64, v64, v89
    v_mul_f32 v65, v65, v89
    v_mfma_f32_16x16x32_bf16 v[76:79], a[104:107], v[168:171], v[76:79]
    v_mul_f32 v66, v66, v89
    v_mul_f32 v67, v67, v89
    v_mfma_f32_16x16x32_bf16 v[76:79], a[108:111], v[184:187], v[76:79]
    ds_read_b64_tr_b16 a[16:17], v96 offset:50432
    ds_read_b64_tr_b16 a[18:19], v96 offset:52480
    v_mfma_f32_16x16x32_bf16 v[76:79], a[112:115], v[200:203], v[76:79]
    ds_read_b64_tr_b16 a[20:21], v96 offset:54528
    ds_read_b64_tr_b16 a[22:23], v96 offset:56576
    v_mfma_f32_16x16x32_bf16 v[76:79], a[116:119], v[216:219], v[76:79]
    ds_read_b64_tr_b16 a[24:25], v96 offset:58624
    ds_read_b64_tr_b16 a[26:27], v96 offset:60672
    v_mfma_f32_16x16x32_bf16 v[76:79], a[120:123], v[232:235], v[76:79]
    ds_read_b64_tr_b16 a[28:29], v96 offset:62720
    ds_read_b64_tr_b16 a[30:31], v96 offset:64768
    v_mfma_f32_16x16x32_bf16 v[76:79], a[124:127], v[248:251], v[76:79]
    s_waitcnt lgkmcnt(12)
    v_mul_f32 v72, v72, v91
    v_mul_f32 v73, v73, v91
    v_mfma_f32_16x16x32_bf16 v[16:19], a[0:3], v[128:131], 0
    v_mul_f32 v74, v74, v91
    v_mul_f32 v75, v75, v91
    v_mfma_f32_16x16x32_bf16 v[16:19], a[4:7], v[144:147], v[16:19]
    s_waitcnt lgkmcnt(10)
    ds_read_b64_tr_b16 a[32:33], v97 offset:34048
    ds_read_b64_tr_b16 a[34:35], v97 offset:36096
    v_mfma_f32_16x16x32_bf16 v[16:19], a[8:11], v[160:163], v[16:19]
    s_waitcnt lgkmcnt(10)
    ds_read_b64_tr_b16 a[36:37], v97 offset:38144
    ds_read_b64_tr_b16 a[38:39], v97 offset:40192
    v_mfma_f32_16x16x32_bf16 v[16:19], a[12:15], v[176:179], v[16:19]
    s_waitcnt lgkmcnt(10)
    ds_read_b64_tr_b16 a[40:41], v97 offset:42240
    ds_read_b64_tr_b16 a[42:43], v97 offset:44288
    v_mfma_f32_16x16x32_bf16 v[16:19], a[16:19], v[192:195], v[16:19]
    s_waitcnt lgkmcnt(10)
    ds_read_b64_tr_b16 a[44:45], v97 offset:46336
    ds_read_b64_tr_b16 a[46:47], v97 offset:48384
    v_mfma_f32_16x16x32_bf16 v[16:19], a[20:23], v[208:211], v[16:19]
    s_waitcnt lgkmcnt(10)
    ds_read_b64_tr_b16 a[48:49], v97 offset:50432
    v_mul_f32 v68, v68, v89
    v_mfma_f32_16x16x32_bf16 v[16:19], a[24:27], v[224:227], v[16:19]
    s_waitcnt lgkmcnt(9)
    v_mul_f32 v69, v69, v89
    v_mul_f32 v70, v70, v89
    v_mfma_f32_16x16x32_bf16 v[16:19], a[28:31], v[240:243], v[16:19]
    v_mul_f32 v71, v71, v89
    v_cvt_pk_bf16_f32 v64, v64, v65
    v_mfma_f32_16x16x32_bf16 v[24:27], a[0:3], v[136:139], 0
    v_cvt_pk_bf16_f32 v65, v66, v67
    v_cvt_pk_bf16_f32 v66, v68, v69
    v_mfma_f32_16x16x32_bf16 v[24:27], a[4:7], v[152:155], v[24:27]
    ds_read_b64_tr_b16 a[50:51], v97 offset:52480
    v_cvt_pk_bf16_f32 v67, v70, v71
    v_mfma_f32_16x16x32_bf16 v[24:27], a[8:11], v[168:171], v[24:27]
    ds_read_b64_tr_b16 a[52:53], v97 offset:54528
    ds_read_b64_tr_b16 a[54:55], v97 offset:56576
    v_mfma_f32_16x16x32_bf16 v[24:27], a[12:15], v[184:187], v[24:27]
    buffer_store_dwordx4 v[64:67], v10, s[20:23], s51 offen offset:384 sc1
    v_mfma_f32_16x16x32_bf16 v[24:27], a[16:19], v[200:203], v[24:27]
    ds_read_b64_tr_b16 a[56:57], v97 offset:58624
    ds_read_b64_tr_b16 a[58:59], v97 offset:60672
    v_mfma_f32_16x16x32_bf16 v[24:27], a[20:23], v[216:219], v[24:27]
    ds_read_b64_tr_b16 a[60:61], v97 offset:62720
    ds_read_b64_tr_b16 a[62:63], v97 offset:64768
    v_mfma_f32_16x16x32_bf16 v[24:27], a[24:27], v[232:235], v[24:27]
    ds_read_b64_tr_b16 a[64:65], v98 offset:34048
    ds_read_b64_tr_b16 a[66:67], v98 offset:36096
    v_mfma_f32_16x16x32_bf16 v[24:27], a[28:31], v[248:251], v[24:27]
    s_waitcnt lgkmcnt(9)
    v_mul_f32 v76, v76, v91
    v_mul_f32 v77, v77, v91
    v_mfma_f32_16x16x32_bf16 v[20:23], a[32:35], v[128:131], 0
    v_mul_f32 v78, v78, v91
    v_mul_f32 v79, v79, v91
    v_mfma_f32_16x16x32_bf16 v[20:23], a[36:39], v[144:147], v[20:23]
    v_cvt_pk_bf16_f32 v72, v72, v73
    v_cvt_pk_bf16_f32 v73, v74, v75
    v_mfma_f32_16x16x32_bf16 v[20:23], a[40:43], v[160:163], v[20:23]
    v_cvt_pk_bf16_f32 v74, v76, v77
    v_cvt_pk_bf16_f32 v75, v78, v79
    v_mfma_f32_16x16x32_bf16 v[20:23], a[44:47], v[176:179], v[20:23]
    s_waitcnt lgkmcnt(8)
    ds_read_b64_tr_b16 a[68:69], v98 offset:38144
    ds_read_b64_tr_b16 a[70:71], v98 offset:40192
    v_mfma_f32_16x16x32_bf16 v[20:23], a[48:51], v[192:195], v[20:23]
    s_waitcnt lgkmcnt(8)
    ds_read_b64_tr_b16 a[72:73], v98 offset:42240
    ds_read_b64_tr_b16 a[74:75], v98 offset:44288
    v_mfma_f32_16x16x32_bf16 v[20:23], a[52:55], v[208:211], v[20:23]
    s_waitcnt lgkmcnt(8)
    buffer_store_dwordx4 v[72:75], v10, s[20:23], s55 offen offset:384 sc1
    v_mfma_f32_16x16x32_bf16 v[20:23], a[56:59], v[224:227], v[20:23]
    s_waitcnt lgkmcnt(6)
    ds_read_b64_tr_b16 a[76:77], v98 offset:46336
    ds_read_b64_tr_b16 a[78:79], v98 offset:48384
    v_mfma_f32_16x16x32_bf16 v[20:23], a[60:63], v[240:243], v[20:23]
    ds_read_b64_tr_b16 a[80:81], v98 offset:50432
    ds_read_b64_tr_b16 a[82:83], v98 offset:52480
    v_mfma_f32_16x16x32_bf16 v[28:31], a[32:35], v[136:139], 0
    ds_read_b64_tr_b16 a[84:85], v98 offset:54528
    v_mul_f32 v16, v16, v89
    v_mfma_f32_16x16x32_bf16 v[28:31], a[36:39], v[152:155], v[28:31]
    v_mul_f32 v17, v17, v89
    v_mul_f32 v18, v18, v89
    v_mfma_f32_16x16x32_bf16 v[28:31], a[40:43], v[168:171], v[28:31]
    ds_read_b64_tr_b16 a[86:87], v98 offset:56576
    v_mul_f32 v19, v19, v89
    v_mfma_f32_16x16x32_bf16 v[28:31], a[44:47], v[184:187], v[28:31]
    ds_read_b64_tr_b16 a[88:89], v98 offset:58624
    ds_read_b64_tr_b16 a[90:91], v98 offset:60672
    v_mfma_f32_16x16x32_bf16 v[28:31], a[48:51], v[200:203], v[28:31]
    ds_read_b64_tr_b16 a[92:93], v98 offset:62720
    ds_read_b64_tr_b16 a[94:95], v98 offset:64768
    v_mfma_f32_16x16x32_bf16 v[28:31], a[52:55], v[216:219], v[28:31]
    ds_read_b64_tr_b16 a[96:97], v99 offset:34048
    ds_read_b64_tr_b16 a[98:99], v99 offset:36096
    v_mfma_f32_16x16x32_bf16 v[28:31], a[56:59], v[232:235], v[28:31]
    ds_read_b64_tr_b16 a[100:101], v99 offset:38144
    ds_read_b64_tr_b16 a[102:103], v99 offset:40192
    v_mfma_f32_16x16x32_bf16 v[28:31], a[60:63], v[248:251], v[28:31]
    s_waitcnt lgkmcnt(14)
    v_mul_f32 v24, v24, v91
    v_mul_f32 v25, v25, v91
    v_mfma_f32_16x16x32_bf16 v[32:35], a[64:67], v[128:131], 0
    v_mul_f32 v26, v26, v91
    v_mul_f32 v27, v27, v91
    v_mfma_f32_16x16x32_bf16 v[32:35], a[68:71], v[144:147], v[32:35]
    ds_read_b64_tr_b16 a[104:105], v99 offset:42240
    ds_read_b64_tr_b16 a[106:107], v99 offset:44288
    ds_read_b64_tr_b16 a[108:109], v99 offset:46336
    ds_read_b64_tr_b16 a[110:111], v99 offset:48384
    ds_read_b64_tr_b16 a[112:113], v99 offset:50432
    ds_read_b64_tr_b16 a[114:115], v99 offset:52480
    ds_read_b64_tr_b16 a[116:117], v99 offset:54528
    ds_read_b64_tr_b16 a[118:119], v99 offset:56576
    ds_read_b64_tr_b16 a[120:121], v99 offset:58624
    ds_read_b64_tr_b16 a[122:123], v99 offset:60672
    ds_read_b64_tr_b16 a[124:125], v99 offset:62720
    ds_read_b64_tr_b16 a[126:127], v99 offset:64768
    v_mfma_f32_16x16x32_bf16 v[32:35], a[72:75], v[160:163], v[32:35]
    s_waitcnt lgkmcnt(15)
    v_mul_f32 v20, v20, v89
    v_mul_f32 v21, v21, v89
    v_mfma_f32_16x16x32_bf16 v[32:35], a[76:79], v[176:179], v[32:35]
    v_mul_f32 v22, v22, v89
    v_mul_f32 v23, v23, v89
    v_mfma_f32_16x16x32_bf16 v[32:35], a[80:83], v[192:195], v[32:35]
    v_cvt_pk_bf16_f32 v16, v16, v17
    v_cvt_pk_bf16_f32 v17, v18, v19
    v_mfma_f32_16x16x32_bf16 v[32:35], a[84:87], v[208:211], v[32:35]
    v_cvt_pk_bf16_f32 v18, v20, v21
    v_cvt_pk_bf16_f32 v19, v22, v23
    v_mfma_f32_16x16x32_bf16 v[32:35], a[88:91], v[224:227], v[32:35]
    s_add_u32 m0, s42, 0
    buffer_store_dwordx4 v[16:19], v10, s[20:23], s51 offen offset:512 sc1
    v_mfma_f32_16x16x32_bf16 v[32:35], a[92:95], v[240:243], v[32:35]
    s_mov_b32 s43, 640
    v_mul_f32 v28, v28, v91
    v_mul_f32 v29, v29, v91
    v_mfma_f32_16x16x32_bf16 v[40:43], a[64:67], v[136:139], 0
    s_waitcnt vmcnt(5) lgkmcnt(0)
    v_mul_f32 v30, v30, v91
    v_mul_f32 v31, v31, v91
    v_mfma_f32_16x16x32_bf16 v[40:43], a[68:71], v[152:155], v[40:43]
    s_barrier
    v_cvt_pk_bf16_f32 v24, v24, v25
    v_cvt_pk_bf16_f32 v25, v26, v27
    v_mfma_f32_16x16x32_bf16 v[40:43], a[72:75], v[168:171], v[40:43]
    s_mov_b32 s44, 6784
    v_cvt_pk_bf16_f32 v26, v28, v29
    v_cvt_pk_bf16_f32 v27, v30, v31
    v_mfma_f32_16x16x32_bf16 v[40:43], a[76:79], v[184:187], v[40:43]
    s_mov_b32 s45, 12928
    buffer_store_dwordx4 v[24:27], v10, s[20:23], s55 offen offset:512 sc1
    v_mfma_f32_16x16x32_bf16 v[40:43], a[80:83], v[200:203], v[40:43]
    ds_read_b64_tr_b16 a[0:1], v100 offset:0
    ds_read_b64_tr_b16 a[2:3], v100 offset:2048
    v_mfma_f32_16x16x32_bf16 v[40:43], a[84:87], v[216:219], v[40:43]
    buffer_load_dwordx4 v14, s[16:19], s43 offen offset:0 lds
    v_mfma_f32_16x16x32_bf16 v[40:43], a[88:91], v[232:235], v[40:43]
    s_mov_b32 s43, 19072
    ds_read_b64_tr_b16 a[4:5], v100 offset:4096
    ds_read_b64_tr_b16 a[6:7], v100 offset:6144
    v_mfma_f32_16x16x32_bf16 v[40:43], a[92:95], v[248:251], v[40:43]
    v_mul_f32 v32, v32, v89
    v_mul_f32 v33, v33, v89
    v_mfma_f32_16x16x32_bf16 v[36:39], a[96:99], v[128:131], 0
    v_mul_f32 v34, v34, v89
    v_mul_f32 v35, v35, v89
    v_mfma_f32_16x16x32_bf16 v[36:39], a[100:103], v[144:147], v[36:39]
    ds_read_b64_tr_b16 a[8:9], v100 offset:8192
    ds_read_b64_tr_b16 a[10:11], v100 offset:10240
    v_mfma_f32_16x16x32_bf16 v[36:39], a[104:107], v[160:163], v[36:39]
    buffer_load_dwordx4 v14, s[16:19], s44 offen offset:1024 lds
    v_mfma_f32_16x16x32_bf16 v[36:39], a[108:111], v[176:179], v[36:39]
    s_mov_b32 s44, 29312
    ds_read_b64_tr_b16 a[12:13], v100 offset:12288
    ds_read_b64_tr_b16 a[14:15], v100 offset:14336
    v_mfma_f32_16x16x32_bf16 v[36:39], a[112:115], v[192:195], v[36:39]
    buffer_load_dwordx4 v14, s[16:19], s45 offen offset:2048 lds
    v_mfma_f32_16x16x32_bf16 v[36:39], a[116:119], v[208:211], v[36:39]
    s_mov_b32 s45, 35456
    ds_read_b64_tr_b16 a[16:17], v100 offset:16384
    ds_read_b64_tr_b16 a[18:19], v100 offset:18432
    v_mfma_f32_16x16x32_bf16 v[36:39], a[120:123], v[224:227], v[36:39]
    ds_read_b64_tr_b16 a[20:21], v100 offset:20480
    ds_read_b64_tr_b16 a[22:23], v100 offset:22528
    v_mfma_f32_16x16x32_bf16 v[36:39], a[124:127], v[240:243], v[36:39]
    buffer_load_dwordx4 v14, s[16:19], s43 offen offset:3072 lds
    v_mfma_f32_16x16x32_bf16 v[44:47], a[96:99], v[136:139], 0
    s_add_u32 m0, s42, 4096
    v_mul_f32 v40, v40, v91
    v_mul_f32 v41, v41, v91
    v_mfma_f32_16x16x32_bf16 v[44:47], a[100:103], v[152:155], v[44:47]
    s_mov_b32 s43, 41600
    v_mul_f32 v42, v42, v91
    v_mul_f32 v43, v43, v91
    v_mfma_f32_16x16x32_bf16 v[44:47], a[104:107], v[168:171], v[44:47]
    ds_read_b64_tr_b16 a[24:25], v100 offset:24576
    ds_read_b64_tr_b16 a[26:27], v100 offset:26624
    v_mfma_f32_16x16x32_bf16 v[44:47], a[108:111], v[184:187], v[44:47]
    buffer_load_dwordx4 v14, s[16:19], s44 offen offset:0 lds
    v_mfma_f32_16x16x32_bf16 v[44:47], a[112:115], v[200:203], v[44:47]
    s_mov_b32 s44, 47744
    ds_read_b64_tr_b16 a[28:29], v100 offset:28672
    ds_read_b64_tr_b16 a[30:31], v100 offset:30720
    v_mfma_f32_16x16x32_bf16 v[44:47], a[116:119], v[216:219], v[44:47]
    ds_read_b64_tr_b16 a[32:33], v101 offset:0
    ds_read_b64_tr_b16 a[34:35], v101 offset:2048
    v_mfma_f32_16x16x32_bf16 v[44:47], a[120:123], v[232:235], v[44:47]
    s_waitcnt lgkmcnt(10)
    buffer_load_dwordx4 v14, s[16:19], s45 offen offset:1024 lds
    v_mfma_f32_16x16x32_bf16 v[44:47], a[124:127], v[248:251], v[44:47]
    s_mov_b32 s45, 768
    ds_read_b64_tr_b16 a[36:37], v101 offset:4096
    ds_read_b64_tr_b16 a[38:39], v101 offset:6144
    v_mfma_f32_16x16x32_bf16 v[48:51], a[0:3], v[128:131], 0
    ds_read_b64_tr_b16 a[40:41], v101 offset:8192
    v_mul_f32 v36, v36, v89
    v_mfma_f32_16x16x32_bf16 v[48:51], a[4:7], v[144:147], v[48:51]
    v_mul_f32 v37, v37, v89
    v_mul_f32 v38, v38, v89
    v_mfma_f32_16x16x32_bf16 v[48:51], a[8:11], v[160:163], v[48:51]
    v_mul_f32 v39, v39, v89
    v_cvt_pk_bf16_f32 v32, v32, v33
    v_mfma_f32_16x16x32_bf16 v[48:51], a[12:15], v[176:179], v[48:51]
    s_waitcnt lgkmcnt(9)
    v_cvt_pk_bf16_f32 v33, v34, v35
    v_cvt_pk_bf16_f32 v34, v36, v37
    v_mfma_f32_16x16x32_bf16 v[48:51], a[16:19], v[192:195], v[48:51]
    s_waitcnt lgkmcnt(5)
    ds_read_b64_tr_b16 a[42:43], v101 offset:10240
    v_cvt_pk_bf16_f32 v35, v38, v39
    v_mfma_f32_16x16x32_bf16 v[48:51], a[20:23], v[208:211], v[48:51]
    s_waitcnt lgkmcnt(8)
    buffer_load_dwordx4 v14, s[16:19], s43 offen offset:2048 lds
    v_mfma_f32_16x16x32_bf16 v[48:51], a[24:27], v[224:227], v[48:51]
    s_mov_b32 s43, 6912
    ds_read_b64_tr_b16 a[44:45], v101 offset:12288
    ds_read_b64_tr_b16 a[46:47], v101 offset:14336
    v_mfma_f32_16x16x32_bf16 v[48:51], a[28:31], v[240:243], v[48:51]
    buffer_store_dwordx4 v[32:35], v10, s[20:23], s51 offen offset:640 sc1
    v_mfma_f32_16x16x32_bf16 v[56:59], a[0:3], v[136:139], 0
    buffer_load_dwordx4 v14, s[16:19], s44 offen offset:3072 lds
    v_mfma_f32_16x16x32_bf16 v[56:59], a[4:7], v[152:155], v[56:59]
    s_add_u32 m0, s42, 34048
    ds_read_b64_tr_b16 a[48:49], v101 offset:16384
    ds_read_b64_tr_b16 a[50:51], v101 offset:18432
    v_mfma_f32_16x16x32_bf16 v[56:59], a[8:11], v[168:171], v[56:59]
    s_mov_b32 s44, 13056
    ds_read_b64_tr_b16 a[52:53], v101 offset:20480
    ds_read_b64_tr_b16 a[54:55], v101 offset:22528
    v_mfma_f32_16x16x32_bf16 v[56:59], a[12:15], v[184:187], v[56:59]
    buffer_load_dwordx4 v14, s[16:19], s45 offen offset:0 lds
    v_mfma_f32_16x16x32_bf16 v[56:59], a[16:19], v[200:203], v[56:59]
    s_mov_b32 s45, 19200
    ds_read_b64_tr_b16 a[56:57], v101 offset:24576
    v_mul_f32 v44, v44, v91
    v_mfma_f32_16x16x32_bf16 v[56:59], a[20:23], v[216:219], v[56:59]
    v_mul_f32 v45, v45, v91
    v_mul_f32 v46, v46, v91
    v_mfma_f32_16x16x32_bf16 v[56:59], a[24:27], v[232:235], v[56:59]
    ds_read_b64_tr_b16 a[58:59], v101 offset:26624
    v_mul_f32 v47, v47, v91
    v_cvt_pk_bf16_f32 v40, v40, v41
    v_mfma_f32_16x16x32_bf16 v[56:59], a[28:31], v[248:251], v[56:59]
    s_waitcnt lgkmcnt(8)
    ds_read_b64_tr_b16 a[60:61], v101 offset:28672
    ds_read_b64_tr_b16 a[62:63], v101 offset:30720
    v_cvt_pk_bf16_f32 v41, v42, v43
    v_cvt_pk_bf16_f32 v42, v44, v45
    v_mfma_f32_16x16x32_bf16 v[52:55], a[32:35], v[128:131], 0
    s_waitcnt lgkmcnt(2)
    ds_read_b64_tr_b16 a[64:65], v102 offset:0
    v_cvt_pk_bf16_f32 v43, v46, v47
    v_mfma_f32_16x16x32_bf16 v[52:55], a[36:39], v[144:147], v[52:55]
    s_waitcnt lgkmcnt(9)
    buffer_load_dwordx4 v14, s[16:19], s43 offen offset:1024 lds
    v_mfma_f32_16x16x32_bf16 v[52:55], a[40:43], v[160:163], v[52:55]
    s_mov_b32 s43, 29440
    buffer_store_dwordx4 v[40:43], v10, s[20:23], s55 offen offset:640 sc1
    v_mfma_f32_16x16x32_bf16 v[52:55], a[44:47], v[176:179], v[52:55]
    s_waitcnt lgkmcnt(7)
    ds_read_b64_tr_b16 a[66:67], v102 offset:2048
    ds_read_b64_tr_b16 a[68:69], v102 offset:4096
    v_mfma_f32_16x16x32_bf16 v[52:55], a[48:51], v[192:195], v[52:55]
    s_waitcnt lgkmcnt(7)
    buffer_load_dwordx4 v14, s[16:19], s44 offen offset:2048 lds
    v_mfma_f32_16x16x32_bf16 v[52:55], a[52:55], v[208:211], v[52:55]
    s_mov_b32 s44, 35584
    ds_read_b64_tr_b16 a[70:71], v102 offset:6144
    ds_read_b64_tr_b16 a[72:73], v102 offset:8192
    v_mfma_f32_16x16x32_bf16 v[52:55], a[56:59], v[224:227], v[52:55]
    s_waitcnt lgkmcnt(5)
    buffer_load_dwordx4 v14, s[16:19], s45 offen offset:3072 lds
    v_mfma_f32_16x16x32_bf16 v[52:55], a[60:63], v[240:243], v[52:55]
    s_add_u32 m0, s42, 38144
    ds_read_b64_tr_b16 a[74:75], v102 offset:10240
    ds_read_b64_tr_b16 a[76:77], v102 offset:12288
    v_mfma_f32_16x16x32_bf16 v[60:63], a[32:35], v[136:139], 0
    s_mov_b32 s45, 41728
    v_mul_f32 v48, v48, v89
    v_mul_f32 v49, v49, v89
    v_mfma_f32_16x16x32_bf16 v[60:63], a[36:39], v[152:155], v[60:63]
    v_mul_f32 v50, v50, v89
    v_mul_f32 v51, v51, v89
    v_mfma_f32_16x16x32_bf16 v[60:63], a[40:43], v[168:171], v[60:63]
    ds_read_b64_tr_b16 a[78:79], v102 offset:14336
    ds_read_b64_tr_b16 a[80:81], v102 offset:16384
    v_mfma_f32_16x16x32_bf16 v[60:63], a[44:47], v[184:187], v[60:63]
    buffer_load_dwordx4 v14, s[16:19], s43 offen offset:0 lds
    v_mfma_f32_16x16x32_bf16 v[60:63], a[48:51], v[200:203], v[60:63]
    s_mov_b32 s43, 47872
    ds_read_b64_tr_b16 a[82:83], v102 offset:18432
    ds_read_b64_tr_b16 a[84:85], v102 offset:20480
    v_mfma_f32_16x16x32_bf16 v[60:63], a[52:55], v[216:219], v[60:63]
    buffer_load_dwordx4 v14, s[16:19], s44 offen offset:1024 lds
    ds_read_b64_tr_b16 a[86:87], v102 offset:22528
    v_mfma_f32_16x16x32_bf16 v[60:63], a[56:59], v[232:235], v[60:63]
    ds_read_b64_tr_b16 a[88:89], v102 offset:24576
    ds_read_b64_tr_b16 a[90:91], v102 offset:26624
    v_mfma_f32_16x16x32_bf16 v[60:63], a[60:63], v[248:251], v[60:63]
    s_waitcnt lgkmcnt(9)
    buffer_load_dwordx4 v14, s[16:19], s45 offen offset:2048 lds
    ds_read_b64_tr_b16 a[92:93], v102 offset:28672
    ds_read_b64_tr_b16 a[94:95], v102 offset:30720
    v_mfma_f32_16x16x32_bf16 v[64:67], a[64:67], v[128:131], 0
    v_mul_f32 v56, v56, v91
    v_mul_f32 v57, v57, v91
    v_mfma_f32_16x16x32_bf16 v[64:67], a[68:71], v[144:147], v[64:67]
    s_waitcnt lgkmcnt(9)
    v_mul_f32 v58, v58, v91
    v_mul_f32 v59, v59, v91
    v_mfma_f32_16x16x32_bf16 v[64:67], a[72:75], v[160:163], v[64:67]
    s_waitcnt lgkmcnt(8)
    ds_read_b64_tr_b16 a[96:97], v103 offset:0
    ds_read_b64_tr_b16 a[98:99], v103 offset:2048
    v_mfma_f32_16x16x32_bf16 v[64:67], a[76:79], v[176:179], v[64:67]
    s_waitcnt lgkmcnt(8)
    buffer_load_dwordx4 v14, s[16:19], s43 offen offset:3072 lds
    v_mfma_f32_16x16x32_bf16 v[64:67], a[80:83], v[192:195], v[64:67]
    s_waitcnt lgkmcnt(6)
    ds_read_b64_tr_b16 a[100:101], v103 offset:4096
    ds_read_b64_tr_b16 a[102:103], v103 offset:6144
    v_mfma_f32_16x16x32_bf16 v[64:67], a[84:87], v[208:211], v[64:67]
    s_waitcnt lgkmcnt(6)
    ds_read_b64_tr_b16 a[104:105], v103 offset:8192
    ds_read_b64_tr_b16 a[106:107], v103 offset:10240
    v_mfma_f32_16x16x32_bf16 v[64:67], a[88:91], v[224:227], v[64:67]
    s_waitcnt lgkmcnt(6)
    ds_read_b64_tr_b16 a[108:109], v103 offset:12288
    ds_read_b64_tr_b16 a[110:111], v103 offset:14336
    v_mfma_f32_16x16x32_bf16 v[64:67], a[92:95], v[240:243], v[64:67]
    v_mul_f32 v52, v52, v89
    v_mul_f32 v53, v53, v89
    v_mfma_f32_16x16x32_bf16 v[72:75], a[64:67], v[136:139], 0
    v_mul_f32 v54, v54, v89
    v_mul_f32 v55, v55, v89
    v_mfma_f32_16x16x32_bf16 v[72:75], a[68:71], v[152:155], v[72:75]
    v_cvt_pk_bf16_f32 v48, v48, v49
    v_cvt_pk_bf16_f32 v49, v50, v51
    v_mfma_f32_16x16x32_bf16 v[72:75], a[72:75], v[168:171], v[72:75]
    v_cvt_pk_bf16_f32 v50, v52, v53
    v_cvt_pk_bf16_f32 v51, v54, v55
    v_mfma_f32_16x16x32_bf16 v[72:75], a[76:79], v[184:187], v[72:75]
    ds_read_b64_tr_b16 a[112:113], v103 offset:16384
    ds_read_b64_tr_b16 a[114:115], v103 offset:18432
    v_mfma_f32_16x16x32_bf16 v[72:75], a[80:83], v[200:203], v[72:75]
    ds_read_b64_tr_b16 a[116:117], v103 offset:20480
    ds_read_b64_tr_b16 a[118:119], v103 offset:22528
    v_mfma_f32_16x16x32_bf16 v[72:75], a[84:87], v[216:219], v[72:75]
    buffer_store_dwordx4 v[48:51], v10, s[20:23], s51 offen offset:768 sc1
    v_mfma_f32_16x16x32_bf16 v[72:75], a[88:91], v[232:235], v[72:75]
    ds_read_b64_tr_b16 a[120:121], v103 offset:24576
    ds_read_b64_tr_b16 a[122:123], v103 offset:26624
    v_mfma_f32_16x16x32_bf16 v[72:75], a[92:95], v[248:251], v[72:75]
    s_waitcnt lgkmcnt(8)
    ds_read_b64_tr_b16 a[124:125], v103 offset:28672
    ds_read_b64_tr_b16 a[126:127], v103 offset:30720
    v_mfma_f32_16x16x32_bf16 v[68:71], a[96:99], v[128:131], 0
    v_mul_f32 v60, v60, v91
    v_mul_f32 v61, v61, v91
    v_mfma_f32_16x16x32_bf16 v[68:71], a[100:103], v[144:147], v[68:71]
    v_mul_f32 v62, v62, v91
    v_mul_f32 v63, v63, v91
    v_mfma_f32_16x16x32_bf16 v[68:71], a[104:107], v[160:163], v[68:71]
    s_waitcnt lgkmcnt(8)
    v_cvt_pk_bf16_f32 v56, v56, v57
    v_cvt_pk_bf16_f32 v57, v58, v59
    v_mfma_f32_16x16x32_bf16 v[68:71], a[108:111], v[176:179], v[68:71]
    s_waitcnt lgkmcnt(6)
    v_cvt_pk_bf16_f32 v58, v60, v61
    v_cvt_pk_bf16_f32 v59, v62, v63
    v_mfma_f32_16x16x32_bf16 v[68:71], a[112:115], v[192:195], v[68:71]
    s_waitcnt lgkmcnt(4)
    ds_read_b64_tr_b16 a[0:1], v100 offset:34048
    ds_read_b64_tr_b16 a[2:3], v100 offset:36096
    v_mfma_f32_16x16x32_bf16 v[68:71], a[116:119], v[208:211], v[68:71]
    s_waitcnt lgkmcnt(4)
    ds_read_b64_tr_b16 a[4:5], v100 offset:38144
    ds_read_b64_tr_b16 a[6:7], v100 offset:40192
    v_mfma_f32_16x16x32_bf16 v[68:71], a[120:123], v[224:227], v[68:71]
    s_waitcnt lgkmcnt(4)
    buffer_store_dwordx4 v[56:59], v10, s[20:23], s55 offen offset:768 sc1
    v_mfma_f32_16x16x32_bf16 v[68:71], a[124:127], v[240:243], v[68:71]
    ds_read_b64_tr_b16 a[8:9], v100 offset:42240
    ds_read_b64_tr_b16 a[10:11], v100 offset:44288
    v_mfma_f32_16x16x32_bf16 v[76:79], a[96:99], v[136:139], 0
    ds_read_b64_tr_b16 a[12:13], v100 offset:46336
    ds_read_b64_tr_b16 a[14:15], v100 offset:48384
    v_mfma_f32_16x16x32_bf16 v[76:79], a[100:103], v[152:155], v[76:79]
    v_mul_f32 v64, v64, v89
    v_mul_f32 v65, v65, v89
    v_mfma_f32_16x16x32_bf16 v[76:79], a[104:107], v[168:171], v[76:79]
    v_mul_f32 v66, v66, v89
    v_mul_f32 v67, v67, v89
    v_mfma_f32_16x16x32_bf16 v[76:79], a[108:111], v[184:187], v[76:79]
    ds_read_b64_tr_b16 a[16:17], v100 offset:50432
    ds_read_b64_tr_b16 a[18:19], v100 offset:52480
    v_mfma_f32_16x16x32_bf16 v[76:79], a[112:115], v[200:203], v[76:79]
    ds_read_b64_tr_b16 a[20:21], v100 offset:54528
    ds_read_b64_tr_b16 a[22:23], v100 offset:56576
    v_mfma_f32_16x16x32_bf16 v[76:79], a[116:119], v[216:219], v[76:79]
    ds_read_b64_tr_b16 a[24:25], v100 offset:58624
    ds_read_b64_tr_b16 a[26:27], v100 offset:60672
    v_mfma_f32_16x16x32_bf16 v[76:79], a[120:123], v[232:235], v[76:79]
    ds_read_b64_tr_b16 a[28:29], v100 offset:62720
    ds_read_b64_tr_b16 a[30:31], v100 offset:64768
    v_mfma_f32_16x16x32_bf16 v[76:79], a[124:127], v[248:251], v[76:79]
    s_waitcnt lgkmcnt(12)
    v_mul_f32 v72, v72, v91
    v_mul_f32 v73, v73, v91
    v_mfma_f32_16x16x32_bf16 v[16:19], a[0:3], v[128:131], 0
    v_mul_f32 v74, v74, v91
    v_mul_f32 v75, v75, v91
    v_mfma_f32_16x16x32_bf16 v[16:19], a[4:7], v[144:147], v[16:19]
    s_waitcnt lgkmcnt(10)
    ds_read_b64_tr_b16 a[32:33], v101 offset:34048
    ds_read_b64_tr_b16 a[34:35], v101 offset:36096
    v_mfma_f32_16x16x32_bf16 v[16:19], a[8:11], v[160:163], v[16:19]
    s_waitcnt lgkmcnt(10)
    ds_read_b64_tr_b16 a[36:37], v101 offset:38144
    ds_read_b64_tr_b16 a[38:39], v101 offset:40192
    v_mfma_f32_16x16x32_bf16 v[16:19], a[12:15], v[176:179], v[16:19]
    s_waitcnt lgkmcnt(10)
    ds_read_b64_tr_b16 a[40:41], v101 offset:42240
    ds_read_b64_tr_b16 a[42:43], v101 offset:44288
    v_mfma_f32_16x16x32_bf16 v[16:19], a[16:19], v[192:195], v[16:19]
    s_waitcnt lgkmcnt(10)
    ds_read_b64_tr_b16 a[44:45], v101 offset:46336
    ds_read_b64_tr_b16 a[46:47], v101 offset:48384
    v_mfma_f32_16x16x32_bf16 v[16:19], a[20:23], v[208:211], v[16:19]
    s_waitcnt lgkmcnt(10)
    ds_read_b64_tr_b16 a[48:49], v101 offset:50432
    v_mul_f32 v68, v68, v89
    v_mfma_f32_16x16x32_bf16 v[16:19], a[24:27], v[224:227], v[16:19]
    s_waitcnt lgkmcnt(9)
    v_mul_f32 v69, v69, v89
    v_mul_f32 v70, v70, v89
    v_mfma_f32_16x16x32_bf16 v[16:19], a[28:31], v[240:243], v[16:19]
    v_mul_f32 v71, v71, v89
    v_cvt_pk_bf16_f32 v64, v64, v65
    v_mfma_f32_16x16x32_bf16 v[24:27], a[0:3], v[136:139], 0
    v_cvt_pk_bf16_f32 v65, v66, v67
    v_cvt_pk_bf16_f32 v66, v68, v69
    v_mfma_f32_16x16x32_bf16 v[24:27], a[4:7], v[152:155], v[24:27]
    ds_read_b64_tr_b16 a[50:51], v101 offset:52480
    v_cvt_pk_bf16_f32 v67, v70, v71
    v_mfma_f32_16x16x32_bf16 v[24:27], a[8:11], v[168:171], v[24:27]
    ds_read_b64_tr_b16 a[52:53], v101 offset:54528
    ds_read_b64_tr_b16 a[54:55], v101 offset:56576
    v_mfma_f32_16x16x32_bf16 v[24:27], a[12:15], v[184:187], v[24:27]
    buffer_store_dwordx4 v[64:67], v10, s[20:23], s51 offen offset:896 sc1
    v_mfma_f32_16x16x32_bf16 v[24:27], a[16:19], v[200:203], v[24:27]
    ds_read_b64_tr_b16 a[56:57], v101 offset:58624
    ds_read_b64_tr_b16 a[58:59], v101 offset:60672
    v_mfma_f32_16x16x32_bf16 v[24:27], a[20:23], v[216:219], v[24:27]
    ds_read_b64_tr_b16 a[60:61], v101 offset:62720
    ds_read_b64_tr_b16 a[62:63], v101 offset:64768
    v_mfma_f32_16x16x32_bf16 v[24:27], a[24:27], v[232:235], v[24:27]
    ds_read_b64_tr_b16 a[64:65], v102 offset:34048
    ds_read_b64_tr_b16 a[66:67], v102 offset:36096
    v_mfma_f32_16x16x32_bf16 v[24:27], a[28:31], v[248:251], v[24:27]
    s_waitcnt lgkmcnt(9)
    v_mul_f32 v76, v76, v91
    v_mul_f32 v77, v77, v91
    v_mfma_f32_16x16x32_bf16 v[20:23], a[32:35], v[128:131], 0
    v_mul_f32 v78, v78, v91
    v_mul_f32 v79, v79, v91
    v_mfma_f32_16x16x32_bf16 v[20:23], a[36:39], v[144:147], v[20:23]
    v_cvt_pk_bf16_f32 v72, v72, v73
    v_cvt_pk_bf16_f32 v73, v74, v75
    v_mfma_f32_16x16x32_bf16 v[20:23], a[40:43], v[160:163], v[20:23]
    v_cvt_pk_bf16_f32 v74, v76, v77
    v_cvt_pk_bf16_f32 v75, v78, v79
    v_mfma_f32_16x16x32_bf16 v[20:23], a[44:47], v[176:179], v[20:23]
    s_waitcnt lgkmcnt(8)
    ds_read_b64_tr_b16 a[68:69], v102 offset:38144
    ds_read_b64_tr_b16 a[70:71], v102 offset:40192
    v_mfma_f32_16x16x32_bf16 v[20:23], a[48:51], v[192:195], v[20:23]
    s_waitcnt lgkmcnt(8)
    ds_read_b64_tr_b16 a[72:73], v102 offset:42240
    ds_read_b64_tr_b16 a[74:75], v102 offset:44288
    v_mfma_f32_16x16x32_bf16 v[20:23], a[52:55], v[208:211], v[20:23]
    s_waitcnt lgkmcnt(8)
    buffer_store_dwordx4 v[72:75], v10, s[20:23], s55 offen offset:896 sc1
    v_mfma_f32_16x16x32_bf16 v[20:23], a[56:59], v[224:227], v[20:23]
    s_waitcnt lgkmcnt(6)
    ds_read_b64_tr_b16 a[76:77], v102 offset:46336
    ds_read_b64_tr_b16 a[78:79], v102 offset:48384
    v_mfma_f32_16x16x32_bf16 v[20:23], a[60:63], v[240:243], v[20:23]
    ds_read_b64_tr_b16 a[80:81], v102 offset:50432
    ds_read_b64_tr_b16 a[82:83], v102 offset:52480
    v_mfma_f32_16x16x32_bf16 v[28:31], a[32:35], v[136:139], 0
    ds_read_b64_tr_b16 a[84:85], v102 offset:54528
    v_mul_f32 v16, v16, v89
    v_mfma_f32_16x16x32_bf16 v[28:31], a[36:39], v[152:155], v[28:31]
    v_mul_f32 v17, v17, v89
    v_mul_f32 v18, v18, v89
    v_mfma_f32_16x16x32_bf16 v[28:31], a[40:43], v[168:171], v[28:31]
    ds_read_b64_tr_b16 a[86:87], v102 offset:56576
    v_mul_f32 v19, v19, v89
    v_mfma_f32_16x16x32_bf16 v[28:31], a[44:47], v[184:187], v[28:31]
    ds_read_b64_tr_b16 a[88:89], v102 offset:58624
    ds_read_b64_tr_b16 a[90:91], v102 offset:60672
    v_mfma_f32_16x16x32_bf16 v[28:31], a[48:51], v[200:203], v[28:31]
    ds_read_b64_tr_b16 a[92:93], v102 offset:62720
    ds_read_b64_tr_b16 a[94:95], v102 offset:64768
    v_mfma_f32_16x16x32_bf16 v[28:31], a[52:55], v[216:219], v[28:31]
    ds_read_b64_tr_b16 a[96:97], v103 offset:34048
    ds_read_b64_tr_b16 a[98:99], v103 offset:36096
    v_mfma_f32_16x16x32_bf16 v[28:31], a[56:59], v[232:235], v[28:31]
    ds_read_b64_tr_b16 a[100:101], v103 offset:38144
    ds_read_b64_tr_b16 a[102:103], v103 offset:40192
    v_mfma_f32_16x16x32_bf16 v[28:31], a[60:63], v[248:251], v[28:31]
    s_waitcnt lgkmcnt(14)
    v_mul_f32 v24, v24, v91
    v_mul_f32 v25, v25, v91
    v_mfma_f32_16x16x32_bf16 v[32:35], a[64:67], v[128:131], 0
    v_mul_f32 v26, v26, v91
    v_mul_f32 v27, v27, v91
    v_mfma_f32_16x16x32_bf16 v[32:35], a[68:71], v[144:147], v[32:35]
    ds_read_b64_tr_b16 a[104:105], v103 offset:42240
    ds_read_b64_tr_b16 a[106:107], v103 offset:44288
    ds_read_b64_tr_b16 a[108:109], v103 offset:46336
    ds_read_b64_tr_b16 a[110:111], v103 offset:48384
    ds_read_b64_tr_b16 a[112:113], v103 offset:50432
    ds_read_b64_tr_b16 a[114:115], v103 offset:52480
    ds_read_b64_tr_b16 a[116:117], v103 offset:54528
    ds_read_b64_tr_b16 a[118:119], v103 offset:56576
    ds_read_b64_tr_b16 a[120:121], v103 offset:58624
    ds_read_b64_tr_b16 a[122:123], v103 offset:60672
    ds_read_b64_tr_b16 a[124:125], v103 offset:62720
    ds_read_b64_tr_b16 a[126:127], v103 offset:64768
    v_mfma_f32_16x16x32_bf16 v[32:35], a[72:75], v[160:163], v[32:35]
    s_waitcnt lgkmcnt(15)
    v_mul_f32 v20, v20, v89
    v_mul_f32 v21, v21, v89
    v_mfma_f32_16x16x32_bf16 v[32:35], a[76:79], v[176:179], v[32:35]
    v_mul_f32 v22, v22, v89
    v_mul_f32 v23, v23, v89
    v_mfma_f32_16x16x32_bf16 v[32:35], a[80:83], v[192:195], v[32:35]
    v_cvt_pk_bf16_f32 v16, v16, v17
    v_cvt_pk_bf16_f32 v17, v18, v19
    v_mfma_f32_16x16x32_bf16 v[32:35], a[84:87], v[208:211], v[32:35]
    v_cvt_pk_bf16_f32 v18, v20, v21
    v_cvt_pk_bf16_f32 v19, v22, v23
    v_mfma_f32_16x16x32_bf16 v[32:35], a[88:91], v[224:227], v[32:35]
    buffer_store_dwordx4 v[16:19], v10, s[20:23], s51 offen offset:1024 sc1
    v_mfma_f32_16x16x32_bf16 v[32:35], a[92:95], v[240:243], v[32:35]
    v_mul_f32 v28, v28, v91
    v_mul_f32 v29, v29, v91
    v_mfma_f32_16x16x32_bf16 v[40:43], a[64:67], v[136:139], 0
    s_waitcnt vmcnt(5) lgkmcnt(0)
    v_mul_f32 v30, v30, v91
    v_mul_f32 v31, v31, v91
    v_mfma_f32_16x16x32_bf16 v[40:43], a[68:71], v[152:155], v[40:43]
    s_barrier
    v_cvt_pk_bf16_f32 v24, v24, v25
    v_cvt_pk_bf16_f32 v25, v26, v27
    v_mfma_f32_16x16x32_bf16 v[40:43], a[72:75], v[168:171], v[40:43]
    v_cvt_pk_bf16_f32 v26, v28, v29
    v_cvt_pk_bf16_f32 v27, v30, v31
    v_mfma_f32_16x16x32_bf16 v[40:43], a[76:79], v[184:187], v[40:43]
    buffer_store_dwordx4 v[24:27], v10, s[20:23], s55 offen offset:1024 sc1
    v_mfma_f32_16x16x32_bf16 v[40:43], a[80:83], v[200:203], v[40:43]
    ds_read_b64_tr_b16 a[0:1], v96 offset:0
    ds_read_b64_tr_b16 a[2:3], v96 offset:2048
    v_mfma_f32_16x16x32_bf16 v[40:43], a[84:87], v[216:219], v[40:43]
    ds_read_b64_tr_b16 a[4:5], v96 offset:4096
    v_mul_f32 v32, v32, v89
    v_mfma_f32_16x16x32_bf16 v[40:43], a[88:91], v[232:235], v[40:43]
    v_mul_f32 v33, v33, v89
    v_mul_f32 v34, v34, v89
    v_mfma_f32_16x16x32_bf16 v[40:43], a[92:95], v[248:251], v[40:43]
    ds_read_b64_tr_b16 a[6:7], v96 offset:6144
    v_mul_f32 v35, v35, v89
    v_mfma_f32_16x16x32_bf16 v[36:39], a[96:99], v[128:131], 0
    ds_read_b64_tr_b16 a[8:9], v96 offset:8192
    ds_read_b64_tr_b16 a[10:11], v96 offset:10240
    v_mfma_f32_16x16x32_bf16 v[36:39], a[100:103], v[144:147], v[36:39]
    ds_read_b64_tr_b16 a[12:13], v96 offset:12288
    ds_read_b64_tr_b16 a[14:15], v96 offset:14336
    v_mfma_f32_16x16x32_bf16 v[36:39], a[104:107], v[160:163], v[36:39]
    ds_read_b64_tr_b16 a[16:17], v96 offset:16384
    ds_read_b64_tr_b16 a[18:19], v96 offset:18432
    v_mfma_f32_16x16x32_bf16 v[36:39], a[108:111], v[176:179], v[36:39]
    ds_read_b64_tr_b16 a[20:21], v96 offset:20480
    v_mul_f32 v40, v40, v91
    v_mfma_f32_16x16x32_bf16 v[36:39], a[112:115], v[192:195], v[36:39]
    v_mul_f32 v41, v41, v91
    v_mul_f32 v42, v42, v91
    v_mfma_f32_16x16x32_bf16 v[36:39], a[116:119], v[208:211], v[36:39]
    ds_read_b64_tr_b16 a[22:23], v96 offset:22528
    v_mul_f32 v43, v43, v91
    v_mfma_f32_16x16x32_bf16 v[36:39], a[120:123], v[224:227], v[36:39]
    ds_read_b64_tr_b16 a[24:25], v96 offset:24576
    ds_read_b64_tr_b16 a[26:27], v96 offset:26624
    v_mfma_f32_16x16x32_bf16 v[36:39], a[124:127], v[240:243], v[36:39]
    ds_read_b64_tr_b16 a[28:29], v96 offset:28672
    v_cvt_pk_bf16_f32 v32, v32, v33
    v_mfma_f32_16x16x32_bf16 v[44:47], a[96:99], v[136:139], 0
    ds_read_b64_tr_b16 a[30:31], v96 offset:30720
    v_cvt_pk_bf16_f32 v33, v34, v35
    v_mfma_f32_16x16x32_bf16 v[44:47], a[100:103], v[152:155], v[44:47]
    ds_read_b64_tr_b16 a[32:33], v97 offset:0
    v_cvt_pk_bf16_f32 v40, v40, v41
    v_mfma_f32_16x16x32_bf16 v[44:47], a[104:107], v[168:171], v[44:47]
    ds_read_b64_tr_b16 a[34:35], v97 offset:2048
    v_mul_f32 v36, v36, v89
    v_mfma_f32_16x16x32_bf16 v[44:47], a[108:111], v[184:187], v[44:47]
    ds_read_b64_tr_b16 a[36:37], v97 offset:4096
    v_mul_f32 v37, v37, v89
    v_mfma_f32_16x16x32_bf16 v[44:47], a[112:115], v[200:203], v[44:47]
    v_mul_f32 v38, v38, v89
    v_mul_f32 v39, v39, v89
    v_mfma_f32_16x16x32_bf16 v[44:47], a[116:119], v[216:219], v[44:47]
    v_cvt_pk_bf16_f32 v34, v36, v37
    v_cvt_pk_bf16_f32 v35, v38, v39
    v_mfma_f32_16x16x32_bf16 v[44:47], a[120:123], v[232:235], v[44:47]
    ds_read_b64_tr_b16 a[38:39], v97 offset:6144
    ds_read_b64_tr_b16 a[40:41], v97 offset:8192
    v_mfma_f32_16x16x32_bf16 v[44:47], a[124:127], v[248:251], v[44:47]
    s_waitcnt lgkmcnt(9)
    ds_read_b64_tr_b16 a[42:43], v97 offset:10240
    ds_read_b64_tr_b16 a[44:45], v97 offset:12288
    v_mfma_f32_16x16x32_bf16 v[48:51], a[0:3], v[128:131], 0
    buffer_store_dwordx4 v[32:35], v10, s[20:23], s51 offen offset:1152 sc1
    v_mfma_f32_16x16x32_bf16 v[48:51], a[4:7], v[144:147], v[48:51]
    ds_read_b64_tr_b16 a[46:47], v97 offset:14336
    ds_read_b64_tr_b16 a[48:49], v97 offset:16384
    v_mfma_f32_16x16x32_bf16 v[48:51], a[8:11], v[160:163], v[48:51]
    ds_read_b64_tr_b16 a[50:51], v97 offset:18432
    v_mul_f32 v44, v44, v91
    v_mfma_f32_16x16x32_bf16 v[48:51], a[12:15], v[176:179], v[48:51]
    v_mul_f32 v45, v45, v91
    v_mul_f32 v46, v46, v91
    v_mfma_f32_16x16x32_bf16 v[48:51], a[16:19], v[192:195], v[48:51]
    v_mul_f32 v47, v47, v91
    v_cvt_pk_bf16_f32 v41, v42, v43
    v_mfma_f32_16x16x32_bf16 v[48:51], a[20:23], v[208:211], v[48:51]
    s_waitcnt lgkmcnt(7)
    v_cvt_pk_bf16_f32 v42, v44, v45
    v_cvt_pk_bf16_f32 v43, v46, v47
    v_mfma_f32_16x16x32_bf16 v[48:51], a[24:27], v[224:227], v[48:51]
    ds_read_b64_tr_b16 a[52:53], v97 offset:20480
    ds_read_b64_tr_b16 a[54:55], v97 offset:22528
    v_mfma_f32_16x16x32_bf16 v[48:51], a[28:31], v[240:243], v[48:51]
    ds_read_b64_tr_b16 a[56:57], v97 offset:24576
    ds_read_b64_tr_b16 a[58:59], v97 offset:26624
    v_mfma_f32_16x16x32_bf16 v[56:59], a[0:3], v[136:139], 0
    buffer_store_dwordx4 v[40:43], v10, s[20:23], s55 offen offset:1152 sc1
    v_mfma_f32_16x16x32_bf16 v[56:59], a[4:7], v[152:155], v[56:59]
    ds_read_b64_tr_b16 a[60:61], v97 offset:28672
    ds_read_b64_tr_b16 a[62:63], v97 offset:30720
    v_mfma_f32_16x16x32_bf16 v[56:59], a[8:11], v[168:171], v[56:59]
    ds_read_b64_tr_b16 a[64:65], v98 offset:0
    v_mul_f32 v48, v48, v89
    v_mfma_f32_16x16x32_bf16 v[56:59], a[12:15], v[184:187], v[56:59]
    ds_read_b64_tr_b16 a[66:67], v98 offset:2048
    v_mul_f32 v49, v49, v89
    v_mfma_f32_16x16x32_bf16 v[56:59], a[16:19], v[200:203], v[56:59]
    ds_read_b64_tr_b16 a[68:69], v98 offset:4096
    v_mul_f32 v50, v50, v89
    v_mfma_f32_16x16x32_bf16 v[56:59], a[20:23], v[216:219], v[56:59]
    ds_read_b64_tr_b16 a[70:71], v98 offset:6144
    v_mul_f32 v51, v51, v89
    v_mfma_f32_16x16x32_bf16 v[56:59], a[24:27], v[232:235], v[56:59]
    ds_read_b64_tr_b16 a[72:73], v98 offset:8192
    v_cvt_pk_bf16_f32 v48, v48, v49
    v_mfma_f32_16x16x32_bf16 v[56:59], a[28:31], v[248:251], v[56:59]
    ds_read_b64_tr_b16 a[74:75], v98 offset:10240
    v_cvt_pk_bf16_f32 v49, v50, v51
    v_mfma_f32_16x16x32_bf16 v[52:55], a[32:35], v[128:131], 0
    s_waitcnt lgkmcnt(10)
    ds_read_b64_tr_b16 a[76:77], v98 offset:12288
    v_mfma_f32_16x16x32_bf16 v[52:55], a[36:39], v[144:147], v[52:55]
    ds_read_b64_tr_b16 a[78:79], v98 offset:14336
    v_mfma_f32_16x16x32_bf16 v[52:55], a[40:43], v[160:163], v[52:55]
    ds_read_b64_tr_b16 a[80:81], v98 offset:16384
    v_mul_f32 v56, v56, v91
    v_mfma_f32_16x16x32_bf16 v[52:55], a[44:47], v[176:179], v[52:55]
    ds_read_b64_tr_b16 a[82:83], v98 offset:18432
    v_mul_f32 v57, v57, v91
    v_mfma_f32_16x16x32_bf16 v[52:55], a[48:51], v[192:195], v[52:55]
    ds_read_b64_tr_b16 a[84:85], v98 offset:20480
    v_mul_f32 v58, v58, v91
    v_mfma_f32_16x16x32_bf16 v[52:55], a[52:55], v[208:211], v[52:55]
    s_waitcnt lgkmcnt(9)
    ds_read_b64_tr_b16 a[86:87], v98 offset:22528
    v_mul_f32 v59, v59, v91
    v_mfma_f32_16x16x32_bf16 v[52:55], a[56:59], v[224:227], v[52:55]
    ds_read_b64_tr_b16 a[88:89], v98 offset:24576
    v_cvt_pk_bf16_f32 v56, v56, v57
    v_mfma_f32_16x16x32_bf16 v[52:55], a[60:63], v[240:243], v[52:55]
    ds_read_b64_tr_b16 a[90:91], v98 offset:26624
    v_cvt_pk_bf16_f32 v57, v58, v59
    v_mfma_f32_16x16x32_bf16 v[60:63], a[32:35], v[136:139], 0
    ds_read_b64_tr_b16 a[92:93], v98 offset:28672
    v_mfma_f32_16x16x32_bf16 v[60:63], a[36:39], v[152:155], v[60:63]
    ds_read_b64_tr_b16 a[94:95], v98 offset:30720
    v_mfma_f32_16x16x32_bf16 v[60:63], a[40:43], v[168:171], v[60:63]
    ds_read_b64_tr_b16 a[96:97], v99 offset:0
    v_mul_f32 v52, v52, v89
    v_mfma_f32_16x16x32_bf16 v[60:63], a[44:47], v[184:187], v[60:63]
    ds_read_b64_tr_b16 a[98:99], v99 offset:2048
    v_mul_f32 v53, v53, v89
    v_mfma_f32_16x16x32_bf16 v[60:63], a[48:51], v[200:203], v[60:63]
    ds_read_b64_tr_b16 a[100:101], v99 offset:4096
    v_mul_f32 v54, v54, v89
    v_mfma_f32_16x16x32_bf16 v[60:63], a[52:55], v[216:219], v[60:63]
    v_mul_f32 v55, v55, v89
    v_cvt_pk_bf16_f32 v50, v52, v53
    v_mfma_f32_16x16x32_bf16 v[60:63], a[56:59], v[232:235], v[60:63]
    ds_read_b64_tr_b16 a[102:103], v99 offset:6144
    v_cvt_pk_bf16_f32 v51, v54, v55
    v_mfma_f32_16x16x32_bf16 v[60:63], a[60:63], v[248:251], v[60:63]
    ds_read_b64_tr_b16 a[104:105], v99 offset:8192
    v_mfma_f32_16x16x32_bf16 v[64:67], a[64:67], v[128:131], 0
    s_waitcnt lgkmcnt(8)
    buffer_store_dwordx4 v[48:51], v10, s[20:23], s51 offen offset:1280 sc1
    v_mfma_f32_16x16x32_bf16 v[64:67], a[68:71], v[144:147], v[64:67]
    ds_read_b64_tr_b16 a[106:107], v99 offset:10240
    ds_read_b64_tr_b16 a[108:109], v99 offset:12288
    v_mfma_f32_16x16x32_bf16 v[64:67], a[72:75], v[160:163], v[64:67]
    ds_read_b64_tr_b16 a[110:111], v99 offset:14336
    v_mul_f32 v60, v60, v91
    v_mfma_f32_16x16x32_bf16 v[64:67], a[76:79], v[176:179], v[64:67]
    ds_read_b64_tr_b16 a[112:113], v99 offset:16384
    v_mul_f32 v61, v61, v91
    v_mfma_f32_16x16x32_bf16 v[64:67], a[80:83], v[192:195], v[64:67]
    ds_read_b64_tr_b16 a[114:115], v99 offset:18432
    v_mul_f32 v62, v62, v91
    v_mfma_f32_16x16x32_bf16 v[64:67], a[84:87], v[208:211], v[64:67]
    s_waitcnt lgkmcnt(8)
    v_mul_f32 v63, v63, v91
    v_cvt_pk_bf16_f32 v58, v60, v61
    v_mfma_f32_16x16x32_bf16 v[64:67], a[88:91], v[224:227], v[64:67]
    ds_read_b64_tr_b16 a[116:117], v99 offset:20480
    v_cvt_pk_bf16_f32 v59, v62, v63
    v_mfma_f32_16x16x32_bf16 v[64:67], a[92:95], v[240:243], v[64:67]
    ds_read_b64_tr_b16 a[118:119], v99 offset:22528
    ds_read_b64_tr_b16 a[120:121], v99 offset:24576
    v_mfma_f32_16x16x32_bf16 v[72:75], a[64:67], v[136:139], 0
    buffer_store_dwordx4 v[56:59], v10, s[20:23], s55 offen offset:1280 sc1
    v_mfma_f32_16x16x32_bf16 v[72:75], a[68:71], v[152:155], v[72:75]
    ds_read_b64_tr_b16 a[122:123], v99 offset:26624
    ds_read_b64_tr_b16 a[124:125], v99 offset:28672
    v_mfma_f32_16x16x32_bf16 v[72:75], a[72:75], v[168:171], v[72:75]
    ds_read_b64_tr_b16 a[126:127], v99 offset:30720
    v_mul_f32 v64, v64, v89
    v_mfma_f32_16x16x32_bf16 v[72:75], a[76:79], v[184:187], v[72:75]
    ds_read_b64_tr_b16 a[0:1], v96 offset:34048
    v_mul_f32 v65, v65, v89
    v_mfma_f32_16x16x32_bf16 v[72:75], a[80:83], v[200:203], v[72:75]
    v_mul_f32 v66, v66, v89
    v_mul_f32 v67, v67, v89
    v_mfma_f32_16x16x32_bf16 v[72:75], a[84:87], v[216:219], v[72:75]
    ds_read_b64_tr_b16 a[2:3], v96 offset:36096
    ds_read_b64_tr_b16 a[4:5], v96 offset:38144
    v_mfma_f32_16x16x32_bf16 v[72:75], a[88:91], v[232:235], v[72:75]
    ds_read_b64_tr_b16 a[6:7], v96 offset:40192
    v_cvt_pk_bf16_f32 v64, v64, v65
    v_mfma_f32_16x16x32_bf16 v[72:75], a[92:95], v[248:251], v[72:75]
    ds_read_b64_tr_b16 a[8:9], v96 offset:42240
    v_cvt_pk_bf16_f32 v65, v66, v67
    v_mfma_f32_16x16x32_bf16 v[68:71], a[96:99], v[128:131], 0
    s_waitcnt lgkmcnt(10)
    ds_read_b64_tr_b16 a[10:11], v96 offset:44288
    v_mfma_f32_16x16x32_bf16 v[68:71], a[100:103], v[144:147], v[68:71]
    ds_read_b64_tr_b16 a[12:13], v96 offset:46336
    v_mfma_f32_16x16x32_bf16 v[68:71], a[104:107], v[160:163], v[68:71]
    ds_read_b64_tr_b16 a[14:15], v96 offset:48384
    v_mul_f32 v72, v72, v91
    v_mfma_f32_16x16x32_bf16 v[68:71], a[108:111], v[176:179], v[68:71]
    ds_read_b64_tr_b16 a[16:17], v96 offset:50432
    v_mul_f32 v73, v73, v91
    v_mfma_f32_16x16x32_bf16 v[68:71], a[112:115], v[192:195], v[68:71]
    s_waitcnt lgkmcnt(9)
    v_mul_f32 v74, v74, v91
    v_mul_f32 v75, v75, v91
    v_mfma_f32_16x16x32_bf16 v[68:71], a[116:119], v[208:211], v[68:71]
    ds_read_b64_tr_b16 a[18:19], v96 offset:52480
    ds_read_b64_tr_b16 a[20:21], v96 offset:54528
    v_mfma_f32_16x16x32_bf16 v[68:71], a[120:123], v[224:227], v[68:71]
    ds_read_b64_tr_b16 a[22:23], v96 offset:56576
    v_cvt_pk_bf16_f32 v72, v72, v73
    v_mfma_f32_16x16x32_bf16 v[68:71], a[124:127], v[240:243], v[68:71]
    ds_read_b64_tr_b16 a[24:25], v96 offset:58624
    v_cvt_pk_bf16_f32 v73, v74, v75
    v_mfma_f32_16x16x32_bf16 v[76:79], a[96:99], v[136:139], 0
    v_mfma_f32_16x16x32_bf16 v[76:79], a[100:103], v[152:155], v[76:79]
    ds_read_b64_tr_b16 a[26:27], v96 offset:60672
    v_mfma_f32_16x16x32_bf16 v[76:79], a[104:107], v[168:171], v[76:79]
    ds_read_b64_tr_b16 a[28:29], v96 offset:62720
    v_mul_f32 v68, v68, v89
    v_mfma_f32_16x16x32_bf16 v[76:79], a[108:111], v[184:187], v[76:79]
    ds_read_b64_tr_b16 a[30:31], v96 offset:64768
    v_mul_f32 v69, v69, v89
    v_mfma_f32_16x16x32_bf16 v[76:79], a[112:115], v[200:203], v[76:79]
    v_mul_f32 v70, v70, v89
    v_mul_f32 v71, v71, v89
    v_mfma_f32_16x16x32_bf16 v[76:79], a[116:119], v[216:219], v[76:79]
    v_cvt_pk_bf16_f32 v66, v68, v69
    v_cvt_pk_bf16_f32 v67, v70, v71
    v_mfma_f32_16x16x32_bf16 v[76:79], a[120:123], v[232:235], v[76:79]
    ds_read_b64_tr_b16 a[32:33], v97 offset:34048
    ds_read_b64_tr_b16 a[34:35], v97 offset:36096
    v_mfma_f32_16x16x32_bf16 v[76:79], a[124:127], v[248:251], v[76:79]
    s_waitcnt lgkmcnt(7)
    ds_read_b64_tr_b16 a[36:37], v97 offset:38144
    ds_read_b64_tr_b16 a[38:39], v97 offset:40192
    v_mfma_f32_16x16x32_bf16 v[16:19], a[0:3], v[128:131], 0
    buffer_store_dwordx4 v[64:67], v10, s[20:23], s51 offen offset:1408 sc1
    v_mfma_f32_16x16x32_bf16 v[16:19], a[4:7], v[144:147], v[16:19]
    ds_read_b64_tr_b16 a[40:41], v97 offset:42240
    ds_read_b64_tr_b16 a[42:43], v97 offset:44288
    v_mfma_f32_16x16x32_bf16 v[16:19], a[8:11], v[160:163], v[16:19]
    ds_read_b64_tr_b16 a[44:45], v97 offset:46336
    v_mul_f32 v76, v76, v91
    v_mfma_f32_16x16x32_bf16 v[16:19], a[12:15], v[176:179], v[16:19]
    ds_read_b64_tr_b16 a[46:47], v97 offset:48384
    v_mul_f32 v77, v77, v91
    v_mfma_f32_16x16x32_bf16 v[16:19], a[16:19], v[192:195], v[16:19]
    s_waitcnt lgkmcnt(9)
    v_mul_f32 v78, v78, v91
    v_mul_f32 v79, v79, v91
    v_mfma_f32_16x16x32_bf16 v[16:19], a[20:23], v[208:211], v[16:19]
    v_cvt_pk_bf16_f32 v74, v76, v77
    v_cvt_pk_bf16_f32 v75, v78, v79
    v_mfma_f32_16x16x32_bf16 v[16:19], a[24:27], v[224:227], v[16:19]
    s_waitcnt lgkmcnt(8)
    ds_read_b64_tr_b16 a[48:49], v97 offset:50432
    ds_read_b64_tr_b16 a[50:51], v97 offset:52480
    v_mfma_f32_16x16x32_bf16 v[16:19], a[28:31], v[240:243], v[16:19]
    ds_read_b64_tr_b16 a[52:53], v97 offset:54528
    ds_read_b64_tr_b16 a[54:55], v97 offset:56576
    v_mfma_f32_16x16x32_bf16 v[24:27], a[0:3], v[136:139], 0
    buffer_store_dwordx4 v[72:75], v10, s[20:23], s55 offen offset:1408 sc1
    v_mfma_f32_16x16x32_bf16 v[24:27], a[4:7], v[152:155], v[24:27]
    ds_read_b64_tr_b16 a[56:57], v97 offset:58624
    ds_read_b64_tr_b16 a[58:59], v97 offset:60672
    v_mfma_f32_16x16x32_bf16 v[24:27], a[8:11], v[168:171], v[24:27]
    ds_read_b64_tr_b16 a[60:61], v97 offset:62720
    v_mul_f32 v16, v16, v89
    v_mfma_f32_16x16x32_bf16 v[24:27], a[12:15], v[184:187], v[24:27]
    ds_read_b64_tr_b16 a[62:63], v97 offset:64768
    v_mul_f32 v17, v17, v89
    v_mfma_f32_16x16x32_bf16 v[24:27], a[16:19], v[200:203], v[24:27]
    ds_read_b64_tr_b16 a[64:65], v98 offset:34048
    v_mul_f32 v18, v18, v89
    v_mfma_f32_16x16x32_bf16 v[24:27], a[20:23], v[216:219], v[24:27]
    ds_read_b64_tr_b16 a[66:67], v98 offset:36096
    v_mul_f32 v19, v19, v89
    v_mfma_f32_16x16x32_bf16 v[24:27], a[24:27], v[232:235], v[24:27]
    ds_read_b64_tr_b16 a[68:69], v98 offset:38144
    v_cvt_pk_bf16_f32 v16, v16, v17
    v_mfma_f32_16x16x32_bf16 v[24:27], a[28:31], v[248:251], v[24:27]
    s_waitcnt lgkmcnt(11)
    ds_read_b64_tr_b16 a[70:71], v98 offset:40192
    v_cvt_pk_bf16_f32 v17, v18, v19
    v_mfma_f32_16x16x32_bf16 v[20:23], a[32:35], v[128:131], 0
    ds_read_b64_tr_b16 a[72:73], v98 offset:42240
    v_mfma_f32_16x16x32_bf16 v[20:23], a[36:39], v[144:147], v[20:23]
    ds_read_b64_tr_b16 a[74:75], v98 offset:44288
    v_mfma_f32_16x16x32_bf16 v[20:23], a[40:43], v[160:163], v[20:23]
    ds_read_b64_tr_b16 a[76:77], v98 offset:46336
    v_mul_f32 v24, v24, v91
    v_mfma_f32_16x16x32_bf16 v[20:23], a[44:47], v[176:179], v[20:23]
    s_waitcnt lgkmcnt(9)
    v_mul_f32 v25, v25, v91
    v_mul_f32 v26, v26, v91
    v_mfma_f32_16x16x32_bf16 v[20:23], a[48:51], v[192:195], v[20:23]
    ds_read_b64_tr_b16 a[78:79], v98 offset:48384
    v_mul_f32 v27, v27, v91
    v_mfma_f32_16x16x32_bf16 v[20:23], a[52:55], v[208:211], v[20:23]
    ds_read_b64_tr_b16 a[80:81], v98 offset:50432
    v_cvt_pk_bf16_f32 v24, v24, v25
    v_mfma_f32_16x16x32_bf16 v[20:23], a[56:59], v[224:227], v[20:23]
    s_waitcnt lgkmcnt(8)
    ds_read_b64_tr_b16 a[82:83], v98 offset:52480
    v_cvt_pk_bf16_f32 v25, v26, v27
    v_mfma_f32_16x16x32_bf16 v[20:23], a[60:63], v[240:243], v[20:23]
    ds_read_b64_tr_b16 a[84:85], v98 offset:54528
    v_mfma_f32_16x16x32_bf16 v[28:31], a[32:35], v[136:139], 0
    ds_read_b64_tr_b16 a[86:87], v98 offset:56576
    v_mfma_f32_16x16x32_bf16 v[28:31], a[36:39], v[152:155], v[28:31]
    ds_read_b64_tr_b16 a[88:89], v98 offset:58624
    v_mfma_f32_16x16x32_bf16 v[28:31], a[40:43], v[168:171], v[28:31]
    ds_read_b64_tr_b16 a[90:91], v98 offset:60672
    v_mul_f32 v20, v20, v89
    v_mfma_f32_16x16x32_bf16 v[28:31], a[44:47], v[184:187], v[28:31]
    ds_read_b64_tr_b16 a[92:93], v98 offset:62720
    v_mul_f32 v21, v21, v89
    v_mfma_f32_16x16x32_bf16 v[28:31], a[48:51], v[200:203], v[28:31]
    ds_read_b64_tr_b16 a[94:95], v98 offset:64768
    v_mul_f32 v22, v22, v89
    v_mfma_f32_16x16x32_bf16 v[28:31], a[52:55], v[216:219], v[28:31]
    v_mul_f32 v23, v23, v89
    v_cvt_pk_bf16_f32 v18, v20, v21
    v_mfma_f32_16x16x32_bf16 v[28:31], a[56:59], v[232:235], v[28:31]
    ds_read_b64_tr_b16 a[96:97], v99 offset:34048
    v_cvt_pk_bf16_f32 v19, v22, v23
    v_mfma_f32_16x16x32_bf16 v[28:31], a[60:63], v[248:251], v[28:31]
    s_waitcnt lgkmcnt(8)
    ds_read_b64_tr_b16 a[98:99], v99 offset:36096
    ds_read_b64_tr_b16 a[100:101], v99 offset:38144
    v_mfma_f32_16x16x32_bf16 v[32:35], a[64:67], v[128:131], 0
    buffer_store_dwordx4 v[16:19], v10, s[20:23], s51 offen offset:1536 sc1
    v_mfma_f32_16x16x32_bf16 v[32:35], a[68:71], v[144:147], v[32:35]
    ds_read_b64_tr_b16 a[102:103], v99 offset:40192
    ds_read_b64_tr_b16 a[104:105], v99 offset:42240
    v_mfma_f32_16x16x32_bf16 v[32:35], a[72:75], v[160:163], v[32:35]
    ds_read_b64_tr_b16 a[106:107], v99 offset:44288
    v_mul_f32 v28, v28, v91
    v_mfma_f32_16x16x32_bf16 v[32:35], a[76:79], v[176:179], v[32:35]
    s_waitcnt lgkmcnt(9)
    ds_read_b64_tr_b16 a[108:109], v99 offset:46336
    v_mul_f32 v29, v29, v91
    v_mfma_f32_16x16x32_bf16 v[32:35], a[80:83], v[192:195], v[32:35]
    ds_read_b64_tr_b16 a[110:111], v99 offset:48384
    v_mul_f32 v30, v30, v91
    v_mfma_f32_16x16x32_bf16 v[32:35], a[84:87], v[208:211], v[32:35]
    s_waitcnt lgkmcnt(9)
    v_mul_f32 v31, v31, v91
    v_cvt_pk_bf16_f32 v26, v28, v29
    v_mfma_f32_16x16x32_bf16 v[32:35], a[88:91], v[224:227], v[32:35]
    s_waitcnt lgkmcnt(8)
    ds_read_b64_tr_b16 a[112:113], v99 offset:50432
    v_cvt_pk_bf16_f32 v27, v30, v31
    v_mfma_f32_16x16x32_bf16 v[32:35], a[92:95], v[240:243], v[32:35]
    ds_read_b64_tr_b16 a[114:115], v99 offset:52480
    ds_read_b64_tr_b16 a[116:117], v99 offset:54528
    v_mfma_f32_16x16x32_bf16 v[40:43], a[64:67], v[136:139], 0
    buffer_store_dwordx4 v[24:27], v10, s[20:23], s55 offen offset:1536 sc1
    v_mfma_f32_16x16x32_bf16 v[40:43], a[68:71], v[152:155], v[40:43]
    ds_read_b64_tr_b16 a[118:119], v99 offset:56576
    ds_read_b64_tr_b16 a[120:121], v99 offset:58624
    v_mfma_f32_16x16x32_bf16 v[40:43], a[72:75], v[168:171], v[40:43]
    ds_read_b64_tr_b16 a[122:123], v99 offset:60672
    v_mul_f32 v32, v32, v89
    v_mfma_f32_16x16x32_bf16 v[40:43], a[76:79], v[184:187], v[40:43]
    ds_read_b64_tr_b16 a[124:125], v99 offset:62720
    v_mul_f32 v33, v33, v89
    v_mfma_f32_16x16x32_bf16 v[40:43], a[80:83], v[200:203], v[40:43]
    ds_read_b64_tr_b16 a[126:127], v99 offset:64768
    v_mul_f32 v34, v34, v89
    v_mfma_f32_16x16x32_bf16 v[40:43], a[84:87], v[216:219], v[40:43]
    v_mul_f32 v35, v35, v89
    v_cvt_pk_bf16_f32 v32, v32, v33
    v_mfma_f32_16x16x32_bf16 v[40:43], a[88:91], v[232:235], v[40:43]
    v_cvt_pk_bf16_f32 v33, v34, v35
    v_mfma_f32_16x16x32_bf16 v[40:43], a[92:95], v[248:251], v[40:43]
    s_waitcnt lgkmcnt(8)
    v_mfma_f32_16x16x32_bf16 v[36:39], a[96:99], v[128:131], 0
    v_mfma_f32_16x16x32_bf16 v[36:39], a[100:103], v[144:147], v[36:39]
    v_mfma_f32_16x16x32_bf16 v[36:39], a[104:107], v[160:163], v[36:39]
    v_mul_f32 v40, v40, v91
    v_mul_f32 v41, v41, v91
    v_mfma_f32_16x16x32_bf16 v[36:39], a[108:111], v[176:179], v[36:39]
    s_waitcnt lgkmcnt(3)
    v_mul_f32 v42, v42, v91
    v_mul_f32 v43, v43, v91
    v_mfma_f32_16x16x32_bf16 v[36:39], a[112:115], v[192:195], v[36:39]
    v_cvt_pk_bf16_f32 v40, v40, v41
    v_cvt_pk_bf16_f32 v41, v42, v43
    v_mfma_f32_16x16x32_bf16 v[36:39], a[116:119], v[208:211], v[36:39]
    s_waitcnt lgkmcnt(1)
    v_mfma_f32_16x16x32_bf16 v[36:39], a[120:123], v[224:227], v[36:39]
    s_waitcnt lgkmcnt(0)
    v_mfma_f32_16x16x32_bf16 v[36:39], a[124:127], v[240:243], v[36:39]
    v_mfma_f32_16x16x32_bf16 v[44:47], a[96:99], v[136:139], 0
    v_mfma_f32_16x16x32_bf16 v[44:47], a[100:103], v[152:155], v[44:47]
    v_mfma_f32_16x16x32_bf16 v[44:47], a[104:107], v[168:171], v[44:47]
    v_mul_f32 v36, v36, v89
    v_mul_f32 v37, v37, v89
    v_mfma_f32_16x16x32_bf16 v[44:47], a[108:111], v[184:187], v[44:47]
    v_mul_f32 v38, v38, v89
    v_mul_f32 v39, v39, v89
    v_mfma_f32_16x16x32_bf16 v[44:47], a[112:115], v[200:203], v[44:47]
    v_cvt_pk_bf16_f32 v34, v36, v37
    v_cvt_pk_bf16_f32 v35, v38, v39
    v_mfma_f32_16x16x32_bf16 v[44:47], a[116:119], v[216:219], v[44:47]
    buffer_load_dword v115, v114, s[20:23], s72 offen sc1
    v_mfma_f32_16x16x32_bf16 v[44:47], a[120:123], v[232:235], v[44:47]
    buffer_store_dwordx4 v[32:35], v10, s[20:23], s51 offen offset:1664 sc1
    v_mfma_f32_16x16x32_bf16 v[44:47], a[124:127], v[248:251], v[44:47]
    s_nop 7
    v_mul_f32 v44, v44, v91
    v_mul_f32 v45, v45, v91
    v_mul_f32 v46, v46, v91
    v_mul_f32 v47, v47, v91
    v_cvt_pk_bf16_f32 v42, v44, v45
    v_cvt_pk_bf16_f32 v43, v46, v47
    buffer_store_dwordx4 v[40:43], v10, s[20:23], s55 offen offset:1664 sc1
    v_or3_b32 v104, v104, v105, v106
    v_or_b32 v104, v104, v107
    s_nop 0
    v_readfirstlane_b32 s53, v104
    s_cmp_lg_u32 s49, 0
    s_cselect_b32 s53, 0, s53
    s_cmp_lg_u32 s53, 0
    s_cbranch_scc1 L2_fb
L2_tail:
    s_and_b32 s40, s2, 6
    s_lshl_b32 s40, s40, 3
    s_and_b32 s41, s2, 24
    s_lshr_b32 s41, s41, 1
    s_add_u32 s40, s40, s41
    s_and_b32 s41, s2, 1
    s_lshl_b32 s41, s41, 3
    s_lshr_b32 s42, s2, 5
    s_add_u32 s41, s41, s42
    s_lshl_b32 s41, s41, 2
    s_add_u32 s41, s41, s48
    s_lshl_b32 s41, s41, 6
    s_add_u32 s40, s40, s41
    s_lshl_b32 s40, s40, 1
    s_add_u32 s19, s40, 4456448
    s_mov_b32 s25, s2
    s_lshl2_add_u32 s25, s25, s48
    s_lshl_b32 s25, s25, 3
    s_add_u32 s25, s25, 4472832
    s_add_u32 s54, s75, 16777216
    s_add_u32 s26, s75, 2097152
    s_add_u32 s27, s75, 6291456
    s_mov_b32 s49, 0xffff
    s_mov_b32 s53, 0
    s_mov_b32 s55, 1
    s_mov_b32 s58, 0x3f80
    s_mov_b32 s59, 0x3f800000
    s_cmp_ge_u32 s2, 224
    s_cselect_b32 s52, 1, 0
    v_accvgpr_read_b32 v11, a253
    v_mov_b32 v15, v116
    v_mov_b32 v80, 0
    v_mov_b32 v81, 0
    v_mov_b32 v82, 0
    v_mov_b32 v83, 0
    v_mov_b32 v84, 0
    v_mov_b32 v85, 0
    v_mov_b32 v86, 0
    v_mov_b32 v87, 0
    v_mov_b32 v88, 0
    v_mov_b32 v89, 0
    v_mov_b32 v90, 0
    v_mov_b32 v91, 0
    v_mov_b32 v92, 0
    v_mov_b32 v93, 0
    v_mov_b32 v94, 0
    v_mov_b32 v95, 0
    s_mov_b32 s10, 0
    s_mov_b32 s24, 0
    s_load_dwordx2 s[4:5], s[0:1], 88
    v_lshrrev_b32 v4, 8, v8
    v_lshl_add_u32 v4, v4, 3, s48
    v_mul_u32_u24 v3, 3584, v4
    v_and_b32 v4, 0xf0, v8
    v_add_u32 v3, v3, v4
    s_and_b32 s40, s2, 7
    s_lshr_b32 s41, s2, 3
    s_mul_i32 s42, s41, 9363
    s_lshr_b32 s42, s42, 16
    s_mul_i32 s43, s42, 7
    s_sub_u32 s43, s41, s43
    s_lshr_b32 s41, s40, 1
    s_lshl_b32 s41, s41, 2
    s_add_u32 s42, s42, s41
    s_and_b32 s41, s40, 1
    s_mul_i32 s41, s41, 7
    s_add_u32 s43, s43, s41
    s_lshl_b32 s44, s42, 2
    s_add_u32 s44, s44, s48
    s_mul_i32 s13, s44, 28672
    s_add_u32 s13, s13, 6291456
    s_add_u32 s16, s13, 14336
    s_mul_i32 s14, s44, 114688
    s_lshl_b32 s45, s43, 12
    s_add_u32 s14, s14, s45
    s_add_u32 s14, s14, 8388608
    s_add_u32 s15, s14, 57344
    s_lshl_b32 s17, s44, 7
    s_add_u32 s17, s17, 4472832
    s_lshl_b32 s18, s44, 8
    s_lshl_b32 s45, s43, 4
    s_add_u32 s18, s18, s45
    s_add_u32 s18, s18, 4489216
    s_mul_i32 s12, s48, 4160
    v_lshrrev_b32 v4, 8, v8
    v_bfe_u32 v5, v8, 6, 2
    v_mul_u32_u24 v2, 4160, v5
    v_and_b32 v5, 1, v4
    v_mul_u32_u24 v5, 2080, v5
    v_add_u32 v2, v2, v5
    v_lshrrev_b32 v5, 1, v4
    v_lshl_add_u32 v2, v5, 8, v2
    v_bfe_u32 v5, v8, 4, 2
    v_lshl_add_u32 v2, v5, 3, v2
    v_add_u32 v1, 68096, v2
    s_waitcnt lgkmcnt(0)
    s_mov_b32 s6, 1835008
    s_mov_b32 s7, 0x20000
    s_add_u32 m0, s12, 68096
    s_mov_b32 s41, 4096
    buffer_load_dwordx4 v3, s[60:63], s41 offen offset:0 lds
    s_mov_b32 s42, 3072
    buffer_load_dwordx4 v3, s[64:67], s42 offen offset:1024 lds
    s_mov_b32 s43, 16352
    buffer_load_dwordx4 v3, s[60:63], s43 offen offset:2080 lds
    s_mov_b32 s40, 15328
    buffer_load_dwordx4 v3, s[64:67], s40 offen offset:3104 lds
    s_add_u32 m0, s12, 84736
    s_mov_b32 s41, 118784
    buffer_load_dwordx4 v3, s[60:63], s41 offen offset:0 lds
    s_mov_b32 s42, 117760
    buffer_load_dwordx4 v3, s[64:67], s42 offen offset:1024 lds
    s_mov_b32 s43, 131040
    buffer_load_dwordx4 v3, s[60:63], s43 offen offset:2080 lds
    s_mov_b32 s40, 130016
    buffer_load_dwordx4 v3, s[64:67], s40 offen offset:3104 lds
    s_add_u32 m0, s12, 101376
    s_mov_b32 s41, 233472
    buffer_load_dwordx4 v3, s[60:63], s41 offen offset:0 lds
    s_mov_b32 s42, 232448
    buffer_load_dwordx4 v3, s[64:67], s42 offen offset:1024 lds
    s_mov_b32 s43, 245728
    buffer_load_dwordx4 v3, s[60:63], s43 offen offset:2080 lds
    s_mov_b32 s40, 244704
    buffer_load_dwordx4 v3, s[64:67], s40 offen offset:3104 lds
    s_add_u32 m0, s12, 118016
    s_mov_b32 s41, 348160
    buffer_load_dwordx4 v3, s[60:63], s41 offen offset:0 lds
    s_mov_b32 s42, 347136
    buffer_load_dwordx4 v3, s[64:67], s42 offen offset:1024 lds
    s_mov_b32 s43, 360416
    buffer_load_dwordx4 v3, s[60:63], s43 offen offset:2080 lds
    s_mov_b32 s40, 359392
    buffer_load_dwordx4 v3, s[64:67], s40 offen offset:3104 lds
    s_waitcnt vmcnt(16)
    s_mov_b64 exec, 1
    buffer_store_dword v11, off, s[20:23], s19 sc1
    s_mov_b64 exec, -1
    s_barrier
L3_chk:
    v_cmp_eq_u32 vcc, v11, v115
    s_nop 0
    s_and_b32 s50, vcc_lo, s49
L3_go:
    s_andn2_b32 s49, s49, s50
    s_bcnt1_i32_b32 s51, s50
    s_cbranch_scc0 L3_i16s
    s_cmp_ge_u32 s51, 9
    s_cbranch_scc1 L3_ti_9_16
    s_cmp_ge_u32 s51, 5
    s_cbranch_scc1 L3_ti_5_8
    s_cmp_ge_u32 s51, 3
    s_cbranch_scc1 L3_ti_3_4
    s_cmp_eq_u32 s51, 1
    s_cbranch_scc1 L3_i15
    s_branch L3_i14
L3_ti_3_4:
    s_cmp_eq_u32 s51, 3
    s_cbranch_scc1 L3_i13
    s_branch L3_i12
L3_ti_5_8:
    s_cmp_ge_u32 s51, 7
    s_cbranch_scc1 L3_ti_7_8
    s_cmp_eq_u32 s51, 5
    s_cbranch_scc1 L3_i11
    s_branch L3_i10
L3_ti_7_8:
    s_cmp_eq_u32 s51, 7
    s_cbranch_scc1 L3_i9
    s_branch L3_i8
L3_ti_9_16:
    s_cmp_ge_u32 s51, 13
    s_cbranch_scc1 L3_ti_13_16
    s_cmp_ge_u32 s51, 11
    s_cbranch_scc1 L3_ti_11_12
    s_cmp_eq_u32 s51, 9
    s_cbranch_scc1 L3_i7
    s_branch L3_i6
L3_ti_11_12:
    s_cmp_eq_u32 s51, 11
    s_cbranch_scc1 L3_i5
    s_branch L3_i4
L3_ti_13_16:
    s_cmp_ge_u32 s51, 15
    s_cbranch_scc1 L3_ti_15_16
    s_cmp_eq_u32 s51, 13
    s_cbranch_scc1 L3_i3
    s_branch L3_i2
L3_ti_15_16:
    s_cmp_eq_u32 s51, 15
    s_cbranch_scc1 L3_i1
    s_branch L3_i0
L3_i0:
    s_ff1_i32_b32 s56, s50
    s_bitset0_b32 s50, s56
    s_mul_i32 s57, s56, 1835008
    s_add_u32 s57, s57, s54
    buffer_load_dwordx4 v[16:19], v8, s[20:23], s57 offen sc1
    buffer_load_dwordx4 v[20:23], v108, s[20:23], s57 offen offset:1024 sc1
L3_i1:
    s_ff1_i32_b32 s56, s50
    s_bitset0_b32 s50, s56
    s_mul_i32 s57, s56, 1835008
    s_add_u32 s57, s57, s54
    buffer_load_dwordx4 v[24:27], v8, s[20:23], s57 offen sc1
    buffer_load_dwordx4 v[28:31], v108, s[20:23], s57 offen offset:1024 sc1
L3_i2:
    s_ff1_i32_b32 s56, s50
    s_bitset0_b32 s50, s56
    s_mul_i32 s57, s56, 1835008
    s_add_u32 s57, s57, s54
    buffer_load_dwordx4 v[32:35], v8, s[20:23], s57 offen sc1
    buffer_load_dwordx4 v[36:39], v108, s[20:23], s57 offen offset:1024 sc1
L3_i3:
    s_ff1_i32_b32 s56, s50
    s_bitset0_b32 s50, s56
    s_mul_i32 s57, s56, 1835008
    s_add_u32 s57, s57, s54
    buffer_load_dwordx4 v[40:43], v8, s[20:23], s57 offen sc1
    buffer_load_dwordx4 v[44:47], v108, s[20:23], s57 offen offset:1024 sc1
L3_i4:
    s_ff1_i32_b32 s56, s50
    s_bitset0_b32 s50, s56
    s_mul_i32 s57, s56, 1835008
    s_add_u32 s57, s57, s54
    buffer_load_dwordx4 v[48:51], v8, s[20:23], s57 offen sc1
    buffer_load_dwordx4 v[52:55], v108, s[20:23], s57 offen offset:1024 sc1
L3_i5:
    s_ff1_i32_b32 s56, s50
    s_bitset0_b32 s50, s56
    s_mul_i32 s57, s56, 1835008
    s_add_u32 s57, s57, s54
    buffer_load_dwordx4 v[56:59], v8, s[20:23], s57 offen sc1
    buffer_load_dwordx4 v[60:63], v108, s[20:23], s57 offen offset:1024 sc1
L3_i6:
    s_ff1_i32_b32 s56, s50
    s_bitset0_b32 s50, s56
    s_mul_i32 s57, s56, 1835008
    s_add_u32 s57, s57, s54
    buffer_load_dwordx4 v[64:67], v8, s[20:23], s57 offen sc1
    buffer_load_dwordx4 v[68:71], v108, s[20:23], s57 offen offset:1024 sc1
L3_i7:
    s_ff1_i32_b32 s56, s50
    s_bitset0_b32 s50, s56
    s_mul_i32 s57, s56, 1835008
    s_add_u32 s57, s57, s54
    buffer_load_dwordx4 v[72:75], v8, s[20:23], s57 offen sc1
    buffer_load_dwordx4 v[76:79], v108, s[20:23], s57 offen offset:1024 sc1
L3_i8:
    s_ff1_i32_b32 s56, s50
    s_bitset0_b32 s50, s56
    s_mul_i32 s57, s56, 1835008
    s_add_u32 s57, s57, s54
    buffer_load_dwordx4 v[128:131], v8, s[20:23], s57 offen sc1
    buffer_load_dwordx4 v[136:139], v108, s[20:23], s57 offen offset:1024 sc1
L3_i9:
    s_ff1_i32_b32 s56, s50
    s_bitset0_b32 s50, s56
    s_mul_i32 s57, s56, 1835008
    s_add_u32 s57, s57, s54
    buffer_load_dwordx4 v[144:147], v8, s[20:23], s57 offen sc1
    buffer_load_dwordx4 v[152:155], v108, s[20:23], s57 offen offset:1024 sc1
L3_i10:
    s_ff1_i32_b32 s56, s50
    s_bitset0_b32 s50, s56
    s_mul_i32 s57, s56, 1835008
    s_add_u32 s57, s57, s54
    buffer_load_dwordx4 v[160:163], v8, s[20:23], s57 offen sc1
    buffer_load_dwordx4 v[168:171], v108, s[20:23], s57 offen offset:1024 sc1
L3_i11:
    s_ff1_i32_b32 s56, s50
    s_bitset0_b32 s50, s56
    s_mul_i32 s57, s56, 1835008
    s_add_u32 s57, s57, s54
    buffer_load_dwordx4 v[176:179], v8, s[20:23], s57 offen sc1
    buffer_load_dwordx4 v[184:187], v108, s[20:23], s57 offen offset:1024 sc1
L3_i12:
    s_ff1_i32_b32 s56, s50
    s_bitset0_b32 s50, s56
    s_mul_i32 s57, s56, 1835008
    s_add_u32 s57, s57, s54
    buffer_load_dwordx4 v[192:195], v8, s[20:23], s57 offen sc1
    buffer_load_dwordx4 v[200:203], v108, s[20:23], s57 offen offset:1024 sc1
L3_i13:
    s_ff1_i32_b32 s56, s50
    s_bitset0_b32 s50, s56
    s_mul_i32 s57, s56, 1835008
    s_add_u32 s57, s57, s54
    buffer_load_dwordx4 v[208:211], v8, s[20:23], s57 offen sc1
    buffer_load_dwordx4 v[216:219], v108, s[20:23], s57 offen offset:1024 sc1
L3_i14:
    s_ff1_i32_b32 s56, s50
    s_bitset0_b32 s50, s56
    s_mul_i32 s57, s56, 1835008
    s_add_u32 s57, s57, s54
    buffer_load_dwordx4 v[224:227], v8, s[20:23], s57 offen sc1
    buffer_load_dwordx4 v[232:235], v108, s[20:23], s57 offen offset:1024 sc1
L3_i15:
    s_ff1_i32_b32 s56, s50
    s_bitset0_b32 s50, s56
    s_mul_i32 s57, s56, 1835008
    s_add_u32 s57, s57, s54
    buffer_load_dwordx4 v[240:243], v8, s[20:23], s57 offen sc1
    buffer_load_dwordx4 v[248:251], v108, s[20:23], s57 offen offset:1024 sc1
L3_i16:
    s_cmp_gt_u32 s51, 3
    s_cbranch_scc1 L3_np
    buffer_load_dword v115, v114, s[20:23], s72 offen sc1
L3_np:
    s_cmp_lg_u32 s55, 0
    s_cbranch_scc1 L3_first
L3_acc:
    s_cmp_eq_u32 s51, 0
    s_cbranch_scc1 L3_idle
    s_cmp_ge_u32 s51, 9
    s_cbranch_scc1 L3_ta_9_16
    s_cmp_ge_u32 s51, 5
    s_cbranch_scc1 L3_ta_5_8
    s_cmp_ge_u32 s51, 3
    s_cbranch_scc1 L3_ta_3_4
    s_cmp_eq_u32 s51, 1
    s_cbranch_scc1 L3_a15
    s_branch L3_a14
L3_ta_3_4:
    s_cmp_eq_u32 s51, 3
    s_cbranch_scc1 L3_a13
    s_branch L3_a12
L3_ta_5_8:
    s_cmp_ge_u32 s51, 7
    s_cbranch_scc1 L3_ta_7_8
    s_cmp_eq_u32 s51, 5
    s_cbranch_scc1 L3_a11
    s_branch L3_a10
L3_ta_7_8:
    s_cmp_eq_u32 s51, 7
    s_cbranch_scc1 L3_a9
    s_branch L3_a8
L3_ta_9_16:
    s_cmp_ge_u32 s51, 13
    s_cbranch_scc1 L3_ta_13_16
    s_cmp_ge_u32 s51, 11
    s_cbranch_scc1 L3_ta_11_12
    s_cmp_eq_u32 s51, 9
    s_cbranch_scc1 L3_a7
    s_branch L3_a6
L3_ta_11_12:
    s_cmp_eq_u32 s51, 11
    s_cbranch_scc1 L3_a5
    s_branch L3_a4
L3_ta_13_16:
    s_cmp_ge_u32 s51, 15
    s_cbranch_scc1 L3_ta_15_16
    s_cmp_eq_u32 s51, 13
    s_cbranch_scc1 L3_a3
    s_branch L3_a2
L3_ta_15_16:
    s_cmp_eq_u32 s51, 15
    s_cbranch_scc1 L3_a1
    s_branch L3_a0
L3_a0:
    s_waitcnt vmcnt(30)
    v_dot2_f32_bf16 v80, v16, s58, v80
    v_dot2_f32_bf16 v81, v16, s59, v81
    v_dot2_f32_bf16 v82, v17, s58, v82
    v_dot2_f32_bf16 v83, v17, s59, v83
    v_dot2_f32_bf16 v84, v18, s58, v84
    v_dot2_f32_bf16 v85, v18, s59, v85
    v_dot2_f32_bf16 v86, v19, s58, v86
    v_dot2_f32_bf16 v87, v19, s59, v87
    v_dot2_f32_bf16 v88, v20, s58, v88
    v_dot2_f32_bf16 v89, v20, s59, v89
    v_dot2_f32_bf16 v90, v21, s58, v90
    v_dot2_f32_bf16 v91, v21, s59, v91
    v_dot2_f32_bf16 v92, v22, s58, v92
    v_dot2_f32_bf16 v93, v22, s59, v93
    v_dot2_f32_bf16 v94, v23, s58, v94
    v_dot2_f32_bf16 v95, v23, s59, v95
L3_a1:
    s_waitcnt vmcnt(28)
    v_dot2_f32_bf16 v80, v24, s58, v80
    v_dot2_f32_bf16 v81, v24, s59, v81
    v_dot2_f32_bf16 v82, v25, s58, v82
    v_dot2_f32_bf16 v83, v25, s59, v83
    v_dot2_f32_bf16 v84, v26, s58, v84
    v_dot2_f32_bf16 v85, v26, s59, v85
    v_dot2_f32_bf16 v86, v27, s58, v86
    v_dot2_f32_bf16 v87, v27, s59, v87
    v_dot2_f32_bf16 v88, v28, s58, v88
    v_dot2_f32_bf16 v89, v28, s59, v89
    v_dot2_f32_bf16 v90, v29, s58, v90
    v_dot2_f32_bf16 v91, v29, s59, v91
    v_dot2_f32_bf16 v92, v30, s58, v92
    v_dot2_f32_bf16 v93, v30, s59, v93
    v_dot2_f32_bf16 v94, v31, s58, v94
    v_dot2_f32_bf16 v95, v31, s59, v95
L3_a2:
    s_waitcnt vmcnt(26)
    v_dot2_f32_bf16 v80, v32, s58, v80
    v_dot2_f32_bf16 v81, v32, s59, v81
    v_dot2_f32_bf16 v82, v33, s58, v82
    v_dot2_f32_bf16 v83, v33, s59, v83
    v_dot2_f32_bf16 v84, v34, s58, v84
    v_dot2_f32_bf16 v85, v34, s59, v85
    v_dot2_f32_bf16 v86, v35, s58, v86
    v_dot2_f32_bf16 v87, v35, s59, v87
    v_dot2_f32_bf16 v88, v36, s58, v88
    v_dot2_f32_bf16 v89, v36, s59, v89
    v_dot2_f32_bf16 v90, v37, s58, v90
    v_dot2_f32_bf16 v91, v37, s59, v91
    v_dot2_f32_bf16 v92, v38, s58, v92
    v_dot2_f32_bf16 v93, v38, s59, v93
    v_dot2_f32_bf16 v94, v39, s58, v94
    v_dot2_f32_bf16 v95, v39, s59, v95
L3_a3:
    s_waitcnt vmcnt(24)
    v_dot2_f32_bf16 v80, v40, s58, v80
    v_dot2_f32_bf16 v81, v40, s59, v81
    v_dot2_f32_bf16 v82, v41, s58, v82
    v_dot2_f32_bf16 v83, v41, s59, v83
    v_dot2_f32_bf16 v84, v42, s58, v84
    v_dot2_f32_bf16 v85, v42, s59, v85
    v_dot2_f32_bf16 v86, v43, s58, v86
    v_dot2_f32_bf16 v87, v43, s59, v87
    v_dot2_f32_bf16 v88, v44, s58, v88
    v_dot2_f32_bf16 v89, v44, s59, v89
    v_dot2_f32_bf16 v90, v45, s58, v90
    v_dot2_f32_bf16 v91, v45, s59, v91
    v_dot2_f32_bf16 v92, v46, s58, v92
    v_dot2_f32_bf16 v93, v46, s59, v93
    v_dot2_f32_bf16 v94, v47, s58, v94
    v_dot2_f32_bf16 v95, v47, s59, v95
L3_a4:
    s_waitcnt vmcnt(22)
    v_dot2_f32_bf16 v80, v48, s58, v80
    v_dot2_f32_bf16 v81, v48, s59, v81
    v_dot2_f32_bf16 v82, v49, s58, v82
    v_dot2_f32_bf16 v83, v49, s59, v83
    v_dot2_f32_bf16 v84, v50, s58, v84
    v_dot2_f32_bf16 v85, v50, s59, v85
    v_dot2_f32_bf16 v86, v51, s58, v86
    v_dot2_f32_bf16 v87, v51, s59, v87
    v_dot2_f32_bf16 v88, v52, s58, v88
    v_dot2_f32_bf16 v89, v52, s59, v89
    v_dot2_f32_bf16 v90, v53, s58, v90
    v_dot2_f32_bf16 v91, v53, s59, v91
    v_dot2_f32_bf16 v92, v54, s58, v92
    v_dot2_f32_bf16 v93, v54, s59, v93
    v_dot2_f32_bf16 v94, v55, s58, v94
    v_dot2_f32_bf16 v95, v55, s59, v95
L3_a5:
    s_waitcnt vmcnt(20)
    v_dot2_f32_bf16 v80, v56, s58, v80
    v_dot2_f32_bf16 v81, v56, s59, v81
    v_dot2_f32_bf16 v82, v57, s58, v82
    v_dot2_f32_bf16 v83, v57, s59, v83
    v_dot2_f32_bf16 v84, v58, s58, v84
    v_dot2_f32_bf16 v85, v58, s59, v85
    v_dot2_f32_bf16 v86, v59, s58, v86
    v_dot2_f32_bf16 v87, v59, s59, v87
    v_dot2_f32_bf16 v88, v60, s58, v88
    v_dot2_f32_bf16 v89, v60, s59, v89
    v_dot2_f32_bf16 v90, v61, s58, v90
    v_dot2_f32_bf16 v91, v61, s59, v91
    v_dot2_f32_bf16 v92, v62, s58, v92
    v_dot2_f32_bf16 v93, v62, s59, v93
    v_dot2_f32_bf16 v94, v63, s58, v94
    v_dot2_f32_bf16 v95, v63, s59, v95
L3_a6:
    s_waitcnt vmcnt(18)
    v_dot2_f32_bf16 v80, v64, s58, v80
    v_dot2_f32_bf16 v81, v64, s59, v81
    v_dot2_f32_bf16 v82, v65, s58, v82
    v_dot2_f32_bf16 v83, v65, s59, v83
    v_dot2_f32_bf16 v84, v66, s58, v84
    v_dot2_f32_bf16 v85, v66, s59, v85
    v_dot2_f32_bf16 v86, v67, s58, v86
    v_dot2_f32_bf16 v87, v67, s59, v87
    v_dot2_f32_bf16 v88, v68, s58, v88
    v_dot2_f32_bf16 v89, v68, s59, v89
    v_dot2_f32_bf16 v90, v69, s58, v90
    v_dot2_f32_bf16 v91, v69, s59, v91
    v_dot2_f32_bf16 v92, v70, s58, v92
    v_dot2_f32_bf16 v93, v70, s59, v93
    v_dot2_f32_bf16 v94, v71, s58, v94
    v_dot2_f32_bf16 v95, v71, s59, v95
L3_a7:
    s_waitcnt vmcnt(16)
    v_dot2_f32_bf16 v80, v72, s58, v80
    v_dot2_f32_bf16 v81, v72, s59, v81
    v_dot2_f32_bf16 v82, v73, s58, v82
    v_dot2_f32_bf16 v83, v73, s59, v83
    v_dot2_f32_bf16 v84, v74, s58, v84
    v_dot2_f32_bf16 v85, v74, s59, v85
    v_dot2_f32_bf16 v86, v75, s58, v86
    v_dot2_f32_bf16 v87, v75, s59, v87
    v_dot2_f32_bf16 v88, v76, s58, v88
    v_dot2_f32_bf16 v89, v76, s59, v89
    v_dot2_f32_bf16 v90, v77, s58, v90
    v_dot2_f32_bf16 v91, v77, s59, v91
    v_dot2_f32_bf16 v92, v78, s58, v92
    v_dot2_f32_bf16 v93, v78, s59, v93
    v_dot2_f32_bf16 v94, v79, s58, v94
    v_dot2_f32_bf16 v95, v79, s59, v95
L3_a8:
    s_waitcnt vmcnt(14)
    v_dot2_f32_bf16 v80, v128, s58, v80
    v_dot2_f32_bf16 v81, v128, s59, v81
    v_dot2_f32_bf16 v82, v129, s58, v82
    v_dot2_f32_bf16 v83, v129, s59, v83
    v_dot2_f32_bf16 v84, v130, s58, v84
    v_dot2_f32_bf16 v85, v130, s59, v85
    v_dot2_f32_bf16 v86, v131, s58, v86
    v_dot2_f32_bf16 v87, v131, s59, v87
    v_dot2_f32_bf16 v88, v136, s58, v88
    v_dot2_f32_bf16 v89, v136, s59, v89
    v_dot2_f32_bf16 v90, v137, s58, v90
    v_dot2_f32_bf16 v91, v137, s59, v91
    v_dot2_f32_bf16 v92, v138, s58, v92
    v_dot2_f32_bf16 v93, v138, s59, v93
    v_dot2_f32_bf16 v94, v139, s58, v94
    v_dot2_f32_bf16 v95, v139, s59, v95
L3_a9:
    s_waitcnt vmcnt(12)
    v_dot2_f32_bf16 v80, v144, s58, v80
    v_dot2_f32_bf16 v81, v144, s59, v81
    v_dot2_f32_bf16 v82, v145, s58, v82
    v_dot2_f32_bf16 v83, v145, s59, v83
    v_dot2_f32_bf16 v84, v146, s58, v84
    v_dot2_f32_bf16 v85, v146, s59, v85
    v_dot2_f32_bf16 v86, v147, s58, v86
    v_dot2_f32_bf16 v87, v147, s59, v87
    v_dot2_f32_bf16 v88, v152, s58, v88
    v_dot2_f32_bf16 v89, v152, s59, v89
    v_dot2_f32_bf16 v90, v153, s58, v90
    v_dot2_f32_bf16 v91, v153, s59, v91
    v_dot2_f32_bf16 v92, v154, s58, v92
    v_dot2_f32_bf16 v93, v154, s59, v93
    v_dot2_f32_bf16 v94, v155, s58, v94
    v_dot2_f32_bf16 v95, v155, s59, v95
L3_a10:
    s_waitcnt vmcnt(10)
    v_dot2_f32_bf16 v80, v160, s58, v80
    v_dot2_f32_bf16 v81, v160, s59, v81
    v_dot2_f32_bf16 v82, v161, s58, v82
    v_dot2_f32_bf16 v83, v161, s59, v83
    v_dot2_f32_bf16 v84, v162, s58, v84
    v_dot2_f32_bf16 v85, v162, s59, v85
    v_dot2_f32_bf16 v86, v163, s58, v86
    v_dot2_f32_bf16 v87, v163, s59, v87
    v_dot2_f32_bf16 v88, v168, s58, v88
    v_dot2_f32_bf16 v89, v168, s59, v89
    v_dot2_f32_bf16 v90, v169, s58, v90
    v_dot2_f32_bf16 v91, v169, s59, v91
    v_dot2_f32_bf16 v92, v170, s58, v92
    v_dot2_f32_bf16 v93, v170, s59, v93
    v_dot2_f32_bf16 v94, v171, s58, v94
    v_dot2_f32_bf16 v95, v171, s59, v95
L3_a11:
    s_waitcnt vmcnt(8)
    v_dot2_f32_bf16 v80, v176, s58, v80
    v_dot2_f32_bf16 v81, v176, s59, v81
    v_dot2_f32_bf16 v82, v177, s58, v82
    v_dot2_f32_bf16 v83, v177, s59, v83
    v_dot2_f32_bf16 v84, v178, s58, v84
    v_dot2_f32_bf16 v85, v178, s59, v85
    v_dot2_f32_bf16 v86, v179, s58, v86
    v_dot2_f32_bf16 v87, v179, s59, v87
    v_dot2_f32_bf16 v88, v184, s58, v88
    v_dot2_f32_bf16 v89, v184, s59, v89
    v_dot2_f32_bf16 v90, v185, s58, v90
    v_dot2_f32_bf16 v91, v185, s59, v91
    v_dot2_f32_bf16 v92, v186, s58, v92
    v_dot2_f32_bf16 v93, v186, s59, v93
    v_dot2_f32_bf16 v94, v187, s58, v94
    v_dot2_f32_bf16 v95, v187, s59, v95
L3_a12:
    s_waitcnt vmcnt(6)
    buffer_load_dword v115, v114, s[20:23], s72 offen sc1
    v_dot2_f32_bf16 v80, v192, s58, v80
    v_dot2_f32_bf16 v81, v192, s59, v81
    v_dot2_f32_bf16 v82, v193, s58, v82
    v_dot2_f32_bf16 v83, v193, s59, v83
    v_dot2_f32_bf16 v84, v194, s58, v84
    v_dot2_f32_bf16 v85, v194, s59, v85
    v_dot2_f32_bf16 v86, v195, s58, v86
    v_dot2_f32_bf16 v87, v195, s59, v87
    v_dot2_f32_bf16 v88, v200, s58, v88
    v_dot2_f32_bf16 v89, v200, s59, v89
    v_dot2_f32_bf16 v90, v201, s58, v90
    v_dot2_f32_bf16 v91, v201, s59, v91
    v_dot2_f32_bf16 v92, v202, s58, v92
    v_dot2_f32_bf16 v93, v202, s59, v93
    v_dot2_f32_bf16 v94, v203, s58, v94
    v_dot2_f32_bf16 v95, v203, s59, v95
L3_a13:
    s_waitcnt vmcnt(5)
    v_dot2_f32_bf16 v80, v208, s58, v80
    v_dot2_f32_bf16 v81, v208, s59, v81
    v_dot2_f32_bf16 v82, v209, s58, v82
    v_dot2_f32_bf16 v83, v209, s59, v83
    v_dot2_f32_bf16 v84, v210, s58, v84
    v_dot2_f32_bf16 v85, v210, s59, v85
    v_dot2_f32_bf16 v86, v211, s58, v86
    v_dot2_f32_bf16 v87, v211, s59, v87
    v_dot2_f32_bf16 v88, v216, s58, v88
    v_dot2_f32_bf16 v89, v216, s59, v89
    v_dot2_f32_bf16 v90, v217, s58, v90
    v_dot2_f32_bf16 v91, v217, s59, v91
    v_dot2_f32_bf16 v92, v218, s58, v92
    v_dot2_f32_bf16 v93, v218, s59, v93
    v_dot2_f32_bf16 v94, v219, s58, v94
    v_dot2_f32_bf16 v95, v219, s59, v95
L3_a14:
    s_waitcnt vmcnt(3)
    v_dot2_f32_bf16 v80, v224, s58, v80
    v_dot2_f32_bf16 v81, v224, s59, v81
    v_dot2_f32_bf16 v82, v225, s58, v82
    v_dot2_f32_bf16 v83, v225, s59, v83
    v_dot2_f32_bf16 v84, v226, s58, v84
    v_dot2_f32_bf16 v85, v226, s59, v85
    v_dot2_f32_bf16 v86, v227, s58, v86
    v_dot2_f32_bf16 v87, v227, s59, v87
    v_dot2_f32_bf16 v88, v232, s58, v88
    v_dot2_f32_bf16 v89, v232, s59, v89
    v_dot2_f32_bf16 v90, v233, s58, v90
    v_dot2_f32_bf16 v91, v233, s59, v91
    v_dot2_f32_bf16 v92, v234, s58, v92
    v_dot2_f32_bf16 v93, v234, s59, v93
    v_dot2_f32_bf16 v94, v235, s58, v94
    v_dot2_f32_bf16 v95, v235, s59, v95
L3_a15:
    s_waitcnt vmcnt(1)
    v_dot2_f32_bf16 v80, v240, s58, v80
    v_dot2_f32_bf16 v81, v240, s59, v81
    v_dot2_f32_bf16 v82, v241, s58, v82
    v_dot2_f32_bf16 v83, v241, s59, v83
    v_dot2_f32_bf16 v84, v242, s58, v84
    v_dot2_f32_bf16 v85, v242, s59, v85
    v_dot2_f32_bf16 v86, v243, s58, v86
    v_dot2_f32_bf16 v87, v243, s59, v87
    v_dot2_f32_bf16 v88, v248, s58, v88
    v_dot2_f32_bf16 v89, v248, s59, v89
    v_dot2_f32_bf16 v90, v249, s58, v90
    v_dot2_f32_bf16 v91, v249, s59, v91
    v_dot2_f32_bf16 v92, v250, s58, v92
    v_dot2_f32_bf16 v93, v250, s59, v93
    v_dot2_f32_bf16 v94, v251, s58, v94
    v_dot2_f32_bf16 v95, v251, s59, v95
    s_cmp_eq_u32 s49, 0
    s_cbranch_scc1 L3_fin
    s_waitcnt vmcnt(0)
    s_branch L3_chk
L3_i16s:
    s_branch L3_i16
L3_first:
    s_mov_b32 s55, 0
    s_branch L3_acc
L3_idle:
    s_cmp_lg_u32 s52, 0
    s_cbranch_scc1 L3_idle2
    s_mov_b32 s52, 1
    s_add_u32 m0, s12, 0
    s_mov_b32 s41, 462848
    buffer_load_dwordx4 v3, s[60:63], s41 offen offset:0 lds
    s_mov_b32 s42, 461824
    buffer_load_dwordx4 v3, s[64:67], s42 offen offset:1024 lds
    s_mov_b32 s43, 475104
    buffer_load_dwordx4 v3, s[60:63], s43 offen offset:2080 lds
    s_mov_b32 s40, 474080
    buffer_load_dwordx4 v3, s[64:67], s40 offen offset:3104 lds
    s_add_u32 m0, s12, 16640
    s_mov_b32 s41, 577536
    buffer_load_dwordx4 v3, s[60:63], s41 offen offset:0 lds
    s_mov_b32 s42, 576512
    buffer_load_dwordx4 v3, s[64:67], s42 offen offset:1024 lds
    s_mov_b32 s43, 589792
    buffer_load_dwordx4 v3, s[60:63], s43 offen offset:2080 lds
    s_mov_b32 s40, 588768
    buffer_load_dwordx4 v3, s[64:67], s40 offen offset:3104 lds
    s_add_u32 m0, s12, 33280
    s_mov_b32 s41, 692224
    buffer_load_dwordx4 v3, s[60:63], s41 offen offset:0 lds
    s_mov_b32 s42, 691200
    buffer_load_dwordx4 v3, s[64:67], s42 offen offset:1024 lds
    s_mov_b32 s43, 704480
    buffer_load_dwordx4 v3, s[60:63], s43 offen offset:2080 lds
    s_mov_b32 s40, 703456
    buffer_load_dwordx4 v3, s[64:67], s40 offen offset:3104 lds
    s_add_u32 m0, s12, 49920
    s_mov_b32 s41, 806912
    buffer_load_dwordx4 v3, s[60:63], s41 offen offset:0 lds
    s_mov_b32 s42, 805888
    buffer_load_dwordx4 v3, s[64:67], s42 offen offset:1024 lds
    s_mov_b32 s43, 819168
    buffer_load_dwordx4 v3, s[60:63], s43 offen offset:2080 lds
    s_mov_b32 s40, 818144
    buffer_load_dwordx4 v3, s[64:67], s40 offen offset:3104 lds
L3_idle2:
    s_add_u32 s53, s53, 1
    s_cmp_lt_u32 s53, 131072
    s_waitcnt vmcnt(0)
    s_cbranch_scc1 L3_chk
    s_mov_b32 s50, s49
    s_branch L3_go
L3_fin:
    v_lshlrev_b32 v16, 16, v132
    v_and_b32 v17, 0xffff0000, v132
    v_lshlrev_b32 v18, 16, v133
    v_and_b32 v19, 0xffff0000, v133
    v_lshlrev_b32 v20, 16, v134
    v_and_b32 v21, 0xffff0000, v134
    v_lshlrev_b32 v22, 16, v135
    v_and_b32 v23, 0xffff0000, v135
    v_lshlrev_b32 v24, 16, v140
    v_and_b32 v25, 0xffff0000, v140
    v_lshlrev_b32 v26, 16, v141
    v_and_b32 v27, 0xffff0000, v141
    v_lshlrev_b32 v28, 16, v142
    v_and_b32 v29, 0xffff0000, v142
    v_lshlrev_b32 v30, 16, v143
    v_and_b32 v31, 0xffff0000, v143
    v_fma_f32 v80, v80, v148, v16
    v_fma_f32 v81, v81, v149, v17
    v_fma_f32 v82, v82, v150, v18
    v_fma_f32 v83, v83, v151, v19
    v_fma_f32 v84, v84, v156, v20
    v_fma_f32 v85, v85, v157, v21
    v_fma_f32 v86, v86, v158, v22
    v_fma_f32 v87, v87, v159, v23
    v_fma_f32 v88, v88, v164, v24
    v_fma_f32 v89, v89, v165, v25
    v_fma_f32 v90, v90, v166, v26
    v_fma_f32 v91, v91, v167, v27
    v_fma_f32 v92, v92, v172, v28
    v_fma_f32 v93, v93, v173, v29
    v_fma_f32 v94, v94, v174, v30
    v_fma_f32 v95, v95, v175, v31
    v_add_f32 v32, v80, v88
    v_add_f32 v33, v81, v89
    v_add_f32 v34, v82, v90
    v_add_f32 v35, v83, v91
    v_add_f32 v36, v84, v92
    v_add_f32 v37, v85, v93
    v_add_f32 v38, v86, v94
    v_add_f32 v39, v87, v95
    v_add_f32 v32, v32, v36
    v_add_f32 v33, v33, v37
    v_add_f32 v34, v34, v38
    v_add_f32 v35, v35, v39
    v_add_f32 v32, v32, v34
    v_add_f32 v33, v33, v35
    v_add_f32 v32, v32, v33
    v_cvt_pk_bf16_f32 v40, v80, v81
    v_cvt_pk_bf16_f32 v41, v82, v83
    v_add_f32_dpp v32, v32, v32 quad_perm:[2,3,0,1] row_mask:0xf bank_mask:0xf
    v_cvt_pk_bf16_f32 v42, v84, v85
    v_cvt_pk_bf16_f32 v43, v86, v87
    v_add_f32_dpp v32, v32, v32 row_ror:4 row_mask:0xf bank_mask:0xf
    v_cvt_pk_bf16_f32 v44, v88, v89
    v_cvt_pk_bf16_f32 v45, v90, v91
    v_add_f32_dpp v32, v32, v32 row_ror:8 row_mask:0xf bank_mask:0xf
    v_cvt_pk_bf16_f32 v46, v92, v93
    v_cvt_pk_bf16_f32 v47, v94, v95
    v_mov_b32 v33, v32
    buffer_store_dwordx4 v[40:43], v8, s[20:23], s26 offen sc1
    buffer_store_dwordx4 v[44:47], v108, s[20:23], s26 offen offset:1024 sc1
    v_permlane16_swap_b32 v32, v33
    v_add_f32 v32, v32, v33
    v_mov_b32 v33, v32
    s_nop 1
    v_permlane32_swap_b32 v32, v33
    v_add_f32 v32, v32, v33
    v_mul_f32 v32, 0x3b124925, v32
    v_sub_f32 v80, v80, v32
    v_sub_f32 v81, v81, v32
    v_sub_f32 v82, v82, v32
    v_sub_f32 v83, v83, v32
    v_sub_f32 v84, v84, v32
    v_sub_f32 v85, v85, v32
    v_sub_f32 v86, v86, v32
    v_sub_f32 v87, v87, v32
    v_sub_f32 v88, v88, v32
    v_sub_f32 v89, v89, v32
    v_sub_f32 v90, v90, v32
    v_sub_f32 v91, v91, v32
    v_sub_f32 v92, v92, v32
    v_sub_f32 v93, v93, v32
    v_sub_f32 v94, v94, v32
    v_sub_f32 v95, v95, v32
    v_mul_f32 v32, v80, v80
    v_mul_f32 v33, v81, v81
    v_fmac_f32 v32, v82, v82
    v_fmac_f32 v33, v83, v83
    v_fmac_f32 v32, v84, v84
    v_fmac_f32 v33, v85, v85
    v_fmac_f32 v32, v86, v86
    v_fmac_f32 v33, v87, v87
    s_mov_b32 exec_hi, 0xffff
    v_fmac_f32 v32, v88, v88
    v_fmac_f32 v33, v89, v89
    v_fmac_f32 v32, v90, v90
    v_fmac_f32 v33, v91, v91
    v_fmac_f32 v32, v92, v92
    v_fmac_f32 v33, v93, v93
    v_fmac_f32 v32, v94, v94
    v_fmac_f32 v33, v95, v95
    s_mov_b32 exec_hi, -1
    v_add_f32 v32, v32, v33
    v_mul_f32 v80, v80, v212
    v_mul_f32 v81, v81, v213
    v_add_f32_dpp v32, v32, v32 quad_perm:[2,3,0,1] row_mask:0xf bank_mask:0xf
    v_mul_f32 v82, v82, v214
    v_mul_f32 v83, v83, v215
    v_add_f32_dpp v32, v32, v32 row_ror:4 row_mask:0xf bank_mask:0xf
    v_mul_f32 v84, v84, v220
    v_mul_f32 v85, v85, v221
    v_add_f32_dpp v32, v32, v32 row_ror:8 row_mask:0xf bank_mask:0xf
    v_mul_f32 v86, v86, v222
    v_mul_f32 v87, v87, v223
    v_mov_b32 v33, v32
    v_mul_f32 v88, v88, v228
    v_mul_f32 v89, v89, v229
    v_permlane16_swap_b32 v32, v33
    v_add_f32 v32, v32, v33
    v_mov_b32 v33, v32
    v_mul_f32 v90, v90, v230
    v_mul_f32 v91, v91, v231
    v_permlane32_swap_b32 v32, v33
    v_add_f32 v32, v32, v33
    v_mul_f32 v92, v92, v236
    v_mul_f32 v93, v93, v237
    v_mul_f32 v94, v94, v238
    v_mul_f32 v95, v95, v239
    v_mov_b32 v33, 0x3727c5ac
    v_fmac_f32 v33, 0x3b124925, v32
    v_rsq_f32 v33, v33
    s_nop 0
    v_fma_f32 v80, v80, v33, v180
    v_fma_f32 v81, v81, v33, v181
    v_fma_f32 v82, v82, v33, v182
    v_fma_f32 v83, v83, v33, v183
    v_fma_f32 v84, v84, v33, v188
    v_fma_f32 v85, v85, v33, v189
    v_fma_f32 v86, v86, v33, v190
    v_fma_f32 v87, v87, v33, v191
    v_fma_f32 v88, v88, v33, v196
    v_fma_f32 v89, v89, v33, v197
    v_fma_f32 v90, v90, v33, v198
    v_fma_f32 v91, v91, v33, v199
    v_fma_f32 v92, v92, v33, v204
    v_fma_f32 v93, v93, v33, v205
    v_fma_f32 v94, v94, v33, v206
    v_fma_f32 v95, v95, v33, v207
    v_cvt_pk_bf16_f32 v48, v80, v81
    v_cvt_pk_bf16_f32 v49, v82, v83
    v_cvt_pk_bf16_f32 v50, v84, v85
    v_cvt_pk_bf16_f32 v51, v86, v87
    v_cvt_pk_bf16_f32 v52, v88, v89
    v_cvt_pk_bf16_f32 v53, v90, v91
    v_cvt_pk_bf16_f32 v54, v92, v93
    v_cvt_pk_bf16_f32 v55, v94, v95
    buffer_store_dwordx4 v[48:51], v8, s[20:23], s27 offen sc1
    buffer_store_dwordx4 v[52:55], v108, s[20:23], s27 offen offset:1024 sc1
    s_mov_b64 exec, 1
    buffer_store_dword v11, off, s[20:23], s25 sc1
    s_mov_b64 exec, -1
    s_cmp_lg_u32 s52, 0
    s_cbranch_scc1 L3_e0
    s_add_u32 m0, s12, 0
    s_mov_b32 s41, 462848
    buffer_load_dwordx4 v3, s[60:63], s41 offen offset:0 lds
    s_mov_b32 s42, 461824
    buffer_load_dwordx4 v3, s[64:67], s42 offen offset:1024 lds
    s_mov_b32 s43, 475104
    buffer_load_dwordx4 v3, s[60:63], s43 offen offset:2080 lds
    s_mov_b32 s40, 474080
    buffer_load_dwordx4 v3, s[64:67], s40 offen offset:3104 lds
    s_add_u32 m0, s12, 16640
    s_mov_b32 s41, 577536
    buffer_load_dwordx4 v3, s[60:63], s41 offen offset:0 lds
    s_mov_b32 s42, 576512
    buffer_load_dwordx4 v3, s[64:67], s42 offen offset:1024 lds
    s_mov_b32 s43, 589792
    buffer_load_dwordx4 v3, s[60:63], s43 offen offset:2080 lds
    s_mov_b32 s40, 588768
    buffer_load_dwordx4 v3, s[64:67], s40 offen offset:3104 lds
    s_add_u32 m0, s12, 33280
    s_mov_b32 s41, 692224
    buffer_load_dwordx4 v3, s[60:63], s41 offen offset:0 lds
    s_mov_b32 s42, 691200
    buffer_load_dwordx4 v3, s[64:67], s42 offen offset:1024 lds
    s_mov_b32 s43, 704480
    buffer_load_dwordx4 v3, s[60:63], s43 offen offset:2080 lds
    s_mov_b32 s40, 703456
    buffer_load_dwordx4 v3, s[64:67], s40 offen offset:3104 lds
    s_add_u32 m0, s12, 49920
    s_mov_b32 s41, 806912
    buffer_load_dwordx4 v3, s[60:63], s41 offen offset:0 lds
    s_mov_b32 s42, 805888
    buffer_load_dwordx4 v3, s[64:67], s42 offen offset:1024 lds
    s_mov_b32 s43, 819168
    buffer_load_dwordx4 v3, s[60:63], s43 offen offset:2080 lds
    s_mov_b32 s40, 818144
    buffer_load_dwordx4 v3, s[64:67], s40 offen offset:3104 lds
L3_e0:
    s_cmp_ge_u32 s2, 224
    s_cbranch_scc1 L2_ep
    s_mov_b32 s53, 0
    buffer_load_dword v0, v15, s[20:23], s17 offen sc1
    s_barrier
    ds_read_b64_tr_b16 a[0:1], v1 offset:0
    ds_read_b64_tr_b16 a[2:3], v1 offset:512
    ds_read_b64_tr_b16 a[4:5], v1 offset:16640
    ds_read_b64_tr_b16 a[6:7], v1 offset:17152
    ds_read_b64_tr_b16 a[8:9], v1 offset:1024
    ds_read_b64_tr_b16 a[10:11], v1 offset:1536
    ds_read_b64_tr_b16 a[12:13], v1 offset:17664
    ds_read_b64_tr_b16 a[14:15], v1 offset:18176
    ds_read_b64_tr_b16 a[16:17], v1 offset:32
    ds_read_b64_tr_b16 a[18:19], v1 offset:544
    ds_read_b64_tr_b16 a[20:21], v1 offset:16672
    ds_read_b64_tr_b16 a[22:23], v1 offset:17184
    ds_read_b64_tr_b16 a[24:25], v1 offset:1056
    ds_read_b64_tr_b16 a[26:27], v1 offset:1568
    ds_read_b64_tr_b16 a[28:29], v1 offset:17696
    ds_read_b64_tr_b16 a[30:31], v1 offset:18208
    ds_read_b64_tr_b16 a[32:33], v1 offset:64
    ds_read_b64_tr_b16 a[34:35], v1 offset:576
    ds_read_b64_tr_b16 a[36:37], v1 offset:16704
    ds_read_b64_tr_b16 a[38:39], v1 offset:17216
    ds_read_b64_tr_b16 a[40:41], v1 offset:1088
    ds_read_b64_tr_b16 a[42:43], v1 offset:1600
    ds_read_b64_tr_b16 a[44:45], v1 offset:17728
    ds_read_b64_tr_b16 a[46:47], v1 offset:18240
    ds_read_b64_tr_b16 a[48:49], v1 offset:96
    ds_read_b64_tr_b16 a[50:51], v1 offset:608
    ds_read_b64_tr_b16 a[52:53], v1 offset:16736
    ds_read_b64_tr_b16 a[54:55], v1 offset:17248
    ds_read_b64_tr_b16 a[56:57], v1 offset:1120
    ds_read_b64_tr_b16 a[58:59], v1 offset:1632
    ds_read_b64_tr_b16 a[60:61], v1 offset:17760
    ds_read_b64_tr_b16 a[62:63], v1 offset:18272
    ds_read_b64_tr_b16 a[64:65], v1 offset:128
    ds_read_b64_tr_b16 a[66:67], v1 offset:640
    ds_read_b64_tr_b16 a[68:69], v1 offset:16768
    ds_read_b64_tr_b16 a[70:71], v1 offset:17280
    ds_read_b64_tr_b16 a[72:73], v1 offset:1152
    ds_read_b64_tr_b16 a[74:75], v1 offset:1664
    ds_read_b64_tr_b16 a[76:77], v1 offset:17792
    ds_read_b64_tr_b16 a[78:79], v1 offset:18304
    ds_read_b64_tr_b16 a[80:81], v1 offset:160
    ds_read_b64_tr_b16 a[82:83], v1 offset:672
    ds_read_b64_tr_b16 a[84:85], v1 offset:16800
    ds_read_b64_tr_b16 a[86:87], v1 offset:17312
    ds_read_b64_tr_b16 a[88:89], v1 offset:1184
    ds_read_b64_tr_b16 a[90:91], v1 offset:1696
    ds_read_b64_tr_b16 a[92:93], v1 offset:17824
    ds_read_b64_tr_b16 a[94:95], v1 offset:18336
    ds_read_b64_tr_b16 a[96:97], v1 offset:192
    ds_read_b64_tr_b16 a[98:99], v1 offset:704
    ds_read_b64_tr_b16 a[100:101], v1 offset:16832
    ds_read_b64_tr_b16 a[102:103], v1 offset:17344
    ds_read_b64_tr_b16 a[104:105], v1 offset:1216
    ds_read_b64_tr_b16 a[106:107], v1 offset:1728
    ds_read_b64_tr_b16 a[108:109], v1 offset:17856
    ds_read_b64_tr_b16 a[110:111], v1 offset:18368
    ds_read_b64_tr_b16 a[112:113], v1 offset:224
    ds_read_b64_tr_b16 a[114:115], v1 offset:736
    ds_read_b64_tr_b16 a[116:117], v1 offset:16864
    ds_read_b64_tr_b16 a[118:119], v1 offset:17376
    ds_read_b64_tr_b16 a[120:121], v1 offset:1248
    ds_read_b64_tr_b16 a[122:123], v1 offset:1760
    ds_read_b64_tr_b16 a[124:125], v1 offset:17888
    ds_read_b64_tr_b16 a[126:127], v1 offset:18400
    ds_read_b64_tr_b16 a[128:129], v1 offset:33280
    ds_read_b64_tr_b16 a[130:131], v1 offset:33792
    ds_read_b64_tr_b16 a[132:133], v1 offset:49920
    ds_read_b64_tr_b16 a[134:135], v1 offset:50432
    ds_read_b64_tr_b16 a[136:137], v1 offset:34304
    ds_read_b64_tr_b16 a[138:139], v1 offset:34816
    ds_read_b64_tr_b16 a[140:141], v1 offset:50944
    ds_read_b64_tr_b16 a[142:143], v1 offset:51456
    ds_read_b64_tr_b16 a[144:145], v1 offset:33312
    ds_read_b64_tr_b16 a[146:147], v1 offset:33824
    ds_read_b64_tr_b16 a[148:149], v1 offset:49952
    ds_read_b64_tr_b16 a[150:151], v1 offset:50464
    ds_read_b64_tr_b16 a[152:153], v1 offset:34336
    ds_read_b64_tr_b16 a[154:155], v1 offset:34848
    ds_read_b64_tr_b16 a[156:157], v1 offset:50976
    ds_read_b64_tr_b16 a[158:159], v1 offset:51488
    ds_read_b64_tr_b16 a[160:161], v1 offset:33344
    ds_read_b64_tr_b16 a[162:163], v1 offset:33856
    ds_read_b64_tr_b16 a[164:165], v1 offset:49984
    ds_read_b64_tr_b16 a[166:167], v1 offset:50496
    ds_read_b64_tr_b16 a[168:169], v1 offset:34368
    ds_read_b64_tr_b16 a[170:171], v1 offset:34880
    ds_read_b64_tr_b16 a[172:173], v1 offset:51008
    ds_read_b64_tr_b16 a[174:175], v1 offset:51520
    ds_read_b64_tr_b16 a[176:177], v1 offset:33376
    ds_read_b64_tr_b16 a[178:179], v1 offset:33888
    ds_read_b64_tr_b16 a[180:181], v1 offset:50016
    ds_read_b64_tr_b16 a[182:183], v1 offset:50528
    ds_read_b64_tr_b16 a[184:185], v1 offset:34400
    ds_read_b64_tr_b16 a[186:187], v1 offset:34912
    ds_read_b64_tr_b16 a[188:189], v1 offset:51040
    ds_read_b64_tr_b16 a[190:191], v1 offset:51552
    ds_read_b64_tr_b16 a[192:193], v1 offset:33408
    ds_read_b64_tr_b16 a[194:195], v1 offset:33920
    ds_read_b64_tr_b16 a[196:197], v1 offset:50048
    ds_read_b64_tr_b16 a[198:199], v1 offset:50560
    ds_read_b64_tr_b16 a[200:201], v1 offset:34432
    ds_read_b64_tr_b16 a[202:203], v1 offset:34944
    ds_read_b64_tr_b16 a[204:205], v1 offset:51072
    ds_read_b64_tr_b16 a[206:207], v1 offset:51584
    ds_read_b64_tr_b16 a[208:209], v1 offset:33440
    ds_read_b64_tr_b16 a[210:211], v1 offset:33952
    ds_read_b64_tr_b16 a[212:213], v1 offset:50080
    ds_read_b64_tr_b16 a[214:215], v1 offset:50592
    ds_read_b64_tr_b16 a[216:217], v1 offset:34464
    ds_read_b64_tr_b16 a[218:219], v1 offset:34976
    ds_read_b64_tr_b16 a[220:221], v1 offset:51104
    ds_read_b64_tr_b16 a[222:223], v1 offset:51616
    ds_read_b64_tr_b16 a[224:225], v1 offset:33472
    ds_read_b64_tr_b16 a[226:227], v1 offset:33984
    ds_read_b64_tr_b16 a[228:229], v1 offset:50112
    ds_read_b64_tr_b16 a[230:231], v1 offset:50624
    ds_read_b64_tr_b16 a[232:233], v1 offset:34496
    ds_read_b64_tr_b16 a[234:235], v1 offset:35008
    ds_read_b64_tr_b16 a[236:237], v1 offset:51136
    ds_read_b64_tr_b16 a[238:239], v1 offset:51648
    ds_read_b64_tr_b16 a[240:241], v1 offset:33504
    ds_read_b64_tr_b16 a[242:243], v1 offset:34016
    ds_read_b64_tr_b16 a[244:245], v1 offset:50144
    ds_read_b64_tr_b16 a[246:247], v1 offset:50656
    ds_read_b64_tr_b16 a[248:249], v1 offset:34528
    ds_read_b64_tr_b16 a[250:251], v1 offset:35040
    ds_read_b64_tr_b16 a[252:253], v1 offset:51168
    ds_read_b64_tr_b16 a[254:255], v1 offset:51680
    s_and_b32 s40, s2, 7
    s_lshr_b32 s41, s2, 3
    s_mul_i32 s42, s41, 9363
    s_lshr_b32 s42, s42, 16
    s_mul_i32 s43, s42, 7
    s_sub_u32 s43, s41, s43
    s_lshl_b32 s44, s40, 2
    s_add_u32 s42, s42, s44
    s_mul_i32 s93, s42, 229376
    s_mul_i32 s44, s48, 14336
    s_add_u32 s93, s93, s44
    s_add_u32 s93, s93, 8388608
    s_mul_i32 s94, s48, 401408
    s_lshl_b32 s45, s43, 7
    s_add_u32 s94, s94, s45
    s_lshl_b32 s92, s48, 12
    s_lshl_b32 s46, s42, 2
    s_add_u32 s46, s46, s48
    s_mul_i32 s46, s46, 14336
    s_add_u32 s96, s46, s45
    s_lshl_b32 s47, s43, 8
    s_add_u32 s95, s46, s47
    s_add_u32 s95, s95, 2097152
    s_add_u32 s97, s47, 1844480
    s_lshl_b32 s98, s42, 5
    s_mul_i32 s99, s48, 7
    s_lshr_b32 s99, s99, 1
    s_add_u32 s98, s98, s99
    s_lshl_b32 s98, s98, 4
    s_add_u32 s98, s98, 4489216
    s_movk_i32 s99, 0xff
    s_add_u32 s44, s92, 134656
    v_lshrrev_b32 v12, 8, v8
    v_lshrrev_b32 v13, 7, v8
    v_mul_u32_u24 v9, 896, v13
    v_bfe_u32 v13, v8, 4, 3
    v_lshlrev_b32 v14, 1, v12
    v_xor_b32 v13, v13, v14
    v_lshl_add_u32 v9, v13, 4, v9
    v_lshrrev_b32 v13, 6, v8
    v_lshlrev_b32 v4, 7, v13
    v_bfe_u32 v13, v13, 1, 2
    v_lshl_add_u32 v4, v13, 5, v4
    v_bfe_u32 v13, v8, 4, 2
    v_lshl_add_u32 v4, v13, 3, v4
    v_add_u32 v4, s44, v4
    v_xor_b32 v5, 32, v4
    v_xor_b32 v6, 64, v4
    v_xor_b32 v7, 0x60, v4
    v_bfe_u32 v13, v8, 4, 4
    v_mul_u32_u24 v13, 896, v13
    v_and_b32 v14, 1, v12
    v_lshl_add_u32 v13, v14, 5, v13
    v_lshrrev_b32 v14, 1, v12
    v_lshl_add_u32 v13, v14, 4, v13
    v_lshlrev_b32 v12, 5, v12
    v_add_u32 v14, s92, v8
    s_and_b32 s49, s42, 3
    s_mul_i32 s49, s49, 50176
    s_add_u32 s49, s49, s94
    s_add_u32 s49, s49, 200704
    s_add_u32 s51, s49, 43008
    s_waitcnt vmcnt(0)
    s_branch L4_chk
L4_poll:
    s_sleep 2
    s_add_u32 s53, s53, 1
    s_cmp_ge_u32 s53, 131072
    s_cbranch_scc1 L4_go
    buffer_load_dword v0, v15, s[20:23], s17 offen sc1
    s_waitcnt vmcnt(0)
L4_chk:
    v_cmp_ne_u32 vcc, v11, v0
    s_nop 0
    s_and_b32 s50, vcc_lo, 0xffff
    s_cbranch_scc1 L4_poll
L4_go:
    v_mul_u32_u24 v15, 56, v8
    buffer_load_dwordx4 v[16:19], v10, s[20:23], s13 offen offset:0 sc1
    buffer_load_dwordx4 v[20:23], v10, s[20:23], s16 offen offset:0 sc1
    buffer_load_dwordx4 v[24:27], v10, s[20:23], s13 offen offset:128 sc1
    buffer_load_dwordx4 v[28:31], v10, s[20:23], s16 offen offset:128 sc1
    buffer_load_dwordx4 v[32:35], v10, s[20:23], s13 offen offset:256 sc1
    buffer_load_dwordx4 v[36:39], v10, s[20:23], s16 offen offset:256 sc1
    buffer_load_dwordx4 v[40:43], v10, s[20:23], s13 offen offset:384 sc1
    buffer_load_dwordx4 v[44:47], v10, s[20:23], s16 offen offset:384 sc1
    s_waitcnt lgkmcnt(0)
    s_waitcnt vmcnt(5)
    v_max3_u32 v0, v16, v20, v24
    s_waitcnt vmcnt(4)
    v_max_u32 v0, v0, v28
    v_cmp_eq_u32 vcc, -1, v0
    s_nop 0
    s_cbranch_vccnz L4_g0
L4_g0b:
    v_mfma_f32_16x16x32_bf16 v[128:131], a[0:3], v[16:19], 0
    v_mfma_f32_16x16x32_bf16 v[128:131], a[4:7], v[24:27], v[128:131]
    buffer_load_dwordx4 v[48:51], v10, s[20:23], s13 offen offset:512 sc1
    v_mfma_f32_16x16x32_bf16 v[136:139], a[0:3], v[20:23], 0
    v_mfma_f32_16x16x32_bf16 v[136:139], a[4:7], v[28:31], v[136:139]
    v_mfma_f32_16x16x32_bf16 v[192:195], a[8:11], v[16:19], 0
    buffer_load_dwordx4 v[52:55], v10, s[20:23], s16 offen offset:512 sc1
    v_mfma_f32_16x16x32_bf16 v[192:195], a[12:15], v[24:27], v[192:195]
    v_mfma_f32_16x16x32_bf16 v[200:203], a[8:11], v[20:23], 0
    v_mfma_f32_16x16x32_bf16 v[200:203], a[12:15], v[28:31], v[200:203]
    s_add_u32 m0, s12, 68096
    buffer_load_dwordx4 v[56:59], v10, s[20:23], s13 offen offset:640 sc1
    v_mfma_f32_16x16x32_bf16 v[132:135], a[16:19], v[16:19], 0
    s_mov_b32 s41, 921600
    v_mfma_f32_16x16x32_bf16 v[132:135], a[20:23], v[24:27], v[132:135]
    v_mfma_f32_16x16x32_bf16 v[140:143], a[16:19], v[20:23], 0
    s_waitcnt lgkmcnt(0)
    v_mfma_f32_16x16x32_bf16 v[140:143], a[20:23], v[28:31], v[140:143]
    s_barrier
    buffer_load_dwordx4 v[60:63], v10, s[20:23], s16 offen offset:640 sc1
    v_mfma_f32_16x16x32_bf16 v[196:199], a[24:27], v[16:19], 0
    s_mov_b32 s42, 920576
    ds_read_b64_tr_b16 a[0:1], v2 offset:0
    ds_read_b64_tr_b16 a[2:3], v2 offset:512
    v_mfma_f32_16x16x32_bf16 v[196:199], a[28:31], v[24:27], v[196:199]
    s_mov_b32 s43, 933856
    buffer_load_dwordx4 v3, s[60:63], s41 offen offset:0 lds
    v_mfma_f32_16x16x32_bf16 v[204:207], a[24:27], v[20:23], 0
    ds_read_b64_tr_b16 a[4:5], v2 offset:16640
    ds_read_b64_tr_b16 a[6:7], v2 offset:17152
    v_mfma_f32_16x16x32_bf16 v[204:207], a[28:31], v[28:31], v[204:207]
    ds_read_b64_tr_b16 a[8:9], v2 offset:1024
    v_mfma_f32_16x16x32_bf16 v[144:147], a[32:35], v[16:19], 0
    s_mov_b32 s40, 932832
    buffer_load_dwordx4 v3, s[64:67], s42 offen offset:1024 lds
    v_mfma_f32_16x16x32_bf16 v[144:147], a[36:39], v[24:27], v[144:147]
    ds_read_b64_tr_b16 a[10:11], v2 offset:1536
    ds_read_b64_tr_b16 a[12:13], v2 offset:17664
    v_mfma_f32_16x16x32_bf16 v[152:155], a[32:35], v[20:23], 0
    ds_read_b64_tr_b16 a[14:15], v2 offset:18176
    v_mfma_f32_16x16x32_bf16 v[152:155], a[36:39], v[28:31], v[152:155]
    s_mov_b32 s41, 1036288
    buffer_load_dwordx4 v3, s[60:63], s43 offen offset:2080 lds
    v_mfma_f32_16x16x32_bf16 v[208:211], a[40:43], v[16:19], 0
    ds_read_b64_tr_b16 a[16:17], v2 offset:32
    ds_read_b64_tr_b16 a[18:19], v2 offset:544
    v_mfma_f32_16x16x32_bf16 v[208:211], a[44:47], v[24:27], v[208:211]
    ds_read_b64_tr_b16 a[20:21], v2 offset:16672
    ds_read_b64_tr_b16 a[22:23], v2 offset:17184
    v_mfma_f32_16x16x32_bf16 v[216:219], a[40:43], v[20:23], 0
    s_mov_b32 s42, 1035264
    buffer_load_dwordx4 v3, s[64:67], s40 offen offset:3104 lds
    v_mfma_f32_16x16x32_bf16 v[216:219], a[44:47], v[28:31], v[216:219]
    s_add_u32 m0, s12, 84736
    ds_read_b64_tr_b16 a[24:25], v2 offset:1056
    ds_read_b64_tr_b16 a[26:27], v2 offset:1568
    v_mfma_f32_16x16x32_bf16 v[148:151], a[48:51], v[16:19], 0
    ds_read_b64_tr_b16 a[28:29], v2 offset:17696
    v_mfma_f32_16x16x32_bf16 v[148:151], a[52:55], v[24:27], v[148:151]
    s_mov_b32 s43, 1048544
    buffer_load_dwordx4 v3, s[60:63], s41 offen offset:0 lds
    v_mfma_f32_16x16x32_bf16 v[156:159], a[48:51], v[20:23], 0
    ds_read_b64_tr_b16 a[30:31], v2 offset:18208
    ds_read_b64_tr_b16 a[32:33], v2 offset:64
    v_mfma_f32_16x16x32_bf16 v[156:159], a[52:55], v[28:31], v[156:159]
    ds_read_b64_tr_b16 a[34:35], v2 offset:576
    ds_read_b64_tr_b16 a[36:37], v2 offset:16704
    v_mfma_f32_16x16x32_bf16 v[212:215], a[56:59], v[16:19], 0
    s_mov_b32 s40, 1047520
    buffer_load_dwordx4 v3, s[64:67], s42 offen offset:1024 lds
    v_mfma_f32_16x16x32_bf16 v[212:215], a[60:63], v[24:27], v[212:215]
    ds_read_b64_tr_b16 a[38:39], v2 offset:17216
    ds_read_b64_tr_b16 a[40:41], v2 offset:1088
    v_mfma_f32_16x16x32_bf16 v[220:223], a[56:59], v[20:23], 0
    ds_read_b64_tr_b16 a[42:43], v2 offset:1600
    v_mfma_f32_16x16x32_bf16 v[220:223], a[60:63], v[28:31], v[220:223]
    buffer_load_dwordx4 v3, s[60:63], s43 offen offset:2080 lds
    v_mfma_f32_16x16x32_bf16 v[160:163], a[64:67], v[16:19], 0
    ds_read_b64_tr_b16 a[44:45], v2 offset:17728
    ds_read_b64_tr_b16 a[46:47], v2 offset:18240
    v_mfma_f32_16x16x32_bf16 v[160:163], a[68:71], v[24:27], v[160:163]
    ds_read_b64_tr_b16 a[48:49], v2 offset:96
    ds_read_b64_tr_b16 a[50:51], v2 offset:608
    v_mfma_f32_16x16x32_bf16 v[168:171], a[64:67], v[20:23], 0
    buffer_load_dwordx4 v3, s[64:67], s40 offen offset:3104 lds
    v_mfma_f32_16x16x32_bf16 v[168:171], a[68:71], v[28:31], v[168:171]
    ds_read_b64_tr_b16 a[52:53], v2 offset:16736
    ds_read_b64_tr_b16 a[54:55], v2 offset:17248
    v_mfma_f32_16x16x32_bf16 v[224:227], a[72:75], v[16:19], 0
    ds_read_b64_tr_b16 a[56:57], v2 offset:1120
    v_mfma_f32_16x16x32_bf16 v[224:227], a[76:79], v[24:27], v[224:227]
    buffer_load_dwordx4 v[64:67], v10, s[20:23], s13 offen offset:768 sc1
    v_mfma_f32_16x16x32_bf16 v[232:235], a[72:75], v[20:23], 0
    ds_read_b64_tr_b16 a[58:59], v2 offset:1632
    ds_read_b64_tr_b16 a[60:61], v2 offset:17760
    v_mfma_f32_16x16x32_bf16 v[232:235], a[76:79], v[28:31], v[232:235]
    ds_read_b64_tr_b16 a[62:63], v2 offset:18272
    v_mfma_f32_16x16x32_bf16 v[164:167], a[80:83], v[16:19], 0
    buffer_load_dwordx4 v[68:71], v10, s[20:23], s16 offen offset:768 sc1
    v_mfma_f32_16x16x32_bf16 v[164:167], a[84:87], v[24:27], v[164:167]
    ds_read_b64_tr_b16 a[64:65], v2 offset:128
    ds_read_b64_tr_b16 a[66:67], v2 offset:640
    v_mfma_f32_16x16x32_bf16 v[172:175], a[80:83], v[20:23], 0
    ds_read_b64_tr_b16 a[68:69], v2 offset:16768
    ds_read_b64_tr_b16 a[70:71], v2 offset:17280
    v_mfma_f32_16x16x32_bf16 v[172:175], a[84:87], v[28:31], v[172:175]
    s_add_u32 m0, s12, 101376
    buffer_load_dwordx4 v[72:75], v10, s[20:23], s13 offen offset:896 sc1
    v_mfma_f32_16x16x32_bf16 v[228:231], a[88:91], v[16:19], 0
    s_mov_b32 s41, 1150976
    ds_read_b64_tr_b16 a[72:73], v2 offset:1152
    ds_read_b64_tr_b16 a[74:75], v2 offset:1664
    v_mfma_f32_16x16x32_bf16 v[228:231], a[92:95], v[24:27], v[228:231]
    ds_read_b64_tr_b16 a[76:77], v2 offset:17792
    v_mfma_f32_16x16x32_bf16 v[236:239], a[88:91], v[20:23], 0
    s_mov_b32 s42, 1149952
    buffer_load_dwordx4 v[76:79], v10, s[20:23], s16 offen offset:896 sc1
    v_mfma_f32_16x16x32_bf16 v[236:239], a[92:95], v[28:31], v[236:239]
    ds_read_b64_tr_b16 a[78:79], v2 offset:18304
    ds_read_b64_tr_b16 a[80:81], v2 offset:160
    v_mfma_f32_16x16x32_bf16 v[176:179], a[96:99], v[16:19], 0
    ds_read_b64_tr_b16 a[82:83], v2 offset:672
    ds_read_b64_tr_b16 a[84:85], v2 offset:16800
    v_mfma_f32_16x16x32_bf16 v[176:179], a[100:103], v[24:27], v[176:179]
    s_mov_b32 s43, 1163232
    buffer_load_dwordx4 v3, s[60:63], s41 offen offset:0 lds
    v_mfma_f32_16x16x32_bf16 v[184:187], a[96:99], v[20:23], 0
    ds_read_b64_tr_b16 a[86:87], v2 offset:17312
    ds_read_b64_tr_b16 a[88:89], v2 offset:1184
    v_mfma_f32_16x16x32_bf16 v[184:187], a[100:103], v[28:31], v[184:187]
    ds_read_b64_tr_b16 a[90:91], v2 offset:1696
    v_mfma_f32_16x16x32_bf16 v[240:243], a[104:107], v[16:19], 0
    s_mov_b32 s40, 1162208
    buffer_load_dwordx4 v3, s[64:67], s42 offen offset:1024 lds
    v_mfma_f32_16x16x32_bf16 v[240:243], a[108:111], v[24:27], v[240:243]
    ds_read_b64_tr_b16 a[92:93], v2 offset:17824
    ds_read_b64_tr_b16 a[94:95], v2 offset:18336
    v_mfma_f32_16x16x32_bf16 v[248:251], a[104:107], v[20:23], 0
    ds_read_b64_tr_b16 a[96:97], v2 offset:192
    ds_read_b64_tr_b16 a[98:99], v2 offset:704
    v_mfma_f32_16x16x32_bf16 v[248:251], a[108:111], v[28:31], v[248:251]
    s_mov_b32 s41, 1265664
    buffer_load_dwordx4 v3, s[60:63], s43 offen offset:2080 lds
    v_mfma_f32_16x16x32_bf16 v[180:183], a[112:115], v[16:19], 0
    s_waitcnt vmcnt(20)
    ds_read_b64_tr_b16 a[100:101], v2 offset:16832
    v_max3_u32 v0, v32, v36, v40
    v_mfma_f32_16x16x32_bf16 v[180:183], a[116:119], v[24:27], v[180:183]
    s_waitcnt vmcnt(19)
    v_max_u32 v0, v0, v44
    v_cmp_eq_u32 vcc, -1, v0
    v_mfma_f32_16x16x32_bf16 v[188:191], a[112:115], v[20:23], 0
    s_mov_b32 s42, 1264640
    ds_read_b64_tr_b16 a[102:103], v2 offset:17344
    ds_read_b64_tr_b16 a[104:105], v2 offset:1216
    v_mfma_f32_16x16x32_bf16 v[188:191], a[116:119], v[28:31], v[188:191]
    buffer_load_dwordx4 v3, s[64:67], s40 offen offset:3104 lds
    v_mfma_f32_16x16x32_bf16 v[244:247], a[120:123], v[16:19], 0
    s_add_u32 m0, s12, 118016
    ds_read_b64_tr_b16 a[106:107], v2 offset:1728
    ds_read_b64_tr_b16 a[108:109], v2 offset:17856
    v_mfma_f32_16x16x32_bf16 v[244:247], a[124:127], v[24:27], v[244:247]
    s_mov_b32 s43, 1277920
    ds_read_b64_tr_b16 a[110:111], v2 offset:18368
    ds_read_b64_tr_b16 a[112:113], v2 offset:224
    v_mfma_f32_16x16x32_bf16 v[252:255], a[120:123], v[20:23], 0
    buffer_load_dwordx4 v3, s[60:63], s41 offen offset:0 lds
    v_mfma_f32_16x16x32_bf16 v[252:255], a[124:127], v[28:31], v[252:255]
    s_cbranch_vccnz L4_g1
L4_g1b:
    ds_read_b64_tr_b16 a[114:115], v2 offset:736
    ds_read_b64_tr_b16 a[116:117], v2 offset:16864
    v_mfma_f32_16x16x32_bf16 v[128:131], a[128:131], v[32:35], v[128:131]
    s_mov_b32 s40, 1276896
    ds_read_b64_tr_b16 a[118:119], v2 offset:17376
    ds_read_b64_tr_b16 a[120:121], v2 offset:1248
    v_mfma_f32_16x16x32_bf16 v[128:131], a[132:135], v[40:43], v[128:131]
    buffer_load_dwordx4 v3, s[64:67], s42 offen offset:1024 lds
    v_mfma_f32_16x16x32_bf16 v[136:139], a[128:131], v[36:39], v[136:139]
    ds_read_b64_tr_b16 a[122:123], v2 offset:1760
    ds_read_b64_tr_b16 a[124:125], v2 offset:17888
    v_mfma_f32_16x16x32_bf16 v[136:139], a[132:135], v[44:47], v[136:139]
    buffer_load_dwordx4 v3, s[60:63], s43 offen offset:2080 lds
    v_mfma_f32_16x16x32_bf16 v[192:195], a[136:139], v[32:35], v[192:195]
    ds_read_b64_tr_b16 a[126:127], v2 offset:18400
    v_mfma_f32_16x16x32_bf16 v[192:195], a[140:143], v[40:43], v[192:195]
    v_mfma_f32_16x16x32_bf16 v[200:203], a[136:139], v[36:39], v[200:203]
    buffer_load_dwordx4 v3, s[64:67], s40 offen offset:3104 lds
    v_mfma_f32_16x16x32_bf16 v[200:203], a[140:143], v[44:47], v[200:203]
    v_mfma_f32_16x16x32_bf16 v[132:135], a[144:147], v[32:35], v[132:135]
    v_mfma_f32_16x16x32_bf16 v[132:135], a[148:151], v[40:43], v[132:135]
    buffer_load_dwordx4 v[80:83], v10, s[20:23], s13 offen offset:1024 sc1
    v_mfma_f32_16x16x32_bf16 v[140:143], a[144:147], v[36:39], v[140:143]
    s_waitcnt lgkmcnt(0)
    v_mfma_f32_16x16x32_bf16 v[140:143], a[148:151], v[44:47], v[140:143]
    s_barrier
    v_mfma_f32_16x16x32_bf16 v[196:199], a[152:155], v[32:35], v[196:199]
    buffer_load_dwordx4 v[84:87], v10, s[20:23], s16 offen offset:1024 sc1
    v_mfma_f32_16x16x32_bf16 v[196:199], a[156:159], v[40:43], v[196:199]
    ds_read_b64_tr_b16 a[128:129], v2 offset:33280
    ds_read_b64_tr_b16 a[130:131], v2 offset:33792
    v_mfma_f32_16x16x32_bf16 v[204:207], a[152:155], v[36:39], v[204:207]
    ds_read_b64_tr_b16 a[132:133], v2 offset:49920
    ds_read_b64_tr_b16 a[134:135], v2 offset:50432
    v_mfma_f32_16x16x32_bf16 v[204:207], a[156:159], v[44:47], v[204:207]
    s_add_u32 m0, s12, 0
    buffer_load_dwordx4 v[88:91], v10, s[20:23], s13 offen offset:1152 sc1
    v_mfma_f32_16x16x32_bf16 v[144:147], a[160:163], v[32:35], v[144:147]
    s_mov_b32 s41, 1380352
    ds_read_b64_tr_b16 a[136:137], v2 offset:34304
    ds_read_b64_tr_b16 a[138:139], v2 offset:34816
    v_mfma_f32_16x16x32_bf16 v[144:147], a[164:167], v[40:43], v[144:147]
    ds_read_b64_tr_b16 a[140:141], v2 offset:50944
    v_mfma_f32_16x16x32_bf16 v[152:155], a[160:163], v[36:39], v[152:155]
    s_mov_b32 s42, 1379328
    buffer_load_dwordx4 v[92:95], v10, s[20:23], s16 offen offset:1152 sc1
    v_mfma_f32_16x16x32_bf16 v[152:155], a[164:167], v[44:47], v[152:155]
    ds_read_b64_tr_b16 a[142:143], v2 offset:51456
    ds_read_b64_tr_b16 a[144:145], v2 offset:33312
    v_mfma_f32_16x16x32_bf16 v[208:211], a[168:171], v[32:35], v[208:211]
    ds_read_b64_tr_b16 a[146:147], v2 offset:33824
    ds_read_b64_tr_b16 a[148:149], v2 offset:49952
    v_mfma_f32_16x16x32_bf16 v[208:211], a[172:175], v[40:43], v[208:211]
    s_mov_b32 s43, 1392608
    buffer_load_dwordx4 v3, s[60:63], s41 offen offset:0 lds
    v_mfma_f32_16x16x32_bf16 v[216:219], a[168:171], v[36:39], v[216:219]
    ds_read_b64_tr_b16 a[150:151], v2 offset:50464
    ds_read_b64_tr_b16 a[152:153], v2 offset:34336
    v_mfma_f32_16x16x32_bf16 v[216:219], a[172:175], v[44:47], v[216:219]
    ds_read_b64_tr_b16 a[154:155], v2 offset:34848
    v_mfma_f32_16x16x32_bf16 v[148:151], a[176:179], v[32:35], v[148:151]
    s_mov_b32 s40, 1391584
    buffer_load_dwordx4 v3, s[64:67], s42 offen offset:1024 lds
    v_mfma_f32_16x16x32_bf16 v[148:151], a[180:183], v[40:43], v[148:151]
    ds_read_b64_tr_b16 a[156:157], v2 offset:50976
    ds_read_b64_tr_b16 a[158:159], v2 offset:51488
    v_mfma_f32_16x16x32_bf16 v[156:159], a[176:179], v[36:39], v[156:159]
    ds_read_b64_tr_b16 a[160:161], v2 offset:33344
    ds_read_b64_tr_b16 a[162:163], v2 offset:33856
    v_mfma_f32_16x16x32_bf16 v[156:159], a[180:183], v[44:47], v[156:159]
    s_mov_b32 s41, 1495040
    buffer_load_dwordx4 v3, s[60:63], s43 offen offset:2080 lds
    v_mfma_f32_16x16x32_bf16 v[212:215], a[184:187], v[32:35], v[212:215]
    ds_read_b64_tr_b16 a[164:165], v2 offset:49984
    ds_read_b64_tr_b16 a[166:167], v2 offset:50496
    v_mfma_f32_16x16x32_bf16 v[212:215], a[188:191], v[40:43], v[212:215]
    ds_read_b64_tr_b16 a[168:169], v2 offset:34368
    v_mfma_f32_16x16x32_bf16 v[220:223], a[184:187], v[36:39], v[220:223]
    s_mov_b32 s42, 1494016
    buffer_load_dwordx4 v3, s[64:67], s40 offen offset:3104 lds
    v_mfma_f32_16x16x32_bf16 v[220:223], a[188:191], v[44:47], v[220:223]
    s_add_u32 m0, s12, 16640
    ds_read_b64_tr_b16 a[170:171], v2 offset:34880
    ds_read_b64_tr_b16 a[172:173], v2 offset:51008
    v_mfma_f32_16x16x32_bf16 v[160:163], a[192:195], v[32:35], v[160:163]
    ds_read_b64_tr_b16 a[174:175], v2 offset:51520
    v_mfma_f32_16x16x32_bf16 v[160:163], a[196:199], v[40:43], v[160:163]
    s_mov_b32 s43, 1507296
    buffer_load_dwordx4 v3, s[60:63], s41 offen offset:0 lds
    v_mfma_f32_16x16x32_bf16 v[168:171], a[192:195], v[36:39], v[168:171]
    ds_read_b64_tr_b16 a[176:177], v2 offset:33376
    ds_read_b64_tr_b16 a[178:179], v2 offset:33888
    v_mfma_f32_16x16x32_bf16 v[168:171], a[196:199], v[44:47], v[168:171]
    ds_read_b64_tr_b16 a[180:181], v2 offset:50016
    ds_read_b64_tr_b16 a[182:183], v2 offset:50528
    v_mfma_f32_16x16x32_bf16 v[224:227], a[200:203], v[32:35], v[224:227]
    s_mov_b32 s40, 1506272
    buffer_load_dwordx4 v3, s[64:67], s42 offen offset:1024 lds
    v_mfma_f32_16x16x32_bf16 v[224:227], a[204:207], v[40:43], v[224:227]
    ds_read_b64_tr_b16 a[184:185], v2 offset:34400
    ds_read_b64_tr_b16 a[186:187], v2 offset:34912
    v_mfma_f32_16x16x32_bf16 v[232:235], a[200:203], v[36:39], v[232:235]
    ds_read_b64_tr_b16 a[188:189], v2 offset:51040
    v_mfma_f32_16x16x32_bf16 v[232:235], a[204:207], v[44:47], v[232:235]
    buffer_load_dwordx4 v3, s[60:63], s43 offen offset:2080 lds
    v_mfma_f32_16x16x32_bf16 v[164:167], a[208:211], v[32:35], v[164:167]
    ds_read_b64_tr_b16 a[190:191], v2 offset:51552
    ds_read_b64_tr_b16 a[192:193], v2 offset:33408
    v_mfma_f32_16x16x32_bf16 v[164:167], a[212:215], v[40:43], v[164:167]
    ds_read_b64_tr_b16 a[194:195], v2 offset:33920
    ds_read_b64_tr_b16 a[196:197], v2 offset:50048
    v_mfma_f32_16x16x32_bf16 v[172:175], a[208:211], v[36:39], v[172:175]
    buffer_load_dwordx4 v3, s[64:67], s40 offen offset:3104 lds
    v_mfma_f32_16x16x32_bf16 v[172:175], a[212:215], v[44:47], v[172:175]
    ds_read_b64_tr_b16 a[198:199], v2 offset:50560
    ds_read_b64_tr_b16 a[200:201], v2 offset:34432
    v_mfma_f32_16x16x32_bf16 v[228:231], a[216:219], v[32:35], v[228:231]
    ds_read_b64_tr_b16 a[202:203], v2 offset:34944
    v_mfma_f32_16x16x32_bf16 v[228:231], a[220:223], v[40:43], v[228:231]
    buffer_load_dwordx4 v[96:99], v10, s[20:23], s13 offen offset:1280 sc1
    v_mfma_f32_16x16x32_bf16 v[236:239], a[216:219], v[36:39], v[236:239]
    ds_read_b64_tr_b16 a[204:205], v2 offset:51072
    ds_read_b64_tr_b16 a[206:207], v2 offset:51584
    v_mfma_f32_16x16x32_bf16 v[236:239], a[220:223], v[44:47], v[236:239]
    ds_read_b64_tr_b16 a[208:209], v2 offset:33440
    ds_read_b64_tr_b16 a[210:211], v2 offset:33952
    v_mfma_f32_16x16x32_bf16 v[176:179], a[224:227], v[32:35], v[176:179]
    buffer_load_dwordx4 v[100:103], v10, s[20:23], s16 offen offset:1280 sc1
    v_mfma_f32_16x16x32_bf16 v[176:179], a[228:231], v[40:43], v[176:179]
    ds_read_b64_tr_b16 a[212:213], v2 offset:50080
    ds_read_b64_tr_b16 a[214:215], v2 offset:50592
    v_mfma_f32_16x16x32_bf16 v[184:187], a[224:227], v[36:39], v[184:187]
    ds_read_b64_tr_b16 a[216:217], v2 offset:34464
    v_mfma_f32_16x16x32_bf16 v[184:187], a[228:231], v[44:47], v[184:187]
    buffer_load_dwordx4 v[104:107], v10, s[20:23], s13 offen offset:1408 sc1
    v_mfma_f32_16x16x32_bf16 v[240:243], a[232:235], v[32:35], v[240:243]
    ds_read_b64_tr_b16 a[218:219], v2 offset:34976
    ds_read_b64_tr_b16 a[220:221], v2 offset:51104
    v_mfma_f32_16x16x32_bf16 v[240:243], a[236:239], v[40:43], v[240:243]
    s_waitcnt vmcnt(36)
    ds_read_b64_tr_b16 a[222:223], v2 offset:51616
    v_max3_u32 v0, v48, v52, v56
    v_mfma_f32_16x16x32_bf16 v[248:251], a[232:235], v[36:39], v[248:251]
    buffer_load_dwordx4 v[108:111], v10, s[20:23], s16 offen offset:1408 sc1
    v_mfma_f32_16x16x32_bf16 v[248:251], a[236:239], v[44:47], v[248:251]
    ds_read_b64_tr_b16 a[224:225], v2 offset:33472
    ds_read_b64_tr_b16 a[226:227], v2 offset:33984
    v_mfma_f32_16x16x32_bf16 v[180:183], a[240:243], v[32:35], v[180:183]
    s_waitcnt vmcnt(36)
    ds_read_b64_tr_b16 a[228:229], v2 offset:50112
    v_max_u32 v0, v0, v60
    v_mfma_f32_16x16x32_bf16 v[180:183], a[244:247], v[40:43], v[180:183]
    ds_read_b64_tr_b16 a[230:231], v2 offset:50624
    v_cmp_eq_u32 vcc, -1, v0
    v_mfma_f32_16x16x32_bf16 v[188:191], a[240:243], v[36:39], v[188:191]
    buffer_load_dwordx4 v[112:115], v10, s[20:23], s13 offen offset:1536 sc1
    v_mfma_f32_16x16x32_bf16 v[188:191], a[244:247], v[44:47], v[188:191]
    ds_read_b64_tr_b16 a[232:233], v2 offset:34496
    ds_read_b64_tr_b16 a[234:235], v2 offset:35008
    v_mfma_f32_16x16x32_bf16 v[244:247], a[248:251], v[32:35], v[244:247]
    ds_read_b64_tr_b16 a[236:237], v2 offset:51136
    ds_read_b64_tr_b16 a[238:239], v2 offset:51648
    v_mfma_f32_16x16x32_bf16 v[244:247], a[252:255], v[40:43], v[244:247]
    buffer_load_dwordx4 v[116:119], v10, s[20:23], s16 offen offset:1536 sc1
    v_mfma_f32_16x16x32_bf16 v[252:255], a[248:251], v[36:39], v[252:255]
    ds_read_b64_tr_b16 a[240:241], v2 offset:33504
    ds_read_b64_tr_b16 a[242:243], v2 offset:34016
    v_mfma_f32_16x16x32_bf16 v[252:255], a[252:255], v[44:47], v[252:255]
    s_cbranch_vccnz L4_g2
L4_g2b:
    ds_read_b64_tr_b16 a[244:245], v2 offset:50144
    ds_read_b64_tr_b16 a[246:247], v2 offset:50656
    v_mfma_f32_16x16x32_bf16 v[128:131], a[0:3], v[48:51], v[128:131]
    s_add_u32 m0, s92, 134656
    buffer_load_dwordx4 v[120:123], v10, s[20:23], s13 offen offset:1664 sc1
    v_mfma_f32_16x16x32_bf16 v[128:131], a[4:7], v[56:59], v[128:131]
    s_add_u32 s45, s94, 0
    ds_read_b64_tr_b16 a[248:249], v2 offset:34528
    ds_read_b64_tr_b16 a[250:251], v2 offset:35040
    v_mfma_f32_16x16x32_bf16 v[136:139], a[0:3], v[52:55], v[136:139]
    buffer_load_dwordx4 v[124:127], v10, s[20:23], s16 offen offset:1664 sc1
    v_mfma_f32_16x16x32_bf16 v[136:139], a[4:7], v[60:63], v[136:139]
    ds_read_b64_tr_b16 a[252:253], v2 offset:51168
    ds_read_b64_tr_b16 a[254:255], v2 offset:51680
    v_mfma_f32_16x16x32_bf16 v[192:195], a[8:11], v[48:51], v[192:195]
    s_add_u32 s46, s94, 6144
    v_mfma_f32_16x16x32_bf16 v[192:195], a[12:15], v[56:59], v[192:195]
    buffer_load_dwordx4 v9, s[68:71], s45 offen offset:0 lds
    v_mfma_f32_16x16x32_bf16 v[200:203], a[8:11], v[52:55], v[200:203]
    v_mfma_f32_16x16x32_bf16 v[200:203], a[12:15], v[60:63], v[200:203]
    v_mfma_f32_16x16x32_bf16 v[132:135], a[16:19], v[48:51], v[132:135]
    v_mfma_f32_16x16x32_bf16 v[132:135], a[20:23], v[56:59], v[132:135]
    s_add_u32 s47, s94, 12288
    v_mfma_f32_16x16x32_bf16 v[140:143], a[16:19], v[52:55], v[140:143]
    s_waitcnt lgkmcnt(0) vmcnt(33)
    v_mfma_f32_16x16x32_bf16 v[140:143], a[20:23], v[60:63], v[140:143]
    s_barrier
    buffer_load_dwordx4 v9, s[68:71], s46 offen offset:1024 lds
    v_mfma_f32_16x16x32_bf16 v[196:199], a[24:27], v[48:51], v[196:199]
    ds_read_b64_tr_b16 a[0:1], v1 offset:0
    ds_read_b64_tr_b16 a[2:3], v1 offset:512
    v_mfma_f32_16x16x32_bf16 v[196:199], a[28:31], v[56:59], v[196:199]
    ds_read_b64_tr_b16 a[4:5], v1 offset:16640
    v_mfma_f32_16x16x32_bf16 v[204:207], a[24:27], v[52:55], v[204:207]
    s_add_u32 s44, s94, 18432
    ds_read_b64_tr_b16 a[6:7], v1 offset:17152
    v_mfma_f32_16x16x32_bf16 v[204:207], a[28:31], v[60:63], v[204:207]
    buffer_load_dwordx4 v9, s[68:71], s47 offen offset:2048 lds
    v_mfma_f32_16x16x32_bf16 v[144:147], a[32:35], v[48:51], v[144:147]
    ds_read_b64_tr_b16 a[8:9], v1 offset:1024
    ds_read_b64_tr_b16 a[10:11], v1 offset:1536
    v_mfma_f32_16x16x32_bf16 v[144:147], a[36:39], v[56:59], v[144:147]
    ds_read_b64_tr_b16 a[12:13], v1 offset:17664
    v_mfma_f32_16x16x32_bf16 v[152:155], a[32:35], v[52:55], v[152:155]
    ds_read_b64_tr_b16 a[14:15], v1 offset:18176
    v_mfma_f32_16x16x32_bf16 v[152:155], a[36:39], v[60:63], v[152:155]
    s_add_u32 s45, s94, 28672
    ds_read_b64_tr_b16 a[16:17], v1 offset:32
    ds_read_b64_tr_b16 a[18:19], v1 offset:544
    v_mfma_f32_16x16x32_bf16 v[208:211], a[40:43], v[48:51], v[208:211]
    buffer_load_dwordx4 v9, s[68:71], s44 offen offset:3072 lds
    v_mfma_f32_16x16x32_bf16 v[208:211], a[44:47], v[56:59], v[208:211]
    s_add_u32 m0, s92, 33280
    ds_read_b64_tr_b16 a[20:21], v1 offset:16672
    ds_read_b64_tr_b16 a[22:23], v1 offset:17184
    v_mfma_f32_16x16x32_bf16 v[216:219], a[40:43], v[52:55], v[216:219]
    ds_read_b64_tr_b16 a[24:25], v1 offset:1056
    v_mfma_f32_16x16x32_bf16 v[216:219], a[44:47], v[60:63], v[216:219]
    ds_read_b64_tr_b16 a[26:27], v1 offset:1568
    v_mfma_f32_16x16x32_bf16 v[148:151], a[48:51], v[48:51], v[148:151]
    s_add_u32 s46, s94, 34816
    ds_read_b64_tr_b16 a[28:29], v1 offset:17696
    v_mfma_f32_16x16x32_bf16 v[148:151], a[52:55], v[56:59], v[148:151]
    buffer_load_dwordx4 v9, s[68:71], s45 offen offset:0 lds
    v_mfma_f32_16x16x32_bf16 v[156:159], a[48:51], v[52:55], v[156:159]
    ds_read_b64_tr_b16 a[30:31], v1 offset:18208
    ds_read_b64_tr_b16 a[32:33], v1 offset:64
    v_mfma_f32_16x16x32_bf16 v[156:159], a[52:55], v[60:63], v[156:159]
    ds_read_b64_tr_b16 a[34:35], v1 offset:576
    ds_read_b64_tr_b16 a[36:37], v1 offset:16704
    v_mfma_f32_16x16x32_bf16 v[212:215], a[56:59], v[48:51], v[212:215]
    ds_read_b64_tr_b16 a[38:39], v1 offset:17216
    v_mfma_f32_16x16x32_bf16 v[212:215], a[60:63], v[56:59], v[212:215]
    s_add_u32 s47, s94, 40960
    ds_read_b64_tr_b16 a[40:41], v1 offset:1088
    v_mfma_f32_16x16x32_bf16 v[220:223], a[56:59], v[52:55], v[220:223]
    buffer_load_dwordx4 v9, s[68:71], s46 offen offset:1024 lds
    v_mfma_f32_16x16x32_bf16 v[220:223], a[60:63], v[60:63], v[220:223]
    ds_read_b64_tr_b16 a[42:43], v1 offset:1600
    ds_read_b64_tr_b16 a[44:45], v1 offset:17728
    v_mfma_f32_16x16x32_bf16 v[160:163], a[64:67], v[48:51], v[160:163]
    ds_read_b64_tr_b16 a[46:47], v1 offset:18240
    v_mfma_f32_16x16x32_bf16 v[160:163], a[68:71], v[56:59], v[160:163]
    ds_read_b64_tr_b16 a[48:49], v1 offset:96
    ds_read_b64_tr_b16 a[50:51], v1 offset:608
    v_mfma_f32_16x16x32_bf16 v[168:171], a[64:67], v[52:55], v[168:171]
    s_add_u32 s44, s94, 47104
    ds_read_b64_tr_b16 a[52:53], v1 offset:16736
    v_mfma_f32_16x16x32_bf16 v[168:171], a[68:71], v[60:63], v[168:171]
    buffer_load_dwordx4 v9, s[68:71], s47 offen offset:2048 lds
    v_mfma_f32_16x16x32_bf16 v[224:227], a[72:75], v[48:51], v[224:227]
    ds_read_b64_tr_b16 a[54:55], v1 offset:17248
    ds_read_b64_tr_b16 a[56:57], v1 offset:1120
    v_mfma_f32_16x16x32_bf16 v[224:227], a[76:79], v[56:59], v[224:227]
    ds_read_b64_tr_b16 a[58:59], v1 offset:1632
    v_mfma_f32_16x16x32_bf16 v[232:235], a[72:75], v[52:55], v[232:235]
    ds_read_b64_tr_b16 a[60:61], v1 offset:17760
    v_mfma_f32_16x16x32_bf16 v[232:235], a[76:79], v[60:63], v[232:235]
    s_add_u32 s45, s94, 57344
    ds_read_b64_tr_b16 a[62:63], v1 offset:18272
    v_mfma_f32_16x16x32_bf16 v[164:167], a[80:83], v[48:51], v[164:167]
    buffer_load_dwordx4 v9, s[68:71], s44 offen offset:3072 lds
    v_mfma_f32_16x16x32_bf16 v[164:167], a[84:87], v[56:59], v[164:167]
    s_add_u32 m0, s92, 49664
    ds_read_b64_tr_b16 a[64:65], v1 offset:128
    ds_read_b64_tr_b16 a[66:67], v1 offset:640
    v_mfma_f32_16x16x32_bf16 v[172:175], a[80:83], v[52:55], v[172:175]
    ds_read_b64_tr_b16 a[68:69], v1 offset:16768
    ds_read_b64_tr_b16 a[70:71], v1 offset:17280
    v_mfma_f32_16x16x32_bf16 v[172:175], a[84:87], v[60:63], v[172:175]
    ds_read_b64_tr_b16 a[72:73], v1 offset:1152
    v_mfma_f32_16x16x32_bf16 v[228:231], a[88:91], v[48:51], v[228:231]
    s_add_u32 s46, s94, 63488
    ds_read_b64_tr_b16 a[74:75], v1 offset:1664
    v_mfma_f32_16x16x32_bf16 v[228:231], a[92:95], v[56:59], v[228:231]
    buffer_load_dwordx4 v9, s[68:71], s45 offen offset:0 lds
    v_mfma_f32_16x16x32_bf16 v[236:239], a[88:91], v[52:55], v[236:239]
    ds_read_b64_tr_b16 a[76:77], v1 offset:17792
    ds_read_b64_tr_b16 a[78:79], v1 offset:18304
    v_mfma_f32_16x16x32_bf16 v[236:239], a[92:95], v[60:63], v[236:239]
    ds_read_b64_tr_b16 a[80:81], v1 offset:160
    ds_read_b64_tr_b16 a[82:83], v1 offset:672
    v_mfma_f32_16x16x32_bf16 v[176:179], a[96:99], v[48:51], v[176:179]
    ds_read_b64_tr_b16 a[84:85], v1 offset:16800
    v_mfma_f32_16x16x32_bf16 v[176:179], a[100:103], v[56:59], v[176:179]
    s_add_u32 s47, s94, 69632
    ds_read_b64_tr_b16 a[86:87], v1 offset:17312
    v_mfma_f32_16x16x32_bf16 v[184:187], a[96:99], v[52:55], v[184:187]
    buffer_load_dwordx4 v9, s[68:71], s46 offen offset:1024 lds
    v_mfma_f32_16x16x32_bf16 v[184:187], a[100:103], v[60:63], v[184:187]
    ds_read_b64_tr_b16 a[88:89], v1 offset:1184
    ds_read_b64_tr_b16 a[90:91], v1 offset:1696
    v_mfma_f32_16x16x32_bf16 v[240:243], a[104:107], v[48:51], v[240:243]
    s_waitcnt vmcnt(39)
    ds_read_b64_tr_b16 a[92:93], v1 offset:17824
    v_max3_u32 v0, v64, v68, v72
    v_mfma_f32_16x16x32_bf16 v[240:243], a[108:111], v[56:59], v[240:243]
    s_waitcnt vmcnt(38)
    ds_read_b64_tr_b16 a[94:95], v1 offset:18336
    v_max_u32 v0, v0, v76
    v_mfma_f32_16x16x32_bf16 v[248:251], a[104:107], v[52:55], v[248:251]
    s_add_u32 s44, s94, 75776
    ds_read_b64_tr_b16 a[96:97], v1 offset:192
    ds_read_b64_tr_b16 a[98:99], v1 offset:704
    v_mfma_f32_16x16x32_bf16 v[248:251], a[108:111], v[60:63], v[248:251]
    buffer_load_dwordx4 v9, s[68:71], s47 offen offset:2048 lds
    v_mfma_f32_16x16x32_bf16 v[180:183], a[112:115], v[48:51], v[180:183]
    ds_read_b64_tr_b16 a[100:101], v1 offset:16832
    v_cmp_eq_u32 vcc, -1, v0
    v_mfma_f32_16x16x32_bf16 v[180:183], a[116:119], v[56:59], v[180:183]
    ds_read_b64_tr_b16 a[102:103], v1 offset:17344
    ds_read_b64_tr_b16 a[104:105], v1 offset:1216
    v_mfma_f32_16x16x32_bf16 v[188:191], a[112:115], v[52:55], v[188:191]
    ds_read_b64_tr_b16 a[106:107], v1 offset:1728
    v_mfma_f32_16x16x32_bf16 v[188:191], a[116:119], v[60:63], v[188:191]
    ds_read_b64_tr_b16 a[108:109], v1 offset:17856
    v_mfma_f32_16x16x32_bf16 v[244:247], a[120:123], v[48:51], v[244:247]
    buffer_load_dwordx4 v9, s[68:71], s44 offen offset:3072 lds
    v_mfma_f32_16x16x32_bf16 v[244:247], a[124:127], v[56:59], v[244:247]
    ds_read_b64_tr_b16 a[110:111], v1 offset:18368
    ds_read_b64_tr_b16 a[112:113], v1 offset:224
    v_mfma_f32_16x16x32_bf16 v[252:255], a[120:123], v[52:55], v[252:255]
    ds_read_b64_tr_b16 a[114:115], v1 offset:736
    ds_read_b64_tr_b16 a[116:117], v1 offset:16864
    v_mfma_f32_16x16x32_bf16 v[252:255], a[124:127], v[60:63], v[252:255]
    s_cbranch_vccnz L4_g3
L4_g3b:
    ds_read_b64_tr_b16 a[118:119], v1 offset:17376
    v_mfma_f32_16x16x32_bf16 v[128:131], a[128:131], v[64:67], v[128:131]
    ds_read_b64_tr_b16 a[120:121], v1 offset:1248
    v_mfma_f32_16x16x32_bf16 v[128:131], a[132:135], v[72:75], v[128:131]
    ds_read_b64_tr_b16 a[122:123], v1 offset:1760
    v_mfma_f32_16x16x32_bf16 v[136:139], a[128:131], v[68:71], v[136:139]
    ds_read_b64_tr_b16 a[124:125], v1 offset:17888
    v_mfma_f32_16x16x32_bf16 v[136:139], a[132:135], v[76:79], v[136:139]
    ds_read_b64_tr_b16 a[126:127], v1 offset:18400
    v_mfma_f32_16x16x32_bf16 v[192:195], a[136:139], v[64:67], v[192:195]
    v_mfma_f32_16x16x32_bf16 v[192:195], a[140:143], v[72:75], v[192:195]
    v_mfma_f32_16x16x32_bf16 v[200:203], a[136:139], v[68:71], v[200:203]
    s_add_u32 m0, s92, 68096
    v_mfma_f32_16x16x32_bf16 v[200:203], a[140:143], v[76:79], v[200:203]
    s_add_u32 s45, s94, 86016
    v_mfma_f32_16x16x32_bf16 v[132:135], a[144:147], v[64:67], v[132:135]
    v_mfma_f32_16x16x32_bf16 v[132:135], a[148:151], v[72:75], v[132:135]
    v_mfma_f32_16x16x32_bf16 v[140:143], a[144:147], v[68:71], v[140:143]
    s_waitcnt lgkmcnt(0) vmcnt(32)
    v_mfma_f32_16x16x32_bf16 v[140:143], a[148:151], v[76:79], v[140:143]
    s_barrier
    v_mfma_f32_16x16x32_bf16 v[196:199], a[152:155], v[64:67], v[196:199]
    s_add_u32 s46, s94, 92160
    buffer_load_dwordx4 v9, s[68:71], s45 offen offset:0 lds
    v_mfma_f32_16x16x32_bf16 v[196:199], a[156:159], v[72:75], v[196:199]
    ds_read_b64_tr_b16 a[128:129], v1 offset:33280
    ds_read_b64_tr_b16 a[130:131], v1 offset:33792
    v_mfma_f32_16x16x32_bf16 v[204:207], a[152:155], v[68:71], v[204:207]
    ds_read_b64_tr_b16 a[132:133], v1 offset:49920
    ds_read_b64_tr_b16 a[134:135], v1 offset:50432
    v_mfma_f32_16x16x32_bf16 v[204:207], a[156:159], v[76:79], v[204:207]
    ds_read_b64_tr_b16 a[136:137], v1 offset:34304
    v_mfma_f32_16x16x32_bf16 v[144:147], a[160:163], v[64:67], v[144:147]
    s_add_u32 s47, s94, 98304
    ds_read_b64_tr_b16 a[138:139], v1 offset:34816
    v_mfma_f32_16x16x32_bf16 v[144:147], a[164:167], v[72:75], v[144:147]
    buffer_load_dwordx4 v9, s[68:71], s46 offen offset:1024 lds
    v_mfma_f32_16x16x32_bf16 v[152:155], a[160:163], v[68:71], v[152:155]
    ds_read_b64_tr_b16 a[140:141], v1 offset:50944
    ds_read_b64_tr_b16 a[142:143], v1 offset:51456
    v_mfma_f32_16x16x32_bf16 v[152:155], a[164:167], v[76:79], v[152:155]
    ds_read_b64_tr_b16 a[144:145], v1 offset:33312
    ds_read_b64_tr_b16 a[146:147], v1 offset:33824
    v_mfma_f32_16x16x32_bf16 v[208:211], a[168:171], v[64:67], v[208:211]
    ds_read_b64_tr_b16 a[148:149], v1 offset:49952
    v_mfma_f32_16x16x32_bf16 v[208:211], a[172:175], v[72:75], v[208:211]
    s_add_u32 s44, s94, 104448
    ds_read_b64_tr_b16 a[150:151], v1 offset:50464
    v_mfma_f32_16x16x32_bf16 v[216:219], a[168:171], v[68:71], v[216:219]
    buffer_load_dwordx4 v9, s[68:71], s47 offen offset:2048 lds
    v_mfma_f32_16x16x32_bf16 v[216:219], a[172:175], v[76:79], v[216:219]
    ds_read_b64_tr_b16 a[152:153], v1 offset:34336
    ds_read_b64_tr_b16 a[154:155], v1 offset:34848
    v_mfma_f32_16x16x32_bf16 v[148:151], a[176:179], v[64:67], v[148:151]
    ds_read_b64_tr_b16 a[156:157], v1 offset:50976
    v_mfma_f32_16x16x32_bf16 v[148:151], a[180:183], v[72:75], v[148:151]
    ds_read_b64_tr_b16 a[158:159], v1 offset:51488
    v_mfma_f32_16x16x32_bf16 v[156:159], a[176:179], v[68:71], v[156:159]
    s_add_u32 s45, s94, 114688
    ds_read_b64_tr_b16 a[160:161], v1 offset:33344
    ds_read_b64_tr_b16 a[162:163], v1 offset:33856
    v_mfma_f32_16x16x32_bf16 v[156:159], a[180:183], v[76:79], v[156:159]
    buffer_load_dwordx4 v9, s[68:71], s44 offen offset:3072 lds
    v_mfma_f32_16x16x32_bf16 v[212:215], a[184:187], v[64:67], v[212:215]
    s_add_u32 m0, s92, 84480
    ds_read_b64_tr_b16 a[164:165], v1 offset:49984
    ds_read_b64_tr_b16 a[166:167], v1 offset:50496
    v_mfma_f32_16x16x32_bf16 v[212:215], a[188:191], v[72:75], v[212:215]
    ds_read_b64_tr_b16 a[168:169], v1 offset:34368
    v_mfma_f32_16x16x32_bf16 v[220:223], a[184:187], v[68:71], v[220:223]
    ds_read_b64_tr_b16 a[170:171], v1 offset:34880
    v_mfma_f32_16x16x32_bf16 v[220:223], a[188:191], v[76:79], v[220:223]
    s_add_u32 s46, s94, 120832
    ds_read_b64_tr_b16 a[172:173], v1 offset:51008
    v_mfma_f32_16x16x32_bf16 v[160:163], a[192:195], v[64:67], v[160:163]
    buffer_load_dwordx4 v9, s[68:71], s45 offen offset:0 lds
    v_mfma_f32_16x16x32_bf16 v[160:163], a[196:199], v[72:75], v[160:163]
    ds_read_b64_tr_b16 a[174:175], v1 offset:51520
    ds_read_b64_tr_b16 a[176:177], v1 offset:33376
    v_mfma_f32_16x16x32_bf16 v[168:171], a[192:195], v[68:71], v[168:171]
    ds_read_b64_tr_b16 a[178:179], v1 offset:33888
    ds_read_b64_tr_b16 a[180:181], v1 offset:50016
    v_mfma_f32_16x16x32_bf16 v[168:171], a[196:199], v[76:79], v[168:171]
    ds_read_b64_tr_b16 a[182:183], v1 offset:50528
    v_mfma_f32_16x16x32_bf16 v[224:227], a[200:203], v[64:67], v[224:227]
    s_add_u32 s47, s94, 126976
    ds_read_b64_tr_b16 a[184:185], v1 offset:34400
    v_mfma_f32_16x16x32_bf16 v[224:227], a[204:207], v[72:75], v[224:227]
    buffer_load_dwordx4 v9, s[68:71], s46 offen offset:1024 lds
    v_mfma_f32_16x16x32_bf16 v[232:235], a[200:203], v[68:71], v[232:235]
    ds_read_b64_tr_b16 a[186:187], v1 offset:34912
    ds_read_b64_tr_b16 a[188:189], v1 offset:51040
    v_mfma_f32_16x16x32_bf16 v[232:235], a[204:207], v[76:79], v[232:235]
    ds_read_b64_tr_b16 a[190:191], v1 offset:51552
    v_mfma_f32_16x16x32_bf16 v[164:167], a[208:211], v[64:67], v[164:167]
    ds_read_b64_tr_b16 a[192:193], v1 offset:33408
    ds_read_b64_tr_b16 a[194:195], v1 offset:33920
    v_mfma_f32_16x16x32_bf16 v[164:167], a[212:215], v[72:75], v[164:167]
    s_add_u32 s44, s94, 133120
    ds_read_b64_tr_b16 a[196:197], v1 offset:50048
    v_mfma_f32_16x16x32_bf16 v[172:175], a[208:211], v[68:71], v[172:175]
    buffer_load_dwordx4 v9, s[68:71], s47 offen offset:2048 lds
    v_mfma_f32_16x16x32_bf16 v[172:175], a[212:215], v[76:79], v[172:175]
    ds_read_b64_tr_b16 a[198:199], v1 offset:50560
    ds_read_b64_tr_b16 a[200:201], v1 offset:34432
    v_mfma_f32_16x16x32_bf16 v[228:231], a[216:219], v[64:67], v[228:231]
    ds_read_b64_tr_b16 a[202:203], v1 offset:34944
    v_mfma_f32_16x16x32_bf16 v[228:231], a[220:223], v[72:75], v[228:231]
    ds_read_b64_tr_b16 a[204:205], v1 offset:51072
    v_mfma_f32_16x16x32_bf16 v[236:239], a[216:219], v[68:71], v[236:239]
    ds_read_b64_tr_b16 a[206:207], v1 offset:51584
    v_mfma_f32_16x16x32_bf16 v[236:239], a[220:223], v[76:79], v[236:239]
    buffer_load_dwordx4 v9, s[68:71], s44 offen offset:3072 lds
    v_mfma_f32_16x16x32_bf16 v[176:179], a[224:227], v[64:67], v[176:179]
    ds_read_b64_tr_b16 a[208:209], v1 offset:33440
    ds_read_b64_tr_b16 a[210:211], v1 offset:33952
    v_mfma_f32_16x16x32_bf16 v[176:179], a[228:231], v[72:75], v[176:179]
    ds_read_b64_tr_b16 a[212:213], v1 offset:50080
    ds_read_b64_tr_b16 a[214:215], v1 offset:50592
    v_mfma_f32_16x16x32_bf16 v[184:187], a[224:227], v[68:71], v[184:187]
    ds_read_b64_tr_b16 a[216:217], v1 offset:34464
    v_mfma_f32_16x16x32_bf16 v[184:187], a[228:231], v[76:79], v[184:187]
    ds_read_b64_tr_b16 a[218:219], v1 offset:34976
    v_mfma_f32_16x16x32_bf16 v[240:243], a[232:235], v[64:67], v[240:243]
    s_waitcnt vmcnt(37)
    ds_read_b64_tr_b16 a[220:221], v1 offset:51104
    v_max3_u32 v0, v80, v84, v88
    v_mfma_f32_16x16x32_bf16 v[240:243], a[236:239], v[72:75], v[240:243]
    buffer_load_dword v18, v15, s[68:71], s49 offen
    v_mfma_f32_16x16x32_bf16 v[248:251], a[232:235], v[68:71], v[248:251]
    ds_read_b64_tr_b16 a[222:223], v1 offset:51616
    ds_read_b64_tr_b16 a[224:225], v1 offset:33472
    v_mfma_f32_16x16x32_bf16 v[248:251], a[236:239], v[76:79], v[248:251]
    ds_read_b64_tr_b16 a[226:227], v1 offset:33984
    ds_read_b64_tr_b16 a[228:229], v1 offset:50112
    v_mfma_f32_16x16x32_bf16 v[180:183], a[240:243], v[64:67], v[180:183]
    s_waitcnt vmcnt(37)
    v_max_u32 v0, v0, v92
    v_cmp_eq_u32 vcc, -1, v0
    v_mfma_f32_16x16x32_bf16 v[180:183], a[244:247], v[72:75], v[180:183]
    ds_read_b64_tr_b16 a[230:231], v1 offset:50624
    ds_read_b64_tr_b16 a[232:233], v1 offset:34496
    v_mfma_f32_16x16x32_bf16 v[188:191], a[240:243], v[68:71], v[188:191]
    ds_read_b64_tr_b16 a[234:235], v1 offset:35008
    v_mfma_f32_16x16x32_bf16 v[188:191], a[244:247], v[76:79], v[188:191]
    ds_read_b64_tr_b16 a[236:237], v1 offset:51136
    v_mfma_f32_16x16x32_bf16 v[244:247], a[248:251], v[64:67], v[244:247]
    ds_read_b64_tr_b16 a[238:239], v1 offset:51648
    v_mfma_f32_16x16x32_bf16 v[244:247], a[252:255], v[72:75], v[244:247]
    ds_read_b64_tr_b16 a[240:241], v1 offset:33504
    ds_read_b64_tr_b16 a[242:243], v1 offset:34016
    v_mfma_f32_16x16x32_bf16 v[252:255], a[248:251], v[68:71], v[252:255]
    ds_read_b64_tr_b16 a[244:245], v1 offset:50144
    v_mfma_f32_16x16x32_bf16 v[252:255], a[252:255], v[76:79], v[252:255]
    s_cbranch_vccnz L4_g4
L4_g4b:
    ds_read_b64_tr_b16 a[246:247], v1 offset:50656
    v_mfma_f32_16x16x32_bf16 v[128:131], a[0:3], v[80:83], v[128:131]
    ds_read_b64_tr_b16 a[248:249], v1 offset:34528
    v_mfma_f32_16x16x32_bf16 v[128:131], a[4:7], v[88:91], v[128:131]
    ds_read_b64_tr_b16 a[250:251], v1 offset:35040
    v_mfma_f32_16x16x32_bf16 v[136:139], a[0:3], v[84:87], v[136:139]
    ds_read_b64_tr_b16 a[252:253], v1 offset:51168
    v_mfma_f32_16x16x32_bf16 v[136:139], a[4:7], v[92:95], v[136:139]
    ds_read_b64_tr_b16 a[254:255], v1 offset:51680
    v_mfma_f32_16x16x32_bf16 v[192:195], a[8:11], v[80:83], v[192:195]
    v_mfma_f32_16x16x32_bf16 v[192:195], a[12:15], v[88:91], v[192:195]
    v_mfma_f32_16x16x32_bf16 v[200:203], a[8:11], v[84:87], v[200:203]
    s_add_u32 m0, s92, 101376
    v_mfma_f32_16x16x32_bf16 v[200:203], a[12:15], v[92:95], v[200:203]
    s_add_u32 s45, s94, 143360
    v_mfma_f32_16x16x32_bf16 v[132:135], a[16:19], v[80:83], v[132:135]
    v_mfma_f32_16x16x32_bf16 v[132:135], a[20:23], v[88:91], v[132:135]
    v_mfma_f32_16x16x32_bf16 v[140:143], a[16:19], v[84:87], v[140:143]
    s_waitcnt lgkmcnt(0) vmcnt(29)
    v_mfma_f32_16x16x32_bf16 v[140:143], a[20:23], v[92:95], v[140:143]
    s_barrier
    v_mfma_f32_16x16x32_bf16 v[196:199], a[24:27], v[80:83], v[196:199]
    s_add_u32 s46, s94, 149504
    buffer_load_dwordx4 v9, s[68:71], s45 offen offset:0 lds
    v_mfma_f32_16x16x32_bf16 v[196:199], a[28:31], v[88:91], v[196:199]
    ds_read_b64_tr_b16 a[0:1], v2 offset:0
    ds_read_b64_tr_b16 a[2:3], v2 offset:512
    v_mfma_f32_16x16x32_bf16 v[204:207], a[24:27], v[84:87], v[204:207]
    ds_read_b64_tr_b16 a[4:5], v2 offset:16640
    ds_read_b64_tr_b16 a[6:7], v2 offset:17152
    v_mfma_f32_16x16x32_bf16 v[204:207], a[28:31], v[92:95], v[204:207]
    ds_read_b64_tr_b16 a[8:9], v2 offset:1024
    v_mfma_f32_16x16x32_bf16 v[144:147], a[32:35], v[80:83], v[144:147]
    s_add_u32 s47, s94, 155648
    ds_read_b64_tr_b16 a[10:11], v2 offset:1536
    v_mfma_f32_16x16x32_bf16 v[144:147], a[36:39], v[88:91], v[144:147]
    buffer_load_dwordx4 v9, s[68:71], s46 offen offset:1024 lds
    v_mfma_f32_16x16x32_bf16 v[152:155], a[32:35], v[84:87], v[152:155]
    ds_read_b64_tr_b16 a[12:13], v2 offset:17664
    ds_read_b64_tr_b16 a[14:15], v2 offset:18176
    v_mfma_f32_16x16x32_bf16 v[152:155], a[36:39], v[92:95], v[152:155]
    ds_read_b64_tr_b16 a[16:17], v2 offset:32
    ds_read_b64_tr_b16 a[18:19], v2 offset:544
    v_mfma_f32_16x16x32_bf16 v[208:211], a[40:43], v[80:83], v[208:211]
    ds_read_b64_tr_b16 a[20:21], v2 offset:16672
    v_mfma_f32_16x16x32_bf16 v[208:211], a[44:47], v[88:91], v[208:211]
    s_add_u32 s44, s94, 161792
    ds_read_b64_tr_b16 a[22:23], v2 offset:17184
    v_mfma_f32_16x16x32_bf16 v[216:219], a[40:43], v[84:87], v[216:219]
    buffer_load_dwordx4 v9, s[68:71], s47 offen offset:2048 lds
    v_mfma_f32_16x16x32_bf16 v[216:219], a[44:47], v[92:95], v[216:219]
    ds_read_b64_tr_b16 a[24:25], v2 offset:1056
    ds_read_b64_tr_b16 a[26:27], v2 offset:1568
    v_mfma_f32_16x16x32_bf16 v[148:151], a[48:51], v[80:83], v[148:151]
    ds_read_b64_tr_b16 a[28:29], v2 offset:17696
    v_mfma_f32_16x16x32_bf16 v[148:151], a[52:55], v[88:91], v[148:151]
    ds_read_b64_tr_b16 a[30:31], v2 offset:18208
    v_mfma_f32_16x16x32_bf16 v[156:159], a[48:51], v[84:87], v[156:159]
    s_add_u32 s45, s94, 172032
    ds_read_b64_tr_b16 a[32:33], v2 offset:64
    ds_read_b64_tr_b16 a[34:35], v2 offset:576
    v_mfma_f32_16x16x32_bf16 v[156:159], a[52:55], v[92:95], v[156:159]
    buffer_load_dwordx4 v9, s[68:71], s44 offen offset:3072 lds
    v_mfma_f32_16x16x32_bf16 v[212:215], a[56:59], v[80:83], v[212:215]
    s_add_u32 m0, s92, 117760
    ds_read_b64_tr_b16 a[36:37], v2 offset:16704
    ds_read_b64_tr_b16 a[38:39], v2 offset:17216
    v_mfma_f32_16x16x32_bf16 v[212:215], a[60:63], v[88:91], v[212:215]
    ds_read_b64_tr_b16 a[40:41], v2 offset:1088
    v_mfma_f32_16x16x32_bf16 v[220:223], a[56:59], v[84:87], v[220:223]
    ds_read_b64_tr_b16 a[42:43], v2 offset:1600
    v_mfma_f32_16x16x32_bf16 v[220:223], a[60:63], v[92:95], v[220:223]
    s_add_u32 s46, s94, 178176
    ds_read_b64_tr_b16 a[44:45], v2 offset:17728
    v_mfma_f32_16x16x32_bf16 v[160:163], a[64:67], v[80:83], v[160:163]
    buffer_load_dwordx4 v9, s[68:71], s45 offen offset:0 lds
    v_mfma_f32_16x16x32_bf16 v[160:163], a[68:71], v[88:91], v[160:163]
    ds_read_b64_tr_b16 a[46:47], v2 offset:18240
    ds_read_b64_tr_b16 a[48:49], v2 offset:96
    v_mfma_f32_16x16x32_bf16 v[168:171], a[64:67], v[84:87], v[168:171]
    ds_read_b64_tr_b16 a[50:51], v2 offset:608
    ds_read_b64_tr_b16 a[52:53], v2 offset:16736
    v_mfma_f32_16x16x32_bf16 v[168:171], a[68:71], v[92:95], v[168:171]
    ds_read_b64_tr_b16 a[54:55], v2 offset:17248
    v_mfma_f32_16x16x32_bf16 v[224:227], a[72:75], v[80:83], v[224:227]
    s_add_u32 s47, s94, 184320
    ds_read_b64_tr_b16 a[56:57], v2 offset:1120
    v_mfma_f32_16x16x32_bf16 v[224:227], a[76:79], v[88:91], v[224:227]
    buffer_load_dwordx4 v9, s[68:71], s46 offen offset:1024 lds
    v_mfma_f32_16x16x32_bf16 v[232:235], a[72:75], v[84:87], v[232:235]
    ds_read_b64_tr_b16 a[58:59], v2 offset:1632
    ds_read_b64_tr_b16 a[60:61], v2 offset:17760
    v_mfma_f32_16x16x32_bf16 v[232:235], a[76:79], v[92:95], v[232:235]
    ds_read_b64_tr_b16 a[62:63], v2 offset:18272
    v_mfma_f32_16x16x32_bf16 v[164:167], a[80:83], v[80:83], v[164:167]
    ds_read_b64_tr_b16 a[64:65], v2 offset:128
    ds_read_b64_tr_b16 a[66:67], v2 offset:640
    v_mfma_f32_16x16x32_bf16 v[164:167], a[84:87], v[88:91], v[164:167]
    s_add_u32 s44, s94, 190464
    ds_read_b64_tr_b16 a[68:69], v2 offset:16768
    v_mfma_f32_16x16x32_bf16 v[172:175], a[80:83], v[84:87], v[172:175]
    buffer_load_dwordx4 v9, s[68:71], s47 offen offset:2048 lds
    v_mfma_f32_16x16x32_bf16 v[172:175], a[84:87], v[92:95], v[172:175]
    ds_read_b64_tr_b16 a[70:71], v2 offset:17280
    ds_read_b64_tr_b16 a[72:73], v2 offset:1152
    v_mfma_f32_16x16x32_bf16 v[228:231], a[88:91], v[80:83], v[228:231]
    ds_read_b64_tr_b16 a[74:75], v2 offset:1664
    v_add_u32 v15, 0x380, v8
    v_mfma_f32_16x16x32_bf16 v[228:231], a[92:95], v[88:91], v[228:231]
    ds_read_b64_tr_b16 a[76:77], v2 offset:17792
    v_lshlrev_b32 v15, 21, v15
    v_mfma_f32_16x16x32_bf16 v[236:239], a[88:91], v[84:87], v[236:239]
    ds_read_b64_tr_b16 a[78:79], v2 offset:18304
    v_and_b32 v15, 0x80000000, v15
    v_mfma_f32_16x16x32_bf16 v[236:239], a[92:95], v[92:95], v[236:239]
    buffer_load_dwordx4 v9, s[68:71], s44 offen offset:3072 lds
    v_mfma_f32_16x16x32_bf16 v[176:179], a[96:99], v[80:83], v[176:179]
    ds_read_b64_tr_b16 a[80:81], v2 offset:160
    ds_read_b64_tr_b16 a[82:83], v2 offset:672
    v_mfma_f32_16x16x32_bf16 v[176:179], a[100:103], v[88:91], v[176:179]
    ds_read_b64_tr_b16 a[84:85], v2 offset:16800
    ds_read_b64_tr_b16 a[86:87], v2 offset:17312
    v_mfma_f32_16x16x32_bf16 v[184:187], a[96:99], v[84:87], v[184:187]
    ds_read_b64_tr_b16 a[88:89], v2 offset:1184
    v_bfe_u32 v16, v8, 4, 2
    v_mfma_f32_16x16x32_bf16 v[184:187], a[100:103], v[92:95], v[184:187]
    ds_read_b64_tr_b16 a[90:91], v2 offset:1696
    v_lshl_or_b32 v15, v16, 4, v15
    v_mfma_f32_16x16x32_bf16 v[240:243], a[104:107], v[80:83], v[240:243]
    s_waitcnt vmcnt(34)
    ds_read_b64_tr_b16 a[92:93], v2 offset:17824
    v_max3_u32 v0, v96, v100, v104
    v_mfma_f32_16x16x32_bf16 v[240:243], a[108:111], v[88:91], v[240:243]
    s_waitcnt vmcnt(33)
    ds_read_b64_tr_b16 a[94:95], v2 offset:18336
    v_max_u32 v0, v0, v108
    v_mfma_f32_16x16x32_bf16 v[248:251], a[104:107], v[84:87], v[248:251]
    ds_read_b64_tr_b16 a[96:97], v2 offset:192
    ds_read_b64_tr_b16 a[98:99], v2 offset:704
    v_mfma_f32_16x16x32_bf16 v[248:251], a[108:111], v[92:95], v[248:251]
    ds_read_b64_tr_b16 a[100:101], v2 offset:16832
    v_cmp_eq_u32 vcc, -1, v0
    v_mfma_f32_16x16x32_bf16 v[180:183], a[112:115], v[80:83], v[180:183]
    ds_read_b64_tr_b16 a[102:103], v2 offset:17344
    v_bfe_u32 v16, v8, 6, 1
    v_mfma_f32_16x16x32_bf16 v[180:183], a[116:119], v[88:91], v[180:183]
    ds_read_b64_tr_b16 a[104:105], v2 offset:1216
    v_lshl_or_b32 v15, v16, 8, v15
    v_mfma_f32_16x16x32_bf16 v[188:191], a[112:115], v[84:87], v[188:191]
    ds_read_b64_tr_b16 a[106:107], v2 offset:1728
    v_mfma_f32_16x16x32_bf16 v[188:191], a[116:119], v[92:95], v[188:191]
    ds_read_b64_tr_b16 a[108:109], v2 offset:17856
    v_mfma_f32_16x16x32_bf16 v[244:247], a[120:123], v[80:83], v[244:247]
    ds_read_b64_tr_b16 a[110:111], v2 offset:18368
    v_mfma_f32_16x16x32_bf16 v[244:247], a[124:127], v[88:91], v[244:247]
    ds_read_b64_tr_b16 a[112:113], v2 offset:224
    ds_read_b64_tr_b16 a[114:115], v2 offset:736
    v_mfma_f32_16x16x32_bf16 v[252:255], a[120:123], v[84:87], v[252:255]
    ds_read_b64_tr_b16 a[116:117], v2 offset:16864
    v_mfma_f32_16x16x32_bf16 v[252:255], a[124:127], v[92:95], v[252:255]
    s_cbranch_vccnz L4_g5
L4_g5b:
    ds_read_b64_tr_b16 a[118:119], v2 offset:17376
    v_mfma_f32_16x16x32_bf16 v[128:131], a[128:131], v[96:99], v[128:131]
    ds_read_b64_tr_b16 a[120:121], v2 offset:1248
    v_mfma_f32_16x16x32_bf16 v[128:131], a[132:135], v[104:107], v[128:131]
    ds_read_b64_tr_b16 a[122:123], v2 offset:1760
    v_mfma_f32_16x16x32_bf16 v[136:139], a[128:131], v[100:103], v[136:139]
    ds_read_b64_tr_b16 a[124:125], v2 offset:17888
    v_mfma_f32_16x16x32_bf16 v[136:139], a[132:135], v[108:111], v[136:139]
    ds_read_b64_tr_b16 a[126:127], v2 offset:18400
    v_mfma_f32_16x16x32_bf16 v[192:195], a[136:139], v[96:99], v[192:195]
    v_mfma_f32_16x16x32_bf16 v[192:195], a[140:143], v[104:107], v[192:195]
    v_mfma_f32_16x16x32_bf16 v[200:203], a[136:139], v[100:103], v[200:203]
    s_add_u32 m0, s92, 0
    v_mfma_f32_16x16x32_bf16 v[200:203], a[140:143], v[108:111], v[200:203]
    s_add_u32 s45, s94, 200704
    v_mfma_f32_16x16x32_bf16 v[132:135], a[144:147], v[96:99], v[132:135]
    v_mfma_f32_16x16x32_bf16 v[132:135], a[148:151], v[104:107], v[132:135]
    v_mfma_f32_16x16x32_bf16 v[140:143], a[144:147], v[100:103], v[140:143]
    s_waitcnt lgkmcnt(0)
    v_mfma_f32_16x16x32_bf16 v[140:143], a[148:151], v[108:111], v[140:143]
    s_barrier
    v_mfma_f32_16x16x32_bf16 v[196:199], a[152:155], v[96:99], v[196:199]
    s_add_u32 s46, s94, 206848
    buffer_load_dwordx4 v9, s[68:71], s45 offen offset:0 lds
    v_mfma_f32_16x16x32_bf16 v[196:199], a[156:159], v[104:107], v[196:199]
    v_mfma_f32_16x16x32_bf16 v[204:207], a[152:155], v[100:103], v[204:207]
    v_mfma_f32_16x16x32_bf16 v[204:207], a[156:159], v[108:111], v[204:207]
    v_mfma_f32_16x16x32_bf16 v[144:147], a[160:163], v[96:99], v[144:147]
    s_add_u32 s47, s94, 212992
    v_mfma_f32_16x16x32_bf16 v[144:147], a[164:167], v[104:107], v[144:147]
    buffer_load_dwordx4 v9, s[68:71], s46 offen offset:1024 lds
    v_mfma_f32_16x16x32_bf16 v[152:155], a[160:163], v[100:103], v[152:155]
    v_mfma_f32_16x16x32_bf16 v[152:155], a[164:167], v[108:111], v[152:155]
    v_mfma_f32_16x16x32_bf16 v[208:211], a[168:171], v[96:99], v[208:211]
    v_mfma_f32_16x16x32_bf16 v[208:211], a[172:175], v[104:107], v[208:211]
    s_add_u32 s44, s94, 219136
    v_mfma_f32_16x16x32_bf16 v[216:219], a[168:171], v[100:103], v[216:219]
    buffer_load_dwordx4 v9, s[68:71], s47 offen offset:2048 lds
    v_mfma_f32_16x16x32_bf16 v[216:219], a[172:175], v[108:111], v[216:219]
    v_mfma_f32_16x16x32_bf16 v[148:151], a[176:179], v[96:99], v[148:151]
    v_mfma_f32_16x16x32_bf16 v[148:151], a[180:183], v[104:107], v[148:151]
    v_mfma_f32_16x16x32_bf16 v[156:159], a[176:179], v[100:103], v[156:159]
    s_add_u32 s45, s94, 229376
    v_mfma_f32_16x16x32_bf16 v[156:159], a[180:183], v[108:111], v[156:159]
    buffer_load_dwordx4 v9, s[68:71], s44 offen offset:3072 lds
    v_mfma_f32_16x16x32_bf16 v[212:215], a[184:187], v[96:99], v[212:215]
    s_add_u32 m0, s92, 16384
    v_mfma_f32_16x16x32_bf16 v[212:215], a[188:191], v[104:107], v[212:215]
    v_mfma_f32_16x16x32_bf16 v[220:223], a[184:187], v[100:103], v[220:223]
    v_mfma_f32_16x16x32_bf16 v[220:223], a[188:191], v[108:111], v[220:223]
    s_add_u32 s46, s94, 235520
    v_mfma_f32_16x16x32_bf16 v[160:163], a[192:195], v[96:99], v[160:163]
    buffer_load_dwordx4 v9, s[68:71], s45 offen offset:0 lds
    v_mfma_f32_16x16x32_bf16 v[160:163], a[196:199], v[104:107], v[160:163]
    v_mfma_f32_16x16x32_bf16 v[168:171], a[192:195], v[100:103], v[168:171]
    v_mfma_f32_16x16x32_bf16 v[168:171], a[196:199], v[108:111], v[168:171]
    v_mfma_f32_16x16x32_bf16 v[224:227], a[200:203], v[96:99], v[224:227]
    s_add_u32 s47, s94, 241664
    v_mfma_f32_16x16x32_bf16 v[224:227], a[204:207], v[104:107], v[224:227]
    buffer_load_dwordx4 v9, s[68:71], s46 offen offset:1024 lds
    v_mfma_f32_16x16x32_bf16 v[232:235], a[200:203], v[100:103], v[232:235]
    v_mfma_f32_16x16x32_bf16 v[232:235], a[204:207], v[108:111], v[232:235]
    v_mfma_f32_16x16x32_bf16 v[164:167], a[208:211], v[96:99], v[164:167]
    v_mfma_f32_16x16x32_bf16 v[164:167], a[212:215], v[104:107], v[164:167]
    s_add_u32 s44, s94, 247808
    v_mfma_f32_16x16x32_bf16 v[172:175], a[208:211], v[100:103], v[172:175]
    buffer_load_dwordx4 v9, s[68:71], s47 offen offset:2048 lds
    v_mfma_f32_16x16x32_bf16 v[172:175], a[212:215], v[108:111], v[172:175]
    v_mfma_f32_16x16x32_bf16 v[228:231], a[216:219], v[96:99], v[228:231]
    v_mfma_f32_16x16x32_bf16 v[228:231], a[220:223], v[104:107], v[228:231]
    v_mfma_f32_16x16x32_bf16 v[236:239], a[216:219], v[100:103], v[236:239]
    v_mfma_f32_16x16x32_bf16 v[236:239], a[220:223], v[108:111], v[236:239]
    buffer_load_dwordx4 v9, s[68:71], s44 offen offset:3072 lds
    v_mfma_f32_16x16x32_bf16 v[176:179], a[224:227], v[96:99], v[176:179]
    v_mfma_f32_16x16x32_bf16 v[176:179], a[228:231], v[104:107], v[176:179]
    v_mfma_f32_16x16x32_bf16 v[184:187], a[224:227], v[100:103], v[184:187]
    v_mfma_f32_16x16x32_bf16 v[184:187], a[228:231], v[108:111], v[184:187]
    s_waitcnt vmcnt(37)
    v_mfma_f32_16x16x32_bf16 v[240:243], a[232:235], v[96:99], v[240:243]
    s_waitcnt vmcnt(38)
    v_max3_u32 v0, v112, v116, v120
    v_max_u32 v0, v0, v124
    v_mfma_f32_16x16x32_bf16 v[240:243], a[236:239], v[104:107], v[240:243]
    v_cmp_eq_u32 vcc, -1, v0
    v_mfma_f32_16x16x32_bf16 v[248:251], a[232:235], v[100:103], v[248:251]
    v_mfma_f32_16x16x32_bf16 v[248:251], a[236:239], v[108:111], v[248:251]
    v_mfma_f32_16x16x32_bf16 v[180:183], a[240:243], v[96:99], v[180:183]
    v_mfma_f32_16x16x32_bf16 v[180:183], a[244:247], v[104:107], v[180:183]
    v_mfma_f32_16x16x32_bf16 v[188:191], a[240:243], v[100:103], v[188:191]
    v_mfma_f32_16x16x32_bf16 v[188:191], a[244:247], v[108:111], v[188:191]
    v_mfma_f32_16x16x32_bf16 v[244:247], a[248:251], v[96:99], v[244:247]
    v_mfma_f32_16x16x32_bf16 v[244:247], a[252:255], v[104:107], v[244:247]
    v_mfma_f32_16x16x32_bf16 v[252:255], a[248:251], v[100:103], v[252:255]
    v_mfma_f32_16x16x32_bf16 v[252:255], a[252:255], v[108:111], v[252:255]
    s_cbranch_vccnz L4_g6
L4_g6b:
    v_mfma_f32_16x16x32_bf16 v[128:131], a[0:3], v[112:115], v[128:131]
    v_mfma_f32_16x16x32_bf16 v[128:131], a[4:7], v[120:123], v[128:131]
    v_mfma_f32_16x16x32_bf16 v[136:139], a[0:3], v[116:119], v[136:139]
    v_mfma_f32_16x16x32_bf16 v[136:139], a[4:7], v[124:127], v[136:139]
    v_mfma_f32_16x16x32_bf16 v[192:195], a[8:11], v[112:115], v[192:195]
    v_mfma_f32_16x16x32_bf16 v[192:195], a[12:15], v[120:123], v[192:195]
    v_mfma_f32_16x16x32_bf16 v[200:203], a[8:11], v[116:119], v[200:203]
    v_mfma_f32_16x16x32_bf16 v[200:203], a[12:15], v[124:127], v[200:203]
    v_mfma_f32_16x16x32_bf16 v[132:135], a[16:19], v[112:115], v[132:135]
    v_mul_f32 v128, v128, v192
    v_mul_f32 v129, v129, v193
    v_mfma_f32_16x16x32_bf16 v[132:135], a[20:23], v[120:123], v[132:135]
    v_mul_f32 v130, v130, v194
    v_mul_f32 v131, v131, v195
    v_mfma_f32_16x16x32_bf16 v[140:143], a[16:19], v[116:119], v[140:143]
    v_cvt_pk_bf16_f32 v128, v128, v129
    v_cvt_pk_bf16_f32 v129, v130, v131
    v_mfma_f32_16x16x32_bf16 v[140:143], a[20:23], v[124:127], v[140:143]
    v_mul_f32 v136, v136, v200
    v_mul_f32 v137, v137, v201
    v_mfma_f32_16x16x32_bf16 v[196:199], a[24:27], v[112:115], v[196:199]
    v_mul_f32 v138, v138, v202
    v_mul_f32 v139, v139, v203
    v_mfma_f32_16x16x32_bf16 v[196:199], a[28:31], v[120:123], v[196:199]
    v_cvt_pk_bf16_f32 v136, v136, v137
    v_cvt_pk_bf16_f32 v137, v138, v139
    v_mfma_f32_16x16x32_bf16 v[204:207], a[24:27], v[116:119], v[204:207]
    v_mfma_f32_16x16x32_bf16 v[204:207], a[28:31], v[124:127], v[204:207]
    v_mfma_f32_16x16x32_bf16 v[144:147], a[32:35], v[112:115], v[144:147]
    v_mul_f32 v132, v132, v196
    v_mul_f32 v133, v133, v197
    v_mfma_f32_16x16x32_bf16 v[144:147], a[36:39], v[120:123], v[144:147]
    v_mul_f32 v134, v134, v198
    v_mul_f32 v135, v135, v199
    v_mfma_f32_16x16x32_bf16 v[152:155], a[32:35], v[116:119], v[152:155]
    v_cvt_pk_bf16_f32 v130, v132, v133
    v_cvt_pk_bf16_f32 v131, v134, v135
    v_mfma_f32_16x16x32_bf16 v[152:155], a[36:39], v[124:127], v[152:155]
    buffer_store_dwordx4 v[128:131], v8, s[20:23], s14 offen offset:0 sc1
    v_mfma_f32_16x16x32_bf16 v[208:211], a[40:43], v[112:115], v[208:211]
    v_mul_f32 v140, v140, v204
    v_mul_f32 v141, v141, v205
    v_mfma_f32_16x16x32_bf16 v[208:211], a[44:47], v[120:123], v[208:211]
    v_mul_f32 v142, v142, v206
    v_mul_f32 v143, v143, v207
    v_mfma_f32_16x16x32_bf16 v[216:219], a[40:43], v[116:119], v[216:219]
    v_cvt_pk_bf16_f32 v138, v140, v141
    v_cvt_pk_bf16_f32 v139, v142, v143
    v_mfma_f32_16x16x32_bf16 v[216:219], a[44:47], v[124:127], v[216:219]
    buffer_store_dwordx4 v[136:139], v8, s[20:23], s15 offen offset:0 sc1
    v_mfma_f32_16x16x32_bf16 v[148:151], a[48:51], v[112:115], v[148:151]
    v_mul_f32 v144, v144, v208
    v_mul_f32 v145, v145, v209
    v_mfma_f32_16x16x32_bf16 v[148:151], a[52:55], v[120:123], v[148:151]
    v_mul_f32 v146, v146, v210
    v_mul_f32 v147, v147, v211
    v_mfma_f32_16x16x32_bf16 v[156:159], a[48:51], v[116:119], v[156:159]
    v_cvt_pk_bf16_f32 v144, v144, v145
    v_cvt_pk_bf16_f32 v145, v146, v147
    v_mfma_f32_16x16x32_bf16 v[156:159], a[52:55], v[124:127], v[156:159]
    v_mul_f32 v152, v152, v216
    v_mul_f32 v153, v153, v217
    v_mfma_f32_16x16x32_bf16 v[212:215], a[56:59], v[112:115], v[212:215]
    v_mul_f32 v154, v154, v218
    v_mul_f32 v155, v155, v219
    v_mfma_f32_16x16x32_bf16 v[212:215], a[60:63], v[120:123], v[212:215]
    v_cvt_pk_bf16_f32 v152, v152, v153
    v_cvt_pk_bf16_f32 v153, v154, v155
    v_mfma_f32_16x16x32_bf16 v[220:223], a[56:59], v[116:119], v[220:223]
    v_mfma_f32_16x16x32_bf16 v[220:223], a[60:63], v[124:127], v[220:223]
    v_mfma_f32_16x16x32_bf16 v[160:163], a[64:67], v[112:115], v[160:163]
    v_mul_f32 v148, v148, v212
    v_mul_f32 v149, v149, v213
    v_mfma_f32_16x16x32_bf16 v[160:163], a[68:71], v[120:123], v[160:163]
    v_mul_f32 v150, v150, v214
    v_mul_f32 v151, v151, v215
    v_mfma_f32_16x16x32_bf16 v[168:171], a[64:67], v[116:119], v[168:171]
    v_cvt_pk_bf16_f32 v146, v148, v149
    v_cvt_pk_bf16_f32 v147, v150, v151
    v_mfma_f32_16x16x32_bf16 v[168:171], a[68:71], v[124:127], v[168:171]
    buffer_store_dwordx4 v[144:147], v8, s[20:23], s14 offen offset:1024 sc1
    v_mfma_f32_16x16x32_bf16 v[224:227], a[72:75], v[112:115], v[224:227]
    v_mul_f32 v156, v156, v220
    v_mul_f32 v157, v157, v221
    v_mfma_f32_16x16x32_bf16 v[224:227], a[76:79], v[120:123], v[224:227]
    v_mul_f32 v158, v158, v222
    v_mul_f32 v159, v159, v223
    v_mfma_f32_16x16x32_bf16 v[232:235], a[72:75], v[116:119], v[232:235]
    v_cvt_pk_bf16_f32 v154, v156, v157
    v_cvt_pk_bf16_f32 v155, v158, v159
    v_mfma_f32_16x16x32_bf16 v[232:235], a[76:79], v[124:127], v[232:235]
    buffer_store_dwordx4 v[152:155], v8, s[20:23], s15 offen offset:1024 sc1
    v_mfma_f32_16x16x32_bf16 v[164:167], a[80:83], v[112:115], v[164:167]
    v_mul_f32 v160, v160, v224
    v_mul_f32 v161, v161, v225
    v_mfma_f32_16x16x32_bf16 v[164:167], a[84:87], v[120:123], v[164:167]
    v_mul_f32 v162, v162, v226
    v_mul_f32 v163, v163, v227
    v_mfma_f32_16x16x32_bf16 v[172:175], a[80:83], v[116:119], v[172:175]
    v_cvt_pk_bf16_f32 v160, v160, v161
    v_cvt_pk_bf16_f32 v161, v162, v163
    v_mfma_f32_16x16x32_bf16 v[172:175], a[84:87], v[124:127], v[172:175]
    v_mul_f32 v168, v168, v232
    v_mul_f32 v169, v169, v233
    v_mfma_f32_16x16x32_bf16 v[228:231], a[88:91], v[112:115], v[228:231]
    v_mul_f32 v170, v170, v234
    v_mul_f32 v171, v171, v235
    v_mfma_f32_16x16x32_bf16 v[228:231], a[92:95], v[120:123], v[228:231]
    v_cvt_pk_bf16_f32 v168, v168, v169
    v_cvt_pk_bf16_f32 v169, v170, v171
    v_mfma_f32_16x16x32_bf16 v[236:239], a[88:91], v[116:119], v[236:239]
    v_mfma_f32_16x16x32_bf16 v[236:239], a[92:95], v[124:127], v[236:239]
    v_mfma_f32_16x16x32_bf16 v[176:179], a[96:99], v[112:115], v[176:179]
    v_mul_f32 v164, v164, v228
    v_mul_f32 v165, v165, v229
    v_mfma_f32_16x16x32_bf16 v[176:179], a[100:103], v[120:123], v[176:179]
    v_mul_f32 v166, v166, v230
    v_mul_f32 v167, v167, v231
    v_mfma_f32_16x16x32_bf16 v[184:187], a[96:99], v[116:119], v[184:187]
    v_cvt_pk_bf16_f32 v162, v164, v165
    v_cvt_pk_bf16_f32 v163, v166, v167
    v_mfma_f32_16x16x32_bf16 v[184:187], a[100:103], v[124:127], v[184:187]
    buffer_store_dwordx4 v[160:163], v8, s[20:23], s14 offen offset:2048 sc1
    v_mfma_f32_16x16x32_bf16 v[240:243], a[104:107], v[112:115], v[240:243]
    v_mul_f32 v172, v172, v236
    v_mul_f32 v173, v173, v237
    v_mfma_f32_16x16x32_bf16 v[240:243], a[108:111], v[120:123], v[240:243]
    v_mul_f32 v174, v174, v238
    v_mul_f32 v175, v175, v239
    v_mfma_f32_16x16x32_bf16 v[248:251], a[104:107], v[116:119], v[248:251]
    v_cvt_pk_bf16_f32 v170, v172, v173
    v_cvt_pk_bf16_f32 v171, v174, v175
    v_mfma_f32_16x16x32_bf16 v[248:251], a[108:111], v[124:127], v[248:251]
    buffer_store_dwordx4 v[168:171], v8, s[20:23], s15 offen offset:2048 sc1
    v_mfma_f32_16x16x32_bf16 v[180:183], a[112:115], v[112:115], v[180:183]
    v_mul_f32 v176, v176, v240
    v_mul_f32 v177, v177, v241
    v_mfma_f32_16x16x32_bf16 v[180:183], a[116:119], v[120:123], v[180:183]
    v_mul_f32 v178, v178, v242
    v_mul_f32 v179, v179, v243
    v_mfma_f32_16x16x32_bf16 v[188:191], a[112:115], v[116:119], v[188:191]
    v_cvt_pk_bf16_f32 v176, v176, v177
    v_cvt_pk_bf16_f32 v177, v178, v179
    v_mfma_f32_16x16x32_bf16 v[188:191], a[116:119], v[124:127], v[188:191]
    v_mul_f32 v184, v184, v248
    v_mul_f32 v185, v185, v249
    v_mfma_f32_16x16x32_bf16 v[244:247], a[120:123], v[112:115], v[244:247]
    v_mul_f32 v186, v186, v250
    v_mul_f32 v187, v187, v251
    v_mfma_f32_16x16x32_bf16 v[244:247], a[124:127], v[120:123], v[244:247]
    v_cvt_pk_bf16_f32 v184, v184, v185
    v_cvt_pk_bf16_f32 v185, v186, v187
    v_mfma_f32_16x16x32_bf16 v[252:255], a[120:123], v[116:119], v[252:255]
    v_mfma_f32_16x16x32_bf16 v[252:255], a[124:127], v[124:127], v[252:255]
    v_mul_f32 v180, v180, v244
    v_mul_f32 v181, v181, v245
    v_mul_f32 v182, v182, v246
    v_mul_f32 v183, v183, v247
    v_cvt_pk_bf16_f32 v178, v180, v181
    v_cvt_pk_bf16_f32 v179, v182, v183
    buffer_store_dwordx4 v[176:179], v8, s[20:23], s14 offen offset:3072 sc1
    s_nop 0
    v_mul_f32 v188, v188, v252
    v_mul_f32 v189, v189, v253
    v_mul_f32 v190, v190, v254
    v_mul_f32 v191, v191, v255
    v_cvt_pk_bf16_f32 v186, v188, v189
    v_cvt_pk_bf16_f32 v187, v190, v191
    buffer_store_dwordx4 v[184:187], v8, s[20:23], s15 offen offset:3072 sc1
    s_waitcnt vmcnt(16)
    ds_read_b64_tr_b16 v[16:17], v4 offset:0
    ds_read_b64_tr_b16 v[18:19], v4 offset:2048
    ds_read_b64_tr_b16 v[20:21], v5 offset:0
    ds_read_b64_tr_b16 v[22:23], v5 offset:2048
    ds_read_b64_tr_b16 v[24:25], v6 offset:0
    ds_read_b64_tr_b16 v[26:27], v6 offset:2048
    ds_read_b64_tr_b16 v[28:29], v7 offset:0
    ds_read_b64_tr_b16 v[30:31], v7 offset:2048
    v_subrev_u32 v4, 134656, v4
    v_subrev_u32 v5, 134656, v5
    v_subrev_u32 v6, 134656, v6
    v_subrev_u32 v7, 134656, v7
    ds_read_b64_tr_b16 v[32:33], v4 offset:33280
    ds_read_b64_tr_b16 v[34:35], v4 offset:35328
    ds_read_b64_tr_b16 v[36:37], v5 offset:33280
    ds_read_b64_tr_b16 v[38:39], v5 offset:35328
    ds_read_b64_tr_b16 v[40:41], v6 offset:33280
    ds_read_b64_tr_b16 v[42:43], v6 offset:35328
    ds_read_b64_tr_b16 v[44:45], v7 offset:33280
    ds_read_b64_tr_b16 v[46:47], v7 offset:35328
    ds_read_b64_tr_b16 v[48:49], v4 offset:49664
    ds_read_b64_tr_b16 v[50:51], v4 offset:51712
    ds_read_b64_tr_b16 v[52:53], v5 offset:49664
    ds_read_b64_tr_b16 v[54:55], v5 offset:51712
    ds_read_b64_tr_b16 v[56:57], v6 offset:49664
    ds_read_b64_tr_b16 v[58:59], v6 offset:51712
    ds_read_b64_tr_b16 v[60:61], v7 offset:49664
    ds_read_b64_tr_b16 v[62:63], v7 offset:51712
    v_add_u32 v4, 68096, v4
    v_add_u32 v5, 68096, v5
    v_add_u32 v6, 68096, v6
    v_add_u32 v7, 68096, v7
    ds_read_b64_tr_b16 v[64:65], v4 offset:0
    ds_read_b64_tr_b16 v[66:67], v4 offset:2048
    ds_read_b64_tr_b16 v[68:69], v5 offset:0
    ds_read_b64_tr_b16 v[70:71], v5 offset:2048
    ds_read_b64_tr_b16 v[72:73], v6 offset:0
    ds_read_b64_tr_b16 v[74:75], v6 offset:2048
    ds_read_b64_tr_b16 v[76:77], v7 offset:0
    ds_read_b64_tr_b16 v[78:79], v7 offset:2048
    ds_read_b64_tr_b16 v[80:81], v4 offset:16384
    ds_read_b64_tr_b16 v[82:83], v4 offset:18432
    ds_read_b64_tr_b16 v[84:85], v5 offset:16384
    ds_read_b64_tr_b16 v[86:87], v5 offset:18432
    ds_read_b64_tr_b16 v[88:89], v6 offset:16384
    ds_read_b64_tr_b16 v[90:91], v6 offset:18432
    ds_read_b64_tr_b16 v[92:93], v7 offset:16384
    ds_read_b64_tr_b16 v[94:95], v7 offset:18432
    ds_read_b64_tr_b16 v[96:97], v4 offset:33280
    ds_read_b64_tr_b16 v[98:99], v4 offset:35328
    ds_read_b64_tr_b16 v[100:101], v5 offset:33280
    ds_read_b64_tr_b16 v[102:103], v5 offset:35328
    ds_read_b64_tr_b16 v[104:105], v6 offset:33280
    ds_read_b64_tr_b16 v[106:107], v6 offset:35328
    ds_read_b64_tr_b16 v[108:109], v7 offset:33280
    ds_read_b64_tr_b16 v[110:111], v7 offset:35328
    ds_read_b64_tr_b16 v[112:113], v4 offset:49664
    ds_read_b64_tr_b16 v[114:115], v4 offset:51712
    ds_read_b64_tr_b16 v[116:117], v5 offset:49664
    ds_read_b64_tr_b16 v[118:119], v5 offset:51712
    ds_read_b64_tr_b16 v[120:121], v6 offset:49664
    ds_read_b64_tr_b16 v[122:123], v6 offset:51712
    ds_read_b64_tr_b16 v[124:125], v7 offset:49664
    ds_read_b64_tr_b16 v[126:127], v7 offset:51712
    s_waitcnt vmcnt(0) lgkmcnt(0)
    s_mov_b64 exec, 1
    buffer_store_dword v11, off, s[20:23], s18 sc1
    s_mov_b64 exec, -1
    s_add_u32 m0, s92, 134656
    s_add_u32 s45, s94, 258048
    buffer_load_dwordx4 v9, s[68:71], s45 offen offset:0 lds
    s_add_u32 s46, s94, 264192
    buffer_load_dwordx4 v9, s[68:71], s46 offen offset:1024 lds
    s_add_u32 s47, s94, 270336
    buffer_load_dwordx4 v9, s[68:71], s47 offen offset:2048 lds
    s_add_u32 s44, s94, 276480
    buffer_load_dwordx4 v9, s[68:71], s44 offen offset:3072 lds
    s_add_u32 m0, s92, 33280
    s_add_u32 s45, s94, 286720
    buffer_load_dwordx4 v9, s[68:71], s45 offen offset:0 lds
    s_add_u32 s46, s94, 292864
    buffer_load_dwordx4 v9, s[68:71], s46 offen offset:1024 lds
    s_add_u32 s47, s94, 299008
    buffer_load_dwordx4 v9, s[68:71], s47 offen offset:2048 lds
    s_add_u32 s44, s94, 305152
    buffer_load_dwordx4 v9, s[68:71], s44 offen offset:3072 lds
    s_add_u32 m0, s92, 49664
    s_add_u32 s45, s94, 315392
    buffer_load_dwordx4 v9, s[68:71], s45 offen offset:0 lds
    s_add_u32 s46, s94, 321536
    buffer_load_dwordx4 v9, s[68:71], s46 offen offset:1024 lds
    s_add_u32 s47, s94, 327680
    buffer_load_dwordx4 v9, s[68:71], s47 offen offset:2048 lds
    s_add_u32 s44, s94, 333824
    buffer_load_dwordx4 v9, s[68:71], s44 offen offset:3072 lds
    s_add_u32 m0, s92, 68096
    s_add_u32 s45, s94, 344064
    buffer_load_dwordx4 v9, s[68:71], s45 offen offset:0 lds
    s_add_u32 s46, s94, 350208
    buffer_load_dwordx4 v9, s[68:71], s46 offen offset:1024 lds
    s_add_u32 s47, s94, 356352
    buffer_load_dwordx4 v9, s[68:71], s47 offen offset:2048 lds
    s_add_u32 s44, s94, 362496
    buffer_load_dwordx4 v9, s[68:71], s44 offen offset:3072 lds
    s_add_u32 m0, s92, 84480
    s_add_u32 s45, s94, 372736
    buffer_load_dwordx4 v9, s[68:71], s45 offen offset:0 lds
    s_add_u32 s46, s94, 378880
    buffer_load_dwordx4 v9, s[68:71], s46 offen offset:1024 lds
    s_add_u32 s47, s94, 385024
    buffer_load_dwordx4 v9, s[68:71], s47 offen offset:2048 lds
    s_add_u32 s44, s94, 391168
    buffer_load_dwordx4 v9, s[68:71], s44 offen offset:3072 lds
    buffer_load_dwordx4 v[200:203], v12, s[20:23], s97 offen offset:0
    buffer_load_dwordx4 v[204:207], v12, s[20:23], s97 offen offset:16
    buffer_load_dwordx4 v[208:211], v12, s[20:23], s97 offen offset:128
    buffer_load_dwordx4 v[212:215], v12, s[20:23], s97 offen offset:144
    s_mov_b32 s53, 0
    buffer_load_dword v0, v15, s[20:23], s98 offen sc1
    s_waitcnt vmcnt(0)
    s_branch L5_chk
L5_poll:
    s_sleep 2
    s_add_u32 s53, s53, 1
    s_cmp_ge_u32 s53, 131072
    s_cbranch_scc1 L5_go
    buffer_load_dword v0, v15, s[20:23], s98 offen sc1
    s_waitcnt vmcnt(0)
L5_chk:
    v_cmp_ne_u32 vcc, v11, v0
    s_nop 0
    s_and_b32 s50, vcc_lo, s99
    s_cbranch_scc1 L5_poll
L5_go:
    s_add_u32 s41, s93, 0
    buffer_load_dwordx4 a[0:3], v8, s[20:23], s41 offen offset:0 sc1
    s_add_u32 s42, s93, 57344
    buffer_load_dwordx4 a[4:7], v8, s[20:23], s42 offen offset:0 sc1
    s_add_u32 s43, s93, 114688
    buffer_load_dwordx4 a[8:11], v8, s[20:23], s43 offen offset:0 sc1
    s_add_u32 s40, s93, 172032
    buffer_load_dwordx4 a[12:15], v8, s[20:23], s40 offen offset:0 sc1
    s_add_u32 s41, s93, 0
    buffer_load_dwordx4 a[16:19], v8, s[20:23], s41 offen offset:1024 sc1
    s_add_u32 s42, s93, 57344
    buffer_load_dwordx4 a[20:23], v8, s[20:23], s42 offen offset:1024 sc1
    s_add_u32 s43, s93, 114688
    buffer_load_dwordx4 a[24:27], v8, s[20:23], s43 offen offset:1024 sc1
    s_add_u32 s40, s93, 172032
    buffer_load_dwordx4 a[28:31], v8, s[20:23], s40 offen offset:1024 sc1
    s_add_u32 s41, s93, 0
    buffer_load_dwordx4 a[32:35], v8, s[20:23], s41 offen offset:2048 sc1
    s_add_u32 s42, s93, 57344
    buffer_load_dwordx4 a[36:39], v8, s[20:23], s42 offen offset:2048 sc1
    s_add_u32 s43, s93, 114688
    buffer_load_dwordx4 a[40:43], v8, s[20:23], s43 offen offset:2048 sc1
    s_add_u32 s40, s93, 172032
    buffer_load_dwordx4 a[44:47], v8, s[20:23], s40 offen offset:2048 sc1
    s_waitcnt lgkmcnt(0)
    s_waitcnt vmcnt(11)
    v_mfma_f32_16x16x32_bf16 v[128:131], v[16:19], a[0:3], 0
    s_add_u32 s41, s93, 0
    v_subrev_u32 v4, 68096, v4
    v_subrev_u32 v5, 68096, v5
    s_waitcnt vmcnt(10)
    v_mfma_f32_16x16x32_bf16 v[144:147], v[16:19], a[4:7], 0
    s_add_u32 s42, s93, 57344
    buffer_load_dwordx4 a[48:51], v8, s[20:23], s41 offen offset:3072 sc1
    s_waitcnt vmcnt(10)
    v_mfma_f32_16x16x32_bf16 v[160:163], v[16:19], a[8:11], 0
    s_waitcnt vmcnt(9)
    v_subrev_u32 v6, 68096, v6
    v_subrev_u32 v7, 68096, v7
    v_mfma_f32_16x16x32_bf16 v[176:179], v[16:19], a[12:15], 0
    s_add_u32 s43, s93, 114688
    ds_read_b64_tr_b16 v[16:17], v4 offset:0
    ds_read_b64_tr_b16 v[18:19], v4 offset:2048
    v_mfma_f32_16x16x32_bf16 v[132:135], v[20:23], a[0:3], 0
    v_mfma_f32_16x16x32_bf16 v[148:151], v[20:23], a[4:7], 0
    buffer_load_dwordx4 a[52:55], v8, s[20:23], s42 offen offset:3072 sc1
    v_mfma_f32_16x16x32_bf16 v[164:167], v[20:23], a[8:11], 0
    v_mfma_f32_16x16x32_bf16 v[180:183], v[20:23], a[12:15], 0
    s_add_u32 s40, s93, 172032
    ds_read_b64_tr_b16 v[20:21], v5 offset:0
    ds_read_b64_tr_b16 v[22:23], v5 offset:2048
    v_mfma_f32_16x16x32_bf16 v[136:139], v[24:27], a[0:3], 0
    v_mfma_f32_16x16x32_bf16 v[152:155], v[24:27], a[4:7], 0
    buffer_load_dwordx4 a[56:59], v8, s[20:23], s43 offen offset:3072 sc1
    v_mfma_f32_16x16x32_bf16 v[168:171], v[24:27], a[8:11], 0
    v_mfma_f32_16x16x32_bf16 v[184:187], v[24:27], a[12:15], 0
    s_add_u32 s41, s93, 4096
    ds_read_b64_tr_b16 v[24:25], v6 offset:0
    ds_read_b64_tr_b16 v[26:27], v6 offset:2048
    v_mfma_f32_16x16x32_bf16 v[140:143], v[28:31], a[0:3], 0
    v_mfma_f32_16x16x32_bf16 v[156:159], v[28:31], a[4:7], 0
    buffer_load_dwordx4 a[60:63], v8, s[20:23], s40 offen offset:3072 sc1
    v_mfma_f32_16x16x32_bf16 v[172:175], v[28:31], a[8:11], 0
    s_waitcnt vmcnt(11)
    v_mfma_f32_16x16x32_bf16 v[188:191], v[28:31], a[12:15], 0
    s_add_u32 s42, s93, 61440
    ds_read_b64_tr_b16 v[28:29], v7 offset:0
    ds_read_b64_tr_b16 v[30:31], v7 offset:2048
    v_mfma_f32_16x16x32_bf16 v[128:131], v[32:35], a[16:19], v[128:131]
    s_waitcnt vmcnt(10)
    v_mfma_f32_16x16x32_bf16 v[144:147], v[32:35], a[20:23], v[144:147]
    s_waitcnt vmcnt(9)
    buffer_load_dwordx4 a[64:67], v8, s[20:23], s41 offen offset:0 sc1
    v_mfma_f32_16x16x32_bf16 v[160:163], v[32:35], a[24:27], v[160:163]
    s_waitcnt vmcnt(9)
    v_mfma_f32_16x16x32_bf16 v[176:179], v[32:35], a[28:31], v[176:179]
    s_add_u32 s43, s93, 118784
    ds_read_b64_tr_b16 v[32:33], v4 offset:16384
    ds_read_b64_tr_b16 v[34:35], v4 offset:18432
    v_mfma_f32_16x16x32_bf16 v[132:135], v[36:39], a[16:19], v[132:135]
    v_add_u32 v4, 134656, v4
    v_mfma_f32_16x16x32_bf16 v[148:151], v[36:39], a[20:23], v[148:151]
    buffer_load_dwordx4 a[68:71], v8, s[20:23], s42 offen offset:0 sc1
    v_mfma_f32_16x16x32_bf16 v[164:167], v[36:39], a[24:27], v[164:167]
    v_mfma_f32_16x16x32_bf16 v[180:183], v[36:39], a[28:31], v[180:183]
    s_add_u32 s40, s93, 176128
    ds_read_b64_tr_b16 v[36:37], v5 offset:16384
    ds_read_b64_tr_b16 v[38:39], v5 offset:18432
    v_mfma_f32_16x16x32_bf16 v[136:139], v[40:43], a[16:19], v[136:139]
    v_add_u32 v5, 134656, v5
    v_mfma_f32_16x16x32_bf16 v[152:155], v[40:43], a[20:23], v[152:155]
    buffer_load_dwordx4 a[72:75], v8, s[20:23], s43 offen offset:0 sc1
    v_mfma_f32_16x16x32_bf16 v[168:171], v[40:43], a[24:27], v[168:171]
    v_mfma_f32_16x16x32_bf16 v[184:187], v[40:43], a[28:31], v[184:187]
    s_add_u32 s41, s93, 4096
    ds_read_b64_tr_b16 v[40:41], v6 offset:16384
    ds_read_b64_tr_b16 v[42:43], v6 offset:18432
    v_mfma_f32_16x16x32_bf16 v[140:143], v[44:47], a[16:19], v[140:143]
    v_add_u32 v6, 134656, v6
    v_mfma_f32_16x16x32_bf16 v[156:159], v[44:47], a[20:23], v[156:159]
    buffer_load_dwordx4 a[76:79], v8, s[20:23], s40 offen offset:0 sc1
    v_mfma_f32_16x16x32_bf16 v[172:175], v[44:47], a[24:27], v[172:175]
    s_waitcnt vmcnt(11)
    v_mfma_f32_16x16x32_bf16 v[188:191], v[44:47], a[28:31], v[188:191]
    s_add_u32 s42, s93, 61440
    ds_read_b64_tr_b16 v[44:45], v7 offset:16384
    ds_read_b64_tr_b16 v[46:47], v7 offset:18432
    v_mfma_f32_16x16x32_bf16 v[128:131], v[48:51], a[32:35], v[128:131]
    s_waitcnt vmcnt(10)
    v_add_u32 v7, 134656, v7
    v_mfma_f32_16x16x32_bf16 v[144:147], v[48:51], a[36:39], v[144:147]
    s_waitcnt vmcnt(9)
    buffer_load_dwordx4 a[80:83], v8, s[20:23], s41 offen offset:1024 sc1
    v_mfma_f32_16x16x32_bf16 v[160:163], v[48:51], a[40:43], v[160:163]
    s_waitcnt vmcnt(9)
    v_mfma_f32_16x16x32_bf16 v[176:179], v[48:51], a[44:47], v[176:179]
    s_add_u32 s43, s93, 118784
    ds_read_b64_tr_b16 v[48:49], v4 offset:0
    ds_read_b64_tr_b16 v[50:51], v4 offset:2048
    v_mfma_f32_16x16x32_bf16 v[132:135], v[52:55], a[32:35], v[132:135]
    v_subrev_u32 v4, 134656, v4
    v_mfma_f32_16x16x32_bf16 v[148:151], v[52:55], a[36:39], v[148:151]
    buffer_load_dwordx4 a[84:87], v8, s[20:23], s42 offen offset:1024 sc1
    v_mfma_f32_16x16x32_bf16 v[164:167], v[52:55], a[40:43], v[164:167]
    v_mfma_f32_16x16x32_bf16 v[180:183], v[52:55], a[44:47], v[180:183]
    s_add_u32 s40, s93, 176128
    ds_read_b64_tr_b16 v[52:53], v5 offset:0
    ds_read_b64_tr_b16 v[54:55], v5 offset:2048
    v_mfma_f32_16x16x32_bf16 v[136:139], v[56:59], a[32:35], v[136:139]
    v_subrev_u32 v5, 134656, v5
    v_mfma_f32_16x16x32_bf16 v[152:155], v[56:59], a[36:39], v[152:155]
    buffer_load_dwordx4 a[88:91], v8, s[20:23], s43 offen offset:1024 sc1
    v_mfma_f32_16x16x32_bf16 v[168:171], v[56:59], a[40:43], v[168:171]
    v_mfma_f32_16x16x32_bf16 v[184:187], v[56:59], a[44:47], v[184:187]
    s_add_u32 s41, s93, 4096
    ds_read_b64_tr_b16 v[56:57], v6 offset:0
    ds_read_b64_tr_b16 v[58:59], v6 offset:2048
    v_mfma_f32_16x16x32_bf16 v[140:143], v[60:63], a[32:35], v[140:143]
    v_subrev_u32 v6, 134656, v6
    v_mfma_f32_16x16x32_bf16 v[156:159], v[60:63], a[36:39], v[156:159]
    buffer_load_dwordx4 a[92:95], v8, s[20:23], s40 offen offset:1024 sc1
    v_mfma_f32_16x16x32_bf16 v[172:175], v[60:63], a[40:43], v[172:175]
    s_waitcnt vmcnt(11)
    v_mfma_f32_16x16x32_bf16 v[188:191], v[60:63], a[44:47], v[188:191]
    s_add_u32 s42, s93, 61440
    ds_read_b64_tr_b16 v[60:61], v7 offset:0
    ds_read_b64_tr_b16 v[62:63], v7 offset:2048
    v_mfma_f32_16x16x32_bf16 v[128:131], v[64:67], a[48:51], v[128:131]
    s_waitcnt vmcnt(10)
    v_subrev_u32 v7, 134656, v7
    v_mfma_f32_16x16x32_bf16 v[144:147], v[64:67], a[52:55], v[144:147]
    s_waitcnt vmcnt(9)
    buffer_load_dwordx4 a[96:99], v8, s[20:23], s41 offen offset:2048 sc1
    v_mfma_f32_16x16x32_bf16 v[160:163], v[64:67], a[56:59], v[160:163]
    s_waitcnt vmcnt(9)
    v_mfma_f32_16x16x32_bf16 v[176:179], v[64:67], a[60:63], v[176:179]
    s_add_u32 s43, s93, 118784
    ds_read_b64_tr_b16 v[64:65], v4 offset:33280
    ds_read_b64_tr_b16 v[66:67], v4 offset:35328
    v_mfma_f32_16x16x32_bf16 v[132:135], v[68:71], a[48:51], v[132:135]
    v_mfma_f32_16x16x32_bf16 v[148:151], v[68:71], a[52:55], v[148:151]
    buffer_load_dwordx4 a[100:103], v8, s[20:23], s42 offen offset:2048 sc1
    v_mfma_f32_16x16x32_bf16 v[164:167], v[68:71], a[56:59], v[164:167]
    v_mfma_f32_16x16x32_bf16 v[180:183], v[68:71], a[60:63], v[180:183]
    s_add_u32 s40, s93, 176128
    ds_read_b64_tr_b16 v[68:69], v5 offset:33280
    ds_read_b64_tr_b16 v[70:71], v5 offset:35328
    v_mfma_f32_16x16x32_bf16 v[136:139], v[72:75], a[48:51], v[136:139]
    v_mfma_f32_16x16x32_bf16 v[152:155], v[72:75], a[52:55], v[152:155]
    buffer_load_dwordx4 a[104:107], v8, s[20:23], s43 offen offset:2048 sc1
    v_mfma_f32_16x16x32_bf16 v[168:171], v[72:75], a[56:59], v[168:171]
    v_mfma_f32_16x16x32_bf16 v[184:187], v[72:75], a[60:63], v[184:187]
    s_add_u32 s41, s93, 4096
    ds_read_b64_tr_b16 v[72:73], v6 offset:33280
    ds_read_b64_tr_b16 v[74:75], v6 offset:35328
    v_mfma_f32_16x16x32_bf16 v[140:143], v[76:79], a[48:51], v[140:143]
    v_mfma_f32_16x16x32_bf16 v[156:159], v[76:79], a[52:55], v[156:159]
    buffer_load_dwordx4 a[108:111], v8, s[20:23], s40 offen offset:2048 sc1
    v_mfma_f32_16x16x32_bf16 v[172:175], v[76:79], a[56:59], v[172:175]
    s_waitcnt vmcnt(11)
    v_mfma_f32_16x16x32_bf16 v[188:191], v[76:79], a[60:63], v[188:191]
    s_add_u32 s42, s93, 61440
    ds_read_b64_tr_b16 v[76:77], v7 offset:33280
    ds_read_b64_tr_b16 v[78:79], v7 offset:35328
    v_mfma_f32_16x16x32_bf16 v[128:131], v[80:83], a[64:67], v[128:131]
    s_waitcnt vmcnt(10)
    v_mfma_f32_16x16x32_bf16 v[144:147], v[80:83], a[68:71], v[144:147]
    s_waitcnt vmcnt(9)
    buffer_load_dwordx4 a[112:115], v8, s[20:23], s41 offen offset:3072 sc1
    v_mfma_f32_16x16x32_bf16 v[160:163], v[80:83], a[72:75], v[160:163]
    s_waitcnt vmcnt(9)
    v_mfma_f32_16x16x32_bf16 v[176:179], v[80:83], a[76:79], v[176:179]
    s_add_u32 s43, s93, 118784
    ds_read_b64_tr_b16 v[80:81], v4 offset:49664
    ds_read_b64_tr_b16 v[82:83], v4 offset:51712
    v_mfma_f32_16x16x32_bf16 v[132:135], v[84:87], a[64:67], v[132:135]
    v_add_u32 v4, 68096, v4
    v_mfma_f32_16x16x32_bf16 v[148:151], v[84:87], a[68:71], v[148:151]
    buffer_load_dwordx4 a[116:119], v8, s[20:23], s42 offen offset:3072 sc1
    v_mfma_f32_16x16x32_bf16 v[164:167], v[84:87], a[72:75], v[164:167]
    v_mfma_f32_16x16x32_bf16 v[180:183], v[84:87], a[76:79], v[180:183]
    s_add_u32 s40, s93, 176128
    ds_read_b64_tr_b16 v[84:85], v5 offset:49664
    ds_read_b64_tr_b16 v[86:87], v5 offset:51712
    v_mfma_f32_16x16x32_bf16 v[136:139], v[88:91], a[64:67], v[136:139]
    v_add_u32 v5, 68096, v5
    v_mfma_f32_16x16x32_bf16 v[152:155], v[88:91], a[68:71], v[152:155]
    buffer_load_dwordx4 a[120:123], v8, s[20:23], s43 offen offset:3072 sc1
    v_mfma_f32_16x16x32_bf16 v[168:171], v[88:91], a[72:75], v[168:171]
    v_mfma_f32_16x16x32_bf16 v[184:187], v[88:91], a[76:79], v[184:187]
    s_add_u32 s41, s93, 8192
    ds_read_b64_tr_b16 v[88:89], v6 offset:49664
    ds_read_b64_tr_b16 v[90:91], v6 offset:51712
    v_mfma_f32_16x16x32_bf16 v[140:143], v[92:95], a[64:67], v[140:143]
    v_add_u32 v6, 68096, v6
    v_mfma_f32_16x16x32_bf16 v[156:159], v[92:95], a[68:71], v[156:159]
    buffer_load_dwordx4 a[124:127], v8, s[20:23], s40 offen offset:3072 sc1
    v_mfma_f32_16x16x32_bf16 v[172:175], v[92:95], a[72:75], v[172:175]
    s_waitcnt vmcnt(11)
    v_mfma_f32_16x16x32_bf16 v[188:191], v[92:95], a[76:79], v[188:191]
    s_add_u32 s42, s93, 65536
    ds_read_b64_tr_b16 v[92:93], v7 offset:49664
    ds_read_b64_tr_b16 v[94:95], v7 offset:51712
    v_mfma_f32_16x16x32_bf16 v[128:131], v[96:99], a[80:83], v[128:131]
    s_waitcnt vmcnt(10)
    v_add_u32 v7, 68096, v7
    v_mfma_f32_16x16x32_bf16 v[144:147], v[96:99], a[84:87], v[144:147]
    s_waitcnt vmcnt(9)
    buffer_load_dwordx4 a[128:131], v8, s[20:23], s41 offen offset:0 sc1
    v_mfma_f32_16x16x32_bf16 v[160:163], v[96:99], a[88:91], v[160:163]
    s_waitcnt vmcnt(9)
    v_mfma_f32_16x16x32_bf16 v[176:179], v[96:99], a[92:95], v[176:179]
    s_add_u32 s43, s93, 122880
    ds_read_b64_tr_b16 v[96:97], v4 offset:0
    ds_read_b64_tr_b16 v[98:99], v4 offset:2048
    v_mfma_f32_16x16x32_bf16 v[132:135], v[100:103], a[80:83], v[132:135]
    v_mfma_f32_16x16x32_bf16 v[148:151], v[100:103], a[84:87], v[148:151]
    buffer_load_dwordx4 a[132:135], v8, s[20:23], s42 offen offset:0 sc1
    v_mfma_f32_16x16x32_bf16 v[164:167], v[100:103], a[88:91], v[164:167]
    v_mfma_f32_16x16x32_bf16 v[180:183], v[100:103], a[92:95], v[180:183]
    s_add_u32 s40, s93, 180224
    ds_read_b64_tr_b16 v[100:101], v5 offset:0
    ds_read_b64_tr_b16 v[102:103], v5 offset:2048
    v_mfma_f32_16x16x32_bf16 v[136:139], v[104:107], a[80:83], v[136:139]
    v_mfma_f32_16x16x32_bf16 v[152:155], v[104:107], a[84:87], v[152:155]
    buffer_load_dwordx4 a[136:139], v8, s[20:23], s43 offen offset:0 sc1
    v_mfma_f32_16x16x32_bf16 v[168:171], v[104:107], a[88:91], v[168:171]
    v_mfma_f32_16x16x32_bf16 v[184:187], v[104:107], a[92:95], v[184:187]
    s_add_u32 s41, s93, 8192
    ds_read_b64_tr_b16 v[104:105], v6 offset:0
    ds_read_b64_tr_b16 v[106:107], v6 offset:2048
    v_mfma_f32_16x16x32_bf16 v[140:143], v[108:111], a[80:83], v[140:143]
    v_mfma_f32_16x16x32_bf16 v[156:159], v[108:111], a[84:87], v[156:159]
    buffer_load_dwordx4 a[140:143], v8, s[20:23], s40 offen offset:0 sc1
    v_mfma_f32_16x16x32_bf16 v[172:175], v[108:111], a[88:91], v[172:175]
    s_waitcnt vmcnt(11)
    v_mfma_f32_16x16x32_bf16 v[188:191], v[108:111], a[92:95], v[188:191]
    s_add_u32 s42, s93, 65536
    ds_read_b64_tr_b16 v[108:109], v7 offset:0
    ds_read_b64_tr_b16 v[110:111], v7 offset:2048
    v_mfma_f32_16x16x32_bf16 v[128:131], v[112:115], a[96:99], v[128:131]
    s_waitcnt vmcnt(10)
    v_mfma_f32_16x16x32_bf16 v[144:147], v[112:115], a[100:103], v[144:147]
    s_waitcnt vmcnt(9)
    buffer_load_dwordx4 a[144:147], v8, s[20:23], s41 offen offset:1024 sc1
    v_mfma_f32_16x16x32_bf16 v[160:163], v[112:115], a[104:107], v[160:163]
    s_waitcnt vmcnt(9)
    v_mfma_f32_16x16x32_bf16 v[176:179], v[112:115], a[108:111], v[176:179]
    s_add_u32 s43, s93, 122880
    ds_read_b64_tr_b16 v[112:113], v4 offset:16384
    ds_read_b64_tr_b16 v[114:115], v4 offset:18432
    v_mfma_f32_16x16x32_bf16 v[132:135], v[116:119], a[96:99], v[132:135]
    s_mul_i32 s50, s48, 16640
    v_mfma_f32_16x16x32_bf16 v[148:151], v[116:119], a[100:103], v[148:151]
    s_andn2_b32 s50, s50, 256
    buffer_load_dwordx4 a[148:151], v8, s[20:23], s42 offen offset:1024 sc1
    v_mfma_f32_16x16x32_bf16 v[164:167], v[116:119], a[104:107], v[164:167]
    v_add_u32 v0, s50, v8
    v_mfma_f32_16x16x32_bf16 v[180:183], v[116:119], a[108:111], v[180:183]
    s_add_u32 s40, s93, 180224
    ds_read_b64_tr_b16 v[116:117], v5 offset:16384
    ds_read_b64_tr_b16 v[118:119], v5 offset:18432
    v_mfma_f32_16x16x32_bf16 v[136:139], v[120:123], a[96:99], v[136:139]
    v_mfma_f32_16x16x32_bf16 v[152:155], v[120:123], a[100:103], v[152:155]
    buffer_load_dwordx4 a[152:155], v8, s[20:23], s43 offen offset:1024 sc1
    v_mfma_f32_16x16x32_bf16 v[168:171], v[120:123], a[104:107], v[168:171]
    v_mfma_f32_16x16x32_bf16 v[184:187], v[120:123], a[108:111], v[184:187]
    s_add_u32 s41, s93, 8192
    ds_read_b64_tr_b16 v[120:121], v6 offset:16384
    ds_read_b64_tr_b16 v[122:123], v6 offset:18432
    v_mfma_f32_16x16x32_bf16 v[140:143], v[124:127], a[96:99], v[140:143]
    v_mfma_f32_16x16x32_bf16 v[156:159], v[124:127], a[100:103], v[156:159]
    s_waitcnt vmcnt(10)
    buffer_load_dwordx4 a[156:159], v8, s[20:23], s40 offen offset:1024 sc1
    v_mfma_f32_16x16x32_bf16 v[172:175], v[124:127], a[104:107], v[172:175]
    s_waitcnt lgkmcnt(4)
    v_mfma_f32_16x16x32_bf16 v[188:191], v[124:127], a[108:111], v[188:191]
    s_add_u32 s42, s93, 65536
    ds_read_b64_tr_b16 v[124:125], v7 offset:16384
    ds_read_b64_tr_b16 v[126:127], v7 offset:18432
    v_mfma_f32_16x16x32_bf16 v[128:131], v[16:19], a[112:115], v[128:131]
    s_waitcnt vmcnt(10)
    v_mfma_f32_16x16x32_bf16 v[144:147], v[16:19], a[116:119], v[144:147]
    s_waitcnt vmcnt(9)
    buffer_load_dwordx4 a[160:163], v8, s[20:23], s41 offen offset:2048 sc1
    v_mfma_f32_16x16x32_bf16 v[160:163], v[16:19], a[120:123], v[160:163]
    s_waitcnt vmcnt(9)
    v_mfma_f32_16x16x32_bf16 v[176:179], v[16:19], a[124:127], v[176:179]
    s_add_u32 s43, s93, 122880
    v_mfma_f32_16x16x32_bf16 v[132:135], v[20:23], a[112:115], v[132:135]
    v_mfma_f32_16x16x32_bf16 v[148:151], v[20:23], a[116:119], v[148:151]
    buffer_load_dwordx4 a[164:167], v8, s[20:23], s42 offen offset:2048 sc1
    v_mfma_f32_16x16x32_bf16 v[164:167], v[20:23], a[120:123], v[164:167]
    v_mfma_f32_16x16x32_bf16 v[180:183], v[20:23], a[124:127], v[180:183]
    s_add_u32 s40, s93, 180224
    v_mfma_f32_16x16x32_bf16 v[136:139], v[24:27], a[112:115], v[136:139]
    v_mfma_f32_16x16x32_bf16 v[152:155], v[24:27], a[116:119], v[152:155]
    buffer_load_dwordx4 a[168:171], v8, s[20:23], s43 offen offset:2048 sc1
    v_mfma_f32_16x16x32_bf16 v[168:171], v[24:27], a[120:123], v[168:171]
    v_mfma_f32_16x16x32_bf16 v[184:187], v[24:27], a[124:127], v[184:187]
    s_add_u32 s41, s93, 8192
    v_mfma_f32_16x16x32_bf16 v[140:143], v[28:31], a[112:115], v[140:143]
    v_mfma_f32_16x16x32_bf16 v[156:159], v[28:31], a[116:119], v[156:159]
    buffer_load_dwordx4 a[172:175], v8, s[20:23], s40 offen offset:2048 sc1
    v_mfma_f32_16x16x32_bf16 v[172:175], v[28:31], a[120:123], v[172:175]
    s_waitcnt vmcnt(11)
    v_mfma_f32_16x16x32_bf16 v[188:191], v[28:31], a[124:127], v[188:191]
    s_add_u32 s42, s93, 65536
    v_mfma_f32_16x16x32_bf16 v[128:131], v[32:35], a[128:131], v[128:131]
    s_waitcnt vmcnt(10)
    v_mfma_f32_16x16x32_bf16 v[144:147], v[32:35], a[132:135], v[144:147]
    s_waitcnt vmcnt(9)
    buffer_load_dwordx4 a[176:179], v8, s[20:23], s41 offen offset:3072 sc1
    v_mfma_f32_16x16x32_bf16 v[160:163], v[32:35], a[136:139], v[160:163]
    s_waitcnt vmcnt(9)
    v_mfma_f32_16x16x32_bf16 v[176:179], v[32:35], a[140:143], v[176:179]
    s_add_u32 s43, s93, 122880
    v_mfma_f32_16x16x32_bf16 v[132:135], v[36:39], a[128:131], v[132:135]
    v_mfma_f32_16x16x32_bf16 v[148:151], v[36:39], a[132:135], v[148:151]
    buffer_load_dwordx4 a[180:183], v8, s[20:23], s42 offen offset:3072 sc1
    v_mfma_f32_16x16x32_bf16 v[164:167], v[36:39], a[136:139], v[164:167]
    v_mfma_f32_16x16x32_bf16 v[180:183], v[36:39], a[140:143], v[180:183]
    s_add_u32 s40, s93, 180224
    v_mfma_f32_16x16x32_bf16 v[136:139], v[40:43], a[128:131], v[136:139]
    v_mfma_f32_16x16x32_bf16 v[152:155], v[40:43], a[132:135], v[152:155]
    buffer_load_dwordx4 a[184:187], v8, s[20:23], s43 offen offset:3072 sc1
    v_mfma_f32_16x16x32_bf16 v[168:171], v[40:43], a[136:139], v[168:171]
    v_mfma_f32_16x16x32_bf16 v[184:187], v[40:43], a[140:143], v[184:187]
    s_add_u32 s41, s93, 12288
    v_mfma_f32_16x16x32_bf16 v[140:143], v[44:47], a[128:131], v[140:143]
    v_mfma_f32_16x16x32_bf16 v[156:159], v[44:47], a[132:135], v[156:159]
    buffer_load_dwordx4 a[188:191], v8, s[20:23], s40 offen offset:3072 sc1
    v_mfma_f32_16x16x32_bf16 v[172:175], v[44:47], a[136:139], v[172:175]
    s_waitcnt vmcnt(11)
    v_mfma_f32_16x16x32_bf16 v[188:191], v[44:47], a[140:143], v[188:191]
    s_add_u32 s42, s93, 69632
    v_mfma_f32_16x16x32_bf16 v[128:131], v[48:51], a[144:147], v[128:131]
    s_waitcnt vmcnt(10)
    v_mfma_f32_16x16x32_bf16 v[144:147], v[48:51], a[148:151], v[144:147]
    s_waitcnt vmcnt(9)
    buffer_load_dwordx4 a[192:195], v8, s[20:23], s41 offen offset:0 sc1
    v_mfma_f32_16x16x32_bf16 v[160:163], v[48:51], a[152:155], v[160:163]
    s_waitcnt vmcnt(9)
    v_mfma_f32_16x16x32_bf16 v[176:179], v[48:51], a[156:159], v[176:179]
    s_add_u32 s43, s93, 126976
    v_mfma_f32_16x16x32_bf16 v[132:135], v[52:55], a[144:147], v[132:135]
    v_mfma_f32_16x16x32_bf16 v[148:151], v[52:55], a[148:151], v[148:151]
    buffer_load_dwordx4 a[196:199], v8, s[20:23], s42 offen offset:0 sc1
    v_mfma_f32_16x16x32_bf16 v[164:167], v[52:55], a[152:155], v[164:167]
    v_mfma_f32_16x16x32_bf16 v[180:183], v[52:55], a[156:159], v[180:183]
    s_add_u32 s40, s93, 184320
    v_mfma_f32_16x16x32_bf16 v[136:139], v[56:59], a[144:147], v[136:139]
    v_mfma_f32_16x16x32_bf16 v[152:155], v[56:59], a[148:151], v[152:155]
    buffer_load_dwordx4 a[200:203], v8, s[20:23], s43 offen offset:0 sc1
    v_mfma_f32_16x16x32_bf16 v[168:171], v[56:59], a[152:155], v[168:171]
    v_mfma_f32_16x16x32_bf16 v[184:187], v[56:59], a[156:159], v[184:187]
    s_add_u32 s41, s93, 12288
    v_mfma_f32_16x16x32_bf16 v[140:143], v[60:63], a[144:147], v[140:143]
    v_mfma_f32_16x16x32_bf16 v[156:159], v[60:63], a[148:151], v[156:159]
    buffer_load_dwordx4 a[204:207], v8, s[20:23], s40 offen offset:0 sc1
    v_mfma_f32_16x16x32_bf16 v[172:175], v[60:63], a[152:155], v[172:175]
    s_waitcnt vmcnt(11)
    v_mfma_f32_16x16x32_bf16 v[188:191], v[60:63], a[156:159], v[188:191]
    s_add_u32 s42, s93, 69632
    v_mfma_f32_16x16x32_bf16 v[128:131], v[64:67], a[160:163], v[128:131]
    s_waitcnt vmcnt(10)
    v_mfma_f32_16x16x32_bf16 v[144:147], v[64:67], a[164:167], v[144:147]
    s_waitcnt vmcnt(9)
    buffer_load_dwordx4 a[208:211], v8, s[20:23], s41 offen offset:1024 sc1
    v_mfma_f32_16x16x32_bf16 v[160:163], v[64:67], a[168:171], v[160:163]
    s_waitcnt vmcnt(9)
    v_mfma_f32_16x16x32_bf16 v[176:179], v[64:67], a[172:175], v[176:179]
    s_add_u32 s43, s93, 126976
    v_mfma_f32_16x16x32_bf16 v[132:135], v[68:71], a[160:163], v[132:135]
    v_mfma_f32_16x16x32_bf16 v[148:151], v[68:71], a[164:167], v[148:151]
    buffer_load_dwordx4 a[212:215], v8, s[20:23], s42 offen offset:1024 sc1
    v_mfma_f32_16x16x32_bf16 v[164:167], v[68:71], a[168:171], v[164:167]
    v_mfma_f32_16x16x32_bf16 v[180:183], v[68:71], a[172:175], v[180:183]
    s_add_u32 s40, s93, 184320
    v_mfma_f32_16x16x32_bf16 v[136:139], v[72:75], a[160:163], v[136:139]
    v_mfma_f32_16x16x32_bf16 v[152:155], v[72:75], a[164:167], v[152:155]
    buffer_load_dwordx4 a[216:219], v8, s[20:23], s43 offen offset:1024 sc1
    v_mfma_f32_16x16x32_bf16 v[168:171], v[72:75], a[168:171], v[168:171]
    v_mfma_f32_16x16x32_bf16 v[184:187], v[72:75], a[172:175], v[184:187]
    v_mfma_f32_16x16x32_bf16 v[140:143], v[76:79], a[160:163], v[140:143]
    v_mfma_f32_16x16x32_bf16 v[156:159], v[76:79], a[164:167], v[156:159]
    buffer_load_dwordx4 a[220:223], v8, s[20:23], s40 offen offset:1024 sc1
    v_mfma_f32_16x16x32_bf16 v[172:175], v[76:79], a[168:171], v[172:175]
    v_mfma_f32_16x16x32_bf16 v[188:191], v[76:79], a[172:175], v[188:191]
    s_waitcnt vmcnt(11)
    v_mfma_f32_16x16x32_bf16 v[128:131], v[80:83], a[176:179], v[128:131]
    s_waitcnt vmcnt(10)
    v_mfma_f32_16x16x32_bf16 v[144:147], v[80:83], a[180:183], v[144:147]
    s_waitcnt vmcnt(9)
    buffer_load_dwordx4 v[192:195], v10, s[20:23], s95 offen offset:0 sc1
    v_mfma_f32_16x16x32_bf16 v[160:163], v[80:83], a[184:187], v[160:163]
    s_waitcnt vmcnt(9)
    v_mfma_f32_16x16x32_bf16 v[176:179], v[80:83], a[188:191], v[176:179]
    buffer_load_dwordx4 v[196:199], v10, s[20:23], s95 offen offset:128 sc1
    v_mfma_f32_16x16x32_bf16 v[132:135], v[84:87], a[176:179], v[132:135]
    v_mfma_f32_16x16x32_bf16 v[148:151], v[84:87], a[180:183], v[148:151]
    v_mfma_f32_16x16x32_bf16 v[164:167], v[84:87], a[184:187], v[164:167]
    v_mfma_f32_16x16x32_bf16 v[180:183], v[84:87], a[188:191], v[180:183]
    v_mfma_f32_16x16x32_bf16 v[136:139], v[88:91], a[176:179], v[136:139]
    v_mfma_f32_16x16x32_bf16 v[152:155], v[88:91], a[180:183], v[152:155]
    v_mfma_f32_16x16x32_bf16 v[168:171], v[88:91], a[184:187], v[168:171]
    v_mfma_f32_16x16x32_bf16 v[184:187], v[88:91], a[188:191], v[184:187]
    v_mfma_f32_16x16x32_bf16 v[140:143], v[92:95], a[176:179], v[140:143]
    v_mfma_f32_16x16x32_bf16 v[156:159], v[92:95], a[180:183], v[156:159]
    v_mfma_f32_16x16x32_bf16 v[172:175], v[92:95], a[184:187], v[172:175]
    v_mfma_f32_16x16x32_bf16 v[188:191], v[92:95], a[188:191], v[188:191]
    s_waitcnt vmcnt(9)
    v_mfma_f32_16x16x32_bf16 v[128:131], v[96:99], a[192:195], v[128:131]
    v_mfma_f32_16x16x32_bf16 v[132:135], v[100:103], a[192:195], v[132:135]
    v_mfma_f32_16x16x32_bf16 v[136:139], v[104:107], a[192:195], v[136:139]
    v_mfma_f32_16x16x32_bf16 v[140:143], v[108:111], a[192:195], v[140:143]
    s_waitcnt vmcnt(5)
    v_mfma_f32_16x16x32_bf16 v[128:131], v[112:115], a[208:211], v[128:131]
    s_waitcnt lgkmcnt(0)
    v_mfma_f32_16x16x32_bf16 v[132:135], v[116:119], a[208:211], v[132:135]
    v_mfma_f32_16x16x32_bf16 v[136:139], v[120:123], a[208:211], v[136:139]
    v_mfma_f32_16x16x32_bf16 v[140:143], v[124:127], a[208:211], v[140:143]
    ds_write_b128 v14, v[128:131] offset:0
    v_mfma_f32_16x16x32_bf16 v[144:147], v[96:99], a[196:199], v[144:147]
    ds_write_b128 v14, v[132:135] offset:1024
    v_mfma_f32_16x16x32_bf16 v[148:151], v[100:103], a[196:199], v[148:151]
    ds_write_b128 v14, v[136:139] offset:2048
    v_mfma_f32_16x16x32_bf16 v[152:155], v[104:107], a[196:199], v[152:155]
    ds_write_b128 v14, v[140:143] offset:3072
    v_mfma_f32_16x16x32_bf16 v[156:159], v[108:111], a[196:199], v[156:159]
    s_waitcnt vmcnt(4)
    v_mfma_f32_16x16x32_bf16 v[144:147], v[112:115], a[212:215], v[144:147]
    v_mfma_f32_16x16x32_bf16 v[148:151], v[116:119], a[212:215], v[148:151]
    v_mfma_f32_16x16x32_bf16 v[152:155], v[120:123], a[212:215], v[152:155]
    v_mfma_f32_16x16x32_bf16 v[156:159], v[124:127], a[212:215], v[156:159]
    ds_write_b128 v14, v[144:147] offset:16384
    v_mfma_f32_16x16x32_bf16 v[160:163], v[96:99], a[200:203], v[160:163]
    ds_write_b128 v14, v[148:151] offset:17408
    v_mfma_f32_16x16x32_bf16 v[164:167], v[100:103], a[200:203], v[164:167]
    ds_write_b128 v14, v[152:155] offset:18432
    v_mfma_f32_16x16x32_bf16 v[168:171], v[104:107], a[200:203], v[168:171]
    s_waitcnt vmcnt(0)
    ds_write_b128 v14, v[156:159] offset:19456
    v_max_u32 v1, v192, v196
    v_mfma_f32_16x16x32_bf16 v[172:175], v[108:111], a[200:203], v[172:175]
    v_cmp_eq_u32 vcc, -1, v1
    v_mfma_f32_16x16x32_bf16 v[160:163], v[112:115], a[216:219], v[160:163]
    v_mfma_f32_16x16x32_bf16 v[164:167], v[116:119], a[216:219], v[164:167]
    v_mfma_f32_16x16x32_bf16 v[168:171], v[120:123], a[216:219], v[168:171]
    v_mfma_f32_16x16x32_bf16 v[172:175], v[124:127], a[216:219], v[172:175]
    ds_write_b128 v14, v[160:163] offset:33280
    v_mfma_f32_16x16x32_bf16 v[176:179], v[96:99], a[204:207], v[176:179]
    ds_write_b128 v14, v[164:167] offset:34304
    v_mfma_f32_16x16x32_bf16 v[180:183], v[100:103], a[204:207], v[180:183]
    ds_write_b128 v14, v[168:171] offset:35328
    v_mfma_f32_16x16x32_bf16 v[184:187], v[104:107], a[204:207], v[184:187]
    ds_write_b128 v14, v[172:175] offset:36352
    v_mfma_f32_16x16x32_bf16 v[188:191], v[108:111], a[204:207], v[188:191]
    v_mfma_f32_16x16x32_bf16 v[176:179], v[112:115], a[220:223], v[176:179]
    v_mfma_f32_16x16x32_bf16 v[180:183], v[116:119], a[220:223], v[180:183]
    s_cbranch_vccnz L5_g
L5_gb:
    v_mfma_f32_16x16x32_bf16 v[184:187], v[120:123], a[220:223], v[184:187]
    v_mfma_f32_16x16x32_bf16 v[188:191], v[124:127], a[220:223], v[188:191]
    ds_write_b128 v14, v[176:179] offset:49664
    ds_write_b128 v14, v[180:183] offset:50688
    s_nop 1
    ds_write_b128 v14, v[184:187] offset:51712
    s_nop 4
    ds_write_b128 v14, v[188:191] offset:52736
    v_lshlrev_b32 v216, 16, v192
    v_and_b32 v217, 0xffff0000, v192
    v_lshlrev_b32 v218, 16, v193
    v_and_b32 v219, 0xffff0000, v193
    v_lshlrev_b32 v220, 16, v194
    v_and_b32 v221, 0xffff0000, v194
    v_lshlrev_b32 v222, 16, v195
    v_and_b32 v223, 0xffff0000, v195
    v_lshlrev_b32 v224, 16, v196
    v_and_b32 v225, 0xffff0000, v196
    v_lshlrev_b32 v226, 16, v197
    v_and_b32 v227, 0xffff0000, v197
    v_lshlrev_b32 v228, 16, v198
    v_and_b32 v229, 0xffff0000, v198
    v_lshlrev_b32 v230, 16, v199
    v_and_b32 v231, 0xffff0000, v199
    s_waitcnt lgkmcnt(0)
    s_barrier
    ds_read_b128 v[128:131], v0 offset:0
    ds_read_b128 v[132:135], v0 offset:1024
    ds_read_b128 v[136:139], v0 offset:2048
    ds_read_b128 v[140:143], v0 offset:3072
    ds_read_b128 v[144:147], v0 offset:4096
    ds_read_b128 v[148:151], v0 offset:5120
    ds_read_b128 v[152:155], v0 offset:6144
    ds_read_b128 v[156:159], v0 offset:7168
    ds_read_b128 v[160:163], v0 offset:8192
    ds_read_b128 v[164:167], v0 offset:9216
    ds_read_b128 v[168:171], v0 offset:10240
    ds_read_b128 v[172:175], v0 offset:11264
    ds_read_b128 v[176:179], v0 offset:12288
    ds_read_b128 v[180:183], v0 offset:13312
    ds_read_b128 v[184:187], v0 offset:14336
    ds_read_b128 v[188:191], v0 offset:15360
    s_waitcnt lgkmcnt(11)
    v_add_f32 v128, v128, v144
    v_add_f32 v129, v129, v145
    v_add_f32 v130, v130, v146
    v_add_f32 v131, v131, v147
    s_waitcnt lgkmcnt(10)
    v_add_f32 v132, v132, v148
    v_add_f32 v133, v133, v149
    v_add_f32 v134, v134, v150
    v_add_f32 v135, v135, v151
    s_waitcnt lgkmcnt(9)
    v_add_f32 v136, v136, v152
    v_add_f32 v137, v137, v153
    v_add_f32 v138, v138, v154
    v_add_f32 v139, v139, v155
    s_waitcnt lgkmcnt(8)
    v_add_f32 v140, v140, v156
    v_add_f32 v141, v141, v157
    v_add_f32 v142, v142, v158
    v_add_f32 v143, v143, v159
    s_waitcnt lgkmcnt(7)
    v_add_f32 v128, v128, v160
    v_add_f32 v129, v129, v161
    v_add_f32 v130, v130, v162
    v_add_f32 v131, v131, v163
    s_waitcnt lgkmcnt(6)
    v_add_f32 v132, v132, v164
    v_add_f32 v133, v133, v165
    v_add_f32 v134, v134, v166
    v_add_f32 v135, v135, v167
    s_waitcnt lgkmcnt(5)
    v_add_f32 v136, v136, v168
    v_add_f32 v137, v137, v169
    v_add_f32 v138, v138, v170
    v_add_f32 v139, v139, v171
    s_waitcnt lgkmcnt(4)
    v_add_f32 v140, v140, v172
    v_add_f32 v141, v141, v173
    v_add_f32 v142, v142, v174
    v_add_f32 v143, v143, v175
    s_waitcnt lgkmcnt(3)
    v_add_f32 v128, v128, v176
    v_add_f32 v129, v129, v177
    v_add_f32 v130, v130, v178
    v_add_f32 v131, v131, v179
    s_waitcnt lgkmcnt(2)
    v_add_f32 v132, v132, v180
    v_add_f32 v133, v133, v181
    v_add_f32 v134, v134, v182
    v_add_f32 v135, v135, v183
    s_waitcnt lgkmcnt(1)
    v_add_f32 v136, v136, v184
    v_add_f32 v137, v137, v185
    v_add_f32 v138, v138, v186
    v_add_f32 v139, v139, v187
    s_waitcnt lgkmcnt(0)
    v_add_f32 v140, v140, v188
    v_add_f32 v141, v141, v189
    v_add_f32 v142, v142, v190
    v_add_f32 v143, v143, v191
    v_fma_f32 v128, v128, v200, v216
    v_fma_f32 v129, v129, v201, v217
    v_fma_f32 v130, v130, v202, v218
    v_fma_f32 v131, v131, v203, v219
    v_fma_f32 v132, v132, v204, v220
    v_fma_f32 v133, v133, v205, v221
    v_fma_f32 v134, v134, v206, v222
    v_fma_f32 v135, v135, v207, v223
    v_fma_f32 v136, v136, v208, v224
    v_fma_f32 v137, v137, v209, v225
    v_fma_f32 v138, v138, v210, v226
    v_fma_f32 v139, v139, v211, v227
    v_fma_f32 v140, v140, v212, v228
    v_fma_f32 v141, v141, v213, v229
    v_fma_f32 v142, v142, v214, v230
    v_fma_f32 v143, v143, v215, v231
    v_cvt_pk_bf16_f32 v216, v128, v129
    v_cvt_pk_bf16_f32 v217, v130, v131
    v_cvt_pk_bf16_f32 v218, v132, v133
    v_cvt_pk_bf16_f32 v219, v134, v135
    v_cvt_pk_bf16_f32 v220, v136, v137
    v_cvt_pk_bf16_f32 v221, v138, v139
    v_cvt_pk_bf16_f32 v222, v140, v141
    v_cvt_pk_bf16_f32 v223, v142, v143
    v_permlane16_swap_b32 v216, v218
    v_permlane16_swap_b32 v217, v219
    v_permlane16_swap_b32 v220, v222
    v_permlane16_swap_b32 v221, v223
    buffer_store_dwordx4 v[216:219], v13, s[4:7], s96 offen offset:0
    buffer_store_dwordx4 v[220:223], v13, s[4:7], s96 offen offset:64
L2_fin:
L2_end:
    s_endpgm
L2_fb:
    v_mov_b32 v12, 0xff800000
    v_mov_b32 v13, 0xff800000
    s_mov_b32 s49, 1
    s_mov_b32 s47, 32
    v_accvgpr_read_b32 v6, a252
    s_waitcnt vmcnt(0) lgkmcnt(0)
    s_barrier
L2_fbl:
    s_add_u32 m0, s40, 0
    s_nop 0
    buffer_load_dwordx4 v6, s[4:7], s24 offen offset:0 lds
    buffer_load_dwordx4 v6, s[4:7], s25 offen offset:1024 lds
    buffer_load_dwordx4 v6, s[4:7], s26 offen offset:2064 lds
    buffer_load_dwordx4 v6, s[4:7], s27 offen offset:3088 lds
    s_add_u32 m0, s40, 17024
    s_nop 0
    buffer_load_dwordx4 v6, s[4:7], s28 offen offset:0 lds
    buffer_load_dwordx4 v6, s[4:7], s29 offen offset:1024 lds
    buffer_load_dwordx4 v6, s[4:7], s30 offen offset:2064 lds
    buffer_load_dwordx4 v6, s[4:7], s31 offen offset:3088 lds
    v_add_u32 v6, 0x8000, v6
    s_waitcnt vmcnt(0)
    s_barrier
    ds_read_b128 a[0:3], v2 offset:0
    ds_read_b128 a[4:7], v2 offset:64
    ds_read_b128 a[8:11], v2 offset:128
    ds_read_b128 a[12:15], v2 offset:192
    ds_read_b128 a[16:19], v2 offset:256
    ds_read_b128 a[20:23], v2 offset:320
    ds_read_b128 a[24:27], v2 offset:384
    ds_read_b128 a[28:31], v2 offset:448
    ds_read_b128 a[32:35], v2 offset:512
    ds_read_b128 a[36:39], v2 offset:576
    ds_read_b128 a[40:43], v2 offset:640
    ds_read_b128 a[44:47], v2 offset:704
    ds_read_b128 a[48:51], v2 offset:768
    ds_read_b128 a[52:55], v2 offset:832
    ds_read_b128 a[56:59], v2 offset:896
    ds_read_b128 a[60:63], v2 offset:960
    ds_read_b128 a[64:67], v2 offset:17024
    ds_read_b128 a[68:71], v2 offset:17088
    ds_read_b128 a[72:75], v2 offset:17152
    ds_read_b128 a[76:79], v2 offset:17216
    ds_read_b128 a[80:83], v2 offset:17280
    ds_read_b128 a[84:87], v2 offset:17344
    ds_read_b128 a[88:91], v2 offset:17408
    ds_read_b128 a[92:95], v2 offset:17472
    ds_read_b128 a[96:99], v2 offset:17536
    ds_read_b128 a[100:103], v2 offset:17600
    ds_read_b128 a[104:107], v2 offset:17664
    ds_read_b128 a[108:111], v2 offset:17728
    ds_read_b128 a[112:115], v2 offset:17792
    ds_read_b128 a[116:119], v2 offset:17856
    ds_read_b128 a[120:123], v2 offset:17920
    ds_read_b128 a[124:127], v2 offset:17984
    s_waitcnt lgkmcnt(0)
    s_barrier
    v_mfma_f32_16x16x32_bf16 v[16:19], a[0:3], a[128:131], 0
    v_mfma_f32_16x16x32_bf16 v[16:19], a[4:7], a[136:139], v[16:19]
    v_mfma_f32_16x16x32_bf16 v[16:19], a[8:11], a[144:147], v[16:19]
    v_mfma_f32_16x16x32_bf16 v[16:19], a[12:15], a[152:155], v[16:19]
    v_mfma_f32_16x16x32_bf16 v[16:19], a[16:19], a[160:163], v[16:19]
    v_mfma_f32_16x16x32_bf16 v[16:19], a[20:23], a[168:171], v[16:19]
    v_mfma_f32_16x16x32_bf16 v[16:19], a[24:27], a[176:179], v[16:19]
    v_mfma_f32_16x16x32_bf16 v[16:19], a[28:31], a[184:187], v[16:19]
    v_mfma_f32_16x16x32_bf16 v[24:27], a[0:3], a[132:135], 0
    v_mfma_f32_16x16x32_bf16 v[24:27], a[4:7], a[140:143], v[24:27]
    v_mfma_f32_16x16x32_bf16 v[24:27], a[8:11], a[148:151], v[24:27]
    v_mfma_f32_16x16x32_bf16 v[24:27], a[12:15], a[156:159], v[24:27]
    v_mfma_f32_16x16x32_bf16 v[24:27], a[16:19], a[164:167], v[24:27]
    v_mfma_f32_16x16x32_bf16 v[24:27], a[20:23], a[172:175], v[24:27]
    v_mfma_f32_16x16x32_bf16 v[24:27], a[24:27], a[180:183], v[24:27]
    v_mfma_f32_16x16x32_bf16 v[24:27], a[28:31], a[188:191], v[24:27]
    v_mfma_f32_16x16x32_bf16 v[20:23], a[32:35], a[128:131], 0
    v_mfma_f32_16x16x32_bf16 v[20:23], a[36:39], a[136:139], v[20:23]
    v_mfma_f32_16x16x32_bf16 v[20:23], a[40:43], a[144:147], v[20:23]
    v_mfma_f32_16x16x32_bf16 v[20:23], a[44:47], a[152:155], v[20:23]
    v_mfma_f32_16x16x32_bf16 v[20:23], a[48:51], a[160:163], v[20:23]
    v_mfma_f32_16x16x32_bf16 v[20:23], a[52:55], a[168:171], v[20:23]
    v_mfma_f32_16x16x32_bf16 v[20:23], a[56:59], a[176:179], v[20:23]
    v_mfma_f32_16x16x32_bf16 v[20:23], a[60:63], a[184:187], v[20:23]
    v_mfma_f32_16x16x32_bf16 v[28:31], a[32:35], a[132:135], 0
    v_mfma_f32_16x16x32_bf16 v[28:31], a[36:39], a[140:143], v[28:31]
    v_mfma_f32_16x16x32_bf16 v[28:31], a[40:43], a[148:151], v[28:31]
    v_mfma_f32_16x16x32_bf16 v[28:31], a[44:47], a[156:159], v[28:31]
    v_mfma_f32_16x16x32_bf16 v[28:31], a[48:51], a[164:167], v[28:31]
    v_mfma_f32_16x16x32_bf16 v[28:31], a[52:55], a[172:175], v[28:31]
    v_mfma_f32_16x16x32_bf16 v[28:31], a[56:59], a[180:183], v[28:31]
    v_mfma_f32_16x16x32_bf16 v[28:31], a[60:63], a[188:191], v[28:31]
    v_mfma_f32_16x16x32_bf16 v[32:35], a[64:67], a[128:131], 0
    v_mfma_f32_16x16x32_bf16 v[32:35], a[68:71], a[136:139], v[32:35]
    v_mfma_f32_16x16x32_bf16 v[32:35], a[72:75], a[144:147], v[32:35]
    v_mfma_f32_16x16x32_bf16 v[32:35], a[76:79], a[152:155], v[32:35]
    v_mfma_f32_16x16x32_bf16 v[32:35], a[80:83], a[160:163], v[32:35]
    v_mfma_f32_16x16x32_bf16 v[32:35], a[84:87], a[168:171], v[32:35]
    v_mfma_f32_16x16x32_bf16 v[32:35], a[88:91], a[176:179], v[32:35]
    v_mfma_f32_16x16x32_bf16 v[32:35], a[92:95], a[184:187], v[32:35]
    v_mfma_f32_16x16x32_bf16 v[40:43], a[64:67], a[132:135], 0
    v_mfma_f32_16x16x32_bf16 v[40:43], a[68:71], a[140:143], v[40:43]
    v_mfma_f32_16x16x32_bf16 v[40:43], a[72:75], a[148:151], v[40:43]
    v_mfma_f32_16x16x32_bf16 v[40:43], a[76:79], a[156:159], v[40:43]
    v_mfma_f32_16x16x32_bf16 v[40:43], a[80:83], a[164:167], v[40:43]
    v_mfma_f32_16x16x32_bf16 v[40:43], a[84:87], a[172:175], v[40:43]
    v_mfma_f32_16x16x32_bf16 v[40:43], a[88:91], a[180:183], v[40:43]
    v_mfma_f32_16x16x32_bf16 v[40:43], a[92:95], a[188:191], v[40:43]
    v_mfma_f32_16x16x32_bf16 v[36:39], a[96:99], a[128:131], 0
    v_mfma_f32_16x16x32_bf16 v[36:39], a[100:103], a[136:139], v[36:39]
    v_mfma_f32_16x16x32_bf16 v[36:39], a[104:107], a[144:147], v[36:39]
    v_mfma_f32_16x16x32_bf16 v[36:39], a[108:111], a[152:155], v[36:39]
    v_mfma_f32_16x16x32_bf16 v[36:39], a[112:115], a[160:163], v[36:39]
    v_mfma_f32_16x16x32_bf16 v[36:39], a[116:119], a[168:171], v[36:39]
    v_mfma_f32_16x16x32_bf16 v[36:39], a[120:123], a[176:179], v[36:39]
    v_mfma_f32_16x16x32_bf16 v[36:39], a[124:127], a[184:187], v[36:39]
    v_mfma_f32_16x16x32_bf16 v[44:47], a[96:99], a[132:135], 0
    v_mfma_f32_16x16x32_bf16 v[44:47], a[100:103], a[140:143], v[44:47]
    v_mfma_f32_16x16x32_bf16 v[44:47], a[104:107], a[148:151], v[44:47]
    v_mfma_f32_16x16x32_bf16 v[44:47], a[108:111], a[156:159], v[44:47]
    v_mfma_f32_16x16x32_bf16 v[44:47], a[112:115], a[164:167], v[44:47]
    v_mfma_f32_16x16x32_bf16 v[44:47], a[116:119], a[172:175], v[44:47]
    v_mfma_f32_16x16x32_bf16 v[44:47], a[120:123], a[180:183], v[44:47]
    v_mfma_f32_16x16x32_bf16 v[44:47], a[124:127], a[188:191], v[44:47]
    s_nop 7
    v_max3_f32 v12, v12, v16, v17
    v_max3_f32 v12, v12, v18, v19
    v_max3_f32 v13, v13, v24, v25
    v_max3_f32 v13, v13, v26, v27
    v_max3_f32 v12, v12, v20, v21
    v_max3_f32 v12, v12, v22, v23
    v_max3_f32 v13, v13, v28, v29
    v_max3_f32 v13, v13, v30, v31
    v_max3_f32 v12, v12, v32, v33
    v_max3_f32 v12, v12, v34, v35
    v_max3_f32 v13, v13, v40, v41
    v_max3_f32 v13, v13, v42, v43
    v_max3_f32 v12, v12, v36, v37
    v_max3_f32 v12, v12, v38, v39
    v_max3_f32 v13, v13, v44, v45
    v_max3_f32 v13, v13, v46, v47
    s_sub_u32 s47, s47, 1
    s_cmp_lg_u32 s47, 0
    s_cbranch_scc1 L2_fbl
    v_accvgpr_write_b32 a250, v12
    v_accvgpr_write_b32 a251, v13
    v_accvgpr_read_b32 v6, a252
    v_accvgpr_read_b32 v249, a253
    s_mov_b32 s74, 2147483648
    s_mov_b32 s75, 2147483648
    s_mov_b32 s76, s3
    s_mov_b32 s77, s52
    v_lshrrev_b32 v250, 7, v8
    v_lshrrev_b32 v251, 4, v8
    v_mul_u32_u24 v250, 896, v250
    v_and_b32 v251, 0x30, v251
    v_xor_b32 v251, v251, v8
    v_and_b32 v251, 0x70, v251
    v_add_u32 v250, v250, v251
    s_mov_b32 s78, 1835008
    s_mov_b32 s79, 0x20000
    v_lshrrev_b32 v255, 6, v8
    v_lshlrev_b32 v255, 13, v255
    v_and_b32 v248, 0x30, v8
    v_lshl_add_u32 v255, v248, 3, v255
    s_bfe_u32 s43, s2, 0x20003
    s_mul_i32 s36, s43, 7168
    s_add_u32 s36, s36, s50
    s_lshl_b32 s44, s43, 10
    s_lshr_b32 s43, s43, 1
    s_lshl_b32 s43, s43, 7
    s_add_u32 s44, s44, s43
    s_add_u32 s28, s44, s41
    s_bfe_u32 s43, s2, 0x20003
    s_xor_b32 s43, s43, 1
    s_mul_i32 s37, s43, 7168
    s_add_u32 s37, s37, s50
    s_lshl_b32 s44, s43, 10
    s_lshr_b32 s43, s43, 1
    s_lshl_b32 s43, s43, 7
    s_add_u32 s44, s44, s43
    s_add_u32 s29, s44, s41
    s_bfe_u32 s43, s2, 0x20003
    s_xor_b32 s43, s43, 2
    s_mul_i32 s38, s43, 7168
    s_add_u32 s38, s38, s50
    s_lshl_b32 s44, s43, 10
    s_lshr_b32 s43, s43, 1
    s_lshl_b32 s43, s43, 7
    s_add_u32 s44, s44, s43
    s_add_u32 s30, s44, s41
    s_bfe_u32 s43, s2, 0x20003
    s_xor_b32 s43, s43, 3
    s_mul_i32 s39, s43, 7168
    s_add_u32 s39, s39, s50
    s_lshl_b32 s44, s43, 10
    s_lshr_b32 s43, s43, 1
    s_lshl_b32 s43, s43, 7
    s_add_u32 s44, s44, s43
    s_add_u32 s31, s44, s41
    s_add_u32 m0, s28, 34048
    s_nop 0
    buffer_load_dwordx4 v250, s[76:79], s36 offen offset:0 lds
    s_add_u32 m0, s28, 50944
    s_nop 0
    buffer_load_dwordx4 v250, s[76:79], s36 offen offset:128 lds
    s_add_u32 m0, s28, 67840
    s_nop 0
    buffer_load_dwordx4 v250, s[76:79], s36 offen offset:256 lds
    s_add_u32 m0, s28, 84736
    s_nop 0
    buffer_load_dwordx4 v250, s[76:79], s36 offen offset:384 lds
    s_add_u32 m0, s28, 101632
    s_nop 0
    buffer_load_dwordx4 v250, s[76:79], s36 offen offset:512 lds
    s_add_u32 m0, s28, 118528
    s_nop 0
    buffer_load_dwordx4 v250, s[76:79], s36 offen offset:640 lds
    s_add_u32 m0, s28, 135424
    s_nop 0
    buffer_load_dwordx4 v250, s[76:79], s36 offen offset:768 lds
    s_branch L2_nog
L2_pw:
    s_add_u32 s53, s53, 1
    s_cmp_ge_u32 s53, 131072
    s_cbranch_scc1 L2_pgo
    buffer_load_dwordx4 v[232:235], v253, s[20:23], s59 offen offset:0 sc1
    buffer_load_dwordx4 v[236:239], v253, s[20:23], s59 offen offset:3584 sc1
    buffer_load_dwordx4 v[240:243], v253, s[20:23], s55 offen offset:0 sc1
    buffer_load_dwordx4 v[244:247], v253, s[20:23], s55 offen offset:3584 sc1
    s_waitcnt vmcnt(0)
    s_branch L2_pchk
L2_mw:
    s_mov_b32 s53, 0
L2_mwl:
    s_sleep 2
    s_add_u32 s53, s53, 1
    s_cmp_ge_u32 s53, 131072
    s_cbranch_scc1 L2_mwb
    buffer_load_dwordx4 v[96:99], v100, s[20:23], s75 offen sc1
    s_waitcnt vmcnt(0)
    v_xor_b32 v96, v96, v101
    v_xor_b32 v97, v97, v101
    v_xor_b32 v98, v98, v101
    v_xor_b32 v99, v99, v101
    v_or3_b32 v96, v96, v97, v98
    v_or_b32 v96, v96, v99
    v_cmp_ne_u32 vcc, 0, v96
    s_nop 0
    s_cmp_lg_u64 vcc, 0
    s_cbranch_scc1 L2_mwl
    s_branch L2_mwb
L2_ep:
    s_lshl_b32 s40, s2, 2
    s_add_u32 s40, s40, s48
    s_cmp_lg_u32 s40, 1023
    s_cbranch_scc1 L2_fin
    s_mov_b32 s40, 4456448
    s_mov_b32 s41, 0
    v_lshrrev_b32 v1, 4, v8
    v_lshlrev_b32 v1, 7, v1
L2_epl:
    s_add_u32 s41, s41, 1
    s_cmp_ge_u32 s41, 131072
    s_cbranch_scc1 L2_epg
    buffer_load_dword v16, v1, s[20:23], s40 offen offset:0 sc1
    buffer_load_dword v17, v1, s[20:23], s40 offen offset:8 sc1
    buffer_load_dword v18, v1, s[20:23], s40 offen offset:16 sc1
    buffer_load_dword v19, v1, s[20:23], s40 offen offset:24 sc1
    buffer_load_dword v20, v1, s[20:23], s40 offen offset:32 sc1
    buffer_load_dword v21, v1, s[20:23], s40 offen offset:40 sc1
    buffer_load_dword v22, v1, s[20:23], s40 offen offset:48 sc1
    buffer_load_dword v23, v1, s[20:23], s40 offen offset:56 sc1
    buffer_load_dword v24, v1, s[20:23], s40 offen offset:64 sc1
    buffer_load_dword v25, v1, s[20:23], s40 offen offset:72 sc1
    buffer_load_dword v26, v1, s[20:23], s40 offen offset:80 sc1
    buffer_load_dword v27, v1, s[20:23], s40 offen offset:88 sc1
    buffer_load_dword v28, v1, s[20:23], s40 offen offset:96 sc1
    buffer_load_dword v29, v1, s[20:23], s40 offen offset:104 sc1
    buffer_load_dword v30, v1, s[20:23], s40 offen offset:112 sc1
    buffer_load_dword v31, v1, s[20:23], s40 offen offset:120 sc1
    s_waitcnt vmcnt(0)
    v_xor_b32 v16, v16, v11
    v_xor_b32 v17, v17, v11
    v_xor_b32 v18, v18, v11
    v_xor_b32 v19, v19, v11
    v_xor_b32 v20, v20, v11
    v_xor_b32 v21, v21, v11
    v_xor_b32 v22, v22, v11
    v_xor_b32 v23, v23, v11
    v_xor_b32 v24, v24, v11
    v_xor_b32 v25, v25, v11
    v_xor_b32 v26, v26, v11
    v_xor_b32 v27, v27, v11
    v_xor_b32 v28, v28, v11
    v_xor_b32 v29, v29, v11
    v_xor_b32 v30, v30, v11
    v_xor_b32 v31, v31, v11
    v_or_b32 v16, v16, v17
    v_or_b32 v16, v16, v18
    v_or_b32 v16, v16, v19
    v_or_b32 v16, v16, v20
    v_or_b32 v16, v16, v21
    v_or_b32 v16, v16, v22
    v_or_b32 v16, v16, v23
    v_or_b32 v16, v16, v24
    v_or_b32 v16, v16, v25
    v_or_b32 v16, v16, v26
    v_or_b32 v16, v16, v27
    v_or_b32 v16, v16, v28
    v_or_b32 v16, v16, v29
    v_or_b32 v16, v16, v30
    v_or_b32 v16, v16, v31
    v_cmp_ne_u32 vcc, 0, v16
    s_nop 0
    s_cmp_lg_u64 vcc, 0
    s_cbranch_scc1 L2_epl
L2_epg:
    s_mov_b32 s40, 4247552
    s_mov_b64 exec, 1
    buffer_store_dword v11, off, s[20:23], s40 sc1
    s_mov_b64 exec, -1
    s_branch L2_fin
L4_g0:
    s_add_u32 s53, s53, 1
    s_cmp_ge_u32 s53, 131072
    s_cbranch_scc1 L4_g0b
    buffer_load_dwordx4 v[16:19], v10, s[20:23], s13 offen offset:0 sc1
    buffer_load_dwordx4 v[20:23], v10, s[20:23], s16 offen offset:0 sc1
    buffer_load_dwordx4 v[24:27], v10, s[20:23], s13 offen offset:128 sc1
    buffer_load_dwordx4 v[28:31], v10, s[20:23], s16 offen offset:128 sc1
    s_waitcnt vmcnt(0)
    v_max3_u32 v0, v16, v20, v24
    v_max_u32 v0, v0, v28
    v_cmp_eq_u32 vcc, -1, v0
    s_nop 1
    s_cbranch_vccnz L4_g0
    s_branch L4_g0b
L4_g1:
    s_add_u32 s53, s53, 1
    s_cmp_ge_u32 s53, 131072
    s_cbranch_scc1 L4_g1b
    buffer_load_dwordx4 v[32:35], v10, s[20:23], s13 offen offset:256 sc1
    buffer_load_dwordx4 v[36:39], v10, s[20:23], s16 offen offset:256 sc1
    buffer_load_dwordx4 v[40:43], v10, s[20:23], s13 offen offset:384 sc1
    buffer_load_dwordx4 v[44:47], v10, s[20:23], s16 offen offset:384 sc1
    s_waitcnt vmcnt(0)
    v_max3_u32 v0, v32, v36, v40
    v_max_u32 v0, v0, v44
    v_cmp_eq_u32 vcc, -1, v0
    s_nop 1
    s_cbranch_vccnz L4_g1
    s_branch L4_g1b
L4_g2:
    s_add_u32 s53, s53, 1
    s_cmp_ge_u32 s53, 131072
    s_cbranch_scc1 L4_g2b
    buffer_load_dwordx4 v[48:51], v10, s[20:23], s13 offen offset:512 sc1
    buffer_load_dwordx4 v[52:55], v10, s[20:23], s16 offen offset:512 sc1
    buffer_load_dwordx4 v[56:59], v10, s[20:23], s13 offen offset:640 sc1
    buffer_load_dwordx4 v[60:63], v10, s[20:23], s16 offen offset:640 sc1
    s_waitcnt vmcnt(0)
    v_max3_u32 v0, v48, v52, v56
    v_max_u32 v0, v0, v60
    v_cmp_eq_u32 vcc, -1, v0
    s_nop 1
    s_cbranch_vccnz L4_g2
    s_branch L4_g2b
L4_g3:
    s_add_u32 s53, s53, 1
    s_cmp_ge_u32 s53, 131072
    s_cbranch_scc1 L4_g3b
    buffer_load_dwordx4 v[64:67], v10, s[20:23], s13 offen offset:768 sc1
    buffer_load_dwordx4 v[68:71], v10, s[20:23], s16 offen offset:768 sc1
    buffer_load_dwordx4 v[72:75], v10, s[20:23], s13 offen offset:896 sc1
    buffer_load_dwordx4 v[76:79], v10, s[20:23], s16 offen offset:896 sc1
    s_waitcnt vmcnt(0)
    v_max3_u32 v0, v64, v68, v72
    v_max_u32 v0, v0, v76
    v_cmp_eq_u32 vcc, -1, v0
    s_nop 1
    s_cbranch_vccnz L4_g3
    s_branch L4_g3b
L4_g4:
    s_add_u32 s53, s53, 1
    s_cmp_ge_u32 s53, 131072
    s_cbranch_scc1 L4_g4b
    buffer_load_dwordx4 v[80:83], v10, s[20:23], s13 offen offset:1024 sc1
    buffer_load_dwordx4 v[84:87], v10, s[20:23], s16 offen offset:1024 sc1
    buffer_load_dwordx4 v[88:91], v10, s[20:23], s13 offen offset:1152 sc1
    buffer_load_dwordx4 v[92:95], v10, s[20:23], s16 offen offset:1152 sc1
    s_waitcnt vmcnt(0)
    v_max3_u32 v0, v80, v84, v88
    v_max_u32 v0, v0, v92
    v_cmp_eq_u32 vcc, -1, v0
    s_nop 1
    s_cbranch_vccnz L4_g4
    s_branch L4_g4b
L4_g5:
    s_add_u32 s53, s53, 1
    s_cmp_ge_u32 s53, 131072
    s_cbranch_scc1 L4_g5b
    buffer_load_dwordx4 v[96:99], v10, s[20:23], s13 offen offset:1280 sc1
    buffer_load_dwordx4 v[100:103], v10, s[20:23], s16 offen offset:1280 sc1
    buffer_load_dwordx4 v[104:107], v10, s[20:23], s13 offen offset:1408 sc1
    buffer_load_dwordx4 v[108:111], v10, s[20:23], s16 offen offset:1408 sc1
    s_waitcnt vmcnt(0)
    v_max3_u32 v0, v96, v100, v104
    v_max_u32 v0, v0, v108
    v_cmp_eq_u32 vcc, -1, v0
    s_nop 1
    s_cbranch_vccnz L4_g5
    s_branch L4_g5b
L4_g6:
    s_add_u32 s53, s53, 1
    s_cmp_ge_u32 s53, 131072
    s_cbranch_scc1 L4_g6b
    buffer_load_dwordx4 v[112:115], v10, s[20:23], s13 offen offset:1536 sc1
    buffer_load_dwordx4 v[116:119], v10, s[20:23], s16 offen offset:1536 sc1
    buffer_load_dwordx4 v[120:123], v10, s[20:23], s13 offen offset:1664 sc1
    buffer_load_dwordx4 v[124:127], v10, s[20:23], s16 offen offset:1664 sc1
    s_waitcnt vmcnt(0)
    v_max3_u32 v0, v112, v116, v120
    v_max_u32 v0, v0, v124
    v_cmp_eq_u32 vcc, -1, v0
    s_nop 1
    s_cbranch_vccnz L4_g6
    s_branch L4_g6b
L5_g:
    s_add_u32 s53, s53, 1
    s_cmp_ge_u32 s53, 131072
    s_cbranch_scc1 L5_gb
    buffer_load_dwordx4 v[192:195], v10, s[20:23], s95 offen offset:0 sc1
    buffer_load_dwordx4 v[196:199], v10, s[20:23], s95 offen offset:128 sc1
    s_waitcnt vmcnt(0)
    v_max_u32 v1, v192, v196
    v_cmp_eq_u32 vcc, -1, v1
    s_nop 1
    s_cbranch_vccnz L5_g
    s_branch L5_gb
L2_codeend:
.section .rodata,"a"
.p2align 6
.amdhsa_kernel adaLN_cond__gqa_block_cached__glu_gated_bilinear__prompt_kernel
  .amdhsa_next_free_vgpr 512
  .amdhsa_next_free_sgpr 102
  .amdhsa_accum_offset 256
  .amdhsa_group_segment_fixed_size 0
  .amdhsa_kernarg_size 112
  .amdhsa_user_sgpr_count 2
  .amdhsa_user_sgpr_kernarg_segment_ptr 1
  .amdhsa_system_sgpr_workgroup_id_x 1
.end_amdhsa_kernel
```
